```python
import torch

def _softmax(x, axis=-1):
    return torch.softmax(x, dim=axis)
def _gelu(x):
    return torch.nn.functional.gelu(x, approximate="tanh")
def _silu(x):
    return torch.nn.functional.silu(x)
def _sigmoid(x):
    return torch.sigmoid(x)
def _layernorm(x, axis=-1, eps=1e-5):
    m = x.mean(dim=axis, keepdim=True)
    v = x.var(dim=axis, keepdim=True, unbiased=False)
    return (x - m) / torch.sqrt(v + eps)
def _scatter_add(tgt, idx, src, axis=0):
    return tgt.clone().index_add_(axis, idx, src)
def _segment_sum(src, seg, n):
    out = torch.zeros((n,) + src.shape[1:], dtype=src.dtype)
    return out.index_add_(0, seg, src)
def _pad(x, pw):
    flat = tuple(v for pair in reversed(pw) for v in pair)
    return torch.nn.functional.pad(x, flat)

kernel_name = 'gated_mix__compressed_kv_cla__linear_attn_block__prompt'

def setup_inputs():

    _w = (lambda a: (lambda t: t.to(torch.bfloat16) if t.is_floating_point() else t)(torch.as_tensor(a)))
    def _A_setup():
        B, H, Sq, Sk, D, M = 1, 16, 2048, 2048, 256, 448
        Dc = 4 * D
        return {
            "x": _w((lambda *s: torch.randn(*s, dtype=torch.bfloat16) * 0.05)(B, Sq, M)),
            "c_kv": _w((lambda *s: torch.randn(*s, dtype=torch.bfloat16) * 1.6)(B, Sk, Dc)),
            "w_q": _w((lambda *s: torch.randn(*s, dtype=torch.bfloat16) * 3.2)(M, H, D) * (M ** -0.5)),
            "w_uk": _w((lambda *s: torch.randn(*s, dtype=torch.bfloat16) * 3.2)(Dc, H, D) * (Dc ** -0.5)),
            "w_uv": _w((lambda *s: torch.randn(*s, dtype=torch.bfloat16) * 1.6)(Dc, H, D) * (Dc ** -0.5)),
            "w_o": _w((lambda *s: torch.randn(*s, dtype=torch.bfloat16) * 1.6)(H, D, M) * ((H * D) ** -0.5)),
        }
    _A_in = _A_setup()

    def _B_setup():
        B, S, D = 1, 2048, 448
        return {
            "x": _w((lambda *s: torch.randn(*s, dtype=torch.bfloat16) * 0.05)(B, S, D)),
            "wqkv": _w((lambda *s: torch.randn(*s, dtype=torch.bfloat16) * 1.6)(D, 3 * D)),
            "wo": _w((lambda *s: torch.randn(*s, dtype=torch.bfloat16) * 1.6)(D, D)),
        }
    _B_in = _B_setup()

    return {
        "A_x": _A_in["x"],
        "A_c_kv": _A_in["c_kv"],
        "A_w_q": _A_in["w_q"],
        "A_w_uk": _A_in["w_uk"],
        "A_w_uv": _A_in["w_uv"],
        "A_w_o": _A_in["w_o"],
        "B_x": _B_in["x"],
        "B_wqkv": _B_in["wqkv"],
        "B_wo": _B_in["wo"],
        "gate_w": _w((lambda *s: torch.randn(*s, dtype=torch.bfloat16) * 0.05)(448) * 16.0),
    }

def reference(A_x, A_c_kv, A_w_q, A_w_uk, A_w_uv, A_w_o, B_x, B_wqkv, B_wo, gate_w):
    def _A_ref(x, c_kv, w_q, w_uk, w_uv, w_o):
        B, Sq, M = x.shape[0], x.shape[1], x.shape[2]
        Sk = c_kv.shape[1]
        H, D = w_q.shape[1], w_q.shape[2]
        q = torch.einsum("bqm,mhd->bhqd", x, w_q)
        k = torch.einsum("bkc,chd->bhkd", c_kv, w_uk)
        v = torch.einsum("bkc,chd->bhkd", c_kv, w_uv)
        scores = torch.einsum("bhqd,bhkd->bhqk", q, k) * (D ** -0.5)
        off = Sk - Sq
        qi = torch.arange(Sq)[:, None]
        kj = torch.arange(Sk)[None, :]
        cmask = kj <= (qi + off)
        scores = torch.where(cmask[None, None], scores, -1e9)
        p = _softmax(scores, axis=-1)
        ctx = torch.einsum("bhqk,bhkd->bhqd", p, v)
        return torch.einsum("bhqd,hdm->bqm", ctx, w_o)

    def _B_ref(x, wqkv, wo):
        B, S, D = x.shape
        H = 16; Dh = D // H
        qkv = (lambda x, *d: x.permute(*d))((x @ wqkv).reshape(B, S, 3, H, Dh), 2, 0, 3, 1, 4)
        q, k, v = qkv[0], qkv[1], qkv[2]
        phi = lambda t: torch.where(t > 0, t + 1, torch.exp(t)) + 1e-6
        pq, pk = phi(q), phi(k)
        kv = torch.einsum("bhsd,bhse->bhde", pk, v)
        z = torch.einsum("bhsd->bhd", pk)
        num = torch.einsum("bhqd,bhde->bhqe", pq, kv)
        den = torch.einsum("bhqd,bhd->bhq", pq, z)[..., None] + 1e-6
        o = num / den
        return (lambda x, *d: x.permute(*d))(o, 0, 2, 1, 3).reshape(B, S, D) @ wo

    x = A_x
    g = _sigmoid((x * gate_w).sum(-1, keepdims=True))
    a = _A_ref(x, A_c_kv, A_w_q, A_w_uk, A_w_uv, A_w_o)
    b = _B_ref(x, B_wqkv, B_wo)
    return g * a + (1 - g) * b
```

```asm
; @launch kernel=proj_kernel grid=(256,1,1) block=(256,1,1) lds=163840
; @launch kernel=attn_kernel grid=(256,1,1) block=(256,1,1) lds=163840
.amdgcn_target "amdgcn-amd-amdhsa--gfx950"
.text
.globl proj_kernel
.p2align 8
.type proj_kernel,@function
proj_kernel:
    s_cmp_ge_u32 s2, 256
    s_cbranch_scc1 K1_END
    s_load_dwordx8 s[4:11], s[0:1], 0
    s_load_dwordx2 s[12:13], s[0:1], 32
    s_load_dwordx2 s[14:15], s[0:1], 56
    s_load_dwordx2 s[16:17], s[0:1], 72
    s_load_dwordx2 s[18:19], s[0:1], 96
    v_lshrrev_b32 v1, 6, v0
    v_and_b32 v2, 63, v0
    v_readfirstlane_b32 s20, v1
    s_and_b32 s21, s2, 7
    s_lshr_b32 s22, s2, 3
    s_lshl_b32 s41, s20, 12
    v_lshrrev_b32 v3, 4, v2
    v_lshrrev_b32 v5, 3, v2
    v_lshl_add_u32 v5, v1, 5, v5
    v_and_b32 v6, 7, v2
    v_xor_b32 v6, v6, v3
    v_lshlrev_b32 v6, 4, v6
    v_and_b32 v4, 15, v2
    v_lshlrev_b32 v7, 1, v3
    v_xor_b32 v4, v4, v7
    v_lshl_add_u32 v1, v1, 4, v3
    s_mov_b32 s60, 2048
    v_mul_lo_u32 v7, v5, s60
    v_xor_b32 v3, 64, v6
    v_add_u32 v8, v7, v6
    v_add_u32 v9, v7, v3
    v_add_u32 v9, 15360, v9
    v_add_u32 v10, v7, v6
    v_add_u32 v10, 30720, v10
    v_add_u32 v11, v7, v3
    v_add_u32 v11, 46080, v11
    s_mov_b32 s61, 8192
    s_mov_b32 s62, 128
    s_mov_b32 s63, 64
    s_mov_b32 s64, 0
    v_mul_lo_u32 v7, v1, s61
    v_add_u32 v7, s64, v7
    v_and_b32 v3, 3, v4
    v_lshl_add_u32 v7, v3, 4, v7
    v_bfe_u32 v3, v4, 2, 1
    v_mul_lo_u32 v3, v3, s63
    v_add_u32 v7, v7, v3
    v_bfe_u32 v3, v4, 3, 1
    v_mul_lo_u32 v32, v3, s62
    v_xor_b32 v3, 1, v3
    v_mul_lo_u32 v33, v3, s62
    s_lshl_b32 s60, s61, 2
    s_sub_u32 s60, s60, 1024
    v_add_u32 v12, v7, v32
    v_add_u32 v7, s60, v7
    v_add_u32 v13, v7, v32
    v_add_u32 v7, s60, v7
    v_add_u32 v14, v7, v33
    v_add_u32 v7, s60, v7
    v_add_u32 v15, v7, v33
    s_and_b32 s3, s22, 7
    s_lshr_b32 s23, s22, 3
    s_lshr_b32 s46, s23, 1
    s_and_b32 s23, s23, 1
    s_lshl_b32 s47, s21, 1
    s_add_u32 s23, s23, s47
    s_lshl_b32 s36, s3, 19
    s_add_u32 s37, s36, 262144
    s_lshl_b32 s38, s23, 9
    s_add_u32 s39, s38, 256
    s_mov_b32 s40, 524288
    s_lshl_b32 s43, s23, 20
    s_lshl_b32 s3, s3, 17
    s_add_u32 s43, s43, s3
    s_lshl_b32 s3, s46, 24
    s_add_u32 s43, s43, s3
    s_add_u32 s43, s43, 16777216
    s_waitcnt lgkmcnt(0)
    s_mov_b32 s24, s6
    s_and_b32 s25, s7, 0xffff
    s_mov_b32 s26, 4194304
    s_mov_b32 s27, 0x20000
    s_cmp_eq_u32 s46, 0
    s_cselect_b32 s28, s10, s12
    s_cselect_b32 s29, s11, s13
    s_and_b32 s29, s29, 0xffff
    s_mov_b32 s30, 8388608
    s_mov_b32 s31, 0x20000
    s_mov_b32 s32, s18
    s_and_b32 s33, s19, 0xffff
    s_mul_i32 s3, s22, 1
    s_lshr_b32 s18, s22, 3
    s_mul_i32 s18, s18, 1
    s_xor_b32 s3, s3, s18
    s_mul_i32 s18, s21, 0
    s_xor_b32 s3, s3, s18
    s_and_b32 s3, s3, 1
    s_lshl_b32 s18, s3, 7
    s_add_u32 s36, s36, s18
    s_add_u32 s37, s37, s18
    s_lshl_b32 s18, s18, 1
    s_sub_u32 s18, 128, s18
    s_lshl_b32 s19, s3, 19
    s_add_u32 s38, s38, s19
    s_add_u32 s39, s39, s19
    s_lshl_b32 s19, s19, 1
    s_sub_u32 s19, 524288, s19
    s_add_u32 m0, s41, 0
    s_nop 0
    buffer_load_dwordx4 v8, s[24:27], s36 offen offset:0  lds
    buffer_load_dwordx4 v9, s[24:27], s36 offen offset:1024  lds
    buffer_load_dwordx4 v10, s[24:27], s36 offen offset:2048  lds
    buffer_load_dwordx4 v11, s[24:27], s36 offen offset:3072  lds
    s_add_u32 s36, s36, s18
    s_add_u32 m0, s41, 65536
    s_nop 0
    buffer_load_dwordx4 v12, s[28:31], s38 offen offset:0  lds
    buffer_load_dwordx4 v13, s[28:31], s38 offen offset:1024  lds
    buffer_load_dwordx4 v14, s[28:31], s38 offen offset:2048  lds
    buffer_load_dwordx4 v15, s[28:31], s38 offen offset:3072  lds
    s_add_u32 s38, s38, s19
    s_add_u32 m0, s41, 81920
    s_nop 0
    buffer_load_dwordx4 v12, s[28:31], s39 offen offset:0  lds
    buffer_load_dwordx4 v13, s[28:31], s39 offen offset:1024  lds
    buffer_load_dwordx4 v14, s[28:31], s39 offen offset:2048  lds
    buffer_load_dwordx4 v15, s[28:31], s39 offen offset:3072  lds
    s_add_u32 s39, s39, s19
    s_add_u32 m0, s41, 16384
    s_nop 0
    buffer_load_dwordx4 v8, s[24:27], s37 offen offset:0  lds
    buffer_load_dwordx4 v9, s[24:27], s37 offen offset:1024  lds
    buffer_load_dwordx4 v10, s[24:27], s37 offen offset:2048  lds
    buffer_load_dwordx4 v11, s[24:27], s37 offen offset:3072  lds
    s_add_u32 s37, s37, s18
    s_mov_b32 s34, 101711872
    s_mov_b32 s35, 0x20000
    s_mov_b32 s45, 3
    s_cmp_lt_u32 s22, 28
    s_cselect_b32 s45, 1, s45
    s_cmp_lt_u32 s22, 24
    s_cselect_b32 s45, 2, s45
    s_cmp_lt_u32 s22, 16
    s_cselect_b32 s45, 0, s45
    s_and_b32 s3, s22, 7
    s_cmp_lt_u32 s22, 16
    s_cselect_b32 s3, s3, s21
    s_cselect_b32 s50, s8, s14
    s_cselect_b32 s51, s9, s15
    s_and_b32 s51, s51, 0xffff
    s_mov_b32 s52, 1204224
    s_mov_b32 s61, 2688
    s_cmp_lt_u32 s22, 16
    s_cselect_b32 s52, 3670016, s52
    s_cselect_b32 s61, 8192, s61
    s_lshl_b32 s57, s61, 6
    s_mul_i32 s53, s3, 229376
    s_add_u32 s54, s53, 114688
    s_mov_b32 s58, 1835008
    s_lshr_b32 s23, s22, 3
    s_add_u32 s23, s23, s47
    s_lshl_b32 s55, s23, 9
    s_add_u32 s56, s55, 256
    s_mov_b32 s62, 128
    s_mov_b32 s63, 64
    s_mov_b32 s64, 0
    s_lshl_b32 s44, s23, 20
    s_lshl_b32 s59, s3, 17
    s_add_u32 s44, s44, s59
    s_cmp_eq_u32 s45, 0
    s_cbranch_scc1 K1_T2DONE
    s_mov_b32 s56, 0x7f000000
    s_sub_u32 s23, s22, 16
    s_mul_i32 s55, s23, 112
    s_mov_b32 s62, 56
    s_mov_b32 s63, 896
    s_mov_b32 s64, 896
    s_lshl_b32 s44, s23, 17
    s_lshl_b32 s59, s3, 13
    s_add_u32 s44, s44, s59
    s_add_u32 s44, s44, 69206016
    s_cmp_eq_u32 s45, 2
    s_cbranch_scc1 K1_T2DONE
    s_sub_u32 s23, s22, 24
    s_mul_i32 s55, s23, 224
    s_mov_b32 s62, 112
    s_mov_b32 s63, 56
    s_mov_b32 s64, 0
    s_lshl_b32 s44, s23, 19
    s_lshl_b32 s59, s3, 14
    s_add_u32 s44, s44, s59
    s_add_u32 s44, s44, 67108864
    s_cmp_eq_u32 s45, 1
    s_cbranch_scc1 K1_T2DONE
    s_mov_b32 s58, 0
    s_mov_b32 s52, 0
K1_T2DONE:
    s_mov_b32 s60, 896
    v_mul_lo_u32 v7, v5, s60
    v_xor_b32 v3, 64, v6
    v_add_u32 v16, v7, v6
    v_add_u32 v17, v7, v3
    v_add_u32 v17, 6144, v17
    v_add_u32 v18, v7, v6
    v_add_u32 v18, 12288, v18
    v_add_u32 v19, v7, v3
    v_add_u32 v19, 18432, v19
    v_mul_lo_u32 v7, v1, s61
    v_add_u32 v7, s64, v7
    v_and_b32 v3, 3, v4
    v_lshl_add_u32 v7, v3, 4, v7
    v_bfe_u32 v3, v4, 2, 1
    v_mul_lo_u32 v3, v3, s63
    v_add_u32 v7, v7, v3
    v_bfe_u32 v3, v4, 3, 1
    v_mul_lo_u32 v32, v3, s62
    v_xor_b32 v3, 1, v3
    v_mul_lo_u32 v33, v3, s62
    s_lshl_b32 s60, s61, 2
    s_sub_u32 s60, s60, 1024
    v_add_u32 v20, v7, v32
    v_add_u32 v7, s60, v7
    v_add_u32 v21, v7, v32
    v_add_u32 v7, s60, v7
    v_add_u32 v22, v7, v33
    v_add_u32 v7, s60, v7
    v_add_u32 v23, v7, v33
    v_and_b32 v3, 15, v2
    v_lshrrev_b32 v4, 4, v2
    s_lshr_b32 s3, s20, 1
    s_and_b32 s23, s20, 1
    v_lshrrev_b32 v5, 1, v3
    v_xor_b32 v5, v5, v4
    v_lshlrev_b32 v5, 4, v5
    v_lshl_add_u32 v5, v3, 7, v5
    s_lshl_b32 s47, s3, 13
    v_add_u32 v24, s47, v5
    v_xor_b32 v25, 64, v24
    v_lshrrev_b32 v5, 2, v3
    v_lshl_add_u32 v6, v4, 3, v5
    v_lshlrev_b32 v6, 8, v6
    v_and_b32 v7, 1, v2
    v_lshl_add_u32 v6, v7, 3, v6
    v_add_u32 v6, 0x10000, v6
    v_and_b32 v7, 1, v4
    v_lshlrev_b32 v7, 3, v7
    v_lshl_add_u32 v7, v5, 1, v7
    v_bfe_u32 v5, v2, 1, 1
    s_lshl_b32 s47, s23, 3
    v_add_u32 v5, s47, v5
    v_add_u32 v3, 0, v5
    v_xor_b32 v3, v3, v7
    v_lshl_add_u32 v26, v3, 4, v6
    v_add_u32 v3, 2, v5
    v_xor_b32 v3, v3, v7
    v_lshl_add_u32 v27, v3, 4, v6
    v_add_u32 v3, 4, v5
    v_xor_b32 v3, v3, v7
    v_lshl_add_u32 v28, v3, 4, v6
    v_add_u32 v3, 6, v5
    v_xor_b32 v3, v3, v7
    v_lshl_add_u32 v29, v3, 4, v6
    s_add_u32 s47, s46, 11
    s_lshl_b32 s47, s23, s47
    s_lshl_b32 s60, s3, 15
    s_add_u32 s47, s47, s60
    v_lshl_add_u32 v30, v2, 4, s47
    s_cmp_eq_u32 s45, 0
    s_cselect_b32 s47, 15, 12
    s_lshl_b32 s47, s3, s47
    s_mov_b32 s60, 11
    s_cmp_eq_u32 s45, 1
    s_cselect_b32 s60, 18, s60
    s_cmp_eq_u32 s45, 2
    s_cselect_b32 s60, 16, s60
    s_lshl_b32 s60, s23, s60
    s_add_u32 s47, s47, s60
    v_lshl_add_u32 v31, v2, 4, s47
    s_load_dwordx2 s[48:49], s[0:1], 40
    s_load_dwordx2 s[62:63], s[0:1], 64
    s_lshl_b32 s47, s2, 2
    s_add_u32 s47, s47, s20
    s_sub_u32 s47, 991, s47
    s_getpc_b64 s[64:65]
K1_PC:
    s_sub_u32 s64, s64, K1_PC-proj_kernel
    s_subb_u32 s65, s65, 0
    s_mov_b32 s66, CODE_END-proj_kernel
    s_waitcnt lgkmcnt(0)
    s_sub_u32 s11, 479, s47
    s_mul_i32 s12, s11, 1821
    s_lshr_b32 s12, s12, 16
    s_mul_i32 s13, s12, 36
    s_sub_u32 s13, s11, s13
    s_lshr_b32 s7, s13, 1
    s_and_b32 s13, s13, 1
    s_lshl_b32 s6, s12, 3
    s_add_u32 s6, s6, s7
    s_xor_b32 s10, s12, 1
    s_lshl_b32 s10, s10, 3
    s_add_u32 s10, s10, s7
    s_sub_u32 s10, s10, 10
    s_cmp_lt_u32 s7, 8
    s_cselect_b32 s6, s6, s10
    s_lshl_b32 s6, s6, 5
    s_andn2_b32 s10, s12, 1
    s_add_u32 s10, s10, s7
    s_sub_u32 s10, s10, 8
    s_mul_i32 s10, s10, 28
    s_mov_b32 s98, 401408
    s_lshr_b32 s99, s7, 1
    s_cmp_lg_u32 s99, 4
    s_cselect_b32 s6, s6, s10
    s_cselect_b32 s96, s48, s62
    s_cselect_b32 s97, s49, s63
    s_cselect_b32 s98, 3670016, s98
    s_and_b32 s97, s97, 0xffff
    s_mul_i32 s6, s6, 896
    s_and_b32 s10, s12, 1
    s_lshl_b32 s10, s10, 1
    s_add_u32 s10, s10, s13
    s_mul_i32 s10, s10, 224
    s_add_u32 s6, s6, s10
    s_mul_i32 s10, s99, 28
    s_mul_i32 s13, s13, 14
    s_add_u32 s10, s10, s13
    s_add_u32 s13, s13, s99
    s_lshl_b32 s13, s13, 1
    s_add_u32 s13, s13, 182
    s_mov_b32 s101, 2048
    s_cmp_ge_u32 s99, 7
    s_cselect_b32 s10, s13, s10
    s_cselect_b32 s101, 4096, s101
    s_and_b32 s7, s7, 1
    s_add_u32 s10, s10, s7
    s_lshl_b32 s12, s12, 8
    s_add_u32 s10, s10, s12
    s_lshl_b32 s10, s10, 10
    s_mov_b32 s99, 0x20000
    s_add_u32 s100, s10, 96468992
    s_cmp_lt_u32 s11, 512
    s_cselect_b32 s100, s100, 0x7f000000
    s_cselect_b32 s6, s6, 0x7f000000
    v_lshrrev_b32 v4, 4, v2
    v_and_b32 v5, 15, v2
    v_mul_u32_u24 v6, 896, v4
    v_lshl_add_u32 v6, v5, 4, v6
    s_lshl_b32 s10, s20, 13
    s_add_u32 s10, s10, 131072
    v_mov_b32 v34, v6
    v_lshrrev_b32 v5, 2, v5
    v_lshl_add_u32 v5, v4, 2, v5
    v_lshlrev_b32 v5, 8, v5
    v_and_b32 v4, 3, v2
    v_lshl_add_u32 v5, v4, 3, v5
    v_add_u32 v0, s10, v5
    v_lshlrev_b32 v1, 4, v2
    s_lshl_b32 s59, s20, 13
    s_mov_b32 s61, 32768
    s_cmp_lt_u32 s2, 248
    s_cselect_b32 s59, 0x7f000000, s59
    s_mov_b32 s63, 0xffff
    s_cselect_b32 s63, -1, s63
    s_sub_u32 s60, s47, 225
    s_mul_i32 s60, s60, 8192
    s_cmp_lt_u32 s47, 165
    s_cselect_b32 s59, s60, s59
    s_cselect_b32 s61, 245760, s61
    s_cselect_b32 s64, s14, s64
    s_cselect_b32 s65, s15, s65
    s_cselect_b32 s66, 1204224, s66
    s_sub_u32 s60, s47, 315
    s_mul_i32 s60, s60, 8192
    s_cmp_lt_u32 s47, 135
    s_cselect_b32 s59, s60, s59
    s_cselect_b32 s61, 737280, s61
    s_cselect_b32 s64, s8, s64
    s_cselect_b32 s65, s9, s65
    s_cselect_b32 s66, 3670016, s66
    s_sub_u32 s60, s47, 135
    s_mul_i32 s60, s60, 8192
    s_cmp_lt_u32 s47, 45
    s_cselect_b32 s59, s60, s59
    s_cselect_b32 s61, 368640, s61
    s_cselect_b32 s64, s4, s64
    s_cselect_b32 s65, s5, s65
    s_cselect_b32 s66, 1835008, s66
    s_and_b32 s65, s65, 0xffff
    s_mov_b32 s67, 0x20000
    v_mul_u32_u24 v3, 128, v2
    buffer_load_dword v33, v3, s[64:67], s59 offen
    v_accvgpr_write_b32 a128, 0
    v_accvgpr_write_b32 a129, 0
    v_accvgpr_write_b32 a130, 0
    v_accvgpr_write_b32 a131, 0
    v_accvgpr_write_b32 a132, 0
    v_accvgpr_write_b32 a133, 0
    s_add_u32 s59, s59, s61
    v_accvgpr_write_b32 a134, 0
    v_accvgpr_write_b32 a135, 0
    v_accvgpr_write_b32 a136, 0
    v_accvgpr_write_b32 a137, 0
    v_accvgpr_write_b32 a138, 0
    s_add_u32 m0, s41, 32768
    v_accvgpr_write_b32 a139, 0
    v_accvgpr_write_b32 a140, 0
    v_accvgpr_write_b32 a141, 0
    v_accvgpr_write_b32 a142, 0
    v_accvgpr_write_b32 a143, 0
    buffer_load_dwordx4 v8, s[24:27], s36 offen offset:0  lds
    v_accvgpr_write_b32 a144, 0
    v_accvgpr_write_b32 a145, 0
    v_accvgpr_write_b32 a146, 0
    v_accvgpr_write_b32 a147, 0
    v_accvgpr_write_b32 a148, 0
    v_accvgpr_write_b32 a149, 0
    buffer_load_dwordx4 v9, s[24:27], s36 offen offset:1024  lds
    v_accvgpr_write_b32 a150, 0
    v_accvgpr_write_b32 a151, 0
    v_accvgpr_write_b32 a152, 0
    v_accvgpr_write_b32 a153, 0
    v_accvgpr_write_b32 a154, 0
    buffer_load_dwordx4 v10, s[24:27], s36 offen offset:2048  lds
    v_accvgpr_write_b32 a155, 0
    v_accvgpr_write_b32 a156, 0
    v_accvgpr_write_b32 a157, 0
    v_accvgpr_write_b32 a158, 0
    v_accvgpr_write_b32 a159, 0
    buffer_load_dwordx4 v11, s[24:27], s36 offen offset:3072  lds
    v_accvgpr_write_b32 a160, 0
    v_accvgpr_write_b32 a161, 0
    v_accvgpr_write_b32 a162, 0
    v_accvgpr_write_b32 a163, 0
    v_accvgpr_write_b32 a164, 0
    v_accvgpr_write_b32 a165, 0
    s_sub_u32 s36, s36, s18
    v_accvgpr_write_b32 a166, 0
    v_accvgpr_write_b32 a167, 0
    v_accvgpr_write_b32 a168, 0
    v_accvgpr_write_b32 a169, 0
    v_accvgpr_write_b32 a170, 0
    s_add_u32 s36, s36, 256
    v_accvgpr_write_b32 a171, 0
    v_accvgpr_write_b32 a172, 0
    v_accvgpr_write_b32 a173, 0
    v_accvgpr_write_b32 a174, 0
    v_accvgpr_write_b32 a175, 0
    s_add_u32 m0, s41, 98304
    v_accvgpr_write_b32 a176, 0
    v_accvgpr_write_b32 a177, 0
    v_accvgpr_write_b32 a178, 0
    v_accvgpr_write_b32 a179, 0
    v_accvgpr_write_b32 a180, 0
    v_accvgpr_write_b32 a181, 0
    buffer_load_dwordx4 v12, s[28:31], s38 offen offset:0  lds
    v_accvgpr_write_b32 a182, 0
    v_accvgpr_write_b32 a183, 0
    v_accvgpr_write_b32 a184, 0
    v_accvgpr_write_b32 a185, 0
    v_accvgpr_write_b32 a186, 0
    buffer_load_dwordx4 v13, s[28:31], s38 offen offset:1024  lds
    v_accvgpr_write_b32 a187, 0
    v_accvgpr_write_b32 a188, 0
    v_accvgpr_write_b32 a189, 0
    v_accvgpr_write_b32 a190, 0
    v_accvgpr_write_b32 a191, 0
    buffer_load_dwordx4 v14, s[28:31], s38 offen offset:2048  lds
    v_mov_b64 v[64:65], 0
    v_mov_b64 v[66:67], 0
    v_mov_b64 v[68:69], 0
    v_mov_b64 v[70:71], 0
    v_mov_b64 v[72:73], 0
    v_mov_b64 v[74:75], 0
    buffer_load_dwordx4 v15, s[28:31], s38 offen offset:3072  lds
    v_mov_b64 v[76:77], 0
    v_mov_b64 v[78:79], 0
    v_mov_b64 v[80:81], 0
    v_mov_b64 v[82:83], 0
    v_mov_b64 v[84:85], 0
    s_sub_u32 s38, s38, s19
    v_mov_b64 v[86:87], 0
    v_mov_b64 v[88:89], 0
    v_mov_b64 v[90:91], 0
    v_mov_b64 v[92:93], 0
    v_mov_b64 v[94:95], 0
    s_add_u32 s38, s38, 1048576
    v_mov_b64 v[96:97], 0
    v_mov_b64 v[98:99], 0
    v_mov_b64 v[100:101], 0
    v_mov_b64 v[102:103], 0
    v_mov_b64 v[104:105], 0
    v_mov_b64 v[106:107], 0
    s_add_u32 m0, s41, 114688
    v_mov_b64 v[108:109], 0
    v_mov_b64 v[110:111], 0
    v_mov_b64 v[112:113], 0
    v_mov_b64 v[114:115], 0
    v_mov_b64 v[116:117], 0
    buffer_load_dwordx4 v12, s[28:31], s39 offen offset:0  lds
    v_mov_b64 v[118:119], 0
    v_mov_b64 v[120:121], 0
    v_mov_b64 v[122:123], 0
    v_mov_b64 v[124:125], 0
    v_mov_b64 v[126:127], 0
    buffer_load_dwordx4 v13, s[28:31], s39 offen offset:1024  lds
    v_mov_b64 v[128:129], 0
    v_mov_b64 v[130:131], 0
    v_mov_b64 v[132:133], 0
    v_mov_b64 v[134:135], 0
    v_mov_b64 v[136:137], 0
    v_mov_b64 v[138:139], 0
    buffer_load_dwordx4 v14, s[28:31], s39 offen offset:2048  lds
    v_mov_b64 v[140:141], 0
    v_mov_b64 v[142:143], 0
    v_mov_b64 v[144:145], 0
    v_mov_b64 v[146:147], 0
    v_mov_b64 v[148:149], 0
    buffer_load_dwordx4 v15, s[28:31], s39 offen offset:3072  lds
    v_mov_b64 v[150:151], 0
    v_mov_b64 v[152:153], 0
    v_mov_b64 v[154:155], 0
    v_mov_b64 v[156:157], 0
    v_mov_b64 v[158:159], 0
    s_sub_u32 s39, s39, s19
    v_mov_b64 v[160:161], 0
    v_mov_b64 v[162:163], 0
    v_mov_b64 v[164:165], 0
    v_mov_b64 v[166:167], 0
    v_mov_b64 v[168:169], 0
    v_mov_b64 v[170:171], 0
    s_add_u32 s39, s39, 1048576
    v_mov_b64 v[172:173], 0
    v_mov_b64 v[174:175], 0
    v_mov_b64 v[176:177], 0
    v_mov_b64 v[178:179], 0
    v_mov_b64 v[180:181], 0
    s_add_u32 m0, s41, 49152
    v_mov_b64 v[182:183], 0
    v_mov_b64 v[184:185], 0
    v_mov_b64 v[186:187], 0
    v_mov_b64 v[188:189], 0
    v_mov_b64 v[190:191], 0
    buffer_load_dwordx4 v8, s[24:27], s37 offen offset:0  lds
    v_mov_b64 v[192:193], 0
    v_mov_b64 v[194:195], 0
    v_mov_b64 v[196:197], 0
    v_mov_b64 v[198:199], 0
    v_mov_b64 v[200:201], 0
    v_mov_b64 v[202:203], 0
    buffer_load_dwordx4 v9, s[24:27], s37 offen offset:1024  lds
    v_mov_b64 v[204:205], 0
    v_mov_b64 v[206:207], 0
    v_mov_b64 v[208:209], 0
    v_mov_b64 v[210:211], 0
    v_mov_b64 v[212:213], 0
    buffer_load_dwordx4 v10, s[24:27], s37 offen offset:2048  lds
    v_mov_b64 v[214:215], 0
    v_mov_b64 v[216:217], 0
    v_mov_b64 v[218:219], 0
    v_mov_b64 v[220:221], 0
    v_mov_b64 v[222:223], 0
    buffer_load_dwordx4 v11, s[24:27], s37 offen offset:3072  lds
    v_mov_b64 v[224:225], 0
    v_mov_b64 v[226:227], 0
    v_mov_b64 v[228:229], 0
    v_mov_b64 v[230:231], 0
    v_mov_b64 v[232:233], 0
    v_mov_b64 v[234:235], 0
    s_sub_u32 s37, s37, s18
    v_mov_b64 v[236:237], 0
    v_mov_b64 v[238:239], 0
    v_mov_b64 v[240:241], 0
    v_mov_b64 v[242:243], 0
    v_mov_b64 v[244:245], 0
    s_add_u32 s37, s37, 256
    v_mov_b64 v[246:247], 0
    v_mov_b64 v[248:249], 0
    v_mov_b64 v[250:251], 0
    v_mov_b64 v[252:253], 0
    v_mov_b64 v[254:255], 0
    s_mov_b32 s42, 0
    s_waitcnt vmcnt(25)
    s_barrier
    ds_read_b128 a[0:3], v24 offset:0
    ds_read_b128 a[4:7], v25 offset:0
    ds_read_b128 a[8:11], v24 offset:2048
    ds_read_b128 a[12:15], v25 offset:2048
    ds_read_b128 a[16:19], v24 offset:4096
    ds_read_b128 a[20:23], v25 offset:4096
    ds_read_b128 a[24:27], v24 offset:6144
    ds_read_b128 a[28:31], v25 offset:6144
    ds_read_b64_tr_b16 a[64:65], v26 offset:0
    ds_read_b64_tr_b16 a[66:67], v26 offset:1024
    ds_read_b64_tr_b16 a[68:69], v26 offset:8192
    ds_read_b64_tr_b16 a[70:71], v26 offset:9216
    ds_read_b64_tr_b16 a[72:73], v27 offset:0
    ds_read_b64_tr_b16 a[74:75], v27 offset:1024
    ds_read_b64_tr_b16 a[76:77], v27 offset:8192
    ds_read_b64_tr_b16 a[78:79], v27 offset:9216
    ds_read_b64_tr_b16 a[80:81], v28 offset:0
    ds_read_b64_tr_b16 a[82:83], v28 offset:1024
    ds_read_b64_tr_b16 a[84:85], v28 offset:8192
    ds_read_b64_tr_b16 a[86:87], v28 offset:9216
    ds_read_b64_tr_b16 a[88:89], v29 offset:0
    ds_read_b64_tr_b16 a[90:91], v29 offset:1024
    ds_read_b64_tr_b16 a[92:93], v29 offset:8192
    ds_read_b64_tr_b16 a[94:95], v29 offset:9216
    s_add_u32 m0, s10, 0
    s_add_u32 s7, s6, 0
    buffer_load_dwordx4 v34, s[96:99], s7 offen lds
    s_add_u32 m0, s10, 1024
    s_add_u32 s7, s6, 3584
    buffer_load_dwordx4 v34, s[96:99], s7 offen lds
    s_add_u32 m0, s10, 2048
    s_add_u32 s7, s6, 7168
    buffer_load_dwordx4 v34, s[96:99], s7 offen lds
    s_add_u32 m0, s10, 3072
    s_add_u32 s7, s6, 10752
    buffer_load_dwordx4 v34, s[96:99], s7 offen lds
    s_add_u32 m0, s10, 4096
    s_add_u32 s7, s6, 14336
    buffer_load_dwordx4 v34, s[96:99], s7 offen lds
    s_add_u32 m0, s10, 5120
    s_add_u32 s7, s6, 17920
    buffer_load_dwordx4 v34, s[96:99], s7 offen lds
    s_add_u32 m0, s10, 6144
    s_add_u32 s7, s6, 21504
    buffer_load_dwordx4 v34, s[96:99], s7 offen lds
    s_add_u32 m0, s10, 7168
    s_add_u32 s7, s6, 25088
    buffer_load_dwordx4 v34, s[96:99], s7 offen lds
    s_waitcnt vmcnt(29) lgkmcnt(0)
    s_barrier
    s_cmp_eq_u32 s46, 0
    s_cbranch_scc1 K1_LOOP_K
.p2align 6
K1_LOOP_V:
    v_mfma_f32_16x16x32_bf16 a[128:131], a[0:3], a[64:67], a[128:131]
    ds_read_b64_tr_b16 a[96:97], v26 offset:16384
    v_mfma_f32_16x16x32_bf16 a[128:131], a[4:7], a[68:71], a[128:131]
    s_add_u32 m0, s41, 0
    ds_read_b64_tr_b16 a[98:99], v26 offset:17408
    v_mfma_f32_16x16x32_bf16 a[144:147], a[4:7], a[76:79], a[144:147]
    ds_read_b64_tr_b16 a[100:101], v26 offset:24576
    v_mfma_f32_16x16x32_bf16 a[144:147], a[0:3], a[72:75], a[144:147]
    buffer_load_dwordx4 v8, s[24:27], s36 offen offset:0  lds
    v_mfma_f32_16x16x32_bf16 a[160:163], a[0:3], a[80:83], a[160:163]
    ds_read_b64_tr_b16 a[102:103], v26 offset:25600
    v_mfma_f32_16x16x32_bf16 a[160:163], a[4:7], a[84:87], a[160:163]
    ds_read_b64_tr_b16 a[104:105], v27 offset:16384
    v_mfma_f32_16x16x32_bf16 a[176:179], a[4:7], a[92:95], a[176:179]
    ds_read_b64_tr_b16 a[106:107], v27 offset:17408
    v_mfma_f32_16x16x32_bf16 a[176:179], a[0:3], a[88:91], a[176:179]
    ds_read_b64_tr_b16 a[108:109], v27 offset:24576
    v_mfma_f32_16x16x32_bf16 a[180:183], a[8:11], a[88:91], a[180:183]
    ds_read_b64_tr_b16 a[110:111], v27 offset:25600
    v_mfma_f32_16x16x32_bf16 a[180:183], a[12:15], a[92:95], a[180:183]
    ds_read_b64_tr_b16 a[112:113], v28 offset:16384
    v_mfma_f32_16x16x32_bf16 a[164:167], a[12:15], a[84:87], a[164:167]
    ds_read_b64_tr_b16 a[114:115], v28 offset:17408
    v_mfma_f32_16x16x32_bf16 a[164:167], a[8:11], a[80:83], a[164:167]
    buffer_load_dwordx4 v9, s[24:27], s36 offen offset:1024  lds
    v_mfma_f32_16x16x32_bf16 a[148:151], a[8:11], a[72:75], a[148:151]
    ds_read_b64_tr_b16 a[116:117], v28 offset:24576
    v_mfma_f32_16x16x32_bf16 a[148:151], a[12:15], a[76:79], a[148:151]
    ds_read_b64_tr_b16 a[118:119], v28 offset:25600
    v_mfma_f32_16x16x32_bf16 a[132:135], a[12:15], a[68:71], a[132:135]
    ds_read_b64_tr_b16 a[120:121], v29 offset:16384
    v_mfma_f32_16x16x32_bf16 a[132:135], a[8:11], a[64:67], a[132:135]
    ds_read_b64_tr_b16 a[122:123], v29 offset:17408
    v_mfma_f32_16x16x32_bf16 a[136:139], a[16:19], a[64:67], a[136:139]
    ds_read_b64_tr_b16 a[124:125], v29 offset:24576
    v_mfma_f32_16x16x32_bf16 a[136:139], a[20:23], a[68:71], a[136:139]
    ds_read_b64_tr_b16 a[126:127], v29 offset:25600
    v_mfma_f32_16x16x32_bf16 a[152:155], a[20:23], a[76:79], a[152:155]
    v_mfma_f32_16x16x32_bf16 a[152:155], a[16:19], a[72:75], a[152:155]
    buffer_load_dwordx4 v10, s[24:27], s36 offen offset:2048  lds
    v_mfma_f32_16x16x32_bf16 a[168:171], a[16:19], a[80:83], a[168:171]
    v_mfma_f32_16x16x32_bf16 a[168:171], a[20:23], a[84:87], a[168:171]
    v_mfma_f32_16x16x32_bf16 a[184:187], a[20:23], a[92:95], a[184:187]
    v_mfma_f32_16x16x32_bf16 a[184:187], a[16:19], a[88:91], a[184:187]
    buffer_load_dword v32, v3, s[64:67], s59 offen
    v_mfma_f32_16x16x32_bf16 a[188:191], a[24:27], a[88:91], a[188:191]
    v_mfma_f32_16x16x32_bf16 a[188:191], a[28:31], a[92:95], a[188:191]
    s_add_u32 s59, s59, s61
    v_mfma_f32_16x16x32_bf16 a[172:175], a[28:31], a[84:87], a[172:175]
    s_and_b32 s59, s59, s63
    v_mfma_f32_16x16x32_bf16 a[172:175], a[24:27], a[80:83], a[172:175]
    buffer_load_dwordx4 v11, s[24:27], s36 offen offset:3072  lds
    v_mfma_f32_16x16x32_bf16 a[156:159], a[24:27], a[72:75], a[156:159]
    s_add_u32 s36, s36, s18
    v_mfma_f32_16x16x32_bf16 a[156:159], a[28:31], a[76:79], a[156:159]
    v_mfma_f32_16x16x32_bf16 a[140:143], a[28:31], a[68:71], a[140:143]
    s_waitcnt vmcnt(21) lgkmcnt(0)
    v_mfma_f32_16x16x32_bf16 a[140:143], a[24:27], a[64:67], a[140:143]
    s_barrier
    v_mfma_f32_16x16x32_bf16 v[64:67], a[0:3], a[96:99], v[64:67]
    ds_read_b128 a[32:35], v24 offset:16384
    v_mfma_f32_16x16x32_bf16 v[64:67], a[4:7], a[100:103], v[64:67]
    s_add_u32 m0, s41, 65536
    v_mfma_f32_16x16x32_bf16 v[80:83], a[4:7], a[108:111], v[80:83]
    ds_read_b128 a[36:39], v25 offset:16384
    v_mfma_f32_16x16x32_bf16 v[80:83], a[0:3], a[104:107], v[80:83]
    buffer_load_dwordx4 v12, s[28:31], s38 offen offset:0  lds
    v_mfma_f32_16x16x32_bf16 v[96:99], a[0:3], a[112:115], v[96:99]
    ds_read_b128 a[40:43], v24 offset:18432
    v_mfma_f32_16x16x32_bf16 v[96:99], a[4:7], a[116:119], v[96:99]
    v_mfma_f32_16x16x32_bf16 v[112:115], a[4:7], a[124:127], v[112:115]
    ds_read_b128 a[44:47], v25 offset:18432
    v_mfma_f32_16x16x32_bf16 v[112:115], a[0:3], a[120:123], v[112:115]
    v_mfma_f32_16x16x32_bf16 v[116:119], a[8:11], a[120:123], v[116:119]
    ds_read_b128 a[48:51], v24 offset:20480
    v_mfma_f32_16x16x32_bf16 v[116:119], a[12:15], a[124:127], v[116:119]
    v_mfma_f32_16x16x32_bf16 v[100:103], a[12:15], a[116:119], v[100:103]
    ds_read_b128 a[52:55], v25 offset:20480
    v_mfma_f32_16x16x32_bf16 v[100:103], a[8:11], a[112:115], v[100:103]
    buffer_load_dwordx4 v13, s[28:31], s38 offen offset:1024  lds
    v_mfma_f32_16x16x32_bf16 v[84:87], a[8:11], a[104:107], v[84:87]
    ds_read_b128 a[56:59], v24 offset:22528
    v_mfma_f32_16x16x32_bf16 v[84:87], a[12:15], a[108:111], v[84:87]
    v_mfma_f32_16x16x32_bf16 v[68:71], a[12:15], a[100:103], v[68:71]
    ds_read_b128 a[60:63], v25 offset:22528
    v_mfma_f32_16x16x32_bf16 v[68:71], a[8:11], a[96:99], v[68:71]
    v_mfma_f32_16x16x32_bf16 v[72:75], a[16:19], a[96:99], v[72:75]
    v_mfma_f32_16x16x32_bf16 v[72:75], a[20:23], a[100:103], v[72:75]
    v_mfma_f32_16x16x32_bf16 v[88:91], a[20:23], a[108:111], v[88:91]
    v_mfma_f32_16x16x32_bf16 v[88:91], a[16:19], a[104:107], v[88:91]
    buffer_load_dwordx4 v14, s[28:31], s38 offen offset:2048  lds
    v_mfma_f32_16x16x32_bf16 v[104:107], a[16:19], a[112:115], v[104:107]
    v_mfma_f32_16x16x32_bf16 v[104:107], a[20:23], a[116:119], v[104:107]
    v_mfma_f32_16x16x32_bf16 v[120:123], a[20:23], a[124:127], v[120:123]
    v_mfma_f32_16x16x32_bf16 v[120:123], a[16:19], a[120:123], v[120:123]
    v_mfma_f32_16x16x32_bf16 v[124:127], a[24:27], a[120:123], v[124:127]
    v_mfma_f32_16x16x32_bf16 v[124:127], a[28:31], a[124:127], v[124:127]
    v_mfma_f32_16x16x32_bf16 v[108:111], a[28:31], a[116:119], v[108:111]
    v_mfma_f32_16x16x32_bf16 v[108:111], a[24:27], a[112:115], v[108:111]
    buffer_load_dwordx4 v15, s[28:31], s38 offen offset:3072  lds
    v_mfma_f32_16x16x32_bf16 v[92:95], a[24:27], a[104:107], v[92:95]
    s_add_u32 s38, s38, s19
    v_mfma_f32_16x16x32_bf16 v[92:95], a[28:31], a[108:111], v[92:95]
    v_mfma_f32_16x16x32_bf16 v[76:79], a[28:31], a[100:103], v[76:79]
    s_waitcnt vmcnt(21) lgkmcnt(0)
    v_mfma_f32_16x16x32_bf16 v[76:79], a[24:27], a[96:99], v[76:79]
    s_barrier
    v_mfma_f32_16x16x32_bf16 v[128:131], a[32:35], a[96:99], v[128:131]
    ds_read_b128 a[0:3], v24 offset:32768
    v_mfma_f32_16x16x32_bf16 v[128:131], a[36:39], a[100:103], v[128:131]
    s_add_u32 m0, s41, 81920
    v_mfma_f32_16x16x32_bf16 v[144:147], a[36:39], a[108:111], v[144:147]
    ds_read_b128 a[4:7], v25 offset:32768
    v_mfma_f32_16x16x32_bf16 v[144:147], a[32:35], a[104:107], v[144:147]
    buffer_load_dwordx4 v12, s[28:31], s39 offen offset:0  lds
    v_mfma_f32_16x16x32_bf16 v[160:163], a[32:35], a[112:115], v[160:163]
    ds_read_b128 a[8:11], v24 offset:34816
    v_mfma_f32_16x16x32_bf16 v[160:163], a[36:39], a[116:119], v[160:163]
    v_mfma_f32_16x16x32_bf16 v[176:179], a[36:39], a[124:127], v[176:179]
    ds_read_b128 a[12:15], v25 offset:34816
    v_mfma_f32_16x16x32_bf16 v[176:179], a[32:35], a[120:123], v[176:179]
    v_mfma_f32_16x16x32_bf16 v[180:183], a[40:43], a[120:123], v[180:183]
    ds_read_b128 a[16:19], v24 offset:36864
    v_mfma_f32_16x16x32_bf16 v[180:183], a[44:47], a[124:127], v[180:183]
    v_mfma_f32_16x16x32_bf16 v[164:167], a[44:47], a[116:119], v[164:167]
    ds_read_b128 a[20:23], v25 offset:36864
    v_mfma_f32_16x16x32_bf16 v[164:167], a[40:43], a[112:115], v[164:167]
    buffer_load_dwordx4 v13, s[28:31], s39 offen offset:1024  lds
    v_mfma_f32_16x16x32_bf16 v[148:151], a[40:43], a[104:107], v[148:151]
    ds_read_b128 a[24:27], v24 offset:38912
    v_mfma_f32_16x16x32_bf16 v[148:151], a[44:47], a[108:111], v[148:151]
    v_mfma_f32_16x16x32_bf16 v[132:135], a[44:47], a[100:103], v[132:135]
    ds_read_b128 a[28:31], v25 offset:38912
    v_mfma_f32_16x16x32_bf16 v[132:135], a[40:43], a[96:99], v[132:135]
    v_mfma_f32_16x16x32_bf16 v[136:139], a[48:51], a[96:99], v[136:139]
    v_mfma_f32_16x16x32_bf16 v[136:139], a[52:55], a[100:103], v[136:139]
    v_mfma_f32_16x16x32_bf16 v[152:155], a[52:55], a[108:111], v[152:155]
    v_mfma_f32_16x16x32_bf16 v[152:155], a[48:51], a[104:107], v[152:155]
    buffer_load_dwordx4 v14, s[28:31], s39 offen offset:2048  lds
    v_mfma_f32_16x16x32_bf16 v[168:171], a[48:51], a[112:115], v[168:171]
    v_mfma_f32_16x16x32_bf16 v[168:171], a[52:55], a[116:119], v[168:171]
    v_mfma_f32_16x16x32_bf16 v[184:187], a[52:55], a[124:127], v[184:187]
    v_mfma_f32_16x16x32_bf16 v[184:187], a[48:51], a[120:123], v[184:187]
    v_mfma_f32_16x16x32_bf16 v[188:191], a[56:59], a[120:123], v[188:191]
    v_mfma_f32_16x16x32_bf16 v[188:191], a[60:63], a[124:127], v[188:191]
    v_mfma_f32_16x16x32_bf16 v[172:175], a[60:63], a[116:119], v[172:175]
    v_mfma_f32_16x16x32_bf16 v[172:175], a[56:59], a[112:115], v[172:175]
    buffer_load_dwordx4 v15, s[28:31], s39 offen offset:3072  lds
    v_mfma_f32_16x16x32_bf16 v[156:159], a[56:59], a[104:107], v[156:159]
    s_add_u32 s39, s39, s19
    v_mfma_f32_16x16x32_bf16 v[156:159], a[60:63], a[108:111], v[156:159]
    v_mfma_f32_16x16x32_bf16 v[140:143], a[60:63], a[100:103], v[140:143]
    s_waitcnt vmcnt(21) lgkmcnt(0)
    v_mfma_f32_16x16x32_bf16 v[140:143], a[56:59], a[96:99], v[140:143]
    s_barrier
    v_mfma_f32_16x16x32_bf16 v[192:195], a[32:35], a[64:67], v[192:195]
    ds_read_b64_tr_b16 a[96:97], v26 offset:32768
    v_mfma_f32_16x16x32_bf16 v[192:195], a[36:39], a[68:71], v[192:195]
    s_add_u32 m0, s41, 16384
    ds_read_b64_tr_b16 a[98:99], v26 offset:33792
    v_mfma_f32_16x16x32_bf16 v[208:211], a[36:39], a[76:79], v[208:211]
    ds_read_b64_tr_b16 a[100:101], v26 offset:40960
    v_mfma_f32_16x16x32_bf16 v[208:211], a[32:35], a[72:75], v[208:211]
    buffer_load_dwordx4 v8, s[24:27], s37 offen offset:0  lds
    v_mfma_f32_16x16x32_bf16 v[224:227], a[32:35], a[80:83], v[224:227]
    ds_read_b64_tr_b16 a[102:103], v26 offset:41984
    v_mfma_f32_16x16x32_bf16 v[224:227], a[36:39], a[84:87], v[224:227]
    ds_read_b64_tr_b16 a[104:105], v27 offset:32768
    v_mfma_f32_16x16x32_bf16 v[240:243], a[36:39], a[92:95], v[240:243]
    ds_read_b64_tr_b16 a[106:107], v27 offset:33792
    v_mfma_f32_16x16x32_bf16 v[240:243], a[32:35], a[88:91], v[240:243]
    ds_read_b64_tr_b16 a[108:109], v27 offset:40960
    v_mfma_f32_16x16x32_bf16 v[244:247], a[40:43], a[88:91], v[244:247]
    ds_read_b64_tr_b16 a[110:111], v27 offset:41984
    v_mfma_f32_16x16x32_bf16 v[244:247], a[44:47], a[92:95], v[244:247]
    ds_read_b64_tr_b16 a[112:113], v28 offset:32768
    v_mfma_f32_16x16x32_bf16 v[228:231], a[44:47], a[84:87], v[228:231]
    ds_read_b64_tr_b16 a[114:115], v28 offset:33792
    v_mfma_f32_16x16x32_bf16 v[228:231], a[40:43], a[80:83], v[228:231]
    buffer_load_dwordx4 v9, s[24:27], s37 offen offset:1024  lds
    v_mfma_f32_16x16x32_bf16 v[212:215], a[40:43], a[72:75], v[212:215]
    ds_read_b64_tr_b16 a[116:117], v28 offset:40960
    v_mfma_f32_16x16x32_bf16 v[212:215], a[44:47], a[76:79], v[212:215]
    ds_read_b64_tr_b16 a[118:119], v28 offset:41984
    v_mfma_f32_16x16x32_bf16 v[196:199], a[44:47], a[68:71], v[196:199]
    ds_read_b64_tr_b16 a[120:121], v29 offset:32768
    v_mfma_f32_16x16x32_bf16 v[196:199], a[40:43], a[64:67], v[196:199]
    ds_read_b64_tr_b16 a[122:123], v29 offset:33792
    v_mfma_f32_16x16x32_bf16 v[200:203], a[48:51], a[64:67], v[200:203]
    ds_read_b64_tr_b16 a[124:125], v29 offset:40960
    v_mfma_f32_16x16x32_bf16 v[200:203], a[52:55], a[68:71], v[200:203]
    ds_read_b64_tr_b16 a[126:127], v29 offset:41984
    v_mfma_f32_16x16x32_bf16 v[216:219], a[52:55], a[76:79], v[216:219]
    v_mfma_f32_16x16x32_bf16 v[216:219], a[48:51], a[72:75], v[216:219]
    buffer_load_dwordx4 v10, s[24:27], s37 offen offset:2048  lds
    v_mfma_f32_16x16x32_bf16 v[232:235], a[48:51], a[80:83], v[232:235]
    v_mfma_f32_16x16x32_bf16 v[232:235], a[52:55], a[84:87], v[232:235]
    v_mfma_f32_16x16x32_bf16 v[248:251], a[52:55], a[92:95], v[248:251]
    v_mfma_f32_16x16x32_bf16 v[248:251], a[48:51], a[88:91], v[248:251]
    v_mfma_f32_16x16x32_bf16 v[252:255], a[56:59], a[88:91], v[252:255]
    v_mfma_f32_16x16x32_bf16 v[252:255], a[60:63], a[92:95], v[252:255]
    v_mfma_f32_16x16x32_bf16 v[236:239], a[60:63], a[84:87], v[236:239]
    v_mfma_f32_16x16x32_bf16 v[236:239], a[56:59], a[80:83], v[236:239]
    buffer_load_dwordx4 v11, s[24:27], s37 offen offset:3072  lds
    v_mfma_f32_16x16x32_bf16 v[220:223], a[56:59], a[72:75], v[220:223]
    s_add_u32 s37, s37, s18
    v_mfma_f32_16x16x32_bf16 v[220:223], a[60:63], a[76:79], v[220:223]
    v_mfma_f32_16x16x32_bf16 v[204:207], a[60:63], a[68:71], v[204:207]
    s_waitcnt vmcnt(21) lgkmcnt(0)
    v_mfma_f32_16x16x32_bf16 v[204:207], a[56:59], a[64:67], v[204:207]
    s_barrier
    v_mfma_f32_16x16x32_bf16 a[128:131], a[0:3], a[96:99], a[128:131]
    ds_read_b64_tr_b16 a[64:65], v26 offset:49152
    v_mfma_f32_16x16x32_bf16 a[128:131], a[4:7], a[100:103], a[128:131]
    s_add_u32 m0, s41, 32768
    ds_read_b64_tr_b16 a[66:67], v26 offset:50176
    v_mfma_f32_16x16x32_bf16 a[144:147], a[4:7], a[108:111], a[144:147]
    ds_read_b64_tr_b16 a[68:69], v26 offset:57344
    v_mfma_f32_16x16x32_bf16 a[144:147], a[0:3], a[104:107], a[144:147]
    buffer_load_dwordx4 v8, s[24:27], s36 offen offset:0  lds
    v_mfma_f32_16x16x32_bf16 a[160:163], a[0:3], a[112:115], a[160:163]
    ds_read_b64_tr_b16 a[70:71], v26 offset:58368
    v_mfma_f32_16x16x32_bf16 a[160:163], a[4:7], a[116:119], a[160:163]
    ds_read_b64_tr_b16 a[72:73], v27 offset:49152
    v_mfma_f32_16x16x32_bf16 a[176:179], a[4:7], a[124:127], a[176:179]
    ds_read_b64_tr_b16 a[74:75], v27 offset:50176
    v_mfma_f32_16x16x32_bf16 a[176:179], a[0:3], a[120:123], a[176:179]
    ds_read_b64_tr_b16 a[76:77], v27 offset:57344
    v_mfma_f32_16x16x32_bf16 a[180:183], a[8:11], a[120:123], a[180:183]
    ds_read_b64_tr_b16 a[78:79], v27 offset:58368
    v_mfma_f32_16x16x32_bf16 a[180:183], a[12:15], a[124:127], a[180:183]
    ds_read_b64_tr_b16 a[80:81], v28 offset:49152
    v_mfma_f32_16x16x32_bf16 a[164:167], a[12:15], a[116:119], a[164:167]
    ds_read_b64_tr_b16 a[82:83], v28 offset:50176
    v_mfma_f32_16x16x32_bf16 a[164:167], a[8:11], a[112:115], a[164:167]
    buffer_load_dwordx4 v9, s[24:27], s36 offen offset:1024  lds
    v_mfma_f32_16x16x32_bf16 a[148:151], a[8:11], a[104:107], a[148:151]
    ds_read_b64_tr_b16 a[84:85], v28 offset:57344
    v_mfma_f32_16x16x32_bf16 a[148:151], a[12:15], a[108:111], a[148:151]
    ds_read_b64_tr_b16 a[86:87], v28 offset:58368
    v_mfma_f32_16x16x32_bf16 a[132:135], a[12:15], a[100:103], a[132:135]
    ds_read_b64_tr_b16 a[88:89], v29 offset:49152
    v_mfma_f32_16x16x32_bf16 a[132:135], a[8:11], a[96:99], a[132:135]
    ds_read_b64_tr_b16 a[90:91], v29 offset:50176
    v_mfma_f32_16x16x32_bf16 a[136:139], a[16:19], a[96:99], a[136:139]
    ds_read_b64_tr_b16 a[92:93], v29 offset:57344
    v_mfma_f32_16x16x32_bf16 a[136:139], a[20:23], a[100:103], a[136:139]
    ds_read_b64_tr_b16 a[94:95], v29 offset:58368
    v_mfma_f32_16x16x32_bf16 a[152:155], a[20:23], a[108:111], a[152:155]
    v_mfma_f32_16x16x32_bf16 a[152:155], a[16:19], a[104:107], a[152:155]
    buffer_load_dwordx4 v10, s[24:27], s36 offen offset:2048  lds
    v_mfma_f32_16x16x32_bf16 a[168:171], a[16:19], a[112:115], a[168:171]
    v_mfma_f32_16x16x32_bf16 a[168:171], a[20:23], a[116:119], a[168:171]
    v_mfma_f32_16x16x32_bf16 a[184:187], a[20:23], a[124:127], a[184:187]
    v_mfma_f32_16x16x32_bf16 a[184:187], a[16:19], a[120:123], a[184:187]
    v_mfma_f32_16x16x32_bf16 a[188:191], a[24:27], a[120:123], a[188:191]
    v_mfma_f32_16x16x32_bf16 a[188:191], a[28:31], a[124:127], a[188:191]
    v_mfma_f32_16x16x32_bf16 a[172:175], a[28:31], a[116:119], a[172:175]
    v_mfma_f32_16x16x32_bf16 a[172:175], a[24:27], a[112:115], a[172:175]
    buffer_load_dwordx4 v11, s[24:27], s36 offen offset:3072  lds
    v_mfma_f32_16x16x32_bf16 a[156:159], a[24:27], a[104:107], a[156:159]
    s_sub_u32 s36, s36, s18
    v_mfma_f32_16x16x32_bf16 a[156:159], a[28:31], a[108:111], a[156:159]
    s_add_u32 s36, s36, 256
    v_mfma_f32_16x16x32_bf16 a[140:143], a[28:31], a[100:103], a[140:143]
    s_waitcnt vmcnt(21) lgkmcnt(0)
    v_mfma_f32_16x16x32_bf16 a[140:143], a[24:27], a[96:99], a[140:143]
    s_barrier
    v_mfma_f32_16x16x32_bf16 v[64:67], a[0:3], a[64:67], v[64:67]
    ds_read_b128 a[32:35], v24 offset:49152
    v_mfma_f32_16x16x32_bf16 v[64:67], a[4:7], a[68:71], v[64:67]
    s_add_u32 m0, s41, 98304
    v_mfma_f32_16x16x32_bf16 v[80:83], a[4:7], a[76:79], v[80:83]
    ds_read_b128 a[36:39], v25 offset:49152
    v_mfma_f32_16x16x32_bf16 v[80:83], a[0:3], a[72:75], v[80:83]
    buffer_load_dwordx4 v12, s[28:31], s38 offen offset:0  lds
    v_mfma_f32_16x16x32_bf16 v[96:99], a[0:3], a[80:83], v[96:99]
    ds_read_b128 a[40:43], v24 offset:51200
    v_mfma_f32_16x16x32_bf16 v[96:99], a[4:7], a[84:87], v[96:99]
    v_mfma_f32_16x16x32_bf16 v[112:115], a[4:7], a[92:95], v[112:115]
    ds_read_b128 a[44:47], v25 offset:51200
    v_mfma_f32_16x16x32_bf16 v[112:115], a[0:3], a[88:91], v[112:115]
    v_mfma_f32_16x16x32_bf16 v[116:119], a[8:11], a[88:91], v[116:119]
    ds_read_b128 a[48:51], v24 offset:53248
    v_mfma_f32_16x16x32_bf16 v[116:119], a[12:15], a[92:95], v[116:119]
    v_mfma_f32_16x16x32_bf16 v[100:103], a[12:15], a[84:87], v[100:103]
    ds_read_b128 a[52:55], v25 offset:53248
    v_mfma_f32_16x16x32_bf16 v[100:103], a[8:11], a[80:83], v[100:103]
    buffer_load_dwordx4 v13, s[28:31], s38 offen offset:1024  lds
    v_mfma_f32_16x16x32_bf16 v[84:87], a[8:11], a[72:75], v[84:87]
    ds_read_b128 a[56:59], v24 offset:55296
    v_mfma_f32_16x16x32_bf16 v[84:87], a[12:15], a[76:79], v[84:87]
    v_mfma_f32_16x16x32_bf16 v[68:71], a[12:15], a[68:71], v[68:71]
    ds_read_b128 a[60:63], v25 offset:55296
    v_mfma_f32_16x16x32_bf16 v[68:71], a[8:11], a[64:67], v[68:71]
    v_mfma_f32_16x16x32_bf16 v[72:75], a[16:19], a[64:67], v[72:75]
    v_mfma_f32_16x16x32_bf16 v[72:75], a[20:23], a[68:71], v[72:75]
    v_mfma_f32_16x16x32_bf16 v[88:91], a[20:23], a[76:79], v[88:91]
    v_mfma_f32_16x16x32_bf16 v[88:91], a[16:19], a[72:75], v[88:91]
    buffer_load_dwordx4 v14, s[28:31], s38 offen offset:2048  lds
    v_mfma_f32_16x16x32_bf16 v[104:107], a[16:19], a[80:83], v[104:107]
    v_mfma_f32_16x16x32_bf16 v[104:107], a[20:23], a[84:87], v[104:107]
    v_mfma_f32_16x16x32_bf16 v[120:123], a[20:23], a[92:95], v[120:123]
    v_mfma_f32_16x16x32_bf16 v[120:123], a[16:19], a[88:91], v[120:123]
    v_mfma_f32_16x16x32_bf16 v[124:127], a[24:27], a[88:91], v[124:127]
    v_mfma_f32_16x16x32_bf16 v[124:127], a[28:31], a[92:95], v[124:127]
    v_mfma_f32_16x16x32_bf16 v[108:111], a[28:31], a[84:87], v[108:111]
    v_mfma_f32_16x16x32_bf16 v[108:111], a[24:27], a[80:83], v[108:111]
    buffer_load_dwordx4 v15, s[28:31], s38 offen offset:3072  lds
    v_mfma_f32_16x16x32_bf16 v[92:95], a[24:27], a[72:75], v[92:95]
    s_sub_u32 s38, s38, s19
    v_mfma_f32_16x16x32_bf16 v[92:95], a[28:31], a[76:79], v[92:95]
    s_add_u32 s38, s38, 1048576
    v_mfma_f32_16x16x32_bf16 v[76:79], a[28:31], a[68:71], v[76:79]
    s_waitcnt vmcnt(20) lgkmcnt(0)
    v_mfma_f32_16x16x32_bf16 v[76:79], a[24:27], a[64:67], v[76:79]
    s_barrier
    v_mfma_f32_16x16x32_bf16 v[128:131], a[32:35], a[64:67], v[128:131]
    ds_read_b128 a[0:3], v24 offset:0
    v_mfma_f32_16x16x32_bf16 v[128:131], a[36:39], a[68:71], v[128:131]
    s_add_u32 m0, s41, 114688
    v_mfma_f32_16x16x32_bf16 v[144:147], a[36:39], a[76:79], v[144:147]
    ds_read_b128 a[4:7], v25 offset:0
    v_mfma_f32_16x16x32_bf16 v[144:147], a[32:35], a[72:75], v[144:147]
    buffer_load_dwordx4 v12, s[28:31], s39 offen offset:0  lds
    v_mfma_f32_16x16x32_bf16 v[160:163], a[32:35], a[80:83], v[160:163]
    ds_read_b128 a[8:11], v24 offset:2048
    v_mfma_f32_16x16x32_bf16 v[160:163], a[36:39], a[84:87], v[160:163]
    v_mfma_f32_16x16x32_bf16 v[176:179], a[36:39], a[92:95], v[176:179]
    ds_read_b128 a[12:15], v25 offset:2048
    v_mfma_f32_16x16x32_bf16 v[176:179], a[32:35], a[88:91], v[176:179]
    v_mfma_f32_16x16x32_bf16 v[180:183], a[40:43], a[88:91], v[180:183]
    ds_read_b128 a[16:19], v24 offset:4096
    v_mfma_f32_16x16x32_bf16 v[180:183], a[44:47], a[92:95], v[180:183]
    v_mfma_f32_16x16x32_bf16 v[164:167], a[44:47], a[84:87], v[164:167]
    ds_read_b128 a[20:23], v25 offset:4096
    v_mfma_f32_16x16x32_bf16 v[164:167], a[40:43], a[80:83], v[164:167]
    buffer_load_dwordx4 v13, s[28:31], s39 offen offset:1024  lds
    v_mfma_f32_16x16x32_bf16 v[148:151], a[40:43], a[72:75], v[148:151]
    ds_read_b128 a[24:27], v24 offset:6144
    v_mfma_f32_16x16x32_bf16 v[148:151], a[44:47], a[76:79], v[148:151]
    v_mfma_f32_16x16x32_bf16 v[132:135], a[44:47], a[68:71], v[132:135]
    ds_read_b128 a[28:31], v25 offset:6144
    v_mfma_f32_16x16x32_bf16 v[132:135], a[40:43], a[64:67], v[132:135]
    v_mfma_f32_16x16x32_bf16 v[136:139], a[48:51], a[64:67], v[136:139]
    v_mfma_f32_16x16x32_bf16 v[136:139], a[52:55], a[68:71], v[136:139]
    v_mfma_f32_16x16x32_bf16 v[152:155], a[52:55], a[76:79], v[152:155]
    v_mfma_f32_16x16x32_bf16 v[152:155], a[48:51], a[72:75], v[152:155]
    buffer_load_dwordx4 v14, s[28:31], s39 offen offset:2048  lds
    v_mfma_f32_16x16x32_bf16 v[168:171], a[48:51], a[80:83], v[168:171]
    v_mfma_f32_16x16x32_bf16 v[168:171], a[52:55], a[84:87], v[168:171]
    v_mfma_f32_16x16x32_bf16 v[184:187], a[52:55], a[92:95], v[184:187]
    v_mfma_f32_16x16x32_bf16 v[184:187], a[48:51], a[88:91], v[184:187]
    v_mfma_f32_16x16x32_bf16 v[188:191], a[56:59], a[88:91], v[188:191]
    v_mfma_f32_16x16x32_bf16 v[188:191], a[60:63], a[92:95], v[188:191]
    v_mfma_f32_16x16x32_bf16 v[172:175], a[60:63], a[84:87], v[172:175]
    v_mfma_f32_16x16x32_bf16 v[172:175], a[56:59], a[80:83], v[172:175]
    buffer_load_dwordx4 v15, s[28:31], s39 offen offset:3072  lds
    v_mfma_f32_16x16x32_bf16 v[156:159], a[56:59], a[72:75], v[156:159]
    s_sub_u32 s39, s39, s19
    v_mfma_f32_16x16x32_bf16 v[156:159], a[60:63], a[76:79], v[156:159]
    s_add_u32 s39, s39, 1048576
    v_mfma_f32_16x16x32_bf16 v[140:143], a[60:63], a[68:71], v[140:143]
    s_waitcnt vmcnt(20) lgkmcnt(0)
    v_mfma_f32_16x16x32_bf16 v[140:143], a[56:59], a[64:67], v[140:143]
    s_barrier
    v_mfma_f32_16x16x32_bf16 v[192:195], a[32:35], a[96:99], v[192:195]
    ds_read_b64_tr_b16 a[64:65], v26 offset:0
    v_mfma_f32_16x16x32_bf16 v[192:195], a[36:39], a[100:103], v[192:195]
    s_add_u32 m0, s41, 49152
    ds_read_b64_tr_b16 a[66:67], v26 offset:1024
    v_mfma_f32_16x16x32_bf16 v[208:211], a[36:39], a[108:111], v[208:211]
    ds_read_b64_tr_b16 a[68:69], v26 offset:8192
    v_mfma_f32_16x16x32_bf16 v[208:211], a[32:35], a[104:107], v[208:211]
    buffer_load_dwordx4 v8, s[24:27], s37 offen offset:0  lds
    v_mfma_f32_16x16x32_bf16 v[224:227], a[32:35], a[112:115], v[224:227]
    ds_read_b64_tr_b16 a[70:71], v26 offset:9216
    v_mfma_f32_16x16x32_bf16 v[224:227], a[36:39], a[116:119], v[224:227]
    ds_read_b64_tr_b16 a[72:73], v27 offset:0
    v_mfma_f32_16x16x32_bf16 v[240:243], a[36:39], a[124:127], v[240:243]
    ds_read_b64_tr_b16 a[74:75], v27 offset:1024
    v_mfma_f32_16x16x32_bf16 v[240:243], a[32:35], a[120:123], v[240:243]
    ds_read_b64_tr_b16 a[76:77], v27 offset:8192
    v_mfma_f32_16x16x32_bf16 v[244:247], a[40:43], a[120:123], v[244:247]
    ds_read_b64_tr_b16 a[78:79], v27 offset:9216
    v_mfma_f32_16x16x32_bf16 v[244:247], a[44:47], a[124:127], v[244:247]
    ds_read_b64_tr_b16 a[80:81], v28 offset:0
    v_mfma_f32_16x16x32_bf16 v[228:231], a[44:47], a[116:119], v[228:231]
    ds_read_b64_tr_b16 a[82:83], v28 offset:1024
    v_mfma_f32_16x16x32_bf16 v[228:231], a[40:43], a[112:115], v[228:231]
    buffer_load_dwordx4 v9, s[24:27], s37 offen offset:1024  lds
    v_mfma_f32_16x16x32_bf16 v[212:215], a[40:43], a[104:107], v[212:215]
    ds_read_b64_tr_b16 a[84:85], v28 offset:8192
    v_mfma_f32_16x16x32_bf16 v[212:215], a[44:47], a[108:111], v[212:215]
    ds_read_b64_tr_b16 a[86:87], v28 offset:9216
    v_mfma_f32_16x16x32_bf16 v[196:199], a[44:47], a[100:103], v[196:199]
    ds_read_b64_tr_b16 a[88:89], v29 offset:0
    v_mfma_f32_16x16x32_bf16 v[196:199], a[40:43], a[96:99], v[196:199]
    ds_read_b64_tr_b16 a[90:91], v29 offset:1024
    v_mfma_f32_16x16x32_bf16 v[200:203], a[48:51], a[96:99], v[200:203]
    ds_read_b64_tr_b16 a[92:93], v29 offset:8192
    v_mfma_f32_16x16x32_bf16 v[200:203], a[52:55], a[100:103], v[200:203]
    ds_read_b64_tr_b16 a[94:95], v29 offset:9216
    v_mfma_f32_16x16x32_bf16 v[216:219], a[52:55], a[108:111], v[216:219]
    v_mfma_f32_16x16x32_bf16 v[216:219], a[48:51], a[104:107], v[216:219]
    buffer_load_dwordx4 v10, s[24:27], s37 offen offset:2048  lds
    v_mfma_f32_16x16x32_bf16 v[232:235], a[48:51], a[112:115], v[232:235]
    v_mfma_f32_16x16x32_bf16 v[232:235], a[52:55], a[116:119], v[232:235]
    v_mfma_f32_16x16x32_bf16 v[248:251], a[52:55], a[124:127], v[248:251]
    v_mfma_f32_16x16x32_bf16 v[248:251], a[48:51], a[120:123], v[248:251]
    v_mfma_f32_16x16x32_bf16 v[252:255], a[56:59], a[120:123], v[252:255]
    v_mfma_f32_16x16x32_bf16 v[252:255], a[60:63], a[124:127], v[252:255]
    v_mfma_f32_16x16x32_bf16 v[236:239], a[60:63], a[116:119], v[236:239]
    s_add_u32 s42, s42, 1
    v_mfma_f32_16x16x32_bf16 v[236:239], a[56:59], a[112:115], v[236:239]
    buffer_load_dwordx4 v11, s[24:27], s37 offen offset:3072  lds
    v_mfma_f32_16x16x32_bf16 v[220:223], a[56:59], a[104:107], v[220:223]
    s_sub_u32 s37, s37, s18
    v_mfma_f32_16x16x32_bf16 v[220:223], a[60:63], a[108:111], v[220:223]
    s_add_u32 s37, s37, 256
    s_cmp_lt_u32 s42, 7
    v_mfma_f32_16x16x32_bf16 v[204:207], a[60:63], a[100:103], v[204:207]
    s_waitcnt vmcnt(20) lgkmcnt(0)
    v_mfma_f32_16x16x32_bf16 v[204:207], a[56:59], a[96:99], v[204:207]
    s_barrier
    s_cbranch_scc1 K1_LOOP_V
    v_mov_b32 v8, v16
    v_mov_b32 v12, v20
    v_mov_b32 v9, v17
    v_mov_b32 v13, v21
    v_mov_b32 v10, v18
    v_mov_b32 v14, v22
    v_mov_b32 v11, v19
    v_mov_b32 v15, v23
    s_mov_b32 s24, s4
    s_and_b32 s25, s5, 0xffff
    s_mov_b32 s26, s58
    s_mov_b32 s28, s50
    s_mov_b32 s29, s51
    s_mov_b32 s30, s52
    s_mov_b32 s36, s53
    s_mov_b32 s37, s54
    s_mov_b32 s38, s55
    s_mov_b32 s39, s56
    s_mov_b32 s40, s57
    v_mfma_f32_16x16x32_bf16 a[128:131], a[0:3], a[64:67], a[128:131]
    s_mov_b32 s48, 0
    ds_read_b64_tr_b16 a[96:97], v26 offset:16384
    v_mfma_f32_16x16x32_bf16 a[128:131], a[4:7], a[68:71], a[128:131]
    s_add_u32 m0, s41, 0
    ds_read_b64_tr_b16 a[98:99], v26 offset:17408
    v_mfma_f32_16x16x32_bf16 a[144:147], a[4:7], a[76:79], a[144:147]
    s_mov_b32 s49, 16384
    ds_read_b64_tr_b16 a[100:101], v26 offset:24576
    v_mfma_f32_16x16x32_bf16 a[144:147], a[0:3], a[72:75], a[144:147]
    buffer_load_dwordx4 v8, s[24:27], s36 offen offset:0  lds
    v_mfma_f32_16x16x32_bf16 a[160:163], a[0:3], a[80:83], a[160:163]
    s_mov_b32 s50, 1024
    ds_read_b64_tr_b16 a[102:103], v26 offset:25600
    v_mfma_f32_16x16x32_bf16 a[160:163], a[4:7], a[84:87], a[160:163]
    s_mov_b32 s51, 17408
    ds_read_b64_tr_b16 a[104:105], v27 offset:16384
    v_mfma_f32_16x16x32_bf16 a[176:179], a[4:7], a[92:95], a[176:179]
    s_mov_b32 s52, 2048
    ds_read_b64_tr_b16 a[106:107], v27 offset:17408
    v_mfma_f32_16x16x32_bf16 a[176:179], a[0:3], a[88:91], a[176:179]
    s_mov_b32 s53, 18432
    ds_read_b64_tr_b16 a[108:109], v27 offset:24576
    v_mfma_f32_16x16x32_bf16 a[180:183], a[8:11], a[88:91], a[180:183]
    s_mov_b32 s54, 3072
    ds_read_b64_tr_b16 a[110:111], v27 offset:25600
    v_mfma_f32_16x16x32_bf16 a[180:183], a[12:15], a[92:95], a[180:183]
    s_mov_b32 s55, 19456
    ds_read_b64_tr_b16 a[112:113], v28 offset:16384
    v_mfma_f32_16x16x32_bf16 a[164:167], a[12:15], a[84:87], a[164:167]
    s_add_u32 s56, s43, 0
    ds_read_b64_tr_b16 a[114:115], v28 offset:17408
    v_mfma_f32_16x16x32_bf16 a[164:167], a[8:11], a[80:83], a[164:167]
    buffer_load_dwordx4 v9, s[24:27], s36 offen offset:1024  lds
    v_mfma_f32_16x16x32_bf16 a[148:151], a[8:11], a[72:75], a[148:151]
    s_add_u32 s57, s43, 8192
    ds_read_b64_tr_b16 a[116:117], v28 offset:24576
    v_mfma_f32_16x16x32_bf16 a[148:151], a[12:15], a[76:79], a[148:151]
    s_add_u32 s58, s43, 73728
    ds_read_b64_tr_b16 a[118:119], v28 offset:25600
    v_mfma_f32_16x16x32_bf16 a[132:135], a[12:15], a[68:71], a[132:135]
    s_add_u32 s59, s43, 65536
    ds_read_b64_tr_b16 a[120:121], v29 offset:16384
    v_mfma_f32_16x16x32_bf16 a[132:135], a[8:11], a[64:67], a[132:135]
    ds_read_b64_tr_b16 a[122:123], v29 offset:17408
    v_mfma_f32_16x16x32_bf16 a[136:139], a[16:19], a[64:67], a[136:139]
    ds_read_b64_tr_b16 a[124:125], v29 offset:24576
    v_mfma_f32_16x16x32_bf16 a[136:139], a[20:23], a[68:71], a[136:139]
    ds_read_b64_tr_b16 a[126:127], v29 offset:25600
    v_mfma_f32_16x16x32_bf16 a[152:155], a[20:23], a[76:79], a[152:155]
    v_mfma_f32_16x16x32_bf16 a[152:155], a[16:19], a[72:75], a[152:155]
    buffer_load_dwordx4 v10, s[24:27], s36 offen offset:2048  lds
    v_mfma_f32_16x16x32_bf16 a[168:171], a[16:19], a[80:83], a[168:171]
    v_mfma_f32_16x16x32_bf16 a[168:171], a[20:23], a[84:87], a[168:171]
    v_mfma_f32_16x16x32_bf16 a[184:187], a[20:23], a[92:95], a[184:187]
    v_mfma_f32_16x16x32_bf16 a[184:187], a[16:19], a[88:91], a[184:187]
    v_mfma_f32_16x16x32_bf16 a[188:191], a[24:27], a[88:91], a[188:191]
    v_mfma_f32_16x16x32_bf16 a[188:191], a[28:31], a[92:95], a[188:191]
    v_mfma_f32_16x16x32_bf16 a[172:175], a[28:31], a[84:87], a[172:175]
    v_mfma_f32_16x16x32_bf16 a[172:175], a[24:27], a[80:83], a[172:175]
    buffer_load_dwordx4 v11, s[24:27], s36 offen offset:3072  lds
    v_mfma_f32_16x16x32_bf16 a[156:159], a[24:27], a[72:75], a[156:159]
    s_add_u32 s36, s36, 128
    v_mfma_f32_16x16x32_bf16 a[156:159], a[28:31], a[76:79], a[156:159]
    v_mfma_f32_16x16x32_bf16 a[140:143], a[28:31], a[68:71], a[140:143]
    s_waitcnt vmcnt(20) lgkmcnt(0)
    v_mfma_f32_16x16x32_bf16 a[140:143], a[24:27], a[64:67], a[140:143]
    s_barrier
    v_mfma_f32_16x16x32_bf16 v[64:67], a[0:3], a[96:99], v[64:67]
    ds_read_b128 a[32:35], v24 offset:16384
    v_mfma_f32_16x16x32_bf16 v[64:67], a[4:7], a[100:103], v[64:67]
    s_add_u32 m0, s41, 65536
    v_mfma_f32_16x16x32_bf16 v[80:83], a[4:7], a[108:111], v[80:83]
    ds_read_b128 a[36:39], v25 offset:16384
    v_mfma_f32_16x16x32_bf16 v[80:83], a[0:3], a[104:107], v[80:83]
    buffer_load_dwordx4 v12, s[28:31], s38 offen offset:0  lds
    v_mfma_f32_16x16x32_bf16 v[96:99], a[0:3], a[112:115], v[96:99]
    ds_read_b128 a[40:43], v24 offset:18432
    v_mfma_f32_16x16x32_bf16 v[96:99], a[4:7], a[116:119], v[96:99]
    v_mfma_f32_16x16x32_bf16 v[112:115], a[4:7], a[124:127], v[112:115]
    ds_read_b128 a[44:47], v25 offset:18432
    v_mfma_f32_16x16x32_bf16 v[112:115], a[0:3], a[120:123], v[112:115]
    v_mfma_f32_16x16x32_bf16 v[116:119], a[8:11], a[120:123], v[116:119]
    ds_read_b128 a[48:51], v24 offset:20480
    v_mfma_f32_16x16x32_bf16 v[116:119], a[12:15], a[124:127], v[116:119]
    v_mfma_f32_16x16x32_bf16 v[100:103], a[12:15], a[116:119], v[100:103]
    ds_read_b128 a[52:55], v25 offset:20480
    v_mfma_f32_16x16x32_bf16 v[100:103], a[8:11], a[112:115], v[100:103]
    buffer_load_dwordx4 v13, s[28:31], s38 offen offset:1024  lds
    v_mfma_f32_16x16x32_bf16 v[84:87], a[8:11], a[104:107], v[84:87]
    ds_read_b128 a[56:59], v24 offset:22528
    v_mfma_f32_16x16x32_bf16 v[84:87], a[12:15], a[108:111], v[84:87]
    v_mfma_f32_16x16x32_bf16 v[68:71], a[12:15], a[100:103], v[68:71]
    ds_read_b128 a[60:63], v25 offset:22528
    v_mfma_f32_16x16x32_bf16 v[68:71], a[8:11], a[96:99], v[68:71]
    v_mfma_f32_16x16x32_bf16 v[72:75], a[16:19], a[96:99], v[72:75]
    v_mfma_f32_16x16x32_bf16 v[72:75], a[20:23], a[100:103], v[72:75]
    v_mfma_f32_16x16x32_bf16 v[88:91], a[20:23], a[108:111], v[88:91]
    v_mfma_f32_16x16x32_bf16 v[88:91], a[16:19], a[104:107], v[88:91]
    buffer_load_dwordx4 v14, s[28:31], s38 offen offset:2048  lds
    v_mfma_f32_16x16x32_bf16 v[104:107], a[16:19], a[112:115], v[104:107]
    v_mfma_f32_16x16x32_bf16 v[104:107], a[20:23], a[116:119], v[104:107]
    v_mfma_f32_16x16x32_bf16 v[120:123], a[20:23], a[124:127], v[120:123]
    v_mfma_f32_16x16x32_bf16 v[120:123], a[16:19], a[120:123], v[120:123]
    v_mfma_f32_16x16x32_bf16 v[124:127], a[24:27], a[120:123], v[124:127]
    v_mfma_f32_16x16x32_bf16 v[124:127], a[28:31], a[124:127], v[124:127]
    v_mfma_f32_16x16x32_bf16 v[108:111], a[28:31], a[116:119], v[108:111]
    v_mfma_f32_16x16x32_bf16 v[108:111], a[24:27], a[112:115], v[108:111]
    buffer_load_dwordx4 v15, s[28:31], s38 offen offset:3072  lds
    v_mfma_f32_16x16x32_bf16 v[92:95], a[24:27], a[104:107], v[92:95]
    s_add_u32 s38, s38, s40
    v_mfma_f32_16x16x32_bf16 v[92:95], a[28:31], a[108:111], v[92:95]
    v_mfma_f32_16x16x32_bf16 v[76:79], a[28:31], a[100:103], v[76:79]
    s_waitcnt vmcnt(20) lgkmcnt(0)
    v_mfma_f32_16x16x32_bf16 v[76:79], a[24:27], a[96:99], v[76:79]
    s_barrier
    v_mfma_f32_16x16x32_bf16 v[128:131], a[32:35], a[96:99], v[128:131]
    ds_read_b128 a[0:3], v24 offset:32768
    v_mfma_f32_16x16x32_bf16 v[128:131], a[36:39], a[100:103], v[128:131]
    s_add_u32 m0, s41, 81920
    v_mfma_f32_16x16x32_bf16 v[144:147], a[36:39], a[108:111], v[144:147]
    ds_read_b128 a[4:7], v25 offset:32768
    v_mfma_f32_16x16x32_bf16 v[144:147], a[32:35], a[104:107], v[144:147]
    buffer_load_dwordx4 v12, s[28:31], s39 offen offset:0  lds
    v_mfma_f32_16x16x32_bf16 v[160:163], a[32:35], a[112:115], v[160:163]
    ds_read_b128 a[8:11], v24 offset:34816
    v_mfma_f32_16x16x32_bf16 v[160:163], a[36:39], a[116:119], v[160:163]
    v_mfma_f32_16x16x32_bf16 v[176:179], a[36:39], a[124:127], v[176:179]
    ds_read_b128 a[12:15], v25 offset:34816
    v_mfma_f32_16x16x32_bf16 v[176:179], a[32:35], a[120:123], v[176:179]
    v_mfma_f32_16x16x32_bf16 v[180:183], a[40:43], a[120:123], v[180:183]
    ds_read_b128 a[16:19], v24 offset:36864
    v_mfma_f32_16x16x32_bf16 v[180:183], a[44:47], a[124:127], v[180:183]
    v_mfma_f32_16x16x32_bf16 v[164:167], a[44:47], a[116:119], v[164:167]
    ds_read_b128 a[20:23], v25 offset:36864
    v_mfma_f32_16x16x32_bf16 v[164:167], a[40:43], a[112:115], v[164:167]
    buffer_load_dwordx4 v13, s[28:31], s39 offen offset:1024  lds
    v_mfma_f32_16x16x32_bf16 v[148:151], a[40:43], a[104:107], v[148:151]
    ds_read_b128 a[24:27], v24 offset:38912
    v_mfma_f32_16x16x32_bf16 v[148:151], a[44:47], a[108:111], v[148:151]
    v_mfma_f32_16x16x32_bf16 v[132:135], a[44:47], a[100:103], v[132:135]
    ds_read_b128 a[28:31], v25 offset:38912
    v_mfma_f32_16x16x32_bf16 v[132:135], a[40:43], a[96:99], v[132:135]
    v_mfma_f32_16x16x32_bf16 v[136:139], a[48:51], a[96:99], v[136:139]
    v_mfma_f32_16x16x32_bf16 v[136:139], a[52:55], a[100:103], v[136:139]
    v_mfma_f32_16x16x32_bf16 v[152:155], a[52:55], a[108:111], v[152:155]
    v_mfma_f32_16x16x32_bf16 v[152:155], a[48:51], a[104:107], v[152:155]
    buffer_load_dwordx4 v14, s[28:31], s39 offen offset:2048  lds
    v_mfma_f32_16x16x32_bf16 v[168:171], a[48:51], a[112:115], v[168:171]
    v_mfma_f32_16x16x32_bf16 v[168:171], a[52:55], a[116:119], v[168:171]
    v_mfma_f32_16x16x32_bf16 v[184:187], a[52:55], a[124:127], v[184:187]
    v_mfma_f32_16x16x32_bf16 v[184:187], a[48:51], a[120:123], v[184:187]
    v_mfma_f32_16x16x32_bf16 v[188:191], a[56:59], a[120:123], v[188:191]
    v_mfma_f32_16x16x32_bf16 v[188:191], a[60:63], a[124:127], v[188:191]
    v_mfma_f32_16x16x32_bf16 v[172:175], a[60:63], a[116:119], v[172:175]
    v_mfma_f32_16x16x32_bf16 v[172:175], a[56:59], a[112:115], v[172:175]
    buffer_load_dwordx4 v15, s[28:31], s39 offen offset:3072  lds
    v_mfma_f32_16x16x32_bf16 v[156:159], a[56:59], a[104:107], v[156:159]
    s_add_u32 s39, s39, s40
    v_mfma_f32_16x16x32_bf16 v[156:159], a[60:63], a[108:111], v[156:159]
    v_mfma_f32_16x16x32_bf16 v[140:143], a[60:63], a[100:103], v[140:143]
    s_waitcnt vmcnt(20) lgkmcnt(0)
    v_mfma_f32_16x16x32_bf16 v[140:143], a[56:59], a[96:99], v[140:143]
    s_barrier
    v_mfma_f32_16x16x32_bf16 v[192:195], a[32:35], a[64:67], v[192:195]
    ds_read_b64_tr_b16 a[96:97], v26 offset:32768
    v_mfma_f32_16x16x32_bf16 v[192:195], a[36:39], a[68:71], v[192:195]
    s_add_u32 m0, s41, 16384
    ds_read_b64_tr_b16 a[98:99], v26 offset:33792
    v_mfma_f32_16x16x32_bf16 v[208:211], a[36:39], a[76:79], v[208:211]
    ds_read_b64_tr_b16 a[100:101], v26 offset:40960
    v_mfma_f32_16x16x32_bf16 v[208:211], a[32:35], a[72:75], v[208:211]
    buffer_load_dwordx4 v8, s[24:27], s37 offen offset:0  lds
    v_mfma_f32_16x16x32_bf16 v[224:227], a[32:35], a[80:83], v[224:227]
    ds_read_b64_tr_b16 a[102:103], v26 offset:41984
    v_mfma_f32_16x16x32_bf16 v[224:227], a[36:39], a[84:87], v[224:227]
    ds_read_b64_tr_b16 a[104:105], v27 offset:32768
    v_mfma_f32_16x16x32_bf16 v[240:243], a[36:39], a[92:95], v[240:243]
    ds_read_b64_tr_b16 a[106:107], v27 offset:33792
    v_mfma_f32_16x16x32_bf16 v[240:243], a[32:35], a[88:91], v[240:243]
    ds_read_b64_tr_b16 a[108:109], v27 offset:40960
    v_mfma_f32_16x16x32_bf16 v[244:247], a[40:43], a[88:91], v[244:247]
    ds_read_b64_tr_b16 a[110:111], v27 offset:41984
    v_mfma_f32_16x16x32_bf16 v[244:247], a[44:47], a[92:95], v[244:247]
    ds_read_b64_tr_b16 a[112:113], v28 offset:32768
    v_mfma_f32_16x16x32_bf16 v[228:231], a[44:47], a[84:87], v[228:231]
    ds_read_b64_tr_b16 a[114:115], v28 offset:33792
    v_mfma_f32_16x16x32_bf16 v[228:231], a[40:43], a[80:83], v[228:231]
    buffer_load_dwordx4 v9, s[24:27], s37 offen offset:1024  lds
    v_mfma_f32_16x16x32_bf16 v[212:215], a[40:43], a[72:75], v[212:215]
    ds_read_b64_tr_b16 a[116:117], v28 offset:40960
    v_mfma_f32_16x16x32_bf16 v[212:215], a[44:47], a[76:79], v[212:215]
    ds_read_b64_tr_b16 a[118:119], v28 offset:41984
    v_mfma_f32_16x16x32_bf16 v[196:199], a[44:47], a[68:71], v[196:199]
    ds_read_b64_tr_b16 a[120:121], v29 offset:32768
    v_mfma_f32_16x16x32_bf16 v[196:199], a[40:43], a[64:67], v[196:199]
    ds_read_b64_tr_b16 a[122:123], v29 offset:33792
    v_mfma_f32_16x16x32_bf16 v[200:203], a[48:51], a[64:67], v[200:203]
    ds_read_b64_tr_b16 a[124:125], v29 offset:40960
    v_mfma_f32_16x16x32_bf16 v[200:203], a[52:55], a[68:71], v[200:203]
    ds_read_b64_tr_b16 a[126:127], v29 offset:41984
    v_mfma_f32_16x16x32_bf16 v[216:219], a[52:55], a[76:79], v[216:219]
    v_mfma_f32_16x16x32_bf16 v[216:219], a[48:51], a[72:75], v[216:219]
    buffer_load_dwordx4 v10, s[24:27], s37 offen offset:2048  lds
    v_mfma_f32_16x16x32_bf16 v[232:235], a[48:51], a[80:83], v[232:235]
    v_mfma_f32_16x16x32_bf16 v[232:235], a[52:55], a[84:87], v[232:235]
    v_mfma_f32_16x16x32_bf16 v[248:251], a[52:55], a[92:95], v[248:251]
    v_mfma_f32_16x16x32_bf16 v[248:251], a[48:51], a[88:91], v[248:251]
    v_mfma_f32_16x16x32_bf16 v[252:255], a[56:59], a[88:91], v[252:255]
    v_mfma_f32_16x16x32_bf16 v[252:255], a[60:63], a[92:95], v[252:255]
    v_mfma_f32_16x16x32_bf16 v[236:239], a[60:63], a[84:87], v[236:239]
    v_mfma_f32_16x16x32_bf16 v[236:239], a[56:59], a[80:83], v[236:239]
    buffer_load_dwordx4 v11, s[24:27], s37 offen offset:3072  lds
    v_mfma_f32_16x16x32_bf16 v[220:223], a[56:59], a[72:75], v[220:223]
    s_add_u32 s37, s37, 128
    v_mfma_f32_16x16x32_bf16 v[220:223], a[60:63], a[76:79], v[220:223]
    v_mfma_f32_16x16x32_bf16 v[204:207], a[60:63], a[68:71], v[204:207]
    s_waitcnt vmcnt(20) lgkmcnt(0)
    v_mfma_f32_16x16x32_bf16 v[204:207], a[56:59], a[64:67], v[204:207]
    s_barrier
    v_mfma_f32_16x16x32_bf16 a[128:131], a[0:3], a[96:99], a[128:131]
    ds_read_b64_tr_b16 a[64:65], v26 offset:49152
    v_mfma_f32_16x16x32_bf16 a[128:131], a[4:7], a[100:103], a[128:131]
    s_add_u32 m0, s41, 32768
    ds_read_b64_tr_b16 a[66:67], v26 offset:50176
    v_mfma_f32_16x16x32_bf16 a[144:147], a[4:7], a[108:111], a[144:147]
    ds_read_b64_tr_b16 a[68:69], v26 offset:57344
    v_mfma_f32_16x16x32_bf16 a[144:147], a[0:3], a[104:107], a[144:147]
    buffer_load_dwordx4 v8, s[24:27], s36 offen offset:0  lds
    v_mfma_f32_16x16x32_bf16 a[160:163], a[0:3], a[112:115], a[160:163]
    ds_read_b64_tr_b16 a[70:71], v26 offset:58368
    v_mfma_f32_16x16x32_bf16 a[160:163], a[4:7], a[116:119], a[160:163]
    ds_read_b64_tr_b16 a[72:73], v27 offset:49152
    v_mfma_f32_16x16x32_bf16 a[176:179], a[4:7], a[124:127], a[176:179]
    ds_read_b64_tr_b16 a[74:75], v27 offset:50176
    v_mfma_f32_16x16x32_bf16 a[176:179], a[0:3], a[120:123], a[176:179]
    ds_read_b64_tr_b16 a[76:77], v27 offset:57344
    v_mfma_f32_16x16x32_bf16 a[180:183], a[8:11], a[120:123], a[180:183]
    ds_read_b64_tr_b16 a[78:79], v27 offset:58368
    v_mfma_f32_16x16x32_bf16 a[180:183], a[12:15], a[124:127], a[180:183]
    ds_read_b64_tr_b16 a[80:81], v28 offset:49152
    v_mfma_f32_16x16x32_bf16 a[164:167], a[12:15], a[116:119], a[164:167]
    ds_read_b64_tr_b16 a[82:83], v28 offset:50176
    v_mfma_f32_16x16x32_bf16 a[164:167], a[8:11], a[112:115], a[164:167]
    buffer_load_dwordx4 v9, s[24:27], s36 offen offset:1024  lds
    v_mfma_f32_16x16x32_bf16 a[148:151], a[8:11], a[104:107], a[148:151]
    ds_read_b64_tr_b16 a[84:85], v28 offset:57344
    v_mfma_f32_16x16x32_bf16 a[148:151], a[12:15], a[108:111], a[148:151]
    ds_read_b64_tr_b16 a[86:87], v28 offset:58368
    v_mfma_f32_16x16x32_bf16 a[132:135], a[12:15], a[100:103], a[132:135]
    ds_read_b64_tr_b16 a[88:89], v29 offset:49152
    v_mfma_f32_16x16x32_bf16 a[132:135], a[8:11], a[96:99], a[132:135]
    ds_read_b64_tr_b16 a[90:91], v29 offset:50176
    v_mfma_f32_16x16x32_bf16 a[136:139], a[16:19], a[96:99], a[136:139]
    ds_read_b64_tr_b16 a[92:93], v29 offset:57344
    v_mfma_f32_16x16x32_bf16 a[136:139], a[20:23], a[100:103], a[136:139]
    ds_read_b64_tr_b16 a[94:95], v29 offset:58368
    v_mfma_f32_16x16x32_bf16 a[152:155], a[20:23], a[108:111], a[152:155]
    v_mfma_f32_16x16x32_bf16 a[152:155], a[16:19], a[104:107], a[152:155]
    buffer_load_dwordx4 v10, s[24:27], s36 offen offset:2048  lds
    v_mfma_f32_16x16x32_bf16 a[168:171], a[16:19], a[112:115], a[168:171]
    v_mfma_f32_16x16x32_bf16 a[168:171], a[20:23], a[116:119], a[168:171]
    v_mfma_f32_16x16x32_bf16 a[184:187], a[20:23], a[124:127], a[184:187]
    v_mfma_f32_16x16x32_bf16 a[184:187], a[16:19], a[120:123], a[184:187]
    v_mfma_f32_16x16x32_bf16 a[188:191], a[24:27], a[120:123], a[188:191]
    v_mfma_f32_16x16x32_bf16 a[188:191], a[28:31], a[124:127], a[188:191]
    v_mfma_f32_16x16x32_bf16 a[172:175], a[28:31], a[116:119], a[172:175]
    v_mfma_f32_16x16x32_bf16 a[172:175], a[24:27], a[112:115], a[172:175]
    buffer_load_dwordx4 v11, s[24:27], s36 offen offset:3072  lds
    v_mfma_f32_16x16x32_bf16 a[156:159], a[24:27], a[104:107], a[156:159]
    s_add_u32 s36, s36, 128
    v_mfma_f32_16x16x32_bf16 a[156:159], a[28:31], a[108:111], a[156:159]
    v_mfma_f32_16x16x32_bf16 a[140:143], a[28:31], a[100:103], a[140:143]
    s_waitcnt vmcnt(20) lgkmcnt(0)
    v_mfma_f32_16x16x32_bf16 a[140:143], a[24:27], a[96:99], a[140:143]
    s_barrier
    v_mfma_f32_16x16x32_bf16 v[64:67], a[0:3], a[64:67], v[64:67]
    ds_read_b128 a[32:35], v24 offset:49152
    v_mfma_f32_16x16x32_bf16 v[64:67], a[4:7], a[68:71], v[64:67]
    s_add_u32 m0, s41, 98304
    v_mfma_f32_16x16x32_bf16 v[80:83], a[4:7], a[76:79], v[80:83]
    ds_read_b128 a[36:39], v25 offset:49152
    v_mfma_f32_16x16x32_bf16 v[80:83], a[0:3], a[72:75], v[80:83]
    buffer_load_dwordx4 v12, s[28:31], s38 offen offset:0  lds
    v_mfma_f32_16x16x32_bf16 v[96:99], a[0:3], a[80:83], v[96:99]
    ds_read_b128 a[40:43], v24 offset:51200
    v_accvgpr_read_b32 v32, a128
    v_mfma_f32_16x16x32_bf16 v[96:99], a[4:7], a[84:87], v[96:99]
    v_accvgpr_read_b32 v33, a129
    v_cvt_pk_bf16_f32 v32, v32, v33
    v_mfma_f32_16x16x32_bf16 v[112:115], a[4:7], a[92:95], v[112:115]
    ds_read_b128 a[44:47], v25 offset:51200
    v_accvgpr_read_b32 v34, a130
    v_mfma_f32_16x16x32_bf16 v[112:115], a[0:3], a[88:91], v[112:115]
    v_accvgpr_read_b32 v35, a131
    v_cvt_pk_bf16_f32 v33, v34, v35
    v_mfma_f32_16x16x32_bf16 v[116:119], a[8:11], a[88:91], v[116:119]
    ds_read_b128 a[48:51], v24 offset:53248
    v_accvgpr_read_b32 v34, a132
    v_mfma_f32_16x16x32_bf16 v[116:119], a[12:15], a[92:95], v[116:119]
    v_accvgpr_read_b32 v35, a133
    v_cvt_pk_bf16_f32 v34, v34, v35
    v_mfma_f32_16x16x32_bf16 v[100:103], a[12:15], a[84:87], v[100:103]
    ds_read_b128 a[52:55], v25 offset:53248
    v_accvgpr_read_b32 v4, a134
    v_mfma_f32_16x16x32_bf16 v[100:103], a[8:11], a[80:83], v[100:103]
    buffer_load_dwordx4 v13, s[28:31], s38 offen offset:1024  lds
    v_mfma_f32_16x16x32_bf16 v[84:87], a[8:11], a[72:75], v[84:87]
    ds_read_b128 a[56:59], v24 offset:55296
    v_accvgpr_read_b32 v5, a135
    v_mfma_f32_16x16x32_bf16 v[84:87], a[12:15], a[76:79], v[84:87]
    v_cvt_pk_bf16_f32 v35, v4, v5
    v_accvgpr_read_b32 v36, a136
    v_mfma_f32_16x16x32_bf16 v[68:71], a[12:15], a[68:71], v[68:71]
    ds_read_b128 a[60:63], v25 offset:55296
    v_accvgpr_read_b32 v37, a137
    v_mfma_f32_16x16x32_bf16 v[68:71], a[8:11], a[64:67], v[68:71]
    v_cvt_pk_bf16_f32 v36, v36, v37
    v_accvgpr_read_b32 v38, a138
    v_mfma_f32_16x16x32_bf16 v[72:75], a[16:19], a[64:67], v[72:75]
    v_accvgpr_read_b32 v39, a139
    v_cvt_pk_bf16_f32 v37, v38, v39
    v_mfma_f32_16x16x32_bf16 v[72:75], a[20:23], a[68:71], v[72:75]
    v_accvgpr_read_b32 v38, a140
    v_accvgpr_read_b32 v39, a141
    v_mfma_f32_16x16x32_bf16 v[88:91], a[20:23], a[76:79], v[88:91]
    v_cvt_pk_bf16_f32 v38, v38, v39
    v_accvgpr_read_b32 v6, a142
    v_mfma_f32_16x16x32_bf16 v[88:91], a[16:19], a[72:75], v[88:91]
    buffer_load_dwordx4 v14, s[28:31], s38 offen offset:2048  lds
    v_mfma_f32_16x16x32_bf16 v[104:107], a[16:19], a[80:83], v[104:107]
    v_accvgpr_read_b32 v7, a143
    v_cvt_pk_bf16_f32 v39, v6, v7
    v_mfma_f32_16x16x32_bf16 v[104:107], a[20:23], a[84:87], v[104:107]
    v_accvgpr_read_b32 v40, a144
    v_accvgpr_read_b32 v41, a145
    v_mfma_f32_16x16x32_bf16 v[120:123], a[20:23], a[92:95], v[120:123]
    v_cvt_pk_bf16_f32 v40, v40, v41
    v_accvgpr_read_b32 v42, a146
    v_mfma_f32_16x16x32_bf16 v[120:123], a[16:19], a[88:91], v[120:123]
    v_accvgpr_read_b32 v43, a147
    v_cvt_pk_bf16_f32 v41, v42, v43
    v_mfma_f32_16x16x32_bf16 v[124:127], a[24:27], a[88:91], v[124:127]
    v_accvgpr_read_b32 v42, a148
    v_accvgpr_read_b32 v43, a149
    v_mfma_f32_16x16x32_bf16 v[124:127], a[28:31], a[92:95], v[124:127]
    v_cvt_pk_bf16_f32 v42, v42, v43
    v_accvgpr_read_b32 v4, a150
    v_mfma_f32_16x16x32_bf16 v[108:111], a[28:31], a[84:87], v[108:111]
    v_accvgpr_read_b32 v5, a151
    v_cvt_pk_bf16_f32 v43, v4, v5
    v_mfma_f32_16x16x32_bf16 v[108:111], a[24:27], a[80:83], v[108:111]
    buffer_load_dwordx4 v15, s[28:31], s38 offen offset:3072  lds
    v_mfma_f32_16x16x32_bf16 v[92:95], a[24:27], a[72:75], v[92:95]
    s_add_u32 s38, s38, s40
    v_accvgpr_read_b32 v44, a152
    v_accvgpr_read_b32 v45, a153
    v_mfma_f32_16x16x32_bf16 v[92:95], a[28:31], a[76:79], v[92:95]
    v_cvt_pk_bf16_f32 v44, v44, v45
    v_accvgpr_read_b32 v46, a154
    v_mfma_f32_16x16x32_bf16 v[76:79], a[28:31], a[68:71], v[76:79]
    s_waitcnt vmcnt(20) lgkmcnt(0)
    v_accvgpr_read_b32 v47, a155
    v_cvt_pk_bf16_f32 v45, v46, v47
    v_mfma_f32_16x16x32_bf16 v[76:79], a[24:27], a[64:67], v[76:79]
    s_barrier
    v_accvgpr_read_b32 v46, a156
    v_accvgpr_read_b32 v47, a157
    v_mfma_f32_16x16x32_bf16 v[128:131], a[32:35], a[64:67], v[128:131]
    ds_read_b128 a[0:3], v24 offset:0
    v_cvt_pk_bf16_f32 v46, v46, v47
    v_mfma_f32_16x16x32_bf16 v[128:131], a[36:39], a[68:71], v[128:131]
    s_add_u32 m0, s41, 114688
    v_accvgpr_read_b32 v6, a158
    v_mfma_f32_16x16x32_bf16 v[144:147], a[36:39], a[76:79], v[144:147]
    ds_read_b128 a[4:7], v25 offset:0
    v_accvgpr_read_b32 v7, a159
    v_mfma_f32_16x16x32_bf16 v[144:147], a[32:35], a[72:75], v[144:147]
    buffer_load_dwordx4 v12, s[28:31], s39 offen offset:0  lds
    v_mfma_f32_16x16x32_bf16 v[160:163], a[32:35], a[80:83], v[160:163]
    s_add_u32 s60, s57, s48
    ds_read_b128 a[8:11], v24 offset:2048
    v_cvt_pk_bf16_f32 v64, v64, v65
    v_mfma_f32_16x16x32_bf16 v[160:163], a[36:39], a[84:87], v[160:163]
    s_add_u32 s61, s57, s49
    v_cvt_pk_bf16_f32 v65, v66, v67
    v_cvt_pk_bf16_f32 v66, v68, v69
    v_mfma_f32_16x16x32_bf16 v[176:179], a[36:39], a[92:95], v[176:179]
    s_add_u32 s64, s57, s50
    ds_read_b128 a[12:15], v25 offset:2048
    v_cvt_pk_bf16_f32 v67, v70, v71
    v_mfma_f32_16x16x32_bf16 v[176:179], a[32:35], a[88:91], v[176:179]
    buffer_store_dwordx4 v[64:67], v30, s[32:35], s60 offen sc1
    v_mfma_f32_16x16x32_bf16 v[180:183], a[40:43], a[88:91], v[180:183]
    s_add_u32 s65, s57, s51
    ds_read_b128 a[16:19], v24 offset:4096
    v_cvt_pk_bf16_f32 v72, v72, v73
    v_mfma_f32_16x16x32_bf16 v[180:183], a[44:47], a[92:95], v[180:183]
    s_add_u32 s60, s57, s52
    v_cvt_pk_bf16_f32 v73, v74, v75
    v_cvt_pk_bf16_f32 v74, v76, v77
    v_mfma_f32_16x16x32_bf16 v[164:167], a[44:47], a[84:87], v[164:167]
    ds_read_b128 a[20:23], v25 offset:4096
    v_cvt_pk_bf16_f32 v75, v78, v79
    v_mfma_f32_16x16x32_bf16 v[164:167], a[40:43], a[80:83], v[164:167]
    buffer_load_dwordx4 v13, s[28:31], s39 offen offset:1024  lds
    v_mfma_f32_16x16x32_bf16 v[148:151], a[40:43], a[72:75], v[148:151]
    ds_read_b128 a[24:27], v24 offset:6144
    v_cvt_pk_bf16_f32 v80, v80, v81
    v_mfma_f32_16x16x32_bf16 v[148:151], a[44:47], a[76:79], v[148:151]
    buffer_store_dwordx4 v[72:75], v30, s[32:35], s61 offen sc1
    v_mfma_f32_16x16x32_bf16 v[132:135], a[44:47], a[68:71], v[132:135]
    s_add_u32 s61, s57, s53
    ds_read_b128 a[28:31], v25 offset:6144
    v_cvt_pk_bf16_f32 v81, v82, v83
    v_mfma_f32_16x16x32_bf16 v[132:135], a[40:43], a[64:67], v[132:135]
    v_cvt_pk_bf16_f32 v82, v84, v85
    v_cvt_pk_bf16_f32 v83, v86, v87
    v_mfma_f32_16x16x32_bf16 v[136:139], a[48:51], a[64:67], v[136:139]
    buffer_store_dwordx4 v[80:83], v30, s[32:35], s64 offen sc1
    v_mfma_f32_16x16x32_bf16 v[136:139], a[52:55], a[68:71], v[136:139]
    s_add_u32 s64, s57, s54
    v_cvt_pk_bf16_f32 v88, v88, v89
    v_cvt_pk_bf16_f32 v89, v90, v91
    v_mfma_f32_16x16x32_bf16 v[152:155], a[52:55], a[76:79], v[152:155]
    v_cvt_pk_bf16_f32 v90, v92, v93
    v_cvt_pk_bf16_f32 v91, v94, v95
    v_mfma_f32_16x16x32_bf16 v[152:155], a[48:51], a[72:75], v[152:155]
    buffer_load_dwordx4 v14, s[28:31], s39 offen offset:2048  lds
    v_mfma_f32_16x16x32_bf16 v[168:171], a[48:51], a[80:83], v[168:171]
    buffer_store_dwordx4 v[88:91], v30, s[32:35], s65 offen sc1
    v_mfma_f32_16x16x32_bf16 v[168:171], a[52:55], a[84:87], v[168:171]
    s_add_u32 s65, s57, s55
    v_cvt_pk_bf16_f32 v96, v96, v97
    v_cvt_pk_bf16_f32 v97, v98, v99
    v_mfma_f32_16x16x32_bf16 v[184:187], a[52:55], a[92:95], v[184:187]
    v_cvt_pk_bf16_f32 v98, v100, v101
    v_cvt_pk_bf16_f32 v99, v102, v103
    v_mfma_f32_16x16x32_bf16 v[184:187], a[48:51], a[88:91], v[184:187]
    buffer_store_dwordx4 v[96:99], v30, s[32:35], s60 offen sc1
    v_mfma_f32_16x16x32_bf16 v[188:191], a[56:59], a[88:91], v[188:191]
    v_cvt_pk_bf16_f32 v104, v104, v105
    v_cvt_pk_bf16_f32 v105, v106, v107
    v_mfma_f32_16x16x32_bf16 v[188:191], a[60:63], a[92:95], v[188:191]
    v_cvt_pk_bf16_f32 v106, v108, v109
    v_cvt_pk_bf16_f32 v107, v110, v111
    v_mfma_f32_16x16x32_bf16 v[172:175], a[60:63], a[84:87], v[172:175]
    buffer_store_dwordx4 v[104:107], v30, s[32:35], s61 offen sc1
    v_mfma_f32_16x16x32_bf16 v[172:175], a[56:59], a[80:83], v[172:175]
    buffer_load_dwordx4 v15, s[28:31], s39 offen offset:3072  lds
    v_mfma_f32_16x16x32_bf16 v[156:159], a[56:59], a[72:75], v[156:159]
    s_add_u32 s39, s39, s40
    v_cvt_pk_bf16_f32 v112, v112, v113
    v_cvt_pk_bf16_f32 v113, v114, v115
    v_mfma_f32_16x16x32_bf16 v[156:159], a[60:63], a[76:79], v[156:159]
    v_cvt_pk_bf16_f32 v114, v116, v117
    v_cvt_pk_bf16_f32 v115, v118, v119
    v_mfma_f32_16x16x32_bf16 v[140:143], a[60:63], a[68:71], v[140:143]
    s_waitcnt vmcnt(26) lgkmcnt(0)
    v_cvt_pk_bf16_f32 v120, v120, v121
    v_cvt_pk_bf16_f32 v121, v122, v123
    v_mfma_f32_16x16x32_bf16 v[140:143], a[56:59], a[64:67], v[140:143]
    s_barrier
    v_cvt_pk_bf16_f32 v122, v124, v125
    v_cvt_pk_bf16_f32 v123, v126, v127
    v_mfma_f32_16x16x32_bf16 v[192:195], a[32:35], a[96:99], v[192:195]
    ds_read_b64_tr_b16 a[64:65], v26 offset:0
    v_cvt_pk_bf16_f32 v47, v6, v7
    v_mfma_f32_16x16x32_bf16 v[192:195], a[36:39], a[100:103], v[192:195]
    s_add_u32 m0, s41, 49152
    ds_read_b64_tr_b16 a[66:67], v26 offset:1024
    v_mfma_f32_16x16x32_bf16 v[208:211], a[36:39], a[108:111], v[208:211]
    ds_read_b64_tr_b16 a[68:69], v26 offset:8192
    v_accvgpr_read_b32 v48, a160
    v_mfma_f32_16x16x32_bf16 v[208:211], a[32:35], a[104:107], v[208:211]
    buffer_load_dwordx4 v8, s[24:27], s37 offen offset:0  lds
    v_mfma_f32_16x16x32_bf16 v[224:227], a[32:35], a[112:115], v[224:227]
    ds_read_b64_tr_b16 a[70:71], v26 offset:9216
    v_accvgpr_read_b32 v49, a161
    v_mfma_f32_16x16x32_bf16 v[224:227], a[36:39], a[116:119], v[224:227]
    ds_read_b64_tr_b16 a[72:73], v27 offset:0
    v_cvt_pk_bf16_f32 v48, v48, v49
    v_mfma_f32_16x16x32_bf16 v[240:243], a[36:39], a[124:127], v[240:243]
    ds_read_b64_tr_b16 a[74:75], v27 offset:1024
    v_accvgpr_read_b32 v50, a162
    v_mfma_f32_16x16x32_bf16 v[240:243], a[32:35], a[120:123], v[240:243]
    ds_read_b64_tr_b16 a[76:77], v27 offset:8192
    v_accvgpr_read_b32 v51, a163
    v_mfma_f32_16x16x32_bf16 v[244:247], a[40:43], a[120:123], v[244:247]
    ds_read_b64_tr_b16 a[78:79], v27 offset:9216
    v_cvt_pk_bf16_f32 v49, v50, v51
    v_mfma_f32_16x16x32_bf16 v[244:247], a[44:47], a[124:127], v[244:247]
    ds_read_b64_tr_b16 a[80:81], v28 offset:0
    v_accvgpr_read_b32 v50, a164
    v_mfma_f32_16x16x32_bf16 v[228:231], a[44:47], a[116:119], v[228:231]
    ds_read_b64_tr_b16 a[82:83], v28 offset:1024
    v_accvgpr_read_b32 v51, a165
    v_mfma_f32_16x16x32_bf16 v[228:231], a[40:43], a[112:115], v[228:231]
    buffer_load_dwordx4 v9, s[24:27], s37 offen offset:1024  lds
    v_mfma_f32_16x16x32_bf16 v[212:215], a[40:43], a[104:107], v[212:215]
    ds_read_b64_tr_b16 a[84:85], v28 offset:8192
    v_cvt_pk_bf16_f32 v50, v50, v51
    v_mfma_f32_16x16x32_bf16 v[212:215], a[44:47], a[108:111], v[212:215]
    ds_read_b64_tr_b16 a[86:87], v28 offset:9216
    v_accvgpr_read_b32 v4, a166
    v_mfma_f32_16x16x32_bf16 v[196:199], a[44:47], a[100:103], v[196:199]
    ds_read_b64_tr_b16 a[88:89], v29 offset:0
    v_accvgpr_read_b32 v5, a167
    v_mfma_f32_16x16x32_bf16 v[196:199], a[40:43], a[96:99], v[196:199]
    ds_read_b64_tr_b16 a[90:91], v29 offset:1024
    v_cvt_pk_bf16_f32 v51, v4, v5
    v_mfma_f32_16x16x32_bf16 v[200:203], a[48:51], a[96:99], v[200:203]
    ds_read_b64_tr_b16 a[92:93], v29 offset:8192
    v_accvgpr_read_b32 v52, a168
    v_mfma_f32_16x16x32_bf16 v[200:203], a[52:55], a[100:103], v[200:203]
    ds_read_b64_tr_b16 a[94:95], v29 offset:9216
    v_accvgpr_read_b32 v53, a169
    v_mfma_f32_16x16x32_bf16 v[216:219], a[52:55], a[108:111], v[216:219]
    buffer_store_dwordx4 v[112:115], v30, s[32:35], s64 offen sc1
    v_mfma_f32_16x16x32_bf16 v[216:219], a[48:51], a[104:107], v[216:219]
    buffer_load_dwordx4 v10, s[24:27], s37 offen offset:2048  lds
    v_mfma_f32_16x16x32_bf16 v[232:235], a[48:51], a[112:115], v[232:235]
    buffer_store_dwordx4 v[120:123], v30, s[32:35], s65 offen sc1
    v_mfma_f32_16x16x32_bf16 v[232:235], a[52:55], a[116:119], v[232:235]
    v_cvt_pk_bf16_f32 v52, v52, v53
    v_accvgpr_read_b32 v54, a170
    v_mfma_f32_16x16x32_bf16 v[248:251], a[52:55], a[124:127], v[248:251]
    v_accvgpr_read_b32 v55, a171
    v_cvt_pk_bf16_f32 v53, v54, v55
    v_mfma_f32_16x16x32_bf16 v[248:251], a[48:51], a[120:123], v[248:251]
    v_accvgpr_read_b32 v54, a172
    v_accvgpr_read_b32 v55, a173
    v_mfma_f32_16x16x32_bf16 v[252:255], a[56:59], a[120:123], v[252:255]
    v_cvt_pk_bf16_f32 v54, v54, v55
    v_accvgpr_read_b32 v6, a174
    v_mfma_f32_16x16x32_bf16 v[252:255], a[60:63], a[124:127], v[252:255]
    v_accvgpr_read_b32 v7, a175
    v_cvt_pk_bf16_f32 v55, v6, v7
    v_mfma_f32_16x16x32_bf16 v[236:239], a[60:63], a[116:119], v[236:239]
    v_accvgpr_read_b32 v56, a176
    v_accvgpr_read_b32 v57, a177
    v_mfma_f32_16x16x32_bf16 v[236:239], a[56:59], a[112:115], v[236:239]
    buffer_load_dwordx4 v11, s[24:27], s37 offen offset:3072  lds
    v_mfma_f32_16x16x32_bf16 v[220:223], a[56:59], a[104:107], v[220:223]
    s_add_u32 s37, s37, 128
    v_cvt_pk_bf16_f32 v56, v56, v57
    v_mfma_f32_16x16x32_bf16 v[220:223], a[60:63], a[108:111], v[220:223]
    v_accvgpr_read_b32 v58, a178
    v_accvgpr_read_b32 v59, a179
    v_mfma_f32_16x16x32_bf16 v[204:207], a[60:63], a[100:103], v[204:207]
    s_waitcnt vmcnt(28) lgkmcnt(0)
    v_cvt_pk_bf16_f32 v57, v58, v59
    v_accvgpr_read_b32 v58, a180
    v_mfma_f32_16x16x32_bf16 v[204:207], a[56:59], a[96:99], v[204:207]
    s_barrier
    v_accvgpr_read_b32 v59, a181
    v_cvt_pk_bf16_f32 v58, v58, v59
    v_accvgpr_read_b32 v4, a182
    v_accvgpr_read_b32 v5, a183
    v_cvt_pk_bf16_f32 v59, v4, v5
    v_accvgpr_read_b32 v60, a184
    v_accvgpr_read_b32 v61, a185
    v_cvt_pk_bf16_f32 v60, v60, v61
    v_accvgpr_read_b32 v62, a186
    v_accvgpr_read_b32 v63, a187
    v_cvt_pk_bf16_f32 v61, v62, v63
    v_accvgpr_read_b32 v62, a188
    v_accvgpr_read_b32 v63, a189
    v_cvt_pk_bf16_f32 v62, v62, v63
    v_accvgpr_read_b32 v6, a190
    v_accvgpr_read_b32 v7, a191
    v_cvt_pk_bf16_f32 v63, v6, v7
    s_branch K1_TILE2
.p2align 6
K1_LOOP_K:
    v_mfma_f32_16x16x32_bf16 a[128:131], a[64:67], a[0:3], a[128:131]
    ds_read_b64_tr_b16 a[96:97], v26 offset:16384
    v_mfma_f32_16x16x32_bf16 a[128:131], a[68:71], a[4:7], a[128:131]
    s_add_u32 m0, s41, 0
    ds_read_b64_tr_b16 a[98:99], v26 offset:17408
    v_mfma_f32_16x16x32_bf16 a[132:135], a[76:79], a[4:7], a[132:135]
    ds_read_b64_tr_b16 a[100:101], v26 offset:24576
    v_mfma_f32_16x16x32_bf16 a[132:135], a[72:75], a[0:3], a[132:135]
    buffer_load_dwordx4 v8, s[24:27], s36 offen offset:0  lds
    v_mfma_f32_16x16x32_bf16 a[136:139], a[80:83], a[0:3], a[136:139]
    ds_read_b64_tr_b16 a[102:103], v26 offset:25600
    v_mfma_f32_16x16x32_bf16 a[136:139], a[84:87], a[4:7], a[136:139]
    ds_read_b64_tr_b16 a[104:105], v27 offset:16384
    v_mfma_f32_16x16x32_bf16 a[140:143], a[92:95], a[4:7], a[140:143]
    ds_read_b64_tr_b16 a[106:107], v27 offset:17408
    v_mfma_f32_16x16x32_bf16 a[140:143], a[88:91], a[0:3], a[140:143]
    ds_read_b64_tr_b16 a[108:109], v27 offset:24576
    v_mfma_f32_16x16x32_bf16 a[156:159], a[88:91], a[8:11], a[156:159]
    ds_read_b64_tr_b16 a[110:111], v27 offset:25600
    v_mfma_f32_16x16x32_bf16 a[156:159], a[92:95], a[12:15], a[156:159]
    ds_read_b64_tr_b16 a[112:113], v28 offset:16384
    v_mfma_f32_16x16x32_bf16 a[152:155], a[84:87], a[12:15], a[152:155]
    ds_read_b64_tr_b16 a[114:115], v28 offset:17408
    v_mfma_f32_16x16x32_bf16 a[152:155], a[80:83], a[8:11], a[152:155]
    buffer_load_dwordx4 v9, s[24:27], s36 offen offset:1024  lds
    v_mfma_f32_16x16x32_bf16 a[148:151], a[72:75], a[8:11], a[148:151]
    ds_read_b64_tr_b16 a[116:117], v28 offset:24576
    v_mfma_f32_16x16x32_bf16 a[148:151], a[76:79], a[12:15], a[148:151]
    ds_read_b64_tr_b16 a[118:119], v28 offset:25600
    v_mfma_f32_16x16x32_bf16 a[144:147], a[68:71], a[12:15], a[144:147]
    ds_read_b64_tr_b16 a[120:121], v29 offset:16384
    v_mfma_f32_16x16x32_bf16 a[144:147], a[64:67], a[8:11], a[144:147]
    ds_read_b64_tr_b16 a[122:123], v29 offset:17408
    v_mfma_f32_16x16x32_bf16 a[160:163], a[64:67], a[16:19], a[160:163]
    ds_read_b64_tr_b16 a[124:125], v29 offset:24576
    v_mfma_f32_16x16x32_bf16 a[160:163], a[68:71], a[20:23], a[160:163]
    ds_read_b64_tr_b16 a[126:127], v29 offset:25600
    v_mfma_f32_16x16x32_bf16 a[164:167], a[76:79], a[20:23], a[164:167]
    v_mfma_f32_16x16x32_bf16 a[164:167], a[72:75], a[16:19], a[164:167]
    buffer_load_dwordx4 v10, s[24:27], s36 offen offset:2048  lds
    v_mfma_f32_16x16x32_bf16 a[168:171], a[80:83], a[16:19], a[168:171]
    v_mfma_f32_16x16x32_bf16 a[168:171], a[84:87], a[20:23], a[168:171]
    v_mfma_f32_16x16x32_bf16 a[172:175], a[92:95], a[20:23], a[172:175]
    v_mfma_f32_16x16x32_bf16 a[172:175], a[88:91], a[16:19], a[172:175]
    buffer_load_dword v32, v3, s[64:67], s59 offen
    v_mfma_f32_16x16x32_bf16 a[188:191], a[88:91], a[24:27], a[188:191]
    v_mfma_f32_16x16x32_bf16 a[188:191], a[92:95], a[28:31], a[188:191]
    s_add_u32 s59, s59, s61
    v_mfma_f32_16x16x32_bf16 a[184:187], a[84:87], a[28:31], a[184:187]
    s_and_b32 s59, s59, s63
    v_mfma_f32_16x16x32_bf16 a[184:187], a[80:83], a[24:27], a[184:187]
    buffer_load_dwordx4 v11, s[24:27], s36 offen offset:3072  lds
    v_mfma_f32_16x16x32_bf16 a[180:183], a[72:75], a[24:27], a[180:183]
    s_add_u32 s36, s36, s18
    v_mfma_f32_16x16x32_bf16 a[180:183], a[76:79], a[28:31], a[180:183]
    v_mfma_f32_16x16x32_bf16 a[176:179], a[68:71], a[28:31], a[176:179]
    s_waitcnt vmcnt(21) lgkmcnt(0)
    v_mfma_f32_16x16x32_bf16 a[176:179], a[64:67], a[24:27], a[176:179]
    s_barrier
    v_mfma_f32_16x16x32_bf16 v[64:67], a[96:99], a[0:3], v[64:67]
    ds_read_b128 a[32:35], v24 offset:16384
    v_mfma_f32_16x16x32_bf16 v[64:67], a[100:103], a[4:7], v[64:67]
    s_add_u32 m0, s41, 65536
    v_mfma_f32_16x16x32_bf16 v[68:71], a[108:111], a[4:7], v[68:71]
    ds_read_b128 a[36:39], v25 offset:16384
    v_mfma_f32_16x16x32_bf16 v[68:71], a[104:107], a[0:3], v[68:71]
    buffer_load_dwordx4 v12, s[28:31], s38 offen offset:0  lds
    v_mfma_f32_16x16x32_bf16 v[72:75], a[112:115], a[0:3], v[72:75]
    ds_read_b128 a[40:43], v24 offset:18432
    v_mfma_f32_16x16x32_bf16 v[72:75], a[116:119], a[4:7], v[72:75]
    v_mfma_f32_16x16x32_bf16 v[76:79], a[124:127], a[4:7], v[76:79]
    ds_read_b128 a[44:47], v25 offset:18432
    v_mfma_f32_16x16x32_bf16 v[76:79], a[120:123], a[0:3], v[76:79]
    v_mfma_f32_16x16x32_bf16 v[92:95], a[120:123], a[8:11], v[92:95]
    ds_read_b128 a[48:51], v24 offset:20480
    v_mfma_f32_16x16x32_bf16 v[92:95], a[124:127], a[12:15], v[92:95]
    v_mfma_f32_16x16x32_bf16 v[88:91], a[116:119], a[12:15], v[88:91]
    ds_read_b128 a[52:55], v25 offset:20480
    v_mfma_f32_16x16x32_bf16 v[88:91], a[112:115], a[8:11], v[88:91]
    buffer_load_dwordx4 v13, s[28:31], s38 offen offset:1024  lds
    v_mfma_f32_16x16x32_bf16 v[84:87], a[104:107], a[8:11], v[84:87]
    ds_read_b128 a[56:59], v24 offset:22528
    v_mfma_f32_16x16x32_bf16 v[84:87], a[108:111], a[12:15], v[84:87]
    v_mfma_f32_16x16x32_bf16 v[80:83], a[100:103], a[12:15], v[80:83]
    ds_read_b128 a[60:63], v25 offset:22528
    v_mfma_f32_16x16x32_bf16 v[80:83], a[96:99], a[8:11], v[80:83]
    v_mfma_f32_16x16x32_bf16 v[96:99], a[96:99], a[16:19], v[96:99]
    v_mfma_f32_16x16x32_bf16 v[96:99], a[100:103], a[20:23], v[96:99]
    v_mfma_f32_16x16x32_bf16 v[100:103], a[108:111], a[20:23], v[100:103]
    v_mfma_f32_16x16x32_bf16 v[100:103], a[104:107], a[16:19], v[100:103]
    buffer_load_dwordx4 v14, s[28:31], s38 offen offset:2048  lds
    v_mfma_f32_16x16x32_bf16 v[104:107], a[112:115], a[16:19], v[104:107]
    v_mfma_f32_16x16x32_bf16 v[104:107], a[116:119], a[20:23], v[104:107]
    v_mfma_f32_16x16x32_bf16 v[108:111], a[124:127], a[20:23], v[108:111]
    v_mfma_f32_16x16x32_bf16 v[108:111], a[120:123], a[16:19], v[108:111]
    v_mfma_f32_16x16x32_bf16 v[124:127], a[120:123], a[24:27], v[124:127]
    v_mfma_f32_16x16x32_bf16 v[124:127], a[124:127], a[28:31], v[124:127]
    v_mfma_f32_16x16x32_bf16 v[120:123], a[116:119], a[28:31], v[120:123]
    v_mfma_f32_16x16x32_bf16 v[120:123], a[112:115], a[24:27], v[120:123]
    buffer_load_dwordx4 v15, s[28:31], s38 offen offset:3072  lds
    v_mfma_f32_16x16x32_bf16 v[116:119], a[104:107], a[24:27], v[116:119]
    s_add_u32 s38, s38, s19
    v_mfma_f32_16x16x32_bf16 v[116:119], a[108:111], a[28:31], v[116:119]
    v_mfma_f32_16x16x32_bf16 v[112:115], a[100:103], a[28:31], v[112:115]
    s_waitcnt vmcnt(21) lgkmcnt(0)
    v_mfma_f32_16x16x32_bf16 v[112:115], a[96:99], a[24:27], v[112:115]
    s_barrier
    v_mfma_f32_16x16x32_bf16 v[128:131], a[96:99], a[32:35], v[128:131]
    ds_read_b128 a[0:3], v24 offset:32768
    v_mfma_f32_16x16x32_bf16 v[128:131], a[100:103], a[36:39], v[128:131]
    s_add_u32 m0, s41, 81920
    v_mfma_f32_16x16x32_bf16 v[132:135], a[108:111], a[36:39], v[132:135]
    ds_read_b128 a[4:7], v25 offset:32768
    v_mfma_f32_16x16x32_bf16 v[132:135], a[104:107], a[32:35], v[132:135]
    buffer_load_dwordx4 v12, s[28:31], s39 offen offset:0  lds
    v_mfma_f32_16x16x32_bf16 v[136:139], a[112:115], a[32:35], v[136:139]
    ds_read_b128 a[8:11], v24 offset:34816
    v_mfma_f32_16x16x32_bf16 v[136:139], a[116:119], a[36:39], v[136:139]
    v_mfma_f32_16x16x32_bf16 v[140:143], a[124:127], a[36:39], v[140:143]
    ds_read_b128 a[12:15], v25 offset:34816
    v_mfma_f32_16x16x32_bf16 v[140:143], a[120:123], a[32:35], v[140:143]
    v_mfma_f32_16x16x32_bf16 v[156:159], a[120:123], a[40:43], v[156:159]
    ds_read_b128 a[16:19], v24 offset:36864
    v_mfma_f32_16x16x32_bf16 v[156:159], a[124:127], a[44:47], v[156:159]
    v_mfma_f32_16x16x32_bf16 v[152:155], a[116:119], a[44:47], v[152:155]
    ds_read_b128 a[20:23], v25 offset:36864
    v_mfma_f32_16x16x32_bf16 v[152:155], a[112:115], a[40:43], v[152:155]
    buffer_load_dwordx4 v13, s[28:31], s39 offen offset:1024  lds
    v_mfma_f32_16x16x32_bf16 v[148:151], a[104:107], a[40:43], v[148:151]
    ds_read_b128 a[24:27], v24 offset:38912
    v_mfma_f32_16x16x32_bf16 v[148:151], a[108:111], a[44:47], v[148:151]
    v_mfma_f32_16x16x32_bf16 v[144:147], a[100:103], a[44:47], v[144:147]
    ds_read_b128 a[28:31], v25 offset:38912
    v_mfma_f32_16x16x32_bf16 v[144:147], a[96:99], a[40:43], v[144:147]
    v_mfma_f32_16x16x32_bf16 v[160:163], a[96:99], a[48:51], v[160:163]
    v_mfma_f32_16x16x32_bf16 v[160:163], a[100:103], a[52:55], v[160:163]
    v_mfma_f32_16x16x32_bf16 v[164:167], a[108:111], a[52:55], v[164:167]
    v_mfma_f32_16x16x32_bf16 v[164:167], a[104:107], a[48:51], v[164:167]
    buffer_load_dwordx4 v14, s[28:31], s39 offen offset:2048  lds
    v_mfma_f32_16x16x32_bf16 v[168:171], a[112:115], a[48:51], v[168:171]
    v_mfma_f32_16x16x32_bf16 v[168:171], a[116:119], a[52:55], v[168:171]
    v_mfma_f32_16x16x32_bf16 v[172:175], a[124:127], a[52:55], v[172:175]
    v_mfma_f32_16x16x32_bf16 v[172:175], a[120:123], a[48:51], v[172:175]
    v_mfma_f32_16x16x32_bf16 v[188:191], a[120:123], a[56:59], v[188:191]
    v_mfma_f32_16x16x32_bf16 v[188:191], a[124:127], a[60:63], v[188:191]
    v_mfma_f32_16x16x32_bf16 v[184:187], a[116:119], a[60:63], v[184:187]
    v_mfma_f32_16x16x32_bf16 v[184:187], a[112:115], a[56:59], v[184:187]
    buffer_load_dwordx4 v15, s[28:31], s39 offen offset:3072  lds
    v_mfma_f32_16x16x32_bf16 v[180:183], a[104:107], a[56:59], v[180:183]
    s_add_u32 s39, s39, s19
    v_mfma_f32_16x16x32_bf16 v[180:183], a[108:111], a[60:63], v[180:183]
    v_mfma_f32_16x16x32_bf16 v[176:179], a[100:103], a[60:63], v[176:179]
    s_waitcnt vmcnt(21) lgkmcnt(0)
    v_mfma_f32_16x16x32_bf16 v[176:179], a[96:99], a[56:59], v[176:179]
    s_barrier
    v_mfma_f32_16x16x32_bf16 v[192:195], a[64:67], a[32:35], v[192:195]
    ds_read_b64_tr_b16 a[96:97], v26 offset:32768
    v_mfma_f32_16x16x32_bf16 v[192:195], a[68:71], a[36:39], v[192:195]
    s_add_u32 m0, s41, 16384
    ds_read_b64_tr_b16 a[98:99], v26 offset:33792
    v_mfma_f32_16x16x32_bf16 v[196:199], a[76:79], a[36:39], v[196:199]
    ds_read_b64_tr_b16 a[100:101], v26 offset:40960
    v_mfma_f32_16x16x32_bf16 v[196:199], a[72:75], a[32:35], v[196:199]
    buffer_load_dwordx4 v8, s[24:27], s37 offen offset:0  lds
    v_mfma_f32_16x16x32_bf16 v[200:203], a[80:83], a[32:35], v[200:203]
    ds_read_b64_tr_b16 a[102:103], v26 offset:41984
    v_mfma_f32_16x16x32_bf16 v[200:203], a[84:87], a[36:39], v[200:203]
    ds_read_b64_tr_b16 a[104:105], v27 offset:32768
    v_mfma_f32_16x16x32_bf16 v[204:207], a[92:95], a[36:39], v[204:207]
    ds_read_b64_tr_b16 a[106:107], v27 offset:33792
    v_mfma_f32_16x16x32_bf16 v[204:207], a[88:91], a[32:35], v[204:207]
    ds_read_b64_tr_b16 a[108:109], v27 offset:40960
    v_mfma_f32_16x16x32_bf16 v[220:223], a[88:91], a[40:43], v[220:223]
    ds_read_b64_tr_b16 a[110:111], v27 offset:41984
    v_mfma_f32_16x16x32_bf16 v[220:223], a[92:95], a[44:47], v[220:223]
    ds_read_b64_tr_b16 a[112:113], v28 offset:32768
    v_mfma_f32_16x16x32_bf16 v[216:219], a[84:87], a[44:47], v[216:219]
    ds_read_b64_tr_b16 a[114:115], v28 offset:33792
    v_mfma_f32_16x16x32_bf16 v[216:219], a[80:83], a[40:43], v[216:219]
    buffer_load_dwordx4 v9, s[24:27], s37 offen offset:1024  lds
    v_mfma_f32_16x16x32_bf16 v[212:215], a[72:75], a[40:43], v[212:215]
    ds_read_b64_tr_b16 a[116:117], v28 offset:40960
    v_mfma_f32_16x16x32_bf16 v[212:215], a[76:79], a[44:47], v[212:215]
    ds_read_b64_tr_b16 a[118:119], v28 offset:41984
    v_mfma_f32_16x16x32_bf16 v[208:211], a[68:71], a[44:47], v[208:211]
    ds_read_b64_tr_b16 a[120:121], v29 offset:32768
    v_mfma_f32_16x16x32_bf16 v[208:211], a[64:67], a[40:43], v[208:211]
    ds_read_b64_tr_b16 a[122:123], v29 offset:33792
    v_mfma_f32_16x16x32_bf16 v[224:227], a[64:67], a[48:51], v[224:227]
    ds_read_b64_tr_b16 a[124:125], v29 offset:40960
    v_mfma_f32_16x16x32_bf16 v[224:227], a[68:71], a[52:55], v[224:227]
    ds_read_b64_tr_b16 a[126:127], v29 offset:41984
    v_mfma_f32_16x16x32_bf16 v[228:231], a[76:79], a[52:55], v[228:231]
    v_mfma_f32_16x16x32_bf16 v[228:231], a[72:75], a[48:51], v[228:231]
    buffer_load_dwordx4 v10, s[24:27], s37 offen offset:2048  lds
    v_mfma_f32_16x16x32_bf16 v[232:235], a[80:83], a[48:51], v[232:235]
    v_mfma_f32_16x16x32_bf16 v[232:235], a[84:87], a[52:55], v[232:235]
    v_mfma_f32_16x16x32_bf16 v[236:239], a[92:95], a[52:55], v[236:239]
    v_mfma_f32_16x16x32_bf16 v[236:239], a[88:91], a[48:51], v[236:239]
    v_mfma_f32_16x16x32_bf16 v[252:255], a[88:91], a[56:59], v[252:255]
    v_mfma_f32_16x16x32_bf16 v[252:255], a[92:95], a[60:63], v[252:255]
    v_mfma_f32_16x16x32_bf16 v[248:251], a[84:87], a[60:63], v[248:251]
    v_mfma_f32_16x16x32_bf16 v[248:251], a[80:83], a[56:59], v[248:251]
    buffer_load_dwordx4 v11, s[24:27], s37 offen offset:3072  lds
    v_mfma_f32_16x16x32_bf16 v[244:247], a[72:75], a[56:59], v[244:247]
    s_add_u32 s37, s37, s18
    v_mfma_f32_16x16x32_bf16 v[244:247], a[76:79], a[60:63], v[244:247]
    v_mfma_f32_16x16x32_bf16 v[240:243], a[68:71], a[60:63], v[240:243]
    s_waitcnt vmcnt(21) lgkmcnt(0)
    v_mfma_f32_16x16x32_bf16 v[240:243], a[64:67], a[56:59], v[240:243]
    s_barrier
    v_mfma_f32_16x16x32_bf16 a[128:131], a[96:99], a[0:3], a[128:131]
    ds_read_b64_tr_b16 a[64:65], v26 offset:49152
    v_mfma_f32_16x16x32_bf16 a[128:131], a[100:103], a[4:7], a[128:131]
    s_add_u32 m0, s41, 32768
    ds_read_b64_tr_b16 a[66:67], v26 offset:50176
    v_mfma_f32_16x16x32_bf16 a[132:135], a[108:111], a[4:7], a[132:135]
    ds_read_b64_tr_b16 a[68:69], v26 offset:57344
    v_mfma_f32_16x16x32_bf16 a[132:135], a[104:107], a[0:3], a[132:135]
    buffer_load_dwordx4 v8, s[24:27], s36 offen offset:0  lds
    v_mfma_f32_16x16x32_bf16 a[136:139], a[112:115], a[0:3], a[136:139]
    ds_read_b64_tr_b16 a[70:71], v26 offset:58368
    v_mfma_f32_16x16x32_bf16 a[136:139], a[116:119], a[4:7], a[136:139]
    ds_read_b64_tr_b16 a[72:73], v27 offset:49152
    v_mfma_f32_16x16x32_bf16 a[140:143], a[124:127], a[4:7], a[140:143]
    ds_read_b64_tr_b16 a[74:75], v27 offset:50176
    v_mfma_f32_16x16x32_bf16 a[140:143], a[120:123], a[0:3], a[140:143]
    ds_read_b64_tr_b16 a[76:77], v27 offset:57344
    v_mfma_f32_16x16x32_bf16 a[156:159], a[120:123], a[8:11], a[156:159]
    ds_read_b64_tr_b16 a[78:79], v27 offset:58368
    v_mfma_f32_16x16x32_bf16 a[156:159], a[124:127], a[12:15], a[156:159]
    ds_read_b64_tr_b16 a[80:81], v28 offset:49152
    v_mfma_f32_16x16x32_bf16 a[152:155], a[116:119], a[12:15], a[152:155]
    ds_read_b64_tr_b16 a[82:83], v28 offset:50176
    v_mfma_f32_16x16x32_bf16 a[152:155], a[112:115], a[8:11], a[152:155]
    buffer_load_dwordx4 v9, s[24:27], s36 offen offset:1024  lds
    v_mfma_f32_16x16x32_bf16 a[148:151], a[104:107], a[8:11], a[148:151]
    ds_read_b64_tr_b16 a[84:85], v28 offset:57344
    v_mfma_f32_16x16x32_bf16 a[148:151], a[108:111], a[12:15], a[148:151]
    ds_read_b64_tr_b16 a[86:87], v28 offset:58368
    v_mfma_f32_16x16x32_bf16 a[144:147], a[100:103], a[12:15], a[144:147]
    ds_read_b64_tr_b16 a[88:89], v29 offset:49152
    v_mfma_f32_16x16x32_bf16 a[144:147], a[96:99], a[8:11], a[144:147]
    ds_read_b64_tr_b16 a[90:91], v29 offset:50176
    v_mfma_f32_16x16x32_bf16 a[160:163], a[96:99], a[16:19], a[160:163]
    ds_read_b64_tr_b16 a[92:93], v29 offset:57344
    v_mfma_f32_16x16x32_bf16 a[160:163], a[100:103], a[20:23], a[160:163]
    ds_read_b64_tr_b16 a[94:95], v29 offset:58368
    v_mfma_f32_16x16x32_bf16 a[164:167], a[108:111], a[20:23], a[164:167]
    v_mfma_f32_16x16x32_bf16 a[164:167], a[104:107], a[16:19], a[164:167]
    buffer_load_dwordx4 v10, s[24:27], s36 offen offset:2048  lds
    v_mfma_f32_16x16x32_bf16 a[168:171], a[112:115], a[16:19], a[168:171]
    v_mfma_f32_16x16x32_bf16 a[168:171], a[116:119], a[20:23], a[168:171]
    v_mfma_f32_16x16x32_bf16 a[172:175], a[124:127], a[20:23], a[172:175]
    v_mfma_f32_16x16x32_bf16 a[172:175], a[120:123], a[16:19], a[172:175]
    v_mfma_f32_16x16x32_bf16 a[188:191], a[120:123], a[24:27], a[188:191]
    v_mfma_f32_16x16x32_bf16 a[188:191], a[124:127], a[28:31], a[188:191]
    v_mfma_f32_16x16x32_bf16 a[184:187], a[116:119], a[28:31], a[184:187]
    v_mfma_f32_16x16x32_bf16 a[184:187], a[112:115], a[24:27], a[184:187]
    buffer_load_dwordx4 v11, s[24:27], s36 offen offset:3072  lds
    v_mfma_f32_16x16x32_bf16 a[180:183], a[104:107], a[24:27], a[180:183]
    s_sub_u32 s36, s36, s18
    v_mfma_f32_16x16x32_bf16 a[180:183], a[108:111], a[28:31], a[180:183]
    s_add_u32 s36, s36, 256
    v_mfma_f32_16x16x32_bf16 a[176:179], a[100:103], a[28:31], a[176:179]
    s_waitcnt vmcnt(21) lgkmcnt(0)
    v_mfma_f32_16x16x32_bf16 a[176:179], a[96:99], a[24:27], a[176:179]
    s_barrier
    v_mfma_f32_16x16x32_bf16 v[64:67], a[64:67], a[0:3], v[64:67]
    ds_read_b128 a[32:35], v24 offset:49152
    v_mfma_f32_16x16x32_bf16 v[64:67], a[68:71], a[4:7], v[64:67]
    s_add_u32 m0, s41, 98304
    v_mfma_f32_16x16x32_bf16 v[68:71], a[76:79], a[4:7], v[68:71]
    ds_read_b128 a[36:39], v25 offset:49152
    v_mfma_f32_16x16x32_bf16 v[68:71], a[72:75], a[0:3], v[68:71]
    buffer_load_dwordx4 v12, s[28:31], s38 offen offset:0  lds
    v_mfma_f32_16x16x32_bf16 v[72:75], a[80:83], a[0:3], v[72:75]
    ds_read_b128 a[40:43], v24 offset:51200
    v_mfma_f32_16x16x32_bf16 v[72:75], a[84:87], a[4:7], v[72:75]
    v_mfma_f32_16x16x32_bf16 v[76:79], a[92:95], a[4:7], v[76:79]
    ds_read_b128 a[44:47], v25 offset:51200
    v_mfma_f32_16x16x32_bf16 v[76:79], a[88:91], a[0:3], v[76:79]
    v_mfma_f32_16x16x32_bf16 v[92:95], a[88:91], a[8:11], v[92:95]
    ds_read_b128 a[48:51], v24 offset:53248
    v_mfma_f32_16x16x32_bf16 v[92:95], a[92:95], a[12:15], v[92:95]
    v_mfma_f32_16x16x32_bf16 v[88:91], a[84:87], a[12:15], v[88:91]
    ds_read_b128 a[52:55], v25 offset:53248
    v_mfma_f32_16x16x32_bf16 v[88:91], a[80:83], a[8:11], v[88:91]
    buffer_load_dwordx4 v13, s[28:31], s38 offen offset:1024  lds
    v_mfma_f32_16x16x32_bf16 v[84:87], a[72:75], a[8:11], v[84:87]
    ds_read_b128 a[56:59], v24 offset:55296
    v_mfma_f32_16x16x32_bf16 v[84:87], a[76:79], a[12:15], v[84:87]
    v_mfma_f32_16x16x32_bf16 v[80:83], a[68:71], a[12:15], v[80:83]
    ds_read_b128 a[60:63], v25 offset:55296
    v_mfma_f32_16x16x32_bf16 v[80:83], a[64:67], a[8:11], v[80:83]
    v_mfma_f32_16x16x32_bf16 v[96:99], a[64:67], a[16:19], v[96:99]
    v_mfma_f32_16x16x32_bf16 v[96:99], a[68:71], a[20:23], v[96:99]
    v_mfma_f32_16x16x32_bf16 v[100:103], a[76:79], a[20:23], v[100:103]
    v_mfma_f32_16x16x32_bf16 v[100:103], a[72:75], a[16:19], v[100:103]
    buffer_load_dwordx4 v14, s[28:31], s38 offen offset:2048  lds
    v_mfma_f32_16x16x32_bf16 v[104:107], a[80:83], a[16:19], v[104:107]
    v_mfma_f32_16x16x32_bf16 v[104:107], a[84:87], a[20:23], v[104:107]
    v_mfma_f32_16x16x32_bf16 v[108:111], a[92:95], a[20:23], v[108:111]
    v_mfma_f32_16x16x32_bf16 v[108:111], a[88:91], a[16:19], v[108:111]
    v_mfma_f32_16x16x32_bf16 v[124:127], a[88:91], a[24:27], v[124:127]
    v_mfma_f32_16x16x32_bf16 v[124:127], a[92:95], a[28:31], v[124:127]
    v_mfma_f32_16x16x32_bf16 v[120:123], a[84:87], a[28:31], v[120:123]
    v_mfma_f32_16x16x32_bf16 v[120:123], a[80:83], a[24:27], v[120:123]
    buffer_load_dwordx4 v15, s[28:31], s38 offen offset:3072  lds
    v_mfma_f32_16x16x32_bf16 v[116:119], a[72:75], a[24:27], v[116:119]
    s_sub_u32 s38, s38, s19
    v_mfma_f32_16x16x32_bf16 v[116:119], a[76:79], a[28:31], v[116:119]
    s_add_u32 s38, s38, 1048576
    v_mfma_f32_16x16x32_bf16 v[112:115], a[68:71], a[28:31], v[112:115]
    s_waitcnt vmcnt(20) lgkmcnt(0)
    v_mfma_f32_16x16x32_bf16 v[112:115], a[64:67], a[24:27], v[112:115]
    s_barrier
    v_mfma_f32_16x16x32_bf16 v[128:131], a[64:67], a[32:35], v[128:131]
    ds_read_b128 a[0:3], v24 offset:0
    v_mfma_f32_16x16x32_bf16 v[128:131], a[68:71], a[36:39], v[128:131]
    s_add_u32 m0, s41, 114688
    v_mfma_f32_16x16x32_bf16 v[132:135], a[76:79], a[36:39], v[132:135]
    ds_read_b128 a[4:7], v25 offset:0
    v_mfma_f32_16x16x32_bf16 v[132:135], a[72:75], a[32:35], v[132:135]
    buffer_load_dwordx4 v12, s[28:31], s39 offen offset:0  lds
    v_mfma_f32_16x16x32_bf16 v[136:139], a[80:83], a[32:35], v[136:139]
    ds_read_b128 a[8:11], v24 offset:2048
    v_mfma_f32_16x16x32_bf16 v[136:139], a[84:87], a[36:39], v[136:139]
    v_mfma_f32_16x16x32_bf16 v[140:143], a[92:95], a[36:39], v[140:143]
    ds_read_b128 a[12:15], v25 offset:2048
    v_mfma_f32_16x16x32_bf16 v[140:143], a[88:91], a[32:35], v[140:143]
    v_mfma_f32_16x16x32_bf16 v[156:159], a[88:91], a[40:43], v[156:159]
    ds_read_b128 a[16:19], v24 offset:4096
    v_mfma_f32_16x16x32_bf16 v[156:159], a[92:95], a[44:47], v[156:159]
    v_mfma_f32_16x16x32_bf16 v[152:155], a[84:87], a[44:47], v[152:155]
    ds_read_b128 a[20:23], v25 offset:4096
    v_mfma_f32_16x16x32_bf16 v[152:155], a[80:83], a[40:43], v[152:155]
    buffer_load_dwordx4 v13, s[28:31], s39 offen offset:1024  lds
    v_mfma_f32_16x16x32_bf16 v[148:151], a[72:75], a[40:43], v[148:151]
    ds_read_b128 a[24:27], v24 offset:6144
    v_mfma_f32_16x16x32_bf16 v[148:151], a[76:79], a[44:47], v[148:151]
    v_mfma_f32_16x16x32_bf16 v[144:147], a[68:71], a[44:47], v[144:147]
    ds_read_b128 a[28:31], v25 offset:6144
    v_mfma_f32_16x16x32_bf16 v[144:147], a[64:67], a[40:43], v[144:147]
    v_mfma_f32_16x16x32_bf16 v[160:163], a[64:67], a[48:51], v[160:163]
    v_mfma_f32_16x16x32_bf16 v[160:163], a[68:71], a[52:55], v[160:163]
    v_mfma_f32_16x16x32_bf16 v[164:167], a[76:79], a[52:55], v[164:167]
    v_mfma_f32_16x16x32_bf16 v[164:167], a[72:75], a[48:51], v[164:167]
    buffer_load_dwordx4 v14, s[28:31], s39 offen offset:2048  lds
    v_mfma_f32_16x16x32_bf16 v[168:171], a[80:83], a[48:51], v[168:171]
    v_mfma_f32_16x16x32_bf16 v[168:171], a[84:87], a[52:55], v[168:171]
    v_mfma_f32_16x16x32_bf16 v[172:175], a[92:95], a[52:55], v[172:175]
    v_mfma_f32_16x16x32_bf16 v[172:175], a[88:91], a[48:51], v[172:175]
    v_mfma_f32_16x16x32_bf16 v[188:191], a[88:91], a[56:59], v[188:191]
    v_mfma_f32_16x16x32_bf16 v[188:191], a[92:95], a[60:63], v[188:191]
    v_mfma_f32_16x16x32_bf16 v[184:187], a[84:87], a[60:63], v[184:187]
    v_mfma_f32_16x16x32_bf16 v[184:187], a[80:83], a[56:59], v[184:187]
    buffer_load_dwordx4 v15, s[28:31], s39 offen offset:3072  lds
    v_mfma_f32_16x16x32_bf16 v[180:183], a[72:75], a[56:59], v[180:183]
    s_sub_u32 s39, s39, s19
    v_mfma_f32_16x16x32_bf16 v[180:183], a[76:79], a[60:63], v[180:183]
    s_add_u32 s39, s39, 1048576
    v_mfma_f32_16x16x32_bf16 v[176:179], a[68:71], a[60:63], v[176:179]
    s_waitcnt vmcnt(20) lgkmcnt(0)
    v_mfma_f32_16x16x32_bf16 v[176:179], a[64:67], a[56:59], v[176:179]
    s_barrier
    v_mfma_f32_16x16x32_bf16 v[192:195], a[96:99], a[32:35], v[192:195]
    ds_read_b64_tr_b16 a[64:65], v26 offset:0
    v_mfma_f32_16x16x32_bf16 v[192:195], a[100:103], a[36:39], v[192:195]
    s_add_u32 m0, s41, 49152
    ds_read_b64_tr_b16 a[66:67], v26 offset:1024
    v_mfma_f32_16x16x32_bf16 v[196:199], a[108:111], a[36:39], v[196:199]
    ds_read_b64_tr_b16 a[68:69], v26 offset:8192
    v_mfma_f32_16x16x32_bf16 v[196:199], a[104:107], a[32:35], v[196:199]
    buffer_load_dwordx4 v8, s[24:27], s37 offen offset:0  lds
    v_mfma_f32_16x16x32_bf16 v[200:203], a[112:115], a[32:35], v[200:203]
    ds_read_b64_tr_b16 a[70:71], v26 offset:9216
    v_mfma_f32_16x16x32_bf16 v[200:203], a[116:119], a[36:39], v[200:203]
    ds_read_b64_tr_b16 a[72:73], v27 offset:0
    v_mfma_f32_16x16x32_bf16 v[204:207], a[124:127], a[36:39], v[204:207]
    ds_read_b64_tr_b16 a[74:75], v27 offset:1024
    v_mfma_f32_16x16x32_bf16 v[204:207], a[120:123], a[32:35], v[204:207]
    ds_read_b64_tr_b16 a[76:77], v27 offset:8192
    v_mfma_f32_16x16x32_bf16 v[220:223], a[120:123], a[40:43], v[220:223]
    ds_read_b64_tr_b16 a[78:79], v27 offset:9216
    v_mfma_f32_16x16x32_bf16 v[220:223], a[124:127], a[44:47], v[220:223]
    ds_read_b64_tr_b16 a[80:81], v28 offset:0
    v_mfma_f32_16x16x32_bf16 v[216:219], a[116:119], a[44:47], v[216:219]
    ds_read_b64_tr_b16 a[82:83], v28 offset:1024
    v_mfma_f32_16x16x32_bf16 v[216:219], a[112:115], a[40:43], v[216:219]
    buffer_load_dwordx4 v9, s[24:27], s37 offen offset:1024  lds
    v_mfma_f32_16x16x32_bf16 v[212:215], a[104:107], a[40:43], v[212:215]
    ds_read_b64_tr_b16 a[84:85], v28 offset:8192
    v_mfma_f32_16x16x32_bf16 v[212:215], a[108:111], a[44:47], v[212:215]
    ds_read_b64_tr_b16 a[86:87], v28 offset:9216
    v_mfma_f32_16x16x32_bf16 v[208:211], a[100:103], a[44:47], v[208:211]
    ds_read_b64_tr_b16 a[88:89], v29 offset:0
    v_mfma_f32_16x16x32_bf16 v[208:211], a[96:99], a[40:43], v[208:211]
    ds_read_b64_tr_b16 a[90:91], v29 offset:1024
    v_mfma_f32_16x16x32_bf16 v[224:227], a[96:99], a[48:51], v[224:227]
    ds_read_b64_tr_b16 a[92:93], v29 offset:8192
    v_mfma_f32_16x16x32_bf16 v[224:227], a[100:103], a[52:55], v[224:227]
    ds_read_b64_tr_b16 a[94:95], v29 offset:9216
    v_mfma_f32_16x16x32_bf16 v[228:231], a[108:111], a[52:55], v[228:231]
    v_mfma_f32_16x16x32_bf16 v[228:231], a[104:107], a[48:51], v[228:231]
    buffer_load_dwordx4 v10, s[24:27], s37 offen offset:2048  lds
    v_mfma_f32_16x16x32_bf16 v[232:235], a[112:115], a[48:51], v[232:235]
    v_mfma_f32_16x16x32_bf16 v[232:235], a[116:119], a[52:55], v[232:235]
    v_mfma_f32_16x16x32_bf16 v[236:239], a[124:127], a[52:55], v[236:239]
    v_mfma_f32_16x16x32_bf16 v[236:239], a[120:123], a[48:51], v[236:239]
    v_mfma_f32_16x16x32_bf16 v[252:255], a[120:123], a[56:59], v[252:255]
    v_mfma_f32_16x16x32_bf16 v[252:255], a[124:127], a[60:63], v[252:255]
    v_mfma_f32_16x16x32_bf16 v[248:251], a[116:119], a[60:63], v[248:251]
    s_add_u32 s42, s42, 1
    v_mfma_f32_16x16x32_bf16 v[248:251], a[112:115], a[56:59], v[248:251]
    buffer_load_dwordx4 v11, s[24:27], s37 offen offset:3072  lds
    v_mfma_f32_16x16x32_bf16 v[244:247], a[104:107], a[56:59], v[244:247]
    s_sub_u32 s37, s37, s18
    v_mfma_f32_16x16x32_bf16 v[244:247], a[108:111], a[60:63], v[244:247]
    s_add_u32 s37, s37, 256
    s_cmp_lt_u32 s42, 7
    v_mfma_f32_16x16x32_bf16 v[240:243], a[100:103], a[60:63], v[240:243]
    s_waitcnt vmcnt(20) lgkmcnt(0)
    v_mfma_f32_16x16x32_bf16 v[240:243], a[96:99], a[56:59], v[240:243]
    s_barrier
    s_cbranch_scc1 K1_LOOP_K
    v_mov_b32 v8, v16
    v_mov_b32 v12, v20
    v_mov_b32 v9, v17
    v_mov_b32 v13, v21
    v_mov_b32 v10, v18
    v_mov_b32 v14, v22
    v_mov_b32 v11, v19
    v_mov_b32 v15, v23
    s_mov_b32 s24, s4
    s_and_b32 s25, s5, 0xffff
    s_mov_b32 s26, s58
    s_mov_b32 s28, s50
    s_mov_b32 s29, s51
    s_mov_b32 s30, s52
    s_mov_b32 s36, s53
    s_mov_b32 s37, s54
    s_mov_b32 s38, s55
    s_mov_b32 s39, s56
    s_mov_b32 s40, s57
    v_mfma_f32_16x16x32_bf16 a[128:131], a[64:67], a[0:3], a[128:131]
    s_mov_b32 s48, 0
    ds_read_b64_tr_b16 a[96:97], v26 offset:16384
    v_mfma_f32_16x16x32_bf16 a[128:131], a[68:71], a[4:7], a[128:131]
    s_add_u32 m0, s41, 0
    ds_read_b64_tr_b16 a[98:99], v26 offset:17408
    v_mfma_f32_16x16x32_bf16 a[132:135], a[76:79], a[4:7], a[132:135]
    s_mov_b32 s49, 1024
    ds_read_b64_tr_b16 a[100:101], v26 offset:24576
    v_mfma_f32_16x16x32_bf16 a[132:135], a[72:75], a[0:3], a[132:135]
    buffer_load_dwordx4 v8, s[24:27], s36 offen offset:0  lds
    v_mfma_f32_16x16x32_bf16 a[136:139], a[80:83], a[0:3], a[136:139]
    s_mov_b32 s50, 8192
    ds_read_b64_tr_b16 a[102:103], v26 offset:25600
    v_mfma_f32_16x16x32_bf16 a[136:139], a[84:87], a[4:7], a[136:139]
    s_mov_b32 s51, 9216
    ds_read_b64_tr_b16 a[104:105], v27 offset:16384
    v_mfma_f32_16x16x32_bf16 a[140:143], a[92:95], a[4:7], a[140:143]
    s_mov_b32 s52, 16384
    ds_read_b64_tr_b16 a[106:107], v27 offset:17408
    v_mfma_f32_16x16x32_bf16 a[140:143], a[88:91], a[0:3], a[140:143]
    s_mov_b32 s53, 17408
    ds_read_b64_tr_b16 a[108:109], v27 offset:24576
    v_mfma_f32_16x16x32_bf16 a[156:159], a[88:91], a[8:11], a[156:159]
    s_mov_b32 s54, 24576
    ds_read_b64_tr_b16 a[110:111], v27 offset:25600
    v_mfma_f32_16x16x32_bf16 a[156:159], a[92:95], a[12:15], a[156:159]
    s_mov_b32 s55, 25600
    ds_read_b64_tr_b16 a[112:113], v28 offset:16384
    v_mfma_f32_16x16x32_bf16 a[152:155], a[84:87], a[12:15], a[152:155]
    s_add_u32 s56, s43, 0
    ds_read_b64_tr_b16 a[114:115], v28 offset:17408
    v_mfma_f32_16x16x32_bf16 a[152:155], a[80:83], a[8:11], a[152:155]
    buffer_load_dwordx4 v9, s[24:27], s36 offen offset:1024  lds
    v_mfma_f32_16x16x32_bf16 a[148:151], a[72:75], a[8:11], a[148:151]
    s_add_u32 s57, s43, 4096
    ds_read_b64_tr_b16 a[116:117], v28 offset:24576
    v_mfma_f32_16x16x32_bf16 a[148:151], a[76:79], a[12:15], a[148:151]
    s_add_u32 s58, s43, 69632
    ds_read_b64_tr_b16 a[118:119], v28 offset:25600
    v_mfma_f32_16x16x32_bf16 a[144:147], a[68:71], a[12:15], a[144:147]
    s_add_u32 s59, s43, 65536
    ds_read_b64_tr_b16 a[120:121], v29 offset:16384
    v_mfma_f32_16x16x32_bf16 a[144:147], a[64:67], a[8:11], a[144:147]
    ds_read_b64_tr_b16 a[122:123], v29 offset:17408
    v_mfma_f32_16x16x32_bf16 a[160:163], a[64:67], a[16:19], a[160:163]
    ds_read_b64_tr_b16 a[124:125], v29 offset:24576
    v_mfma_f32_16x16x32_bf16 a[160:163], a[68:71], a[20:23], a[160:163]
    ds_read_b64_tr_b16 a[126:127], v29 offset:25600
    v_mfma_f32_16x16x32_bf16 a[164:167], a[76:79], a[20:23], a[164:167]
    v_mfma_f32_16x16x32_bf16 a[164:167], a[72:75], a[16:19], a[164:167]
    buffer_load_dwordx4 v10, s[24:27], s36 offen offset:2048  lds
    v_mfma_f32_16x16x32_bf16 a[168:171], a[80:83], a[16:19], a[168:171]
    v_mfma_f32_16x16x32_bf16 a[168:171], a[84:87], a[20:23], a[168:171]
    v_mfma_f32_16x16x32_bf16 a[172:175], a[92:95], a[20:23], a[172:175]
    v_mfma_f32_16x16x32_bf16 a[172:175], a[88:91], a[16:19], a[172:175]
    v_mfma_f32_16x16x32_bf16 a[188:191], a[88:91], a[24:27], a[188:191]
    v_mfma_f32_16x16x32_bf16 a[188:191], a[92:95], a[28:31], a[188:191]
    v_mfma_f32_16x16x32_bf16 a[184:187], a[84:87], a[28:31], a[184:187]
    v_mfma_f32_16x16x32_bf16 a[184:187], a[80:83], a[24:27], a[184:187]
    buffer_load_dwordx4 v11, s[24:27], s36 offen offset:3072  lds
    v_mfma_f32_16x16x32_bf16 a[180:183], a[72:75], a[24:27], a[180:183]
    s_add_u32 s36, s36, 128
    v_mfma_f32_16x16x32_bf16 a[180:183], a[76:79], a[28:31], a[180:183]
    v_mfma_f32_16x16x32_bf16 a[176:179], a[68:71], a[28:31], a[176:179]
    s_waitcnt vmcnt(20) lgkmcnt(0)
    v_mfma_f32_16x16x32_bf16 a[176:179], a[64:67], a[24:27], a[176:179]
    s_barrier
    v_mfma_f32_16x16x32_bf16 v[64:67], a[96:99], a[0:3], v[64:67]
    ds_read_b128 a[32:35], v24 offset:16384
    v_mfma_f32_16x16x32_bf16 v[64:67], a[100:103], a[4:7], v[64:67]
    s_add_u32 m0, s41, 65536
    v_mfma_f32_16x16x32_bf16 v[68:71], a[108:111], a[4:7], v[68:71]
    ds_read_b128 a[36:39], v25 offset:16384
    v_mfma_f32_16x16x32_bf16 v[68:71], a[104:107], a[0:3], v[68:71]
    buffer_load_dwordx4 v12, s[28:31], s38 offen offset:0  lds
    v_mfma_f32_16x16x32_bf16 v[72:75], a[112:115], a[0:3], v[72:75]
    ds_read_b128 a[40:43], v24 offset:18432
    v_mfma_f32_16x16x32_bf16 v[72:75], a[116:119], a[4:7], v[72:75]
    v_mfma_f32_16x16x32_bf16 v[76:79], a[124:127], a[4:7], v[76:79]
    ds_read_b128 a[44:47], v25 offset:18432
    v_mfma_f32_16x16x32_bf16 v[76:79], a[120:123], a[0:3], v[76:79]
    v_mfma_f32_16x16x32_bf16 v[92:95], a[120:123], a[8:11], v[92:95]
    ds_read_b128 a[48:51], v24 offset:20480
    v_mfma_f32_16x16x32_bf16 v[92:95], a[124:127], a[12:15], v[92:95]
    v_mfma_f32_16x16x32_bf16 v[88:91], a[116:119], a[12:15], v[88:91]
    ds_read_b128 a[52:55], v25 offset:20480
    v_mfma_f32_16x16x32_bf16 v[88:91], a[112:115], a[8:11], v[88:91]
    buffer_load_dwordx4 v13, s[28:31], s38 offen offset:1024  lds
    v_mfma_f32_16x16x32_bf16 v[84:87], a[104:107], a[8:11], v[84:87]
    ds_read_b128 a[56:59], v24 offset:22528
    v_mfma_f32_16x16x32_bf16 v[84:87], a[108:111], a[12:15], v[84:87]
    v_mfma_f32_16x16x32_bf16 v[80:83], a[100:103], a[12:15], v[80:83]
    ds_read_b128 a[60:63], v25 offset:22528
    v_mfma_f32_16x16x32_bf16 v[80:83], a[96:99], a[8:11], v[80:83]
    v_mfma_f32_16x16x32_bf16 v[96:99], a[96:99], a[16:19], v[96:99]
    v_mfma_f32_16x16x32_bf16 v[96:99], a[100:103], a[20:23], v[96:99]
    v_mfma_f32_16x16x32_bf16 v[100:103], a[108:111], a[20:23], v[100:103]
    v_mfma_f32_16x16x32_bf16 v[100:103], a[104:107], a[16:19], v[100:103]
    buffer_load_dwordx4 v14, s[28:31], s38 offen offset:2048  lds
    v_mfma_f32_16x16x32_bf16 v[104:107], a[112:115], a[16:19], v[104:107]
    v_mfma_f32_16x16x32_bf16 v[104:107], a[116:119], a[20:23], v[104:107]
    v_mfma_f32_16x16x32_bf16 v[108:111], a[124:127], a[20:23], v[108:111]
    v_mfma_f32_16x16x32_bf16 v[108:111], a[120:123], a[16:19], v[108:111]
    v_mfma_f32_16x16x32_bf16 v[124:127], a[120:123], a[24:27], v[124:127]
    v_mfma_f32_16x16x32_bf16 v[124:127], a[124:127], a[28:31], v[124:127]
    v_mfma_f32_16x16x32_bf16 v[120:123], a[116:119], a[28:31], v[120:123]
    v_mfma_f32_16x16x32_bf16 v[120:123], a[112:115], a[24:27], v[120:123]
    buffer_load_dwordx4 v15, s[28:31], s38 offen offset:3072  lds
    v_mfma_f32_16x16x32_bf16 v[116:119], a[104:107], a[24:27], v[116:119]
    s_add_u32 s38, s38, s40
    v_mfma_f32_16x16x32_bf16 v[116:119], a[108:111], a[28:31], v[116:119]
    v_mfma_f32_16x16x32_bf16 v[112:115], a[100:103], a[28:31], v[112:115]
    s_waitcnt vmcnt(20) lgkmcnt(0)
    v_mfma_f32_16x16x32_bf16 v[112:115], a[96:99], a[24:27], v[112:115]
    s_barrier
    v_mfma_f32_16x16x32_bf16 v[128:131], a[96:99], a[32:35], v[128:131]
    ds_read_b128 a[0:3], v24 offset:32768
    v_mfma_f32_16x16x32_bf16 v[128:131], a[100:103], a[36:39], v[128:131]
    s_add_u32 m0, s41, 81920
    v_mfma_f32_16x16x32_bf16 v[132:135], a[108:111], a[36:39], v[132:135]
    ds_read_b128 a[4:7], v25 offset:32768
    v_mfma_f32_16x16x32_bf16 v[132:135], a[104:107], a[32:35], v[132:135]
    buffer_load_dwordx4 v12, s[28:31], s39 offen offset:0  lds
    v_mfma_f32_16x16x32_bf16 v[136:139], a[112:115], a[32:35], v[136:139]
    ds_read_b128 a[8:11], v24 offset:34816
    v_mfma_f32_16x16x32_bf16 v[136:139], a[116:119], a[36:39], v[136:139]
    v_mfma_f32_16x16x32_bf16 v[140:143], a[124:127], a[36:39], v[140:143]
    ds_read_b128 a[12:15], v25 offset:34816
    v_mfma_f32_16x16x32_bf16 v[140:143], a[120:123], a[32:35], v[140:143]
    v_mfma_f32_16x16x32_bf16 v[156:159], a[120:123], a[40:43], v[156:159]
    ds_read_b128 a[16:19], v24 offset:36864
    v_mfma_f32_16x16x32_bf16 v[156:159], a[124:127], a[44:47], v[156:159]
    v_mfma_f32_16x16x32_bf16 v[152:155], a[116:119], a[44:47], v[152:155]
    ds_read_b128 a[20:23], v25 offset:36864
    v_mfma_f32_16x16x32_bf16 v[152:155], a[112:115], a[40:43], v[152:155]
    buffer_load_dwordx4 v13, s[28:31], s39 offen offset:1024  lds
    v_mfma_f32_16x16x32_bf16 v[148:151], a[104:107], a[40:43], v[148:151]
    ds_read_b128 a[24:27], v24 offset:38912
    v_mfma_f32_16x16x32_bf16 v[148:151], a[108:111], a[44:47], v[148:151]
    v_mfma_f32_16x16x32_bf16 v[144:147], a[100:103], a[44:47], v[144:147]
    ds_read_b128 a[28:31], v25 offset:38912
    v_mfma_f32_16x16x32_bf16 v[144:147], a[96:99], a[40:43], v[144:147]
    v_mfma_f32_16x16x32_bf16 v[160:163], a[96:99], a[48:51], v[160:163]
    v_mfma_f32_16x16x32_bf16 v[160:163], a[100:103], a[52:55], v[160:163]
    v_mfma_f32_16x16x32_bf16 v[164:167], a[108:111], a[52:55], v[164:167]
    v_mfma_f32_16x16x32_bf16 v[164:167], a[104:107], a[48:51], v[164:167]
    buffer_load_dwordx4 v14, s[28:31], s39 offen offset:2048  lds
    v_mfma_f32_16x16x32_bf16 v[168:171], a[112:115], a[48:51], v[168:171]
    v_mfma_f32_16x16x32_bf16 v[168:171], a[116:119], a[52:55], v[168:171]
    v_mfma_f32_16x16x32_bf16 v[172:175], a[124:127], a[52:55], v[172:175]
    v_mfma_f32_16x16x32_bf16 v[172:175], a[120:123], a[48:51], v[172:175]
    v_mfma_f32_16x16x32_bf16 v[188:191], a[120:123], a[56:59], v[188:191]
    v_mfma_f32_16x16x32_bf16 v[188:191], a[124:127], a[60:63], v[188:191]
    v_mfma_f32_16x16x32_bf16 v[184:187], a[116:119], a[60:63], v[184:187]
    v_mfma_f32_16x16x32_bf16 v[184:187], a[112:115], a[56:59], v[184:187]
    buffer_load_dwordx4 v15, s[28:31], s39 offen offset:3072  lds
    v_mfma_f32_16x16x32_bf16 v[180:183], a[104:107], a[56:59], v[180:183]
    s_add_u32 s39, s39, s40
    v_mfma_f32_16x16x32_bf16 v[180:183], a[108:111], a[60:63], v[180:183]
    v_mfma_f32_16x16x32_bf16 v[176:179], a[100:103], a[60:63], v[176:179]
    s_waitcnt vmcnt(20) lgkmcnt(0)
    v_mfma_f32_16x16x32_bf16 v[176:179], a[96:99], a[56:59], v[176:179]
    s_barrier
    v_mfma_f32_16x16x32_bf16 v[192:195], a[64:67], a[32:35], v[192:195]
    ds_read_b64_tr_b16 a[96:97], v26 offset:32768
    v_mfma_f32_16x16x32_bf16 v[192:195], a[68:71], a[36:39], v[192:195]
    s_add_u32 m0, s41, 16384
    ds_read_b64_tr_b16 a[98:99], v26 offset:33792
    v_mfma_f32_16x16x32_bf16 v[196:199], a[76:79], a[36:39], v[196:199]
    ds_read_b64_tr_b16 a[100:101], v26 offset:40960
    v_mfma_f32_16x16x32_bf16 v[196:199], a[72:75], a[32:35], v[196:199]
    buffer_load_dwordx4 v8, s[24:27], s37 offen offset:0  lds
    v_mfma_f32_16x16x32_bf16 v[200:203], a[80:83], a[32:35], v[200:203]
    ds_read_b64_tr_b16 a[102:103], v26 offset:41984
    v_mfma_f32_16x16x32_bf16 v[200:203], a[84:87], a[36:39], v[200:203]
    ds_read_b64_tr_b16 a[104:105], v27 offset:32768
    v_mfma_f32_16x16x32_bf16 v[204:207], a[92:95], a[36:39], v[204:207]
    ds_read_b64_tr_b16 a[106:107], v27 offset:33792
    v_mfma_f32_16x16x32_bf16 v[204:207], a[88:91], a[32:35], v[204:207]
    ds_read_b64_tr_b16 a[108:109], v27 offset:40960
    v_mfma_f32_16x16x32_bf16 v[220:223], a[88:91], a[40:43], v[220:223]
    ds_read_b64_tr_b16 a[110:111], v27 offset:41984
    v_mfma_f32_16x16x32_bf16 v[220:223], a[92:95], a[44:47], v[220:223]
    ds_read_b64_tr_b16 a[112:113], v28 offset:32768
    v_mfma_f32_16x16x32_bf16 v[216:219], a[84:87], a[44:47], v[216:219]
    ds_read_b64_tr_b16 a[114:115], v28 offset:33792
    v_mfma_f32_16x16x32_bf16 v[216:219], a[80:83], a[40:43], v[216:219]
    buffer_load_dwordx4 v9, s[24:27], s37 offen offset:1024  lds
    v_mfma_f32_16x16x32_bf16 v[212:215], a[72:75], a[40:43], v[212:215]
    ds_read_b64_tr_b16 a[116:117], v28 offset:40960
    v_mfma_f32_16x16x32_bf16 v[212:215], a[76:79], a[44:47], v[212:215]
    ds_read_b64_tr_b16 a[118:119], v28 offset:41984
    v_mfma_f32_16x16x32_bf16 v[208:211], a[68:71], a[44:47], v[208:211]
    ds_read_b64_tr_b16 a[120:121], v29 offset:32768
    v_mfma_f32_16x16x32_bf16 v[208:211], a[64:67], a[40:43], v[208:211]
    ds_read_b64_tr_b16 a[122:123], v29 offset:33792
    v_mfma_f32_16x16x32_bf16 v[224:227], a[64:67], a[48:51], v[224:227]
    ds_read_b64_tr_b16 a[124:125], v29 offset:40960
    v_mfma_f32_16x16x32_bf16 v[224:227], a[68:71], a[52:55], v[224:227]
    ds_read_b64_tr_b16 a[126:127], v29 offset:41984
    v_mfma_f32_16x16x32_bf16 v[228:231], a[76:79], a[52:55], v[228:231]
    v_mfma_f32_16x16x32_bf16 v[228:231], a[72:75], a[48:51], v[228:231]
    buffer_load_dwordx4 v10, s[24:27], s37 offen offset:2048  lds
    v_mfma_f32_16x16x32_bf16 v[232:235], a[80:83], a[48:51], v[232:235]
    v_mfma_f32_16x16x32_bf16 v[232:235], a[84:87], a[52:55], v[232:235]
    v_mfma_f32_16x16x32_bf16 v[236:239], a[92:95], a[52:55], v[236:239]
    v_mfma_f32_16x16x32_bf16 v[236:239], a[88:91], a[48:51], v[236:239]
    v_mfma_f32_16x16x32_bf16 v[252:255], a[88:91], a[56:59], v[252:255]
    v_mfma_f32_16x16x32_bf16 v[252:255], a[92:95], a[60:63], v[252:255]
    v_mfma_f32_16x16x32_bf16 v[248:251], a[84:87], a[60:63], v[248:251]
    v_mfma_f32_16x16x32_bf16 v[248:251], a[80:83], a[56:59], v[248:251]
    buffer_load_dwordx4 v11, s[24:27], s37 offen offset:3072  lds
    v_mfma_f32_16x16x32_bf16 v[244:247], a[72:75], a[56:59], v[244:247]
    s_add_u32 s37, s37, 128
    v_mfma_f32_16x16x32_bf16 v[244:247], a[76:79], a[60:63], v[244:247]
    v_mfma_f32_16x16x32_bf16 v[240:243], a[68:71], a[60:63], v[240:243]
    s_waitcnt vmcnt(20) lgkmcnt(0)
    v_mfma_f32_16x16x32_bf16 v[240:243], a[64:67], a[56:59], v[240:243]
    s_barrier
    v_mfma_f32_16x16x32_bf16 a[128:131], a[96:99], a[0:3], a[128:131]
    ds_read_b64_tr_b16 a[64:65], v26 offset:49152
    v_mfma_f32_16x16x32_bf16 a[128:131], a[100:103], a[4:7], a[128:131]
    s_add_u32 m0, s41, 32768
    ds_read_b64_tr_b16 a[66:67], v26 offset:50176
    v_mfma_f32_16x16x32_bf16 a[132:135], a[108:111], a[4:7], a[132:135]
    ds_read_b64_tr_b16 a[68:69], v26 offset:57344
    v_mfma_f32_16x16x32_bf16 a[132:135], a[104:107], a[0:3], a[132:135]
    buffer_load_dwordx4 v8, s[24:27], s36 offen offset:0  lds
    v_mfma_f32_16x16x32_bf16 a[136:139], a[112:115], a[0:3], a[136:139]
    ds_read_b64_tr_b16 a[70:71], v26 offset:58368
    v_mfma_f32_16x16x32_bf16 a[136:139], a[116:119], a[4:7], a[136:139]
    ds_read_b64_tr_b16 a[72:73], v27 offset:49152
    v_mfma_f32_16x16x32_bf16 a[140:143], a[124:127], a[4:7], a[140:143]
    ds_read_b64_tr_b16 a[74:75], v27 offset:50176
    v_mfma_f32_16x16x32_bf16 a[140:143], a[120:123], a[0:3], a[140:143]
    ds_read_b64_tr_b16 a[76:77], v27 offset:57344
    v_mfma_f32_16x16x32_bf16 a[156:159], a[120:123], a[8:11], a[156:159]
    ds_read_b64_tr_b16 a[78:79], v27 offset:58368
    v_mfma_f32_16x16x32_bf16 a[156:159], a[124:127], a[12:15], a[156:159]
    ds_read_b64_tr_b16 a[80:81], v28 offset:49152
    v_mfma_f32_16x16x32_bf16 a[152:155], a[116:119], a[12:15], a[152:155]
    ds_read_b64_tr_b16 a[82:83], v28 offset:50176
    v_mfma_f32_16x16x32_bf16 a[152:155], a[112:115], a[8:11], a[152:155]
    buffer_load_dwordx4 v9, s[24:27], s36 offen offset:1024  lds
    v_mfma_f32_16x16x32_bf16 a[148:151], a[104:107], a[8:11], a[148:151]
    ds_read_b64_tr_b16 a[84:85], v28 offset:57344
    v_mfma_f32_16x16x32_bf16 a[148:151], a[108:111], a[12:15], a[148:151]
    ds_read_b64_tr_b16 a[86:87], v28 offset:58368
    v_mfma_f32_16x16x32_bf16 a[144:147], a[100:103], a[12:15], a[144:147]
    ds_read_b64_tr_b16 a[88:89], v29 offset:49152
    v_mfma_f32_16x16x32_bf16 a[144:147], a[96:99], a[8:11], a[144:147]
    ds_read_b64_tr_b16 a[90:91], v29 offset:50176
    v_mfma_f32_16x16x32_bf16 a[160:163], a[96:99], a[16:19], a[160:163]
    ds_read_b64_tr_b16 a[92:93], v29 offset:57344
    v_mfma_f32_16x16x32_bf16 a[160:163], a[100:103], a[20:23], a[160:163]
    ds_read_b64_tr_b16 a[94:95], v29 offset:58368
    v_mfma_f32_16x16x32_bf16 a[164:167], a[108:111], a[20:23], a[164:167]
    v_mfma_f32_16x16x32_bf16 a[164:167], a[104:107], a[16:19], a[164:167]
    buffer_load_dwordx4 v10, s[24:27], s36 offen offset:2048  lds
    v_mfma_f32_16x16x32_bf16 a[168:171], a[112:115], a[16:19], a[168:171]
    v_mfma_f32_16x16x32_bf16 a[168:171], a[116:119], a[20:23], a[168:171]
    v_mfma_f32_16x16x32_bf16 a[172:175], a[124:127], a[20:23], a[172:175]
    v_mfma_f32_16x16x32_bf16 a[172:175], a[120:123], a[16:19], a[172:175]
    v_mfma_f32_16x16x32_bf16 a[188:191], a[120:123], a[24:27], a[188:191]
    v_mfma_f32_16x16x32_bf16 a[188:191], a[124:127], a[28:31], a[188:191]
    v_mfma_f32_16x16x32_bf16 a[184:187], a[116:119], a[28:31], a[184:187]
    v_mfma_f32_16x16x32_bf16 a[184:187], a[112:115], a[24:27], a[184:187]
    buffer_load_dwordx4 v11, s[24:27], s36 offen offset:3072  lds
    v_mfma_f32_16x16x32_bf16 a[180:183], a[104:107], a[24:27], a[180:183]
    s_add_u32 s36, s36, 128
    v_mfma_f32_16x16x32_bf16 a[180:183], a[108:111], a[28:31], a[180:183]
    v_mfma_f32_16x16x32_bf16 a[176:179], a[100:103], a[28:31], a[176:179]
    s_waitcnt vmcnt(20) lgkmcnt(0)
    v_mfma_f32_16x16x32_bf16 a[176:179], a[96:99], a[24:27], a[176:179]
    s_barrier
    v_mfma_f32_16x16x32_bf16 v[64:67], a[64:67], a[0:3], v[64:67]
    ds_read_b128 a[32:35], v24 offset:49152
    v_mfma_f32_16x16x32_bf16 v[64:67], a[68:71], a[4:7], v[64:67]
    s_add_u32 m0, s41, 98304
    v_mfma_f32_16x16x32_bf16 v[68:71], a[76:79], a[4:7], v[68:71]
    ds_read_b128 a[36:39], v25 offset:49152
    v_mfma_f32_16x16x32_bf16 v[68:71], a[72:75], a[0:3], v[68:71]
    buffer_load_dwordx4 v12, s[28:31], s38 offen offset:0  lds
    v_mfma_f32_16x16x32_bf16 v[72:75], a[80:83], a[0:3], v[72:75]
    ds_read_b128 a[40:43], v24 offset:51200
    v_accvgpr_read_b32 v32, a128
    v_mfma_f32_16x16x32_bf16 v[72:75], a[84:87], a[4:7], v[72:75]
    v_accvgpr_read_b32 v33, a129
    v_cvt_pk_bf16_f32 v32, v32, v33
    v_mfma_f32_16x16x32_bf16 v[76:79], a[92:95], a[4:7], v[76:79]
    ds_read_b128 a[44:47], v25 offset:51200
    v_accvgpr_read_b32 v34, a130
    v_mfma_f32_16x16x32_bf16 v[76:79], a[88:91], a[0:3], v[76:79]
    v_accvgpr_read_b32 v35, a131
    v_cvt_pk_bf16_f32 v33, v34, v35
    v_mfma_f32_16x16x32_bf16 v[92:95], a[88:91], a[8:11], v[92:95]
    ds_read_b128 a[48:51], v24 offset:53248
    v_accvgpr_read_b32 v34, a132
    v_mfma_f32_16x16x32_bf16 v[92:95], a[92:95], a[12:15], v[92:95]
    v_accvgpr_read_b32 v35, a133
    v_cvt_pk_bf16_f32 v34, v34, v35
    v_mfma_f32_16x16x32_bf16 v[88:91], a[84:87], a[12:15], v[88:91]
    ds_read_b128 a[52:55], v25 offset:53248
    v_accvgpr_read_b32 v4, a134
    v_mfma_f32_16x16x32_bf16 v[88:91], a[80:83], a[8:11], v[88:91]
    buffer_load_dwordx4 v13, s[28:31], s38 offen offset:1024  lds
    v_mfma_f32_16x16x32_bf16 v[84:87], a[72:75], a[8:11], v[84:87]
    ds_read_b128 a[56:59], v24 offset:55296
    v_accvgpr_read_b32 v5, a135
    v_mfma_f32_16x16x32_bf16 v[84:87], a[76:79], a[12:15], v[84:87]
    v_cvt_pk_bf16_f32 v35, v4, v5
    v_accvgpr_read_b32 v36, a136
    v_mfma_f32_16x16x32_bf16 v[80:83], a[68:71], a[12:15], v[80:83]
    ds_read_b128 a[60:63], v25 offset:55296
    v_accvgpr_read_b32 v37, a137
    v_mfma_f32_16x16x32_bf16 v[80:83], a[64:67], a[8:11], v[80:83]
    v_cvt_pk_bf16_f32 v36, v36, v37
    v_accvgpr_read_b32 v38, a138
    v_mfma_f32_16x16x32_bf16 v[96:99], a[64:67], a[16:19], v[96:99]
    v_accvgpr_read_b32 v39, a139
    v_cvt_pk_bf16_f32 v37, v38, v39
    v_mfma_f32_16x16x32_bf16 v[96:99], a[68:71], a[20:23], v[96:99]
    v_accvgpr_read_b32 v38, a140
    v_accvgpr_read_b32 v39, a141
    v_mfma_f32_16x16x32_bf16 v[100:103], a[76:79], a[20:23], v[100:103]
    v_cvt_pk_bf16_f32 v38, v38, v39
    v_accvgpr_read_b32 v6, a142
    v_mfma_f32_16x16x32_bf16 v[100:103], a[72:75], a[16:19], v[100:103]
    buffer_load_dwordx4 v14, s[28:31], s38 offen offset:2048  lds
    v_mfma_f32_16x16x32_bf16 v[104:107], a[80:83], a[16:19], v[104:107]
    v_accvgpr_read_b32 v7, a143
    v_cvt_pk_bf16_f32 v39, v6, v7
    v_mfma_f32_16x16x32_bf16 v[104:107], a[84:87], a[20:23], v[104:107]
    v_accvgpr_read_b32 v40, a144
    v_accvgpr_read_b32 v41, a145
    v_mfma_f32_16x16x32_bf16 v[108:111], a[92:95], a[20:23], v[108:111]
    v_cvt_pk_bf16_f32 v40, v40, v41
    v_accvgpr_read_b32 v42, a146
    v_mfma_f32_16x16x32_bf16 v[108:111], a[88:91], a[16:19], v[108:111]
    v_accvgpr_read_b32 v43, a147
    v_cvt_pk_bf16_f32 v41, v42, v43
    v_mfma_f32_16x16x32_bf16 v[124:127], a[88:91], a[24:27], v[124:127]
    v_accvgpr_read_b32 v42, a148
    v_accvgpr_read_b32 v43, a149
    v_mfma_f32_16x16x32_bf16 v[124:127], a[92:95], a[28:31], v[124:127]
    v_cvt_pk_bf16_f32 v42, v42, v43
    v_accvgpr_read_b32 v4, a150
    v_mfma_f32_16x16x32_bf16 v[120:123], a[84:87], a[28:31], v[120:123]
    v_accvgpr_read_b32 v5, a151
    v_cvt_pk_bf16_f32 v43, v4, v5
    v_mfma_f32_16x16x32_bf16 v[120:123], a[80:83], a[24:27], v[120:123]
    buffer_load_dwordx4 v15, s[28:31], s38 offen offset:3072  lds
    v_mfma_f32_16x16x32_bf16 v[116:119], a[72:75], a[24:27], v[116:119]
    s_add_u32 s38, s38, s40
    v_accvgpr_read_b32 v44, a152
    v_accvgpr_read_b32 v45, a153
    v_mfma_f32_16x16x32_bf16 v[116:119], a[76:79], a[28:31], v[116:119]
    v_cvt_pk_bf16_f32 v44, v44, v45
    v_accvgpr_read_b32 v46, a154
    v_mfma_f32_16x16x32_bf16 v[112:115], a[68:71], a[28:31], v[112:115]
    s_waitcnt vmcnt(20) lgkmcnt(0)
    v_accvgpr_read_b32 v47, a155
    v_cvt_pk_bf16_f32 v45, v46, v47
    v_mfma_f32_16x16x32_bf16 v[112:115], a[64:67], a[24:27], v[112:115]
    s_barrier
    v_accvgpr_read_b32 v46, a156
    v_accvgpr_read_b32 v47, a157
    v_mfma_f32_16x16x32_bf16 v[128:131], a[64:67], a[32:35], v[128:131]
    ds_read_b128 a[0:3], v24 offset:0
    v_cvt_pk_bf16_f32 v46, v46, v47
    v_mfma_f32_16x16x32_bf16 v[128:131], a[68:71], a[36:39], v[128:131]
    s_add_u32 m0, s41, 114688
    v_accvgpr_read_b32 v6, a158
    v_mfma_f32_16x16x32_bf16 v[132:135], a[76:79], a[36:39], v[132:135]
    ds_read_b128 a[4:7], v25 offset:0
    v_accvgpr_read_b32 v7, a159
    v_mfma_f32_16x16x32_bf16 v[132:135], a[72:75], a[32:35], v[132:135]
    buffer_load_dwordx4 v12, s[28:31], s39 offen offset:0  lds
    v_mfma_f32_16x16x32_bf16 v[136:139], a[80:83], a[32:35], v[136:139]
    s_add_u32 s60, s57, s48
    ds_read_b128 a[8:11], v24 offset:2048
    v_cvt_pk_bf16_f32 v64, v64, v65
    v_mfma_f32_16x16x32_bf16 v[136:139], a[84:87], a[36:39], v[136:139]
    s_add_u32 s61, s57, s49
    v_cvt_pk_bf16_f32 v65, v66, v67
    v_cvt_pk_bf16_f32 v66, v68, v69
    v_mfma_f32_16x16x32_bf16 v[140:143], a[92:95], a[36:39], v[140:143]
    s_add_u32 s64, s57, s50
    ds_read_b128 a[12:15], v25 offset:2048
    v_cvt_pk_bf16_f32 v67, v70, v71
    v_mfma_f32_16x16x32_bf16 v[140:143], a[88:91], a[32:35], v[140:143]
    buffer_store_dwordx4 v[64:67], v30, s[32:35], s60 offen sc1
    v_mfma_f32_16x16x32_bf16 v[156:159], a[88:91], a[40:43], v[156:159]
    s_add_u32 s65, s57, s51
    ds_read_b128 a[16:19], v24 offset:4096
    v_cvt_pk_bf16_f32 v72, v72, v73
    v_mfma_f32_16x16x32_bf16 v[156:159], a[92:95], a[44:47], v[156:159]
    s_add_u32 s60, s57, s52
    v_cvt_pk_bf16_f32 v73, v74, v75
    v_cvt_pk_bf16_f32 v74, v76, v77
    v_mfma_f32_16x16x32_bf16 v[152:155], a[84:87], a[44:47], v[152:155]
    ds_read_b128 a[20:23], v25 offset:4096
    v_cvt_pk_bf16_f32 v75, v78, v79
    v_mfma_f32_16x16x32_bf16 v[152:155], a[80:83], a[40:43], v[152:155]
    buffer_load_dwordx4 v13, s[28:31], s39 offen offset:1024  lds
    v_mfma_f32_16x16x32_bf16 v[148:151], a[72:75], a[40:43], v[148:151]
    ds_read_b128 a[24:27], v24 offset:6144
    v_cvt_pk_bf16_f32 v80, v80, v81
    v_mfma_f32_16x16x32_bf16 v[148:151], a[76:79], a[44:47], v[148:151]
    buffer_store_dwordx4 v[72:75], v30, s[32:35], s61 offen sc1
    v_mfma_f32_16x16x32_bf16 v[144:147], a[68:71], a[44:47], v[144:147]
    s_add_u32 s61, s57, s53
    ds_read_b128 a[28:31], v25 offset:6144
    v_cvt_pk_bf16_f32 v81, v82, v83
    v_mfma_f32_16x16x32_bf16 v[144:147], a[64:67], a[40:43], v[144:147]
    v_cvt_pk_bf16_f32 v82, v84, v85
    v_cvt_pk_bf16_f32 v83, v86, v87
    v_mfma_f32_16x16x32_bf16 v[160:163], a[64:67], a[48:51], v[160:163]
    buffer_store_dwordx4 v[80:83], v30, s[32:35], s64 offen sc1
    v_mfma_f32_16x16x32_bf16 v[160:163], a[68:71], a[52:55], v[160:163]
    s_add_u32 s64, s57, s54
    v_cvt_pk_bf16_f32 v88, v88, v89
    v_cvt_pk_bf16_f32 v89, v90, v91
    v_mfma_f32_16x16x32_bf16 v[164:167], a[76:79], a[52:55], v[164:167]
    v_cvt_pk_bf16_f32 v90, v92, v93
    v_cvt_pk_bf16_f32 v91, v94, v95
    v_mfma_f32_16x16x32_bf16 v[164:167], a[72:75], a[48:51], v[164:167]
    buffer_load_dwordx4 v14, s[28:31], s39 offen offset:2048  lds
    v_mfma_f32_16x16x32_bf16 v[168:171], a[80:83], a[48:51], v[168:171]
    buffer_store_dwordx4 v[88:91], v30, s[32:35], s65 offen sc1
    v_mfma_f32_16x16x32_bf16 v[168:171], a[84:87], a[52:55], v[168:171]
    s_add_u32 s65, s57, s55
    v_cvt_pk_bf16_f32 v96, v96, v97
    v_cvt_pk_bf16_f32 v97, v98, v99
    v_mfma_f32_16x16x32_bf16 v[172:175], a[92:95], a[52:55], v[172:175]
    v_cvt_pk_bf16_f32 v98, v100, v101
    v_cvt_pk_bf16_f32 v99, v102, v103
    v_mfma_f32_16x16x32_bf16 v[172:175], a[88:91], a[48:51], v[172:175]
    buffer_store_dwordx4 v[96:99], v30, s[32:35], s60 offen sc1
    v_mfma_f32_16x16x32_bf16 v[188:191], a[88:91], a[56:59], v[188:191]
    v_cvt_pk_bf16_f32 v104, v104, v105
    v_cvt_pk_bf16_f32 v105, v106, v107
    v_mfma_f32_16x16x32_bf16 v[188:191], a[92:95], a[60:63], v[188:191]
    v_cvt_pk_bf16_f32 v106, v108, v109
    v_cvt_pk_bf16_f32 v107, v110, v111
    v_mfma_f32_16x16x32_bf16 v[184:187], a[84:87], a[60:63], v[184:187]
    buffer_store_dwordx4 v[104:107], v30, s[32:35], s61 offen sc1
    v_mfma_f32_16x16x32_bf16 v[184:187], a[80:83], a[56:59], v[184:187]
    buffer_load_dwordx4 v15, s[28:31], s39 offen offset:3072  lds
    v_mfma_f32_16x16x32_bf16 v[180:183], a[72:75], a[56:59], v[180:183]
    s_add_u32 s39, s39, s40
    v_cvt_pk_bf16_f32 v112, v112, v113
    v_cvt_pk_bf16_f32 v113, v114, v115
    v_mfma_f32_16x16x32_bf16 v[180:183], a[76:79], a[60:63], v[180:183]
    v_cvt_pk_bf16_f32 v114, v116, v117
    v_cvt_pk_bf16_f32 v115, v118, v119
    v_mfma_f32_16x16x32_bf16 v[176:179], a[68:71], a[60:63], v[176:179]
    s_waitcnt vmcnt(26) lgkmcnt(0)
    v_cvt_pk_bf16_f32 v120, v120, v121
    v_cvt_pk_bf16_f32 v121, v122, v123
    v_mfma_f32_16x16x32_bf16 v[176:179], a[64:67], a[56:59], v[176:179]
    s_barrier
    v_cvt_pk_bf16_f32 v122, v124, v125
    v_cvt_pk_bf16_f32 v123, v126, v127
    v_mfma_f32_16x16x32_bf16 v[192:195], a[96:99], a[32:35], v[192:195]
    ds_read_b64_tr_b16 a[64:65], v26 offset:0
    v_cvt_pk_bf16_f32 v47, v6, v7
    v_mfma_f32_16x16x32_bf16 v[192:195], a[100:103], a[36:39], v[192:195]
    s_add_u32 m0, s41, 49152
    ds_read_b64_tr_b16 a[66:67], v26 offset:1024
    v_mfma_f32_16x16x32_bf16 v[196:199], a[108:111], a[36:39], v[196:199]
    ds_read_b64_tr_b16 a[68:69], v26 offset:8192
    v_accvgpr_read_b32 v48, a160
    v_mfma_f32_16x16x32_bf16 v[196:199], a[104:107], a[32:35], v[196:199]
    buffer_load_dwordx4 v8, s[24:27], s37 offen offset:0  lds
    v_mfma_f32_16x16x32_bf16 v[200:203], a[112:115], a[32:35], v[200:203]
    ds_read_b64_tr_b16 a[70:71], v26 offset:9216
    v_accvgpr_read_b32 v49, a161
    v_mfma_f32_16x16x32_bf16 v[200:203], a[116:119], a[36:39], v[200:203]
    ds_read_b64_tr_b16 a[72:73], v27 offset:0
    v_cvt_pk_bf16_f32 v48, v48, v49
    v_mfma_f32_16x16x32_bf16 v[204:207], a[124:127], a[36:39], v[204:207]
    ds_read_b64_tr_b16 a[74:75], v27 offset:1024
    v_accvgpr_read_b32 v50, a162
    v_mfma_f32_16x16x32_bf16 v[204:207], a[120:123], a[32:35], v[204:207]
    ds_read_b64_tr_b16 a[76:77], v27 offset:8192
    v_accvgpr_read_b32 v51, a163
    v_mfma_f32_16x16x32_bf16 v[220:223], a[120:123], a[40:43], v[220:223]
    ds_read_b64_tr_b16 a[78:79], v27 offset:9216
    v_cvt_pk_bf16_f32 v49, v50, v51
    v_mfma_f32_16x16x32_bf16 v[220:223], a[124:127], a[44:47], v[220:223]
    ds_read_b64_tr_b16 a[80:81], v28 offset:0
    v_accvgpr_read_b32 v50, a164
    v_mfma_f32_16x16x32_bf16 v[216:219], a[116:119], a[44:47], v[216:219]
    ds_read_b64_tr_b16 a[82:83], v28 offset:1024
    v_accvgpr_read_b32 v51, a165
    v_mfma_f32_16x16x32_bf16 v[216:219], a[112:115], a[40:43], v[216:219]
    buffer_load_dwordx4 v9, s[24:27], s37 offen offset:1024  lds
    v_mfma_f32_16x16x32_bf16 v[212:215], a[104:107], a[40:43], v[212:215]
    ds_read_b64_tr_b16 a[84:85], v28 offset:8192
    v_cvt_pk_bf16_f32 v50, v50, v51
    v_mfma_f32_16x16x32_bf16 v[212:215], a[108:111], a[44:47], v[212:215]
    ds_read_b64_tr_b16 a[86:87], v28 offset:9216
    v_accvgpr_read_b32 v4, a166
    v_mfma_f32_16x16x32_bf16 v[208:211], a[100:103], a[44:47], v[208:211]
    ds_read_b64_tr_b16 a[88:89], v29 offset:0
    v_accvgpr_read_b32 v5, a167
    v_mfma_f32_16x16x32_bf16 v[208:211], a[96:99], a[40:43], v[208:211]
    ds_read_b64_tr_b16 a[90:91], v29 offset:1024
    v_cvt_pk_bf16_f32 v51, v4, v5
    v_mfma_f32_16x16x32_bf16 v[224:227], a[96:99], a[48:51], v[224:227]
    ds_read_b64_tr_b16 a[92:93], v29 offset:8192
    v_accvgpr_read_b32 v52, a168
    v_mfma_f32_16x16x32_bf16 v[224:227], a[100:103], a[52:55], v[224:227]
    ds_read_b64_tr_b16 a[94:95], v29 offset:9216
    v_accvgpr_read_b32 v53, a169
    v_mfma_f32_16x16x32_bf16 v[228:231], a[108:111], a[52:55], v[228:231]
    buffer_store_dwordx4 v[112:115], v30, s[32:35], s64 offen sc1
    v_mfma_f32_16x16x32_bf16 v[228:231], a[104:107], a[48:51], v[228:231]
    buffer_load_dwordx4 v10, s[24:27], s37 offen offset:2048  lds
    v_mfma_f32_16x16x32_bf16 v[232:235], a[112:115], a[48:51], v[232:235]
    buffer_store_dwordx4 v[120:123], v30, s[32:35], s65 offen sc1
    v_mfma_f32_16x16x32_bf16 v[232:235], a[116:119], a[52:55], v[232:235]
    v_cvt_pk_bf16_f32 v52, v52, v53
    v_accvgpr_read_b32 v54, a170
    v_mfma_f32_16x16x32_bf16 v[236:239], a[124:127], a[52:55], v[236:239]
    v_accvgpr_read_b32 v55, a171
    v_cvt_pk_bf16_f32 v53, v54, v55
    v_mfma_f32_16x16x32_bf16 v[236:239], a[120:123], a[48:51], v[236:239]
    v_accvgpr_read_b32 v54, a172
    v_accvgpr_read_b32 v55, a173
    v_mfma_f32_16x16x32_bf16 v[252:255], a[120:123], a[56:59], v[252:255]
    v_cvt_pk_bf16_f32 v54, v54, v55
    v_accvgpr_read_b32 v6, a174
    v_mfma_f32_16x16x32_bf16 v[252:255], a[124:127], a[60:63], v[252:255]
    v_accvgpr_read_b32 v7, a175
    v_cvt_pk_bf16_f32 v55, v6, v7
    v_mfma_f32_16x16x32_bf16 v[248:251], a[116:119], a[60:63], v[248:251]
    v_accvgpr_read_b32 v56, a176
    v_accvgpr_read_b32 v57, a177
    v_mfma_f32_16x16x32_bf16 v[248:251], a[112:115], a[56:59], v[248:251]
    buffer_load_dwordx4 v11, s[24:27], s37 offen offset:3072  lds
    v_mfma_f32_16x16x32_bf16 v[244:247], a[104:107], a[56:59], v[244:247]
    s_add_u32 s37, s37, 128
    v_cvt_pk_bf16_f32 v56, v56, v57
    v_mfma_f32_16x16x32_bf16 v[244:247], a[108:111], a[60:63], v[244:247]
    v_accvgpr_read_b32 v58, a178
    v_accvgpr_read_b32 v59, a179
    v_mfma_f32_16x16x32_bf16 v[240:243], a[100:103], a[60:63], v[240:243]
    s_waitcnt vmcnt(28) lgkmcnt(0)
    v_cvt_pk_bf16_f32 v57, v58, v59
    v_accvgpr_read_b32 v58, a180
    v_mfma_f32_16x16x32_bf16 v[240:243], a[96:99], a[56:59], v[240:243]
    s_barrier
    v_accvgpr_read_b32 v59, a181
    v_cvt_pk_bf16_f32 v58, v58, v59
    v_accvgpr_read_b32 v4, a182
    v_accvgpr_read_b32 v5, a183
    v_cvt_pk_bf16_f32 v59, v4, v5
    v_accvgpr_read_b32 v60, a184
    v_accvgpr_read_b32 v61, a185
    v_cvt_pk_bf16_f32 v60, v60, v61
    v_accvgpr_read_b32 v62, a186
    v_accvgpr_read_b32 v63, a187
    v_cvt_pk_bf16_f32 v61, v62, v63
    v_accvgpr_read_b32 v62, a188
    v_accvgpr_read_b32 v63, a189
    v_cvt_pk_bf16_f32 v62, v62, v63
    v_accvgpr_read_b32 v6, a190
    v_accvgpr_read_b32 v7, a191
    v_cvt_pk_bf16_f32 v63, v6, v7
    s_branch K1_TILE2
K1_TILE2:
    s_cmp_eq_u32 s45, 1
    s_cbranch_scc1 K1_T2_BQ
    s_cmp_eq_u32 s45, 2
    s_cbranch_scc1 K1_T2_BKV
    s_cmp_eq_u32 s45, 3
    s_cbranch_scc1 K1_GATE
K1_T2_Q:
    v_mfma_f32_16x16x32_bf16 a[192:195], a[64:67], a[0:3], 0
    s_mov_b32 s62, 0x3db8aa3b
    ds_read_b64_tr_b16 a[96:97], v26 offset:16384
    v_mfma_f32_16x16x32_bf16 a[192:195], a[68:71], a[4:7], a[192:195]
    s_add_u32 m0, s41, 0
    ds_read_b64_tr_b16 a[98:99], v26 offset:17408
    v_cvt_pk_bf16_f32 v128, v128, v129
    v_mfma_f32_16x16x32_bf16 a[196:199], a[76:79], a[4:7], 0
    s_mov_b32 s63, 0x3db8aa3b
    ds_read_b64_tr_b16 a[100:101], v26 offset:24576
    v_mfma_f32_16x16x32_bf16 a[196:199], a[72:75], a[0:3], a[196:199]
    buffer_load_dwordx4 v8, s[24:27], s36 offen offset:0  lds
    v_mfma_f32_16x16x32_bf16 a[200:203], a[80:83], a[0:3], 0
    ds_read_b64_tr_b16 a[102:103], v26 offset:25600
    v_cvt_pk_bf16_f32 v129, v130, v131
    v_mfma_f32_16x16x32_bf16 a[200:203], a[84:87], a[4:7], a[200:203]
    ds_read_b64_tr_b16 a[104:105], v27 offset:16384
    v_cvt_pk_bf16_f32 v130, v132, v133
    v_mfma_f32_16x16x32_bf16 a[204:207], a[92:95], a[4:7], 0
    s_add_u32 s60, s56, s48
    ds_read_b64_tr_b16 a[106:107], v27 offset:17408
    v_cvt_pk_bf16_f32 v131, v134, v135
    v_mfma_f32_16x16x32_bf16 a[204:207], a[88:91], a[0:3], a[204:207]
    ds_read_b64_tr_b16 a[108:109], v27 offset:24576
    v_cvt_pk_bf16_f32 v136, v136, v137
    v_mfma_f32_16x16x32_bf16 a[220:223], a[88:91], a[8:11], 0
    ds_read_b64_tr_b16 a[110:111], v27 offset:25600
    v_cvt_pk_bf16_f32 v137, v138, v139
    v_mfma_f32_16x16x32_bf16 a[220:223], a[92:95], a[12:15], a[220:223]
    ds_read_b64_tr_b16 a[112:113], v28 offset:16384
    v_cvt_pk_bf16_f32 v138, v140, v141
    v_mfma_f32_16x16x32_bf16 a[216:219], a[84:87], a[12:15], 0
    ds_read_b64_tr_b16 a[114:115], v28 offset:17408
    v_cvt_pk_bf16_f32 v139, v142, v143
    v_mfma_f32_16x16x32_bf16 a[216:219], a[80:83], a[8:11], a[216:219]
    buffer_load_dwordx4 v9, s[24:27], s36 offen offset:1024  lds
    v_mfma_f32_16x16x32_bf16 a[212:215], a[72:75], a[8:11], 0
    ds_read_b64_tr_b16 a[116:117], v28 offset:24576
    v_cvt_pk_bf16_f32 v144, v144, v145
    v_mfma_f32_16x16x32_bf16 a[212:215], a[76:79], a[12:15], a[212:215]
    ds_read_b64_tr_b16 a[118:119], v28 offset:25600
    v_cvt_pk_bf16_f32 v145, v146, v147
    v_mfma_f32_16x16x32_bf16 a[208:211], a[68:71], a[12:15], 0
    ds_read_b64_tr_b16 a[120:121], v29 offset:16384
    v_cvt_pk_bf16_f32 v146, v148, v149
    v_mfma_f32_16x16x32_bf16 a[208:211], a[64:67], a[8:11], a[208:211]
    ds_read_b64_tr_b16 a[122:123], v29 offset:17408
    v_cvt_pk_bf16_f32 v147, v150, v151
    v_mfma_f32_16x16x32_bf16 a[224:227], a[64:67], a[16:19], 0
    ds_read_b64_tr_b16 a[124:125], v29 offset:24576
    v_cvt_pk_bf16_f32 v152, v152, v153
    v_mfma_f32_16x16x32_bf16 a[224:227], a[68:71], a[20:23], a[224:227]
    ds_read_b64_tr_b16 a[126:127], v29 offset:25600
    v_cvt_pk_bf16_f32 v153, v154, v155
    v_mfma_f32_16x16x32_bf16 a[228:231], a[76:79], a[20:23], 0
    buffer_store_dwordx4 v[32:35], v30, s[32:35], s60 offen sc1
    v_mfma_f32_16x16x32_bf16 a[228:231], a[72:75], a[16:19], a[228:231]
    buffer_load_dwordx4 v10, s[24:27], s36 offen offset:2048  lds
    v_mfma_f32_16x16x32_bf16 a[232:235], a[80:83], a[16:19], 0
    v_cvt_pk_bf16_f32 v154, v156, v157
    v_cvt_pk_bf16_f32 v155, v158, v159
    v_mfma_f32_16x16x32_bf16 a[232:235], a[84:87], a[20:23], a[232:235]
    v_cvt_pk_bf16_f32 v160, v160, v161
    v_cvt_pk_bf16_f32 v161, v162, v163
    v_mfma_f32_16x16x32_bf16 a[236:239], a[92:95], a[20:23], 0
    v_cvt_pk_bf16_f32 v162, v164, v165
    v_cvt_pk_bf16_f32 v163, v166, v167
    v_mfma_f32_16x16x32_bf16 a[236:239], a[88:91], a[16:19], a[236:239]
    v_cvt_pk_bf16_f32 v168, v168, v169
    v_cvt_pk_bf16_f32 v169, v170, v171
    v_mfma_f32_16x16x32_bf16 a[252:255], a[88:91], a[24:27], 0
    v_cvt_pk_bf16_f32 v170, v172, v173
    v_cvt_pk_bf16_f32 v171, v174, v175
    v_mfma_f32_16x16x32_bf16 a[252:255], a[92:95], a[28:31], a[252:255]
    v_cvt_pk_bf16_f32 v176, v176, v177
    v_cvt_pk_bf16_f32 v177, v178, v179
    v_mfma_f32_16x16x32_bf16 a[248:251], a[84:87], a[28:31], 0
    v_cvt_pk_bf16_f32 v178, v180, v181
    v_cvt_pk_bf16_f32 v179, v182, v183
    v_mfma_f32_16x16x32_bf16 a[248:251], a[80:83], a[24:27], a[248:251]
    buffer_load_dwordx4 v11, s[24:27], s36 offen offset:3072  lds
    v_mfma_f32_16x16x32_bf16 a[244:247], a[72:75], a[24:27], 0
    s_add_u32 s36, s36, 128
    v_cvt_pk_bf16_f32 v184, v184, v185
    v_mfma_f32_16x16x32_bf16 a[244:247], a[76:79], a[28:31], a[244:247]
    v_cvt_pk_bf16_f32 v185, v186, v187
    v_cvt_pk_bf16_f32 v186, v188, v189
    v_mfma_f32_16x16x32_bf16 a[240:243], a[68:71], a[28:31], 0
    s_waitcnt vmcnt(29) lgkmcnt(0)
    v_cvt_pk_bf16_f32 v187, v190, v191
    v_cvt_pk_bf16_f32 v192, v192, v193
    v_mfma_f32_16x16x32_bf16 a[240:243], a[64:67], a[24:27], a[240:243]
    s_barrier
    v_cvt_pk_bf16_f32 v193, v194, v195
    v_cvt_pk_bf16_f32 v194, v196, v197
    v_mfma_f32_16x16x32_bf16 a[128:131], a[96:99], a[0:3], 0
    ds_read_b128 a[32:35], v24 offset:16384
    v_cvt_pk_bf16_f32 v195, v198, v199
    v_mfma_f32_16x16x32_bf16 a[128:131], a[100:103], a[4:7], a[128:131]
    s_add_u32 m0, s41, 65536
    v_cvt_pk_bf16_f32 v200, v200, v201
    v_mfma_f32_16x16x32_bf16 a[132:135], a[108:111], a[4:7], 0
    ds_read_b128 a[36:39], v25 offset:16384
    v_cvt_pk_bf16_f32 v201, v202, v203
    v_mfma_f32_16x16x32_bf16 a[132:135], a[104:107], a[0:3], a[132:135]
    buffer_load_dwordx4 v12, s[28:31], s38 offen offset:0  lds
    v_mfma_f32_16x16x32_bf16 a[136:139], a[112:115], a[0:3], 0
    s_add_u32 s61, s56, s49
    ds_read_b128 a[40:43], v24 offset:18432
    v_cvt_pk_bf16_f32 v202, v204, v205
    v_mfma_f32_16x16x32_bf16 a[136:139], a[116:119], a[4:7], a[136:139]
    v_cvt_pk_bf16_f32 v203, v206, v207
    v_cvt_pk_bf16_f32 v208, v208, v209
    v_mfma_f32_16x16x32_bf16 a[140:143], a[124:127], a[4:7], 0
    ds_read_b128 a[44:47], v25 offset:18432
    v_cvt_pk_bf16_f32 v209, v210, v211
    v_mfma_f32_16x16x32_bf16 a[140:143], a[120:123], a[0:3], a[140:143]
    buffer_store_dwordx4 v[36:39], v30, s[32:35], s61 offen sc1
    v_mfma_f32_16x16x32_bf16 a[156:159], a[120:123], a[8:11], 0
    ds_read_b128 a[48:51], v24 offset:20480
    v_cvt_pk_bf16_f32 v210, v212, v213
    v_mfma_f32_16x16x32_bf16 a[156:159], a[124:127], a[12:15], a[156:159]
    v_cvt_pk_bf16_f32 v211, v214, v215
    v_cvt_pk_bf16_f32 v216, v216, v217
    v_mfma_f32_16x16x32_bf16 a[152:155], a[116:119], a[12:15], 0
    ds_read_b128 a[52:55], v25 offset:20480
    v_cvt_pk_bf16_f32 v217, v218, v219
    v_mfma_f32_16x16x32_bf16 a[152:155], a[112:115], a[8:11], a[152:155]
    buffer_load_dwordx4 v13, s[28:31], s38 offen offset:1024  lds
    v_mfma_f32_16x16x32_bf16 a[148:151], a[104:107], a[8:11], 0
    ds_read_b128 a[56:59], v24 offset:22528
    v_cvt_pk_bf16_f32 v218, v220, v221
    v_mfma_f32_16x16x32_bf16 a[148:151], a[108:111], a[12:15], a[148:151]
    v_cvt_pk_bf16_f32 v219, v222, v223
    v_cvt_pk_bf16_f32 v224, v224, v225
    v_mfma_f32_16x16x32_bf16 a[144:147], a[100:103], a[12:15], 0
    ds_read_b128 a[60:63], v25 offset:22528
    v_cvt_pk_bf16_f32 v225, v226, v227
    v_mfma_f32_16x16x32_bf16 a[144:147], a[96:99], a[8:11], a[144:147]
    v_cvt_pk_bf16_f32 v226, v228, v229
    v_cvt_pk_bf16_f32 v227, v230, v231
    v_mfma_f32_16x16x32_bf16 a[160:163], a[96:99], a[16:19], 0
    v_cvt_pk_bf16_f32 v232, v232, v233
    v_cvt_pk_bf16_f32 v233, v234, v235
    v_mfma_f32_16x16x32_bf16 a[160:163], a[100:103], a[20:23], a[160:163]
    v_cvt_pk_bf16_f32 v234, v236, v237
    v_cvt_pk_bf16_f32 v235, v238, v239
    v_mfma_f32_16x16x32_bf16 a[164:167], a[108:111], a[20:23], 0
    v_cvt_pk_bf16_f32 v240, v240, v241
    v_cvt_pk_bf16_f32 v241, v242, v243
    v_mfma_f32_16x16x32_bf16 a[164:167], a[104:107], a[16:19], a[164:167]
    buffer_load_dwordx4 v14, s[28:31], s38 offen offset:2048  lds
    v_mfma_f32_16x16x32_bf16 a[168:171], a[112:115], a[16:19], 0
    v_cvt_pk_bf16_f32 v242, v244, v245
    v_cvt_pk_bf16_f32 v243, v246, v247
    v_mfma_f32_16x16x32_bf16 a[168:171], a[116:119], a[20:23], a[168:171]
    v_cvt_pk_bf16_f32 v248, v248, v249
    v_cvt_pk_bf16_f32 v249, v250, v251
    v_mfma_f32_16x16x32_bf16 a[172:175], a[124:127], a[20:23], 0
    v_cvt_pk_bf16_f32 v250, v252, v253
    v_cvt_pk_bf16_f32 v251, v254, v255
    v_mfma_f32_16x16x32_bf16 a[172:175], a[120:123], a[16:19], a[172:175]
    v_mfma_f32_16x16x32_bf16 a[188:191], a[120:123], a[24:27], 0
    v_mfma_f32_16x16x32_bf16 a[188:191], a[124:127], a[28:31], a[188:191]
    v_mfma_f32_16x16x32_bf16 a[184:187], a[116:119], a[28:31], 0
    v_mfma_f32_16x16x32_bf16 a[184:187], a[112:115], a[24:27], a[184:187]
    buffer_load_dwordx4 v15, s[28:31], s38 offen offset:3072  lds
    v_mfma_f32_16x16x32_bf16 a[180:183], a[104:107], a[24:27], 0
    s_add_u32 s38, s38, s40
    v_mfma_f32_16x16x32_bf16 a[180:183], a[108:111], a[28:31], a[180:183]
    v_mfma_f32_16x16x32_bf16 a[176:179], a[100:103], a[28:31], 0
    s_waitcnt vmcnt(30) lgkmcnt(0)
    v_mfma_f32_16x16x32_bf16 a[176:179], a[96:99], a[24:27], a[176:179]
    s_barrier
    v_mfma_f32_16x16x32_bf16 v[64:67], a[96:99], a[32:35], 0
    ds_read_b128 a[0:3], v24 offset:32768
    v_mfma_f32_16x16x32_bf16 v[64:67], a[100:103], a[36:39], v[64:67]
    s_add_u32 m0, s41, 81920
    v_mfma_f32_16x16x32_bf16 v[68:71], a[108:111], a[36:39], 0
    s_add_u32 s64, s56, s50
    ds_read_b128 a[4:7], v25 offset:32768
    v_mfma_f32_16x16x32_bf16 v[68:71], a[104:107], a[32:35], v[68:71]
    buffer_load_dwordx4 v12, s[28:31], s39 offen offset:0  lds
    v_mfma_f32_16x16x32_bf16 v[72:75], a[112:115], a[32:35], 0
    ds_read_b128 a[8:11], v24 offset:34816
    v_mfma_f32_16x16x32_bf16 v[72:75], a[116:119], a[36:39], v[72:75]
    buffer_store_dwordx4 v[40:43], v30, s[32:35], s64 offen sc1
    v_mfma_f32_16x16x32_bf16 v[76:79], a[124:127], a[36:39], 0
    ds_read_b128 a[12:15], v25 offset:34816
    v_mfma_f32_16x16x32_bf16 v[76:79], a[120:123], a[32:35], v[76:79]
    v_mfma_f32_16x16x32_bf16 v[92:95], a[120:123], a[40:43], 0
    ds_read_b128 a[16:19], v24 offset:36864
    v_mfma_f32_16x16x32_bf16 v[92:95], a[124:127], a[44:47], v[92:95]
    v_mfma_f32_16x16x32_bf16 v[88:91], a[116:119], a[44:47], 0
    ds_read_b128 a[20:23], v25 offset:36864
    v_mfma_f32_16x16x32_bf16 v[88:91], a[112:115], a[40:43], v[88:91]
    buffer_load_dwordx4 v13, s[28:31], s39 offen offset:1024  lds
    v_mfma_f32_16x16x32_bf16 v[84:87], a[104:107], a[40:43], 0
    ds_read_b128 a[24:27], v24 offset:38912
    v_mfma_f32_16x16x32_bf16 v[84:87], a[108:111], a[44:47], v[84:87]
    v_mfma_f32_16x16x32_bf16 v[80:83], a[100:103], a[44:47], 0
    ds_read_b128 a[28:31], v25 offset:38912
    v_mfma_f32_16x16x32_bf16 v[80:83], a[96:99], a[40:43], v[80:83]
    v_mfma_f32_16x16x32_bf16 v[96:99], a[96:99], a[48:51], 0
    v_mfma_f32_16x16x32_bf16 v[96:99], a[100:103], a[52:55], v[96:99]
    v_mfma_f32_16x16x32_bf16 v[100:103], a[108:111], a[52:55], 0
    v_mfma_f32_16x16x32_bf16 v[100:103], a[104:107], a[48:51], v[100:103]
    buffer_load_dwordx4 v14, s[28:31], s39 offen offset:2048  lds
    v_mfma_f32_16x16x32_bf16 v[104:107], a[112:115], a[48:51], 0
    v_mfma_f32_16x16x32_bf16 v[104:107], a[116:119], a[52:55], v[104:107]
    v_mfma_f32_16x16x32_bf16 v[108:111], a[124:127], a[52:55], 0
    v_mfma_f32_16x16x32_bf16 v[108:111], a[120:123], a[48:51], v[108:111]
    v_mfma_f32_16x16x32_bf16 v[124:127], a[120:123], a[56:59], 0
    v_mfma_f32_16x16x32_bf16 v[124:127], a[124:127], a[60:63], v[124:127]
    v_mfma_f32_16x16x32_bf16 v[120:123], a[116:119], a[60:63], 0
    v_mfma_f32_16x16x32_bf16 v[120:123], a[112:115], a[56:59], v[120:123]
    buffer_load_dwordx4 v15, s[28:31], s39 offen offset:3072  lds
    v_mfma_f32_16x16x32_bf16 v[116:119], a[104:107], a[56:59], 0
    s_add_u32 s39, s39, s40
    v_mfma_f32_16x16x32_bf16 v[116:119], a[108:111], a[60:63], v[116:119]
    v_mfma_f32_16x16x32_bf16 v[112:115], a[100:103], a[60:63], 0
    s_waitcnt vmcnt(31) lgkmcnt(0)
    v_mfma_f32_16x16x32_bf16 v[112:115], a[96:99], a[56:59], v[112:115]
    s_barrier
    v_mfma_f32_16x16x32_bf16 v[132:135], a[64:67], a[32:35], 0
    s_add_u32 s65, s56, s51
    ds_read_b64_tr_b16 a[96:97], v26 offset:32768
    v_mfma_f32_16x16x32_bf16 v[132:135], a[68:71], a[36:39], v[132:135]
    s_add_u32 m0, s41, 16384
    ds_read_b64_tr_b16 a[98:99], v26 offset:33792
    v_mfma_f32_16x16x32_bf16 v[140:143], a[76:79], a[36:39], 0
    ds_read_b64_tr_b16 a[100:101], v26 offset:40960
    v_mfma_f32_16x16x32_bf16 v[140:143], a[72:75], a[32:35], v[140:143]
    buffer_load_dwordx4 v8, s[24:27], s37 offen offset:0  lds
    v_mfma_f32_16x16x32_bf16 v[148:151], a[80:83], a[32:35], 0
    ds_read_b64_tr_b16 a[102:103], v26 offset:41984
    v_mfma_f32_16x16x32_bf16 v[148:151], a[84:87], a[36:39], v[148:151]
    ds_read_b64_tr_b16 a[104:105], v27 offset:32768
    v_mfma_f32_16x16x32_bf16 v[156:159], a[92:95], a[36:39], 0
    ds_read_b64_tr_b16 a[106:107], v27 offset:33792
    v_mfma_f32_16x16x32_bf16 v[156:159], a[88:91], a[32:35], v[156:159]
    ds_read_b64_tr_b16 a[108:109], v27 offset:40960
    v_mfma_f32_16x16x32_bf16 v[188:191], a[88:91], a[40:43], 0
    ds_read_b64_tr_b16 a[110:111], v27 offset:41984
    v_mfma_f32_16x16x32_bf16 v[188:191], a[92:95], a[44:47], v[188:191]
    ds_read_b64_tr_b16 a[112:113], v28 offset:32768
    v_mfma_f32_16x16x32_bf16 v[180:183], a[84:87], a[44:47], 0
    ds_read_b64_tr_b16 a[114:115], v28 offset:33792
    v_mfma_f32_16x16x32_bf16 v[180:183], a[80:83], a[40:43], v[180:183]
    buffer_load_dwordx4 v9, s[24:27], s37 offen offset:1024  lds
    v_mfma_f32_16x16x32_bf16 v[172:175], a[72:75], a[40:43], 0
    ds_read_b64_tr_b16 a[116:117], v28 offset:40960
    v_mfma_f32_16x16x32_bf16 v[172:175], a[76:79], a[44:47], v[172:175]
    ds_read_b64_tr_b16 a[118:119], v28 offset:41984
    v_mfma_f32_16x16x32_bf16 v[164:167], a[68:71], a[44:47], 0
    ds_read_b64_tr_b16 a[120:121], v29 offset:32768
    v_mfma_f32_16x16x32_bf16 v[164:167], a[64:67], a[40:43], v[164:167]
    ds_read_b64_tr_b16 a[122:123], v29 offset:33792
    v_mfma_f32_16x16x32_bf16 v[196:199], a[64:67], a[48:51], 0
    ds_read_b64_tr_b16 a[124:125], v29 offset:40960
    v_mfma_f32_16x16x32_bf16 v[196:199], a[68:71], a[52:55], v[196:199]
    ds_read_b64_tr_b16 a[126:127], v29 offset:41984
    v_mfma_f32_16x16x32_bf16 v[204:207], a[76:79], a[52:55], 0
    buffer_store_dwordx4 v[44:47], v30, s[32:35], s65 offen sc1
    v_mfma_f32_16x16x32_bf16 v[204:207], a[72:75], a[48:51], v[204:207]
    buffer_load_dwordx4 v10, s[24:27], s37 offen offset:2048  lds
    v_mfma_f32_16x16x32_bf16 v[212:215], a[80:83], a[48:51], 0
    v_mfma_f32_16x16x32_bf16 v[212:215], a[84:87], a[52:55], v[212:215]
    v_mfma_f32_16x16x32_bf16 v[220:223], a[92:95], a[52:55], 0
    v_mfma_f32_16x16x32_bf16 v[220:223], a[88:91], a[48:51], v[220:223]
    v_mfma_f32_16x16x32_bf16 v[252:255], a[88:91], a[56:59], 0
    v_mfma_f32_16x16x32_bf16 v[252:255], a[92:95], a[60:63], v[252:255]
    v_mfma_f32_16x16x32_bf16 v[244:247], a[84:87], a[60:63], 0
    v_mfma_f32_16x16x32_bf16 v[244:247], a[80:83], a[56:59], v[244:247]
    buffer_load_dwordx4 v11, s[24:27], s37 offen offset:3072  lds
    v_mfma_f32_16x16x32_bf16 v[236:239], a[72:75], a[56:59], 0
    s_add_u32 s37, s37, 128
    v_mfma_f32_16x16x32_bf16 v[236:239], a[76:79], a[60:63], v[236:239]
    v_mfma_f32_16x16x32_bf16 v[228:231], a[68:71], a[60:63], 0
    s_waitcnt vmcnt(26) lgkmcnt(0)
    v_mfma_f32_16x16x32_bf16 v[228:231], a[64:67], a[56:59], v[228:231]
    s_barrier
    v_mfma_f32_16x16x32_bf16 a[192:195], a[96:99], a[0:3], a[192:195]
    s_add_u32 s60, s56, s52
    ds_read_b64_tr_b16 a[64:65], v26 offset:49152
    v_mfma_f32_16x16x32_bf16 a[192:195], a[100:103], a[4:7], a[192:195]
    s_add_u32 m0, s41, 32768
    ds_read_b64_tr_b16 a[66:67], v26 offset:50176
    v_mfma_f32_16x16x32_bf16 a[196:199], a[108:111], a[4:7], a[196:199]
    ds_read_b64_tr_b16 a[68:69], v26 offset:57344
    v_mfma_f32_16x16x32_bf16 a[196:199], a[104:107], a[0:3], a[196:199]
    buffer_load_dwordx4 v8, s[24:27], s36 offen offset:0  lds
    v_mfma_f32_16x16x32_bf16 a[200:203], a[112:115], a[0:3], a[200:203]
    ds_read_b64_tr_b16 a[70:71], v26 offset:58368
    v_mfma_f32_16x16x32_bf16 a[200:203], a[116:119], a[4:7], a[200:203]
    ds_read_b64_tr_b16 a[72:73], v27 offset:49152
    v_mfma_f32_16x16x32_bf16 a[204:207], a[124:127], a[4:7], a[204:207]
    ds_read_b64_tr_b16 a[74:75], v27 offset:50176
    v_mfma_f32_16x16x32_bf16 a[204:207], a[120:123], a[0:3], a[204:207]
    ds_read_b64_tr_b16 a[76:77], v27 offset:57344
    v_mfma_f32_16x16x32_bf16 a[220:223], a[120:123], a[8:11], a[220:223]
    ds_read_b64_tr_b16 a[78:79], v27 offset:58368
    v_mfma_f32_16x16x32_bf16 a[220:223], a[124:127], a[12:15], a[220:223]
    ds_read_b64_tr_b16 a[80:81], v28 offset:49152
    v_mfma_f32_16x16x32_bf16 a[216:219], a[116:119], a[12:15], a[216:219]
    ds_read_b64_tr_b16 a[82:83], v28 offset:50176
    v_mfma_f32_16x16x32_bf16 a[216:219], a[112:115], a[8:11], a[216:219]
    buffer_load_dwordx4 v9, s[24:27], s36 offen offset:1024  lds
    v_mfma_f32_16x16x32_bf16 a[212:215], a[104:107], a[8:11], a[212:215]
    ds_read_b64_tr_b16 a[84:85], v28 offset:57344
    v_mfma_f32_16x16x32_bf16 a[212:215], a[108:111], a[12:15], a[212:215]
    ds_read_b64_tr_b16 a[86:87], v28 offset:58368
    v_mfma_f32_16x16x32_bf16 a[208:211], a[100:103], a[12:15], a[208:211]
    ds_read_b64_tr_b16 a[88:89], v29 offset:49152
    v_mfma_f32_16x16x32_bf16 a[208:211], a[96:99], a[8:11], a[208:211]
    ds_read_b64_tr_b16 a[90:91], v29 offset:50176
    v_mfma_f32_16x16x32_bf16 a[224:227], a[96:99], a[16:19], a[224:227]
    ds_read_b64_tr_b16 a[92:93], v29 offset:57344
    v_mfma_f32_16x16x32_bf16 a[224:227], a[100:103], a[20:23], a[224:227]
    ds_read_b64_tr_b16 a[94:95], v29 offset:58368
    v_mfma_f32_16x16x32_bf16 a[228:231], a[108:111], a[20:23], a[228:231]
    buffer_store_dwordx4 v[48:51], v30, s[32:35], s60 offen sc1
    v_mfma_f32_16x16x32_bf16 a[228:231], a[104:107], a[16:19], a[228:231]
    buffer_load_dwordx4 v10, s[24:27], s36 offen offset:2048  lds
    v_mfma_f32_16x16x32_bf16 a[232:235], a[112:115], a[16:19], a[232:235]
    v_mfma_f32_16x16x32_bf16 a[232:235], a[116:119], a[20:23], a[232:235]
    v_mfma_f32_16x16x32_bf16 a[236:239], a[124:127], a[20:23], a[236:239]
    v_mfma_f32_16x16x32_bf16 a[236:239], a[120:123], a[16:19], a[236:239]
    v_mfma_f32_16x16x32_bf16 a[252:255], a[120:123], a[24:27], a[252:255]
    v_mfma_f32_16x16x32_bf16 a[252:255], a[124:127], a[28:31], a[252:255]
    v_mfma_f32_16x16x32_bf16 a[248:251], a[116:119], a[28:31], a[248:251]
    v_mfma_f32_16x16x32_bf16 a[248:251], a[112:115], a[24:27], a[248:251]
    buffer_load_dwordx4 v11, s[24:27], s36 offen offset:3072  lds
    v_mfma_f32_16x16x32_bf16 a[244:247], a[104:107], a[24:27], a[244:247]
    s_add_u32 s36, s36, 128
    v_mfma_f32_16x16x32_bf16 a[244:247], a[108:111], a[28:31], a[244:247]
    s_add_u32 s61, s56, s53
    v_mfma_f32_16x16x32_bf16 a[240:243], a[100:103], a[28:31], a[240:243]
    s_waitcnt vmcnt(25) lgkmcnt(0)
    v_mfma_f32_16x16x32_bf16 a[240:243], a[96:99], a[24:27], a[240:243]
    s_barrier
    v_mfma_f32_16x16x32_bf16 a[128:131], a[64:67], a[0:3], a[128:131]
    ds_read_b128 a[32:35], v24 offset:49152
    v_mfma_f32_16x16x32_bf16 a[128:131], a[68:71], a[4:7], a[128:131]
    s_add_u32 m0, s41, 98304
    v_mfma_f32_16x16x32_bf16 a[132:135], a[76:79], a[4:7], a[132:135]
    ds_read_b128 a[36:39], v25 offset:49152
    v_mfma_f32_16x16x32_bf16 a[132:135], a[72:75], a[0:3], a[132:135]
    buffer_load_dwordx4 v12, s[28:31], s38 offen offset:0  lds
    v_mfma_f32_16x16x32_bf16 a[136:139], a[80:83], a[0:3], a[136:139]
    ds_read_b128 a[40:43], v24 offset:51200
    v_mfma_f32_16x16x32_bf16 a[136:139], a[84:87], a[4:7], a[136:139]
    buffer_store_dwordx4 v[52:55], v30, s[32:35], s61 offen sc1
    v_mfma_f32_16x16x32_bf16 a[140:143], a[92:95], a[4:7], a[140:143]
    ds_read_b128 a[44:47], v25 offset:51200
    v_mfma_f32_16x16x32_bf16 a[140:143], a[88:91], a[0:3], a[140:143]
    v_mfma_f32_16x16x32_bf16 a[156:159], a[88:91], a[8:11], a[156:159]
    ds_read_b128 a[48:51], v24 offset:53248
    v_mfma_f32_16x16x32_bf16 a[156:159], a[92:95], a[12:15], a[156:159]
    v_mfma_f32_16x16x32_bf16 a[152:155], a[84:87], a[12:15], a[152:155]
    ds_read_b128 a[52:55], v25 offset:53248
    v_mfma_f32_16x16x32_bf16 a[152:155], a[80:83], a[8:11], a[152:155]
    buffer_load_dwordx4 v13, s[28:31], s38 offen offset:1024  lds
    v_mfma_f32_16x16x32_bf16 a[148:151], a[72:75], a[8:11], a[148:151]
    ds_read_b128 a[56:59], v24 offset:55296
    v_mfma_f32_16x16x32_bf16 a[148:151], a[76:79], a[12:15], a[148:151]
    v_mfma_f32_16x16x32_bf16 a[144:147], a[68:71], a[12:15], a[144:147]
    ds_read_b128 a[60:63], v25 offset:55296
    v_mfma_f32_16x16x32_bf16 a[144:147], a[64:67], a[8:11], a[144:147]
    v_mfma_f32_16x16x32_bf16 a[160:163], a[64:67], a[16:19], a[160:163]
    v_mfma_f32_16x16x32_bf16 a[160:163], a[68:71], a[20:23], a[160:163]
    v_mfma_f32_16x16x32_bf16 a[164:167], a[76:79], a[20:23], a[164:167]
    v_mfma_f32_16x16x32_bf16 a[164:167], a[72:75], a[16:19], a[164:167]
    buffer_load_dwordx4 v14, s[28:31], s38 offen offset:2048  lds
    v_mfma_f32_16x16x32_bf16 a[168:171], a[80:83], a[16:19], a[168:171]
    v_mfma_f32_16x16x32_bf16 a[168:171], a[84:87], a[20:23], a[168:171]
    v_mfma_f32_16x16x32_bf16 a[172:175], a[92:95], a[20:23], a[172:175]
    v_mfma_f32_16x16x32_bf16 a[172:175], a[88:91], a[16:19], a[172:175]
    v_mfma_f32_16x16x32_bf16 a[188:191], a[88:91], a[24:27], a[188:191]
    v_mfma_f32_16x16x32_bf16 a[188:191], a[92:95], a[28:31], a[188:191]
    v_mfma_f32_16x16x32_bf16 a[184:187], a[84:87], a[28:31], a[184:187]
    s_add_u32 s64, s56, s54
    v_mfma_f32_16x16x32_bf16 a[184:187], a[80:83], a[24:27], a[184:187]
    buffer_load_dwordx4 v15, s[28:31], s38 offen offset:3072  lds
    v_mfma_f32_16x16x32_bf16 a[180:183], a[72:75], a[24:27], a[180:183]
    s_add_u32 s38, s38, s40
    v_mfma_f32_16x16x32_bf16 a[180:183], a[76:79], a[28:31], a[180:183]
    buffer_store_dwordx4 v[56:59], v30, s[32:35], s64 offen sc1
    v_mfma_f32_16x16x32_bf16 a[176:179], a[68:71], a[28:31], a[176:179]
    s_waitcnt vmcnt(26) lgkmcnt(0)
    v_mfma_f32_16x16x32_bf16 a[176:179], a[64:67], a[24:27], a[176:179]
    s_barrier
    v_mfma_f32_16x16x32_bf16 v[64:67], a[64:67], a[32:35], v[64:67]
    ds_read_b128 a[0:3], v24 offset:0
    v_mfma_f32_16x16x32_bf16 v[64:67], a[68:71], a[36:39], v[64:67]
    s_add_u32 m0, s41, 114688
    v_mfma_f32_16x16x32_bf16 v[68:71], a[76:79], a[36:39], v[68:71]
    ds_read_b128 a[4:7], v25 offset:0
    v_mfma_f32_16x16x32_bf16 v[68:71], a[72:75], a[32:35], v[68:71]
    buffer_load_dwordx4 v12, s[28:31], s39 offen offset:0  lds
    v_mfma_f32_16x16x32_bf16 v[72:75], a[80:83], a[32:35], v[72:75]
    ds_read_b128 a[8:11], v24 offset:2048
    v_mfma_f32_16x16x32_bf16 v[72:75], a[84:87], a[36:39], v[72:75]
    v_mfma_f32_16x16x32_bf16 v[76:79], a[92:95], a[36:39], v[76:79]
    ds_read_b128 a[12:15], v25 offset:2048
    v_mfma_f32_16x16x32_bf16 v[76:79], a[88:91], a[32:35], v[76:79]
    v_mfma_f32_16x16x32_bf16 v[92:95], a[88:91], a[40:43], v[92:95]
    ds_read_b128 a[16:19], v24 offset:4096
    v_mfma_f32_16x16x32_bf16 v[92:95], a[92:95], a[44:47], v[92:95]
    v_mfma_f32_16x16x32_bf16 v[88:91], a[84:87], a[44:47], v[88:91]
    ds_read_b128 a[20:23], v25 offset:4096
    v_mfma_f32_16x16x32_bf16 v[88:91], a[80:83], a[40:43], v[88:91]
    buffer_load_dwordx4 v13, s[28:31], s39 offen offset:1024  lds
    v_mfma_f32_16x16x32_bf16 v[84:87], a[72:75], a[40:43], v[84:87]
    ds_read_b128 a[24:27], v24 offset:6144
    v_mfma_f32_16x16x32_bf16 v[84:87], a[76:79], a[44:47], v[84:87]
    v_mfma_f32_16x16x32_bf16 v[80:83], a[68:71], a[44:47], v[80:83]
    ds_read_b128 a[28:31], v25 offset:6144
    v_mfma_f32_16x16x32_bf16 v[80:83], a[64:67], a[40:43], v[80:83]
    v_mfma_f32_16x16x32_bf16 v[96:99], a[64:67], a[48:51], v[96:99]
    v_mfma_f32_16x16x32_bf16 v[96:99], a[68:71], a[52:55], v[96:99]
    v_mfma_f32_16x16x32_bf16 v[100:103], a[76:79], a[52:55], v[100:103]
    v_mfma_f32_16x16x32_bf16 v[100:103], a[72:75], a[48:51], v[100:103]
    buffer_load_dwordx4 v14, s[28:31], s39 offen offset:2048  lds
    v_mfma_f32_16x16x32_bf16 v[104:107], a[80:83], a[48:51], v[104:107]
    v_mfma_f32_16x16x32_bf16 v[104:107], a[84:87], a[52:55], v[104:107]
    v_mfma_f32_16x16x32_bf16 v[108:111], a[92:95], a[52:55], v[108:111]
    v_mfma_f32_16x16x32_bf16 v[108:111], a[88:91], a[48:51], v[108:111]
    v_mfma_f32_16x16x32_bf16 v[124:127], a[88:91], a[56:59], v[124:127]
    s_add_u32 s65, s56, s55
    v_mfma_f32_16x16x32_bf16 v[124:127], a[92:95], a[60:63], v[124:127]
    v_mfma_f32_16x16x32_bf16 v[120:123], a[84:87], a[60:63], v[120:123]
    buffer_store_dwordx4 v[60:63], v30, s[32:35], s65 offen sc1
    v_mfma_f32_16x16x32_bf16 v[120:123], a[80:83], a[56:59], v[120:123]
    buffer_load_dwordx4 v15, s[28:31], s39 offen offset:3072  lds
    v_mfma_f32_16x16x32_bf16 v[116:119], a[72:75], a[56:59], v[116:119]
    s_add_u32 s39, s39, s40
    v_mfma_f32_16x16x32_bf16 v[116:119], a[76:79], a[60:63], v[116:119]
    v_mfma_f32_16x16x32_bf16 v[112:115], a[68:71], a[60:63], v[112:115]
    s_waitcnt vmcnt(26) lgkmcnt(0)
    v_mfma_f32_16x16x32_bf16 v[112:115], a[64:67], a[56:59], v[112:115]
    s_barrier
    v_mfma_f32_16x16x32_bf16 v[132:135], a[96:99], a[32:35], v[132:135]
    ds_read_b64_tr_b16 a[64:65], v26 offset:0
    v_mfma_f32_16x16x32_bf16 v[132:135], a[100:103], a[36:39], v[132:135]
    s_add_u32 m0, s41, 49152
    ds_read_b64_tr_b16 a[66:67], v26 offset:1024
    v_mfma_f32_16x16x32_bf16 v[140:143], a[108:111], a[36:39], v[140:143]
    ds_read_b64_tr_b16 a[68:69], v26 offset:8192
    v_mfma_f32_16x16x32_bf16 v[140:143], a[104:107], a[32:35], v[140:143]
    buffer_load_dwordx4 v8, s[24:27], s37 offen offset:0  lds
    v_mfma_f32_16x16x32_bf16 v[148:151], a[112:115], a[32:35], v[148:151]
    ds_read_b64_tr_b16 a[70:71], v26 offset:9216
    v_mfma_f32_16x16x32_bf16 v[148:151], a[116:119], a[36:39], v[148:151]
    ds_read_b64_tr_b16 a[72:73], v27 offset:0
    v_mfma_f32_16x16x32_bf16 v[156:159], a[124:127], a[36:39], v[156:159]
    ds_read_b64_tr_b16 a[74:75], v27 offset:1024
    v_mfma_f32_16x16x32_bf16 v[156:159], a[120:123], a[32:35], v[156:159]
    ds_read_b64_tr_b16 a[76:77], v27 offset:8192
    v_mfma_f32_16x16x32_bf16 v[188:191], a[120:123], a[40:43], v[188:191]
    ds_read_b64_tr_b16 a[78:79], v27 offset:9216
    v_mfma_f32_16x16x32_bf16 v[188:191], a[124:127], a[44:47], v[188:191]
    ds_read_b64_tr_b16 a[80:81], v28 offset:0
    v_mfma_f32_16x16x32_bf16 v[180:183], a[116:119], a[44:47], v[180:183]
    ds_read_b64_tr_b16 a[82:83], v28 offset:1024
    v_mfma_f32_16x16x32_bf16 v[180:183], a[112:115], a[40:43], v[180:183]
    buffer_load_dwordx4 v9, s[24:27], s37 offen offset:1024  lds
    v_mfma_f32_16x16x32_bf16 v[172:175], a[104:107], a[40:43], v[172:175]
    ds_read_b64_tr_b16 a[84:85], v28 offset:8192
    v_mfma_f32_16x16x32_bf16 v[172:175], a[108:111], a[44:47], v[172:175]
    ds_read_b64_tr_b16 a[86:87], v28 offset:9216
    v_mfma_f32_16x16x32_bf16 v[164:167], a[100:103], a[44:47], v[164:167]
    ds_read_b64_tr_b16 a[88:89], v29 offset:0
    v_mfma_f32_16x16x32_bf16 v[164:167], a[96:99], a[40:43], v[164:167]
    ds_read_b64_tr_b16 a[90:91], v29 offset:1024
    v_mfma_f32_16x16x32_bf16 v[196:199], a[96:99], a[48:51], v[196:199]
    ds_read_b64_tr_b16 a[92:93], v29 offset:8192
    v_mfma_f32_16x16x32_bf16 v[196:199], a[100:103], a[52:55], v[196:199]
    ds_read_b64_tr_b16 a[94:95], v29 offset:9216
    v_mfma_f32_16x16x32_bf16 v[204:207], a[108:111], a[52:55], v[204:207]
    v_mfma_f32_16x16x32_bf16 v[204:207], a[104:107], a[48:51], v[204:207]
    buffer_load_dwordx4 v10, s[24:27], s37 offen offset:2048  lds
    v_mfma_f32_16x16x32_bf16 v[212:215], a[112:115], a[48:51], v[212:215]
    v_mfma_f32_16x16x32_bf16 v[212:215], a[116:119], a[52:55], v[212:215]
    v_mfma_f32_16x16x32_bf16 v[220:223], a[124:127], a[52:55], v[220:223]
    s_add_u32 s60, s58, s48
    v_mfma_f32_16x16x32_bf16 v[220:223], a[120:123], a[48:51], v[220:223]
    v_mfma_f32_16x16x32_bf16 v[252:255], a[120:123], a[56:59], v[252:255]
    buffer_store_dwordx4 v[128:131], v30, s[32:35], s60 offen sc1
    v_mfma_f32_16x16x32_bf16 v[252:255], a[124:127], a[60:63], v[252:255]
    v_mfma_f32_16x16x32_bf16 v[244:247], a[116:119], a[60:63], v[244:247]
    v_mfma_f32_16x16x32_bf16 v[244:247], a[112:115], a[56:59], v[244:247]
    buffer_load_dwordx4 v11, s[24:27], s37 offen offset:3072  lds
    v_mfma_f32_16x16x32_bf16 v[236:239], a[104:107], a[56:59], v[236:239]
    s_add_u32 s37, s37, 128
    v_mfma_f32_16x16x32_bf16 v[236:239], a[108:111], a[60:63], v[236:239]
    v_mfma_f32_16x16x32_bf16 v[228:231], a[100:103], a[60:63], v[228:231]
    s_waitcnt vmcnt(26) lgkmcnt(0)
    v_mfma_f32_16x16x32_bf16 v[228:231], a[96:99], a[56:59], v[228:231]
    s_barrier
    v_mfma_f32_16x16x32_bf16 a[192:195], a[64:67], a[0:3], a[192:195]
    ds_read_b64_tr_b16 a[96:97], v26 offset:16384
    v_mfma_f32_16x16x32_bf16 a[192:195], a[68:71], a[4:7], a[192:195]
    s_add_u32 m0, s41, 0
    ds_read_b64_tr_b16 a[98:99], v26 offset:17408
    v_mfma_f32_16x16x32_bf16 a[196:199], a[76:79], a[4:7], a[196:199]
    ds_read_b64_tr_b16 a[100:101], v26 offset:24576
    v_mfma_f32_16x16x32_bf16 a[196:199], a[72:75], a[0:3], a[196:199]
    buffer_load_dwordx4 v8, s[24:27], s36 offen offset:0  lds
    v_mfma_f32_16x16x32_bf16 a[200:203], a[80:83], a[0:3], a[200:203]
    ds_read_b64_tr_b16 a[102:103], v26 offset:25600
    v_mfma_f32_16x16x32_bf16 a[200:203], a[84:87], a[4:7], a[200:203]
    ds_read_b64_tr_b16 a[104:105], v27 offset:16384
    v_mfma_f32_16x16x32_bf16 a[204:207], a[92:95], a[4:7], a[204:207]
    ds_read_b64_tr_b16 a[106:107], v27 offset:17408
    v_mfma_f32_16x16x32_bf16 a[204:207], a[88:91], a[0:3], a[204:207]
    ds_read_b64_tr_b16 a[108:109], v27 offset:24576
    v_mfma_f32_16x16x32_bf16 a[220:223], a[88:91], a[8:11], a[220:223]
    ds_read_b64_tr_b16 a[110:111], v27 offset:25600
    v_mfma_f32_16x16x32_bf16 a[220:223], a[92:95], a[12:15], a[220:223]
    ds_read_b64_tr_b16 a[112:113], v28 offset:16384
    v_mfma_f32_16x16x32_bf16 a[216:219], a[84:87], a[12:15], a[216:219]
    ds_read_b64_tr_b16 a[114:115], v28 offset:17408
    v_mfma_f32_16x16x32_bf16 a[216:219], a[80:83], a[8:11], a[216:219]
    buffer_load_dwordx4 v9, s[24:27], s36 offen offset:1024  lds
    v_mfma_f32_16x16x32_bf16 a[212:215], a[72:75], a[8:11], a[212:215]
    ds_read_b64_tr_b16 a[116:117], v28 offset:24576
    v_mfma_f32_16x16x32_bf16 a[212:215], a[76:79], a[12:15], a[212:215]
    ds_read_b64_tr_b16 a[118:119], v28 offset:25600
    v_mfma_f32_16x16x32_bf16 a[208:211], a[68:71], a[12:15], a[208:211]
    ds_read_b64_tr_b16 a[120:121], v29 offset:16384
    v_mfma_f32_16x16x32_bf16 a[208:211], a[64:67], a[8:11], a[208:211]
    ds_read_b64_tr_b16 a[122:123], v29 offset:17408
    v_mfma_f32_16x16x32_bf16 a[224:227], a[64:67], a[16:19], a[224:227]
    ds_read_b64_tr_b16 a[124:125], v29 offset:24576
    v_mfma_f32_16x16x32_bf16 a[224:227], a[68:71], a[20:23], a[224:227]
    ds_read_b64_tr_b16 a[126:127], v29 offset:25600
    v_mfma_f32_16x16x32_bf16 a[228:231], a[76:79], a[20:23], a[228:231]
    v_mfma_f32_16x16x32_bf16 a[228:231], a[72:75], a[16:19], a[228:231]
    buffer_load_dwordx4 v10, s[24:27], s36 offen offset:2048  lds
    v_mfma_f32_16x16x32_bf16 a[232:235], a[80:83], a[16:19], a[232:235]
    s_add_u32 s61, s58, s49
    v_mfma_f32_16x16x32_bf16 a[232:235], a[84:87], a[20:23], a[232:235]
    v_mfma_f32_16x16x32_bf16 a[236:239], a[92:95], a[20:23], a[236:239]
    buffer_store_dwordx4 v[136:139], v30, s[32:35], s61 offen sc1
    v_mfma_f32_16x16x32_bf16 a[236:239], a[88:91], a[16:19], a[236:239]
    v_mfma_f32_16x16x32_bf16 a[252:255], a[88:91], a[24:27], a[252:255]
    v_mfma_f32_16x16x32_bf16 a[252:255], a[92:95], a[28:31], a[252:255]
    v_mfma_f32_16x16x32_bf16 a[248:251], a[84:87], a[28:31], a[248:251]
    v_mfma_f32_16x16x32_bf16 a[248:251], a[80:83], a[24:27], a[248:251]
    buffer_load_dwordx4 v11, s[24:27], s36 offen offset:3072  lds
    v_mfma_f32_16x16x32_bf16 a[244:247], a[72:75], a[24:27], a[244:247]
    s_add_u32 s36, s36, 128
    v_mfma_f32_16x16x32_bf16 a[244:247], a[76:79], a[28:31], a[244:247]
    v_mfma_f32_16x16x32_bf16 a[240:243], a[68:71], a[28:31], a[240:243]
    s_waitcnt vmcnt(26) lgkmcnt(0)
    v_mfma_f32_16x16x32_bf16 a[240:243], a[64:67], a[24:27], a[240:243]
    s_barrier
    v_mfma_f32_16x16x32_bf16 a[128:131], a[96:99], a[0:3], a[128:131]
    ds_read_b128 a[32:35], v24 offset:16384
    v_mfma_f32_16x16x32_bf16 a[128:131], a[100:103], a[4:7], a[128:131]
    s_add_u32 m0, s41, 65536
    v_mfma_f32_16x16x32_bf16 a[132:135], a[108:111], a[4:7], a[132:135]
    ds_read_b128 a[36:39], v25 offset:16384
    v_mfma_f32_16x16x32_bf16 a[132:135], a[104:107], a[0:3], a[132:135]
    buffer_load_dwordx4 v12, s[28:31], s38 offen offset:0  lds
    v_mfma_f32_16x16x32_bf16 a[136:139], a[112:115], a[0:3], a[136:139]
    ds_read_b128 a[40:43], v24 offset:18432
    v_mfma_f32_16x16x32_bf16 a[136:139], a[116:119], a[4:7], a[136:139]
    v_mfma_f32_16x16x32_bf16 a[140:143], a[124:127], a[4:7], a[140:143]
    ds_read_b128 a[44:47], v25 offset:18432
    v_mfma_f32_16x16x32_bf16 a[140:143], a[120:123], a[0:3], a[140:143]
    v_mfma_f32_16x16x32_bf16 a[156:159], a[120:123], a[8:11], a[156:159]
    ds_read_b128 a[48:51], v24 offset:20480
    v_mfma_f32_16x16x32_bf16 a[156:159], a[124:127], a[12:15], a[156:159]
    v_mfma_f32_16x16x32_bf16 a[152:155], a[116:119], a[12:15], a[152:155]
    ds_read_b128 a[52:55], v25 offset:20480
    v_mfma_f32_16x16x32_bf16 a[152:155], a[112:115], a[8:11], a[152:155]
    buffer_load_dwordx4 v13, s[28:31], s38 offen offset:1024  lds
    v_mfma_f32_16x16x32_bf16 a[148:151], a[104:107], a[8:11], a[148:151]
    ds_read_b128 a[56:59], v24 offset:22528
    v_mfma_f32_16x16x32_bf16 a[148:151], a[108:111], a[12:15], a[148:151]
    v_mfma_f32_16x16x32_bf16 a[144:147], a[100:103], a[12:15], a[144:147]
    ds_read_b128 a[60:63], v25 offset:22528
    v_mfma_f32_16x16x32_bf16 a[144:147], a[96:99], a[8:11], a[144:147]
    v_mfma_f32_16x16x32_bf16 a[160:163], a[96:99], a[16:19], a[160:163]
    v_mfma_f32_16x16x32_bf16 a[160:163], a[100:103], a[20:23], a[160:163]
    v_mfma_f32_16x16x32_bf16 a[164:167], a[108:111], a[20:23], a[164:167]
    s_add_u32 s64, s58, s50
    v_mfma_f32_16x16x32_bf16 a[164:167], a[104:107], a[16:19], a[164:167]
    buffer_load_dwordx4 v14, s[28:31], s38 offen offset:2048  lds
    v_mfma_f32_16x16x32_bf16 a[168:171], a[112:115], a[16:19], a[168:171]
    buffer_store_dwordx4 v[144:147], v30, s[32:35], s64 offen sc1
    v_mfma_f32_16x16x32_bf16 a[168:171], a[116:119], a[20:23], a[168:171]
    v_mfma_f32_16x16x32_bf16 a[172:175], a[124:127], a[20:23], a[172:175]
    v_mfma_f32_16x16x32_bf16 a[172:175], a[120:123], a[16:19], a[172:175]
    v_mfma_f32_16x16x32_bf16 a[188:191], a[120:123], a[24:27], a[188:191]
    v_mfma_f32_16x16x32_bf16 a[188:191], a[124:127], a[28:31], a[188:191]
    v_mfma_f32_16x16x32_bf16 a[184:187], a[116:119], a[28:31], a[184:187]
    v_mfma_f32_16x16x32_bf16 a[184:187], a[112:115], a[24:27], a[184:187]
    buffer_load_dwordx4 v15, s[28:31], s38 offen offset:3072  lds
    v_mfma_f32_16x16x32_bf16 a[180:183], a[104:107], a[24:27], a[180:183]
    s_add_u32 s38, s38, s40
    v_mfma_f32_16x16x32_bf16 a[180:183], a[108:111], a[28:31], a[180:183]
    v_mfma_f32_16x16x32_bf16 a[176:179], a[100:103], a[28:31], a[176:179]
    s_waitcnt vmcnt(26) lgkmcnt(0)
    v_mfma_f32_16x16x32_bf16 a[176:179], a[96:99], a[24:27], a[176:179]
    s_barrier
    v_mfma_f32_16x16x32_bf16 v[64:67], a[96:99], a[32:35], v[64:67]
    ds_read_b128 a[0:3], v24 offset:32768
    v_mfma_f32_16x16x32_bf16 v[64:67], a[100:103], a[36:39], v[64:67]
    s_add_u32 m0, s41, 81920
    v_mfma_f32_16x16x32_bf16 v[68:71], a[108:111], a[36:39], v[68:71]
    ds_read_b128 a[4:7], v25 offset:32768
    v_mfma_f32_16x16x32_bf16 v[68:71], a[104:107], a[32:35], v[68:71]
    buffer_load_dwordx4 v12, s[28:31], s39 offen offset:0  lds
    v_mfma_f32_16x16x32_bf16 v[72:75], a[112:115], a[32:35], v[72:75]
    ds_read_b128 a[8:11], v24 offset:34816
    v_mfma_f32_16x16x32_bf16 v[72:75], a[116:119], a[36:39], v[72:75]
    v_mfma_f32_16x16x32_bf16 v[76:79], a[124:127], a[36:39], v[76:79]
    ds_read_b128 a[12:15], v25 offset:34816
    v_mfma_f32_16x16x32_bf16 v[76:79], a[120:123], a[32:35], v[76:79]
    v_mfma_f32_16x16x32_bf16 v[92:95], a[120:123], a[40:43], v[92:95]
    ds_read_b128 a[16:19], v24 offset:36864
    v_mfma_f32_16x16x32_bf16 v[92:95], a[124:127], a[44:47], v[92:95]
    v_mfma_f32_16x16x32_bf16 v[88:91], a[116:119], a[44:47], v[88:91]
    ds_read_b128 a[20:23], v25 offset:36864
    v_mfma_f32_16x16x32_bf16 v[88:91], a[112:115], a[40:43], v[88:91]
    buffer_load_dwordx4 v13, s[28:31], s39 offen offset:1024  lds
    v_mfma_f32_16x16x32_bf16 v[84:87], a[104:107], a[40:43], v[84:87]
    ds_read_b128 a[24:27], v24 offset:38912
    v_mfma_f32_16x16x32_bf16 v[84:87], a[108:111], a[44:47], v[84:87]
    v_mfma_f32_16x16x32_bf16 v[80:83], a[100:103], a[44:47], v[80:83]
    ds_read_b128 a[28:31], v25 offset:38912
    v_mfma_f32_16x16x32_bf16 v[80:83], a[96:99], a[40:43], v[80:83]
    v_mfma_f32_16x16x32_bf16 v[96:99], a[96:99], a[48:51], v[96:99]
    s_add_u32 s65, s58, s51
    v_mfma_f32_16x16x32_bf16 v[96:99], a[100:103], a[52:55], v[96:99]
    v_mfma_f32_16x16x32_bf16 v[100:103], a[108:111], a[52:55], v[100:103]
    buffer_store_dwordx4 v[152:155], v30, s[32:35], s65 offen sc1
    v_mfma_f32_16x16x32_bf16 v[100:103], a[104:107], a[48:51], v[100:103]
    buffer_load_dwordx4 v14, s[28:31], s39 offen offset:2048  lds
    v_mfma_f32_16x16x32_bf16 v[104:107], a[112:115], a[48:51], v[104:107]
    v_mfma_f32_16x16x32_bf16 v[104:107], a[116:119], a[52:55], v[104:107]
    v_mfma_f32_16x16x32_bf16 v[108:111], a[124:127], a[52:55], v[108:111]
    v_mfma_f32_16x16x32_bf16 v[108:111], a[120:123], a[48:51], v[108:111]
    v_mfma_f32_16x16x32_bf16 v[124:127], a[120:123], a[56:59], v[124:127]
    v_mfma_f32_16x16x32_bf16 v[124:127], a[124:127], a[60:63], v[124:127]
    v_mfma_f32_16x16x32_bf16 v[120:123], a[116:119], a[60:63], v[120:123]
    v_mfma_f32_16x16x32_bf16 v[120:123], a[112:115], a[56:59], v[120:123]
    buffer_load_dwordx4 v15, s[28:31], s39 offen offset:3072  lds
    v_mfma_f32_16x16x32_bf16 v[116:119], a[104:107], a[56:59], v[116:119]
    s_add_u32 s39, s39, s40
    v_mfma_f32_16x16x32_bf16 v[116:119], a[108:111], a[60:63], v[116:119]
    v_mfma_f32_16x16x32_bf16 v[112:115], a[100:103], a[60:63], v[112:115]
    s_waitcnt vmcnt(26) lgkmcnt(0)
    v_mfma_f32_16x16x32_bf16 v[112:115], a[96:99], a[56:59], v[112:115]
    s_barrier
    v_mfma_f32_16x16x32_bf16 v[132:135], a[64:67], a[32:35], v[132:135]
    ds_read_b64_tr_b16 a[96:97], v26 offset:32768
    v_mfma_f32_16x16x32_bf16 v[132:135], a[68:71], a[36:39], v[132:135]
    s_add_u32 m0, s41, 16384
    ds_read_b64_tr_b16 a[98:99], v26 offset:33792
    v_mfma_f32_16x16x32_bf16 v[140:143], a[76:79], a[36:39], v[140:143]
    ds_read_b64_tr_b16 a[100:101], v26 offset:40960
    v_mfma_f32_16x16x32_bf16 v[140:143], a[72:75], a[32:35], v[140:143]
    buffer_load_dwordx4 v8, s[24:27], s37 offen offset:0  lds
    v_mfma_f32_16x16x32_bf16 v[148:151], a[80:83], a[32:35], v[148:151]
    ds_read_b64_tr_b16 a[102:103], v26 offset:41984
    v_mfma_f32_16x16x32_bf16 v[148:151], a[84:87], a[36:39], v[148:151]
    ds_read_b64_tr_b16 a[104:105], v27 offset:32768
    v_mfma_f32_16x16x32_bf16 v[156:159], a[92:95], a[36:39], v[156:159]
    ds_read_b64_tr_b16 a[106:107], v27 offset:33792
    v_mfma_f32_16x16x32_bf16 v[156:159], a[88:91], a[32:35], v[156:159]
    ds_read_b64_tr_b16 a[108:109], v27 offset:40960
    v_mfma_f32_16x16x32_bf16 v[188:191], a[88:91], a[40:43], v[188:191]
    ds_read_b64_tr_b16 a[110:111], v27 offset:41984
    v_mfma_f32_16x16x32_bf16 v[188:191], a[92:95], a[44:47], v[188:191]
    ds_read_b64_tr_b16 a[112:113], v28 offset:32768
    v_mfma_f32_16x16x32_bf16 v[180:183], a[84:87], a[44:47], v[180:183]
    ds_read_b64_tr_b16 a[114:115], v28 offset:33792
    v_mfma_f32_16x16x32_bf16 v[180:183], a[80:83], a[40:43], v[180:183]
    buffer_load_dwordx4 v9, s[24:27], s37 offen offset:1024  lds
    v_mfma_f32_16x16x32_bf16 v[172:175], a[72:75], a[40:43], v[172:175]
    ds_read_b64_tr_b16 a[116:117], v28 offset:40960
    v_mfma_f32_16x16x32_bf16 v[172:175], a[76:79], a[44:47], v[172:175]
    ds_read_b64_tr_b16 a[118:119], v28 offset:41984
    v_mfma_f32_16x16x32_bf16 v[164:167], a[68:71], a[44:47], v[164:167]
    s_add_u32 s60, s58, s52
    ds_read_b64_tr_b16 a[120:121], v29 offset:32768
    v_mfma_f32_16x16x32_bf16 v[164:167], a[64:67], a[40:43], v[164:167]
    ds_read_b64_tr_b16 a[122:123], v29 offset:33792
    v_mfma_f32_16x16x32_bf16 v[196:199], a[64:67], a[48:51], v[196:199]
    ds_read_b64_tr_b16 a[124:125], v29 offset:40960
    v_mfma_f32_16x16x32_bf16 v[196:199], a[68:71], a[52:55], v[196:199]
    ds_read_b64_tr_b16 a[126:127], v29 offset:41984
    v_mfma_f32_16x16x32_bf16 v[204:207], a[76:79], a[52:55], v[204:207]
    buffer_store_dwordx4 v[160:163], v30, s[32:35], s60 offen sc1
    v_mfma_f32_16x16x32_bf16 v[204:207], a[72:75], a[48:51], v[204:207]
    buffer_load_dwordx4 v10, s[24:27], s37 offen offset:2048  lds
    v_mfma_f32_16x16x32_bf16 v[212:215], a[80:83], a[48:51], v[212:215]
    v_mfma_f32_16x16x32_bf16 v[212:215], a[84:87], a[52:55], v[212:215]
    v_mfma_f32_16x16x32_bf16 v[220:223], a[92:95], a[52:55], v[220:223]
    v_mfma_f32_16x16x32_bf16 v[220:223], a[88:91], a[48:51], v[220:223]
    v_mfma_f32_16x16x32_bf16 v[252:255], a[88:91], a[56:59], v[252:255]
    v_mfma_f32_16x16x32_bf16 v[252:255], a[92:95], a[60:63], v[252:255]
    v_mfma_f32_16x16x32_bf16 v[244:247], a[84:87], a[60:63], v[244:247]
    v_mfma_f32_16x16x32_bf16 v[244:247], a[80:83], a[56:59], v[244:247]
    buffer_load_dwordx4 v11, s[24:27], s37 offen offset:3072  lds
    v_mfma_f32_16x16x32_bf16 v[236:239], a[72:75], a[56:59], v[236:239]
    s_add_u32 s37, s37, 128
    v_mfma_f32_16x16x32_bf16 v[236:239], a[76:79], a[60:63], v[236:239]
    v_mfma_f32_16x16x32_bf16 v[228:231], a[68:71], a[60:63], v[228:231]
    s_waitcnt vmcnt(25) lgkmcnt(0)
    v_mfma_f32_16x16x32_bf16 v[228:231], a[64:67], a[56:59], v[228:231]
    s_barrier
    v_mfma_f32_16x16x32_bf16 a[192:195], a[96:99], a[0:3], a[192:195]
    ds_read_b64_tr_b16 a[64:65], v26 offset:49152
    v_mfma_f32_16x16x32_bf16 a[192:195], a[100:103], a[4:7], a[192:195]
    s_add_u32 m0, s41, 32768
    ds_read_b64_tr_b16 a[66:67], v26 offset:50176
    v_mfma_f32_16x16x32_bf16 a[196:199], a[108:111], a[4:7], a[196:199]
    ds_read_b64_tr_b16 a[68:69], v26 offset:57344
    v_mfma_f32_16x16x32_bf16 a[196:199], a[104:107], a[0:3], a[196:199]
    buffer_load_dwordx4 v8, s[24:27], s36 offen offset:0  lds
    v_mfma_f32_16x16x32_bf16 a[200:203], a[112:115], a[0:3], a[200:203]
    ds_read_b64_tr_b16 a[70:71], v26 offset:58368
    v_mfma_f32_16x16x32_bf16 a[200:203], a[116:119], a[4:7], a[200:203]
    ds_read_b64_tr_b16 a[72:73], v27 offset:49152
    v_mfma_f32_16x16x32_bf16 a[204:207], a[124:127], a[4:7], a[204:207]
    ds_read_b64_tr_b16 a[74:75], v27 offset:50176
    v_mfma_f32_16x16x32_bf16 a[204:207], a[120:123], a[0:3], a[204:207]
    ds_read_b64_tr_b16 a[76:77], v27 offset:57344
    v_mfma_f32_16x16x32_bf16 a[220:223], a[120:123], a[8:11], a[220:223]
    ds_read_b64_tr_b16 a[78:79], v27 offset:58368
    v_mfma_f32_16x16x32_bf16 a[220:223], a[124:127], a[12:15], a[220:223]
    ds_read_b64_tr_b16 a[80:81], v28 offset:49152
    v_mfma_f32_16x16x32_bf16 a[216:219], a[116:119], a[12:15], a[216:219]
    ds_read_b64_tr_b16 a[82:83], v28 offset:50176
    v_mfma_f32_16x16x32_bf16 a[216:219], a[112:115], a[8:11], a[216:219]
    buffer_load_dwordx4 v9, s[24:27], s36 offen offset:1024  lds
    v_mfma_f32_16x16x32_bf16 a[212:215], a[104:107], a[8:11], a[212:215]
    s_add_u32 s61, s58, s53
    ds_read_b64_tr_b16 a[84:85], v28 offset:57344
    v_mfma_f32_16x16x32_bf16 a[212:215], a[108:111], a[12:15], a[212:215]
    ds_read_b64_tr_b16 a[86:87], v28 offset:58368
    v_mfma_f32_16x16x32_bf16 a[208:211], a[100:103], a[12:15], a[208:211]
    ds_read_b64_tr_b16 a[88:89], v29 offset:49152
    v_mfma_f32_16x16x32_bf16 a[208:211], a[96:99], a[8:11], a[208:211]
    ds_read_b64_tr_b16 a[90:91], v29 offset:50176
    v_mfma_f32_16x16x32_bf16 a[224:227], a[96:99], a[16:19], a[224:227]
    ds_read_b64_tr_b16 a[92:93], v29 offset:57344
    v_mfma_f32_16x16x32_bf16 a[224:227], a[100:103], a[20:23], a[224:227]
    ds_read_b64_tr_b16 a[94:95], v29 offset:58368
    v_mfma_f32_16x16x32_bf16 a[228:231], a[108:111], a[20:23], a[228:231]
    buffer_store_dwordx4 v[168:171], v30, s[32:35], s61 offen sc1
    v_mfma_f32_16x16x32_bf16 a[228:231], a[104:107], a[16:19], a[228:231]
    buffer_load_dwordx4 v10, s[24:27], s36 offen offset:2048  lds
    v_mfma_f32_16x16x32_bf16 a[232:235], a[112:115], a[16:19], a[232:235]
    v_mfma_f32_16x16x32_bf16 a[232:235], a[116:119], a[20:23], a[232:235]
    v_mfma_f32_16x16x32_bf16 a[236:239], a[124:127], a[20:23], a[236:239]
    v_mfma_f32_16x16x32_bf16 a[236:239], a[120:123], a[16:19], a[236:239]
    v_mfma_f32_16x16x32_bf16 a[252:255], a[120:123], a[24:27], a[252:255]
    v_mfma_f32_16x16x32_bf16 a[252:255], a[124:127], a[28:31], a[252:255]
    v_mfma_f32_16x16x32_bf16 a[248:251], a[116:119], a[28:31], a[248:251]
    v_mfma_f32_16x16x32_bf16 a[248:251], a[112:115], a[24:27], a[248:251]
    buffer_load_dwordx4 v11, s[24:27], s36 offen offset:3072  lds
    v_mfma_f32_16x16x32_bf16 a[244:247], a[104:107], a[24:27], a[244:247]
    s_add_u32 s36, s36, 128
    v_mfma_f32_16x16x32_bf16 a[244:247], a[108:111], a[28:31], a[244:247]
    v_mfma_f32_16x16x32_bf16 a[240:243], a[100:103], a[28:31], a[240:243]
    s_waitcnt vmcnt(25) lgkmcnt(0)
    v_mfma_f32_16x16x32_bf16 a[240:243], a[96:99], a[24:27], a[240:243]
    s_barrier
    v_mfma_f32_16x16x32_bf16 a[128:131], a[64:67], a[0:3], a[128:131]
    ds_read_b128 a[32:35], v24 offset:49152
    v_mfma_f32_16x16x32_bf16 a[128:131], a[68:71], a[4:7], a[128:131]
    s_add_u32 m0, s41, 98304
    v_mfma_f32_16x16x32_bf16 a[132:135], a[76:79], a[4:7], a[132:135]
    ds_read_b128 a[36:39], v25 offset:49152
    v_mfma_f32_16x16x32_bf16 a[132:135], a[72:75], a[0:3], a[132:135]
    buffer_load_dwordx4 v12, s[28:31], s38 offen offset:0  lds
    v_mfma_f32_16x16x32_bf16 a[136:139], a[80:83], a[0:3], a[136:139]
    ds_read_b128 a[40:43], v24 offset:51200
    v_mfma_f32_16x16x32_bf16 a[136:139], a[84:87], a[4:7], a[136:139]
    v_mfma_f32_16x16x32_bf16 a[140:143], a[92:95], a[4:7], a[140:143]
    ds_read_b128 a[44:47], v25 offset:51200
    v_mfma_f32_16x16x32_bf16 a[140:143], a[88:91], a[0:3], a[140:143]
    v_mfma_f32_16x16x32_bf16 a[156:159], a[88:91], a[8:11], a[156:159]
    ds_read_b128 a[48:51], v24 offset:53248
    v_mfma_f32_16x16x32_bf16 a[156:159], a[92:95], a[12:15], a[156:159]
    v_mfma_f32_16x16x32_bf16 a[152:155], a[84:87], a[12:15], a[152:155]
    s_add_u32 s64, s58, s54
    ds_read_b128 a[52:55], v25 offset:53248
    v_mfma_f32_16x16x32_bf16 a[152:155], a[80:83], a[8:11], a[152:155]
    buffer_load_dwordx4 v13, s[28:31], s38 offen offset:1024  lds
    v_mfma_f32_16x16x32_bf16 a[148:151], a[72:75], a[8:11], a[148:151]
    ds_read_b128 a[56:59], v24 offset:55296
    v_mfma_f32_16x16x32_bf16 a[148:151], a[76:79], a[12:15], a[148:151]
    buffer_store_dwordx4 v[176:179], v30, s[32:35], s64 offen sc1
    v_mfma_f32_16x16x32_bf16 a[144:147], a[68:71], a[12:15], a[144:147]
    ds_read_b128 a[60:63], v25 offset:55296
    v_mfma_f32_16x16x32_bf16 a[144:147], a[64:67], a[8:11], a[144:147]
    v_mfma_f32_16x16x32_bf16 a[160:163], a[64:67], a[16:19], a[160:163]
    v_mfma_f32_16x16x32_bf16 a[160:163], a[68:71], a[20:23], a[160:163]
    v_mfma_f32_16x16x32_bf16 a[164:167], a[76:79], a[20:23], a[164:167]
    v_mfma_f32_16x16x32_bf16 a[164:167], a[72:75], a[16:19], a[164:167]
    buffer_load_dwordx4 v14, s[28:31], s38 offen offset:2048  lds
    v_mfma_f32_16x16x32_bf16 a[168:171], a[80:83], a[16:19], a[168:171]
    v_mfma_f32_16x16x32_bf16 a[168:171], a[84:87], a[20:23], a[168:171]
    v_mfma_f32_16x16x32_bf16 a[172:175], a[92:95], a[20:23], a[172:175]
    v_mfma_f32_16x16x32_bf16 a[172:175], a[88:91], a[16:19], a[172:175]
    v_mfma_f32_16x16x32_bf16 a[188:191], a[88:91], a[24:27], a[188:191]
    v_mfma_f32_16x16x32_bf16 a[188:191], a[92:95], a[28:31], a[188:191]
    v_mfma_f32_16x16x32_bf16 a[184:187], a[84:87], a[28:31], a[184:187]
    v_mfma_f32_16x16x32_bf16 a[184:187], a[80:83], a[24:27], a[184:187]
    buffer_load_dwordx4 v15, s[28:31], s38 offen offset:3072  lds
    v_mfma_f32_16x16x32_bf16 a[180:183], a[72:75], a[24:27], a[180:183]
    s_add_u32 s38, s38, s40
    v_mfma_f32_16x16x32_bf16 a[180:183], a[76:79], a[28:31], a[180:183]
    v_mfma_f32_16x16x32_bf16 a[176:179], a[68:71], a[28:31], a[176:179]
    s_waitcnt vmcnt(25) lgkmcnt(0)
    v_mfma_f32_16x16x32_bf16 a[176:179], a[64:67], a[24:27], a[176:179]
    s_barrier
    v_mfma_f32_16x16x32_bf16 v[64:67], a[64:67], a[32:35], v[64:67]
    ds_read_b128 a[0:3], v24 offset:0
    v_mfma_f32_16x16x32_bf16 v[64:67], a[68:71], a[36:39], v[64:67]
    s_add_u32 m0, s41, 114688
    v_mfma_f32_16x16x32_bf16 v[68:71], a[76:79], a[36:39], v[68:71]
    ds_read_b128 a[4:7], v25 offset:0
    v_mfma_f32_16x16x32_bf16 v[68:71], a[72:75], a[32:35], v[68:71]
    buffer_load_dwordx4 v12, s[28:31], s39 offen offset:0  lds
    v_mfma_f32_16x16x32_bf16 v[72:75], a[80:83], a[32:35], v[72:75]
    ds_read_b128 a[8:11], v24 offset:2048
    v_mfma_f32_16x16x32_bf16 v[72:75], a[84:87], a[36:39], v[72:75]
    v_mfma_f32_16x16x32_bf16 v[76:79], a[92:95], a[36:39], v[76:79]
    ds_read_b128 a[12:15], v25 offset:2048
    v_mfma_f32_16x16x32_bf16 v[76:79], a[88:91], a[32:35], v[76:79]
    v_mfma_f32_16x16x32_bf16 v[92:95], a[88:91], a[40:43], v[92:95]
    s_add_u32 s65, s58, s55
    ds_read_b128 a[16:19], v24 offset:4096
    v_mfma_f32_16x16x32_bf16 v[92:95], a[92:95], a[44:47], v[92:95]
    v_mfma_f32_16x16x32_bf16 v[88:91], a[84:87], a[44:47], v[88:91]
    ds_read_b128 a[20:23], v25 offset:4096
    v_mfma_f32_16x16x32_bf16 v[88:91], a[80:83], a[40:43], v[88:91]
    buffer_load_dwordx4 v13, s[28:31], s39 offen offset:1024  lds
    v_mfma_f32_16x16x32_bf16 v[84:87], a[72:75], a[40:43], v[84:87]
    ds_read_b128 a[24:27], v24 offset:6144
    v_mfma_f32_16x16x32_bf16 v[84:87], a[76:79], a[44:47], v[84:87]
    buffer_store_dwordx4 v[184:187], v30, s[32:35], s65 offen sc1
    v_mfma_f32_16x16x32_bf16 v[80:83], a[68:71], a[44:47], v[80:83]
    ds_read_b128 a[28:31], v25 offset:6144
    v_mfma_f32_16x16x32_bf16 v[80:83], a[64:67], a[40:43], v[80:83]
    v_mfma_f32_16x16x32_bf16 v[96:99], a[64:67], a[48:51], v[96:99]
    v_mfma_f32_16x16x32_bf16 v[96:99], a[68:71], a[52:55], v[96:99]
    v_mfma_f32_16x16x32_bf16 v[100:103], a[76:79], a[52:55], v[100:103]
    v_mfma_f32_16x16x32_bf16 v[100:103], a[72:75], a[48:51], v[100:103]
    buffer_load_dwordx4 v14, s[28:31], s39 offen offset:2048  lds
    v_mfma_f32_16x16x32_bf16 v[104:107], a[80:83], a[48:51], v[104:107]
    v_mfma_f32_16x16x32_bf16 v[104:107], a[84:87], a[52:55], v[104:107]
    v_mfma_f32_16x16x32_bf16 v[108:111], a[92:95], a[52:55], v[108:111]
    v_mfma_f32_16x16x32_bf16 v[108:111], a[88:91], a[48:51], v[108:111]
    v_mfma_f32_16x16x32_bf16 v[124:127], a[88:91], a[56:59], v[124:127]
    v_mfma_f32_16x16x32_bf16 v[124:127], a[92:95], a[60:63], v[124:127]
    v_mfma_f32_16x16x32_bf16 v[120:123], a[84:87], a[60:63], v[120:123]
    v_mfma_f32_16x16x32_bf16 v[120:123], a[80:83], a[56:59], v[120:123]
    buffer_load_dwordx4 v15, s[28:31], s39 offen offset:3072  lds
    v_mfma_f32_16x16x32_bf16 v[116:119], a[72:75], a[56:59], v[116:119]
    s_add_u32 s39, s39, s40
    v_mfma_f32_16x16x32_bf16 v[116:119], a[76:79], a[60:63], v[116:119]
    v_mfma_f32_16x16x32_bf16 v[112:115], a[68:71], a[60:63], v[112:115]
    s_waitcnt vmcnt(25) lgkmcnt(0)
    v_mfma_f32_16x16x32_bf16 v[112:115], a[64:67], a[56:59], v[112:115]
    s_barrier
    v_mfma_f32_16x16x32_bf16 v[132:135], a[96:99], a[32:35], v[132:135]
    ds_read_b64_tr_b16 a[64:65], v26 offset:0
    v_mfma_f32_16x16x32_bf16 v[132:135], a[100:103], a[36:39], v[132:135]
    s_add_u32 m0, s41, 49152
    ds_read_b64_tr_b16 a[66:67], v26 offset:1024
    v_mfma_f32_16x16x32_bf16 v[140:143], a[108:111], a[36:39], v[140:143]
    ds_read_b64_tr_b16 a[68:69], v26 offset:8192
    v_mfma_f32_16x16x32_bf16 v[140:143], a[104:107], a[32:35], v[140:143]
    buffer_load_dwordx4 v8, s[24:27], s37 offen offset:0  lds
    v_mfma_f32_16x16x32_bf16 v[148:151], a[112:115], a[32:35], v[148:151]
    ds_read_b64_tr_b16 a[70:71], v26 offset:9216
    v_mfma_f32_16x16x32_bf16 v[148:151], a[116:119], a[36:39], v[148:151]
    ds_read_b64_tr_b16 a[72:73], v27 offset:0
    v_mfma_f32_16x16x32_bf16 v[156:159], a[124:127], a[36:39], v[156:159]
    s_add_u32 s60, s59, s48
    ds_read_b64_tr_b16 a[74:75], v27 offset:1024
    v_mfma_f32_16x16x32_bf16 v[156:159], a[120:123], a[32:35], v[156:159]
    ds_read_b64_tr_b16 a[76:77], v27 offset:8192
    v_mfma_f32_16x16x32_bf16 v[188:191], a[120:123], a[40:43], v[188:191]
    ds_read_b64_tr_b16 a[78:79], v27 offset:9216
    v_mfma_f32_16x16x32_bf16 v[188:191], a[124:127], a[44:47], v[188:191]
    ds_read_b64_tr_b16 a[80:81], v28 offset:0
    v_mfma_f32_16x16x32_bf16 v[180:183], a[116:119], a[44:47], v[180:183]
    ds_read_b64_tr_b16 a[82:83], v28 offset:1024
    v_mfma_f32_16x16x32_bf16 v[180:183], a[112:115], a[40:43], v[180:183]
    buffer_load_dwordx4 v9, s[24:27], s37 offen offset:1024  lds
    v_mfma_f32_16x16x32_bf16 v[172:175], a[104:107], a[40:43], v[172:175]
    ds_read_b64_tr_b16 a[84:85], v28 offset:8192
    v_mfma_f32_16x16x32_bf16 v[172:175], a[108:111], a[44:47], v[172:175]
    ds_read_b64_tr_b16 a[86:87], v28 offset:9216
    v_mfma_f32_16x16x32_bf16 v[164:167], a[100:103], a[44:47], v[164:167]
    ds_read_b64_tr_b16 a[88:89], v29 offset:0
    v_mfma_f32_16x16x32_bf16 v[164:167], a[96:99], a[40:43], v[164:167]
    ds_read_b64_tr_b16 a[90:91], v29 offset:1024
    v_mfma_f32_16x16x32_bf16 v[196:199], a[96:99], a[48:51], v[196:199]
    ds_read_b64_tr_b16 a[92:93], v29 offset:8192
    v_mfma_f32_16x16x32_bf16 v[196:199], a[100:103], a[52:55], v[196:199]
    ds_read_b64_tr_b16 a[94:95], v29 offset:9216
    v_mfma_f32_16x16x32_bf16 v[204:207], a[108:111], a[52:55], v[204:207]
    buffer_store_dwordx4 v[192:195], v30, s[32:35], s60 offen sc1
    v_mfma_f32_16x16x32_bf16 v[204:207], a[104:107], a[48:51], v[204:207]
    buffer_load_dwordx4 v10, s[24:27], s37 offen offset:2048  lds
    v_mfma_f32_16x16x32_bf16 v[212:215], a[112:115], a[48:51], v[212:215]
    v_mfma_f32_16x16x32_bf16 v[212:215], a[116:119], a[52:55], v[212:215]
    v_mfma_f32_16x16x32_bf16 v[220:223], a[124:127], a[52:55], v[220:223]
    v_mfma_f32_16x16x32_bf16 v[220:223], a[120:123], a[48:51], v[220:223]
    v_mfma_f32_16x16x32_bf16 v[252:255], a[120:123], a[56:59], v[252:255]
    v_mfma_f32_16x16x32_bf16 v[252:255], a[124:127], a[60:63], v[252:255]
    v_mfma_f32_16x16x32_bf16 v[244:247], a[116:119], a[60:63], v[244:247]
    v_mfma_f32_16x16x32_bf16 v[244:247], a[112:115], a[56:59], v[244:247]
    buffer_load_dwordx4 v11, s[24:27], s37 offen offset:3072  lds
    v_mfma_f32_16x16x32_bf16 v[236:239], a[104:107], a[56:59], v[236:239]
    s_add_u32 s37, s37, 128
    v_mfma_f32_16x16x32_bf16 v[236:239], a[108:111], a[60:63], v[236:239]
    v_mfma_f32_16x16x32_bf16 v[228:231], a[100:103], a[60:63], v[228:231]
    s_waitcnt vmcnt(25) lgkmcnt(0)
    v_mfma_f32_16x16x32_bf16 v[228:231], a[96:99], a[56:59], v[228:231]
    s_barrier
    v_mfma_f32_16x16x32_bf16 a[192:195], a[64:67], a[0:3], a[192:195]
    ds_read_b64_tr_b16 a[96:97], v26 offset:16384
    v_mfma_f32_16x16x32_bf16 a[192:195], a[68:71], a[4:7], a[192:195]
    s_add_u32 m0, s41, 0
    ds_read_b64_tr_b16 a[98:99], v26 offset:17408
    v_mfma_f32_16x16x32_bf16 a[196:199], a[76:79], a[4:7], a[196:199]
    ds_read_b64_tr_b16 a[100:101], v26 offset:24576
    v_mfma_f32_16x16x32_bf16 a[196:199], a[72:75], a[0:3], a[196:199]
    buffer_load_dwordx4 v8, s[24:27], s36 offen offset:0  lds
    v_mfma_f32_16x16x32_bf16 a[200:203], a[80:83], a[0:3], a[200:203]
    s_add_u32 s61, s59, s49
    ds_read_b64_tr_b16 a[102:103], v26 offset:25600
    v_mfma_f32_16x16x32_bf16 a[200:203], a[84:87], a[4:7], a[200:203]
    ds_read_b64_tr_b16 a[104:105], v27 offset:16384
    v_mfma_f32_16x16x32_bf16 a[204:207], a[92:95], a[4:7], a[204:207]
    ds_read_b64_tr_b16 a[106:107], v27 offset:17408
    v_mfma_f32_16x16x32_bf16 a[204:207], a[88:91], a[0:3], a[204:207]
    ds_read_b64_tr_b16 a[108:109], v27 offset:24576
    v_mfma_f32_16x16x32_bf16 a[220:223], a[88:91], a[8:11], a[220:223]
    ds_read_b64_tr_b16 a[110:111], v27 offset:25600
    v_mfma_f32_16x16x32_bf16 a[220:223], a[92:95], a[12:15], a[220:223]
    ds_read_b64_tr_b16 a[112:113], v28 offset:16384
    v_mfma_f32_16x16x32_bf16 a[216:219], a[84:87], a[12:15], a[216:219]
    ds_read_b64_tr_b16 a[114:115], v28 offset:17408
    v_mfma_f32_16x16x32_bf16 a[216:219], a[80:83], a[8:11], a[216:219]
    buffer_load_dwordx4 v9, s[24:27], s36 offen offset:1024  lds
    v_mfma_f32_16x16x32_bf16 a[212:215], a[72:75], a[8:11], a[212:215]
    ds_read_b64_tr_b16 a[116:117], v28 offset:24576
    v_mfma_f32_16x16x32_bf16 a[212:215], a[76:79], a[12:15], a[212:215]
    ds_read_b64_tr_b16 a[118:119], v28 offset:25600
    v_mfma_f32_16x16x32_bf16 a[208:211], a[68:71], a[12:15], a[208:211]
    ds_read_b64_tr_b16 a[120:121], v29 offset:16384
    v_mfma_f32_16x16x32_bf16 a[208:211], a[64:67], a[8:11], a[208:211]
    ds_read_b64_tr_b16 a[122:123], v29 offset:17408
    v_mfma_f32_16x16x32_bf16 a[224:227], a[64:67], a[16:19], a[224:227]
    ds_read_b64_tr_b16 a[124:125], v29 offset:24576
    v_mfma_f32_16x16x32_bf16 a[224:227], a[68:71], a[20:23], a[224:227]
    ds_read_b64_tr_b16 a[126:127], v29 offset:25600
    v_mfma_f32_16x16x32_bf16 a[228:231], a[76:79], a[20:23], a[228:231]
    buffer_store_dwordx4 v[200:203], v30, s[32:35], s61 offen sc1
    v_mfma_f32_16x16x32_bf16 a[228:231], a[72:75], a[16:19], a[228:231]
    buffer_load_dwordx4 v10, s[24:27], s36 offen offset:2048  lds
    v_mfma_f32_16x16x32_bf16 a[232:235], a[80:83], a[16:19], a[232:235]
    v_mfma_f32_16x16x32_bf16 a[232:235], a[84:87], a[20:23], a[232:235]
    v_mfma_f32_16x16x32_bf16 a[236:239], a[92:95], a[20:23], a[236:239]
    v_mfma_f32_16x16x32_bf16 a[236:239], a[88:91], a[16:19], a[236:239]
    v_mfma_f32_16x16x32_bf16 a[252:255], a[88:91], a[24:27], a[252:255]
    v_mfma_f32_16x16x32_bf16 a[252:255], a[92:95], a[28:31], a[252:255]
    v_mfma_f32_16x16x32_bf16 a[248:251], a[84:87], a[28:31], a[248:251]
    v_mfma_f32_16x16x32_bf16 a[248:251], a[80:83], a[24:27], a[248:251]
    buffer_load_dwordx4 v11, s[24:27], s36 offen offset:3072  lds
    v_mfma_f32_16x16x32_bf16 a[244:247], a[72:75], a[24:27], a[244:247]
    s_add_u32 s36, s36, 128
    v_mfma_f32_16x16x32_bf16 a[244:247], a[76:79], a[28:31], a[244:247]
    v_mfma_f32_16x16x32_bf16 a[240:243], a[68:71], a[28:31], a[240:243]
    s_waitcnt vmcnt(25) lgkmcnt(0)
    v_mfma_f32_16x16x32_bf16 a[240:243], a[64:67], a[24:27], a[240:243]
    s_barrier
    v_mfma_f32_16x16x32_bf16 a[128:131], a[96:99], a[0:3], a[128:131]
    ds_read_b128 a[32:35], v24 offset:16384
    v_mfma_f32_16x16x32_bf16 a[128:131], a[100:103], a[4:7], a[128:131]
    s_add_u32 m0, s41, 65536
    v_mfma_f32_16x16x32_bf16 a[132:135], a[108:111], a[4:7], a[132:135]
    s_add_u32 s64, s59, s50
    ds_read_b128 a[36:39], v25 offset:16384
    v_mfma_f32_16x16x32_bf16 a[132:135], a[104:107], a[0:3], a[132:135]
    buffer_load_dwordx4 v12, s[28:31], s38 offen offset:0  lds
    v_mfma_f32_16x16x32_bf16 a[136:139], a[112:115], a[0:3], a[136:139]
    ds_read_b128 a[40:43], v24 offset:18432
    v_mfma_f32_16x16x32_bf16 a[136:139], a[116:119], a[4:7], a[136:139]
    buffer_store_dwordx4 v[208:211], v30, s[32:35], s64 offen sc1
    v_mfma_f32_16x16x32_bf16 a[140:143], a[124:127], a[4:7], a[140:143]
    ds_read_b128 a[44:47], v25 offset:18432
    v_mfma_f32_16x16x32_bf16 a[140:143], a[120:123], a[0:3], a[140:143]
    v_mfma_f32_16x16x32_bf16 a[156:159], a[120:123], a[8:11], a[156:159]
    ds_read_b128 a[48:51], v24 offset:20480
    v_mfma_f32_16x16x32_bf16 a[156:159], a[124:127], a[12:15], a[156:159]
    v_mfma_f32_16x16x32_bf16 a[152:155], a[116:119], a[12:15], a[152:155]
    ds_read_b128 a[52:55], v25 offset:20480
    v_mfma_f32_16x16x32_bf16 a[152:155], a[112:115], a[8:11], a[152:155]
    buffer_load_dwordx4 v13, s[28:31], s38 offen offset:1024  lds
    v_mfma_f32_16x16x32_bf16 a[148:151], a[104:107], a[8:11], a[148:151]
    ds_read_b128 a[56:59], v24 offset:22528
    v_mfma_f32_16x16x32_bf16 a[148:151], a[108:111], a[12:15], a[148:151]
    v_mfma_f32_16x16x32_bf16 a[144:147], a[100:103], a[12:15], a[144:147]
    ds_read_b128 a[60:63], v25 offset:22528
    v_mfma_f32_16x16x32_bf16 a[144:147], a[96:99], a[8:11], a[144:147]
    v_mfma_f32_16x16x32_bf16 a[160:163], a[96:99], a[16:19], a[160:163]
    v_mfma_f32_16x16x32_bf16 a[160:163], a[100:103], a[20:23], a[160:163]
    v_mfma_f32_16x16x32_bf16 a[164:167], a[108:111], a[20:23], a[164:167]
    v_mfma_f32_16x16x32_bf16 a[164:167], a[104:107], a[16:19], a[164:167]
    buffer_load_dwordx4 v14, s[28:31], s38 offen offset:2048  lds
    v_mfma_f32_16x16x32_bf16 a[168:171], a[112:115], a[16:19], a[168:171]
    v_mfma_f32_16x16x32_bf16 a[168:171], a[116:119], a[20:23], a[168:171]
    v_mfma_f32_16x16x32_bf16 a[172:175], a[124:127], a[20:23], a[172:175]
    v_mfma_f32_16x16x32_bf16 a[172:175], a[120:123], a[16:19], a[172:175]
    v_mfma_f32_16x16x32_bf16 a[188:191], a[120:123], a[24:27], a[188:191]
    v_mfma_f32_16x16x32_bf16 a[188:191], a[124:127], a[28:31], a[188:191]
    v_mfma_f32_16x16x32_bf16 a[184:187], a[116:119], a[28:31], a[184:187]
    v_mfma_f32_16x16x32_bf16 a[184:187], a[112:115], a[24:27], a[184:187]
    buffer_load_dwordx4 v15, s[28:31], s38 offen offset:3072  lds
    v_mfma_f32_16x16x32_bf16 a[180:183], a[104:107], a[24:27], a[180:183]
    s_add_u32 s38, s38, s40
    v_mfma_f32_16x16x32_bf16 a[180:183], a[108:111], a[28:31], a[180:183]
    v_mfma_f32_16x16x32_bf16 a[176:179], a[100:103], a[28:31], a[176:179]
    s_waitcnt vmcnt(25) lgkmcnt(0)
    v_mfma_f32_16x16x32_bf16 a[176:179], a[96:99], a[24:27], a[176:179]
    s_barrier
    v_mfma_f32_16x16x32_bf16 v[64:67], a[96:99], a[32:35], v[64:67]
    s_add_u32 s65, s59, s51
    ds_read_b128 a[0:3], v24 offset:32768
    v_mfma_f32_16x16x32_bf16 v[64:67], a[100:103], a[36:39], v[64:67]
    s_add_u32 m0, s41, 81920
    v_mfma_f32_16x16x32_bf16 v[68:71], a[108:111], a[36:39], v[68:71]
    ds_read_b128 a[4:7], v25 offset:32768
    v_mfma_f32_16x16x32_bf16 v[68:71], a[104:107], a[32:35], v[68:71]
    buffer_load_dwordx4 v12, s[28:31], s39 offen offset:0  lds
    v_mfma_f32_16x16x32_bf16 v[72:75], a[112:115], a[32:35], v[72:75]
    ds_read_b128 a[8:11], v24 offset:34816
    v_mfma_f32_16x16x32_bf16 v[72:75], a[116:119], a[36:39], v[72:75]
    buffer_store_dwordx4 v[216:219], v30, s[32:35], s65 offen sc1
    v_mfma_f32_16x16x32_bf16 v[76:79], a[124:127], a[36:39], v[76:79]
    ds_read_b128 a[12:15], v25 offset:34816
    v_mfma_f32_16x16x32_bf16 v[76:79], a[120:123], a[32:35], v[76:79]
    v_mfma_f32_16x16x32_bf16 v[92:95], a[120:123], a[40:43], v[92:95]
    ds_read_b128 a[16:19], v24 offset:36864
    v_mfma_f32_16x16x32_bf16 v[92:95], a[124:127], a[44:47], v[92:95]
    v_mfma_f32_16x16x32_bf16 v[88:91], a[116:119], a[44:47], v[88:91]
    ds_read_b128 a[20:23], v25 offset:36864
    v_mfma_f32_16x16x32_bf16 v[88:91], a[112:115], a[40:43], v[88:91]
    buffer_load_dwordx4 v13, s[28:31], s39 offen offset:1024  lds
    v_mfma_f32_16x16x32_bf16 v[84:87], a[104:107], a[40:43], v[84:87]
    ds_read_b128 a[24:27], v24 offset:38912
    v_mfma_f32_16x16x32_bf16 v[84:87], a[108:111], a[44:47], v[84:87]
    v_mfma_f32_16x16x32_bf16 v[80:83], a[100:103], a[44:47], v[80:83]
    ds_read_b128 a[28:31], v25 offset:38912
    v_mfma_f32_16x16x32_bf16 v[80:83], a[96:99], a[40:43], v[80:83]
    v_mfma_f32_16x16x32_bf16 v[96:99], a[96:99], a[48:51], v[96:99]
    v_mfma_f32_16x16x32_bf16 v[96:99], a[100:103], a[52:55], v[96:99]
    v_mfma_f32_16x16x32_bf16 v[100:103], a[108:111], a[52:55], v[100:103]
    v_mfma_f32_16x16x32_bf16 v[100:103], a[104:107], a[48:51], v[100:103]
    buffer_load_dwordx4 v14, s[28:31], s39 offen offset:2048  lds
    v_mfma_f32_16x16x32_bf16 v[104:107], a[112:115], a[48:51], v[104:107]
    v_mfma_f32_16x16x32_bf16 v[104:107], a[116:119], a[52:55], v[104:107]
    v_mfma_f32_16x16x32_bf16 v[108:111], a[124:127], a[52:55], v[108:111]
    v_mfma_f32_16x16x32_bf16 v[108:111], a[120:123], a[48:51], v[108:111]
    v_mfma_f32_16x16x32_bf16 v[124:127], a[120:123], a[56:59], v[124:127]
    v_mfma_f32_16x16x32_bf16 v[124:127], a[124:127], a[60:63], v[124:127]
    v_mfma_f32_16x16x32_bf16 v[120:123], a[116:119], a[60:63], v[120:123]
    v_mfma_f32_16x16x32_bf16 v[120:123], a[112:115], a[56:59], v[120:123]
    buffer_load_dwordx4 v15, s[28:31], s39 offen offset:3072  lds
    v_mfma_f32_16x16x32_bf16 v[116:119], a[104:107], a[56:59], v[116:119]
    s_add_u32 s39, s39, s40
    v_mfma_f32_16x16x32_bf16 v[116:119], a[108:111], a[60:63], v[116:119]
    v_mfma_f32_16x16x32_bf16 v[112:115], a[100:103], a[60:63], v[112:115]
    s_waitcnt vmcnt(25) lgkmcnt(0)
    v_mfma_f32_16x16x32_bf16 v[112:115], a[96:99], a[56:59], v[112:115]
    s_barrier
    v_mfma_f32_16x16x32_bf16 v[132:135], a[64:67], a[32:35], v[132:135]
    s_add_u32 s60, s59, s52
    ds_read_b64_tr_b16 a[96:97], v26 offset:32768
    v_mfma_f32_16x16x32_bf16 v[132:135], a[68:71], a[36:39], v[132:135]
    s_add_u32 m0, s41, 16384
    ds_read_b64_tr_b16 a[98:99], v26 offset:33792
    v_mfma_f32_16x16x32_bf16 v[140:143], a[76:79], a[36:39], v[140:143]
    ds_read_b64_tr_b16 a[100:101], v26 offset:40960
    v_mfma_f32_16x16x32_bf16 v[140:143], a[72:75], a[32:35], v[140:143]
    buffer_load_dwordx4 v8, s[24:27], s37 offen offset:0  lds
    v_mfma_f32_16x16x32_bf16 v[148:151], a[80:83], a[32:35], v[148:151]
    ds_read_b64_tr_b16 a[102:103], v26 offset:41984
    v_mfma_f32_16x16x32_bf16 v[148:151], a[84:87], a[36:39], v[148:151]
    ds_read_b64_tr_b16 a[104:105], v27 offset:32768
    v_mfma_f32_16x16x32_bf16 v[156:159], a[92:95], a[36:39], v[156:159]
    ds_read_b64_tr_b16 a[106:107], v27 offset:33792
    v_mfma_f32_16x16x32_bf16 v[156:159], a[88:91], a[32:35], v[156:159]
    ds_read_b64_tr_b16 a[108:109], v27 offset:40960
    v_mfma_f32_16x16x32_bf16 v[188:191], a[88:91], a[40:43], v[188:191]
    ds_read_b64_tr_b16 a[110:111], v27 offset:41984
    v_mfma_f32_16x16x32_bf16 v[188:191], a[92:95], a[44:47], v[188:191]
    ds_read_b64_tr_b16 a[112:113], v28 offset:32768
    v_mfma_f32_16x16x32_bf16 v[180:183], a[84:87], a[44:47], v[180:183]
    ds_read_b64_tr_b16 a[114:115], v28 offset:33792
    v_mfma_f32_16x16x32_bf16 v[180:183], a[80:83], a[40:43], v[180:183]
    buffer_load_dwordx4 v9, s[24:27], s37 offen offset:1024  lds
    v_mfma_f32_16x16x32_bf16 v[172:175], a[72:75], a[40:43], v[172:175]
    ds_read_b64_tr_b16 a[116:117], v28 offset:40960
    v_mfma_f32_16x16x32_bf16 v[172:175], a[76:79], a[44:47], v[172:175]
    ds_read_b64_tr_b16 a[118:119], v28 offset:41984
    v_mfma_f32_16x16x32_bf16 v[164:167], a[68:71], a[44:47], v[164:167]
    ds_read_b64_tr_b16 a[120:121], v29 offset:32768
    v_mfma_f32_16x16x32_bf16 v[164:167], a[64:67], a[40:43], v[164:167]
    ds_read_b64_tr_b16 a[122:123], v29 offset:33792
    v_mfma_f32_16x16x32_bf16 v[196:199], a[64:67], a[48:51], v[196:199]
    ds_read_b64_tr_b16 a[124:125], v29 offset:40960
    v_mfma_f32_16x16x32_bf16 v[196:199], a[68:71], a[52:55], v[196:199]
    ds_read_b64_tr_b16 a[126:127], v29 offset:41984
    v_mfma_f32_16x16x32_bf16 v[204:207], a[76:79], a[52:55], v[204:207]
    buffer_store_dwordx4 v[224:227], v30, s[32:35], s60 offen sc1
    v_mfma_f32_16x16x32_bf16 v[204:207], a[72:75], a[48:51], v[204:207]
    buffer_load_dwordx4 v10, s[24:27], s37 offen offset:2048  lds
    v_mfma_f32_16x16x32_bf16 v[212:215], a[80:83], a[48:51], v[212:215]
    v_mfma_f32_16x16x32_bf16 v[212:215], a[84:87], a[52:55], v[212:215]
    v_mfma_f32_16x16x32_bf16 v[220:223], a[92:95], a[52:55], v[220:223]
    v_mfma_f32_16x16x32_bf16 v[220:223], a[88:91], a[48:51], v[220:223]
    v_mfma_f32_16x16x32_bf16 v[252:255], a[88:91], a[56:59], v[252:255]
    v_mfma_f32_16x16x32_bf16 v[252:255], a[92:95], a[60:63], v[252:255]
    v_mfma_f32_16x16x32_bf16 v[244:247], a[84:87], a[60:63], v[244:247]
    v_mfma_f32_16x16x32_bf16 v[244:247], a[80:83], a[56:59], v[244:247]
    buffer_load_dwordx4 v11, s[24:27], s37 offen offset:3072  lds
    v_mfma_f32_16x16x32_bf16 v[236:239], a[72:75], a[56:59], v[236:239]
    s_add_u32 s37, s37, 128
    v_mfma_f32_16x16x32_bf16 v[236:239], a[76:79], a[60:63], v[236:239]
    s_add_u32 s61, s59, s53
    v_mfma_f32_16x16x32_bf16 v[228:231], a[68:71], a[60:63], v[228:231]
    s_waitcnt vmcnt(25) lgkmcnt(0)
    v_mfma_f32_16x16x32_bf16 v[228:231], a[64:67], a[56:59], v[228:231]
    s_barrier
    v_mfma_f32_16x16x32_bf16 a[192:195], a[96:99], a[0:3], a[192:195]
    ds_read_b64_tr_b16 a[64:65], v26 offset:49152
    v_mfma_f32_16x16x32_bf16 a[192:195], a[100:103], a[4:7], a[192:195]
    ds_read_b64_tr_b16 a[66:67], v26 offset:50176
    v_mfma_f32_16x16x32_bf16 a[196:199], a[108:111], a[4:7], a[196:199]
    ds_read_b64_tr_b16 a[68:69], v26 offset:57344
    v_mfma_f32_16x16x32_bf16 a[196:199], a[104:107], a[0:3], a[196:199]
    ds_read_b64_tr_b16 a[70:71], v26 offset:58368
    v_mfma_f32_16x16x32_bf16 a[200:203], a[112:115], a[0:3], a[200:203]
    ds_read_b64_tr_b16 a[72:73], v27 offset:49152
    v_mfma_f32_16x16x32_bf16 a[200:203], a[116:119], a[4:7], a[200:203]
    ds_read_b64_tr_b16 a[74:75], v27 offset:50176
    v_mfma_f32_16x16x32_bf16 a[204:207], a[124:127], a[4:7], a[204:207]
    ds_read_b64_tr_b16 a[76:77], v27 offset:57344
    v_mfma_f32_16x16x32_bf16 a[204:207], a[120:123], a[0:3], a[204:207]
    ds_read_b64_tr_b16 a[78:79], v27 offset:58368
    v_mfma_f32_16x16x32_bf16 a[220:223], a[120:123], a[8:11], a[220:223]
    ds_read_b64_tr_b16 a[80:81], v28 offset:49152
    v_mfma_f32_16x16x32_bf16 a[220:223], a[124:127], a[12:15], a[220:223]
    ds_read_b64_tr_b16 a[82:83], v28 offset:50176
    v_mfma_f32_16x16x32_bf16 a[216:219], a[116:119], a[12:15], a[216:219]
    ds_read_b64_tr_b16 a[84:85], v28 offset:57344
    v_mfma_f32_16x16x32_bf16 a[216:219], a[112:115], a[8:11], a[216:219]
    ds_read_b64_tr_b16 a[86:87], v28 offset:58368
    v_mfma_f32_16x16x32_bf16 a[212:215], a[104:107], a[8:11], a[212:215]
    ds_read_b64_tr_b16 a[88:89], v29 offset:49152
    v_mfma_f32_16x16x32_bf16 a[212:215], a[108:111], a[12:15], a[212:215]
    ds_read_b64_tr_b16 a[90:91], v29 offset:50176
    v_mfma_f32_16x16x32_bf16 a[208:211], a[100:103], a[12:15], a[208:211]
    ds_read_b64_tr_b16 a[92:93], v29 offset:57344
    v_mfma_f32_16x16x32_bf16 a[208:211], a[96:99], a[8:11], a[208:211]
    ds_read_b64_tr_b16 a[94:95], v29 offset:58368
    v_mfma_f32_16x16x32_bf16 a[224:227], a[96:99], a[16:19], a[224:227]
    buffer_store_dwordx4 v[232:235], v30, s[32:35], s61 offen sc1
    v_mfma_f32_16x16x32_bf16 a[224:227], a[100:103], a[20:23], a[224:227]
    v_mfma_f32_16x16x32_bf16 a[228:231], a[108:111], a[20:23], a[228:231]
    v_mfma_f32_16x16x32_bf16 a[228:231], a[104:107], a[16:19], a[228:231]
    v_mfma_f32_16x16x32_bf16 a[232:235], a[112:115], a[16:19], a[232:235]
    v_mfma_f32_16x16x32_bf16 a[232:235], a[116:119], a[20:23], a[232:235]
    v_mfma_f32_16x16x32_bf16 a[236:239], a[124:127], a[20:23], a[236:239]
    v_mfma_f32_16x16x32_bf16 a[236:239], a[120:123], a[16:19], a[236:239]
    v_mfma_f32_16x16x32_bf16 a[252:255], a[120:123], a[24:27], a[252:255]
    v_mfma_f32_16x16x32_bf16 a[252:255], a[124:127], a[28:31], a[252:255]
    v_mfma_f32_16x16x32_bf16 a[248:251], a[116:119], a[28:31], a[248:251]
    s_add_u32 s64, s59, s54
    v_mfma_f32_16x16x32_bf16 a[248:251], a[112:115], a[24:27], a[248:251]
    v_mfma_f32_16x16x32_bf16 a[244:247], a[104:107], a[24:27], a[244:247]
    buffer_store_dwordx4 v[240:243], v30, s[32:35], s64 offen sc1
    v_mfma_f32_16x16x32_bf16 a[244:247], a[108:111], a[28:31], a[244:247]
    v_mfma_f32_16x16x32_bf16 a[240:243], a[100:103], a[28:31], a[240:243]
    s_waitcnt vmcnt(22) lgkmcnt(0)
    v_mfma_f32_16x16x32_bf16 a[240:243], a[96:99], a[24:27], a[240:243]
    s_barrier
    v_mfma_f32_16x16x32_bf16 a[128:131], a[64:67], a[0:3], a[128:131]
    ds_read_b128 a[32:35], v24 offset:49152
    v_mfma_f32_16x16x32_bf16 a[128:131], a[68:71], a[4:7], a[128:131]
    v_mfma_f32_16x16x32_bf16 a[132:135], a[76:79], a[4:7], a[132:135]
    ds_read_b128 a[36:39], v25 offset:49152
    v_mfma_f32_16x16x32_bf16 a[132:135], a[72:75], a[0:3], a[132:135]
    v_mfma_f32_16x16x32_bf16 a[136:139], a[80:83], a[0:3], a[136:139]
    ds_read_b128 a[40:43], v24 offset:51200
    v_mfma_f32_16x16x32_bf16 a[136:139], a[84:87], a[4:7], a[136:139]
    v_mfma_f32_16x16x32_bf16 a[140:143], a[92:95], a[4:7], a[140:143]
    ds_read_b128 a[44:47], v25 offset:51200
    v_mfma_f32_16x16x32_bf16 a[140:143], a[88:91], a[0:3], a[140:143]
    v_mfma_f32_16x16x32_bf16 a[156:159], a[88:91], a[8:11], a[156:159]
    ds_read_b128 a[48:51], v24 offset:53248
    v_mfma_f32_16x16x32_bf16 a[156:159], a[92:95], a[12:15], a[156:159]
    v_mfma_f32_16x16x32_bf16 a[152:155], a[84:87], a[12:15], a[152:155]
    ds_read_b128 a[52:55], v25 offset:53248
    v_mfma_f32_16x16x32_bf16 a[152:155], a[80:83], a[8:11], a[152:155]
    v_mfma_f32_16x16x32_bf16 a[148:151], a[72:75], a[8:11], a[148:151]
    ds_read_b128 a[56:59], v24 offset:55296
    v_mfma_f32_16x16x32_bf16 a[148:151], a[76:79], a[12:15], a[148:151]
    v_mfma_f32_16x16x32_bf16 a[144:147], a[68:71], a[12:15], a[144:147]
    ds_read_b128 a[60:63], v25 offset:55296
    v_mfma_f32_16x16x32_bf16 a[144:147], a[64:67], a[8:11], a[144:147]
    v_mfma_f32_16x16x32_bf16 a[160:163], a[64:67], a[16:19], a[160:163]
    v_mfma_f32_16x16x32_bf16 a[160:163], a[68:71], a[20:23], a[160:163]
    v_mfma_f32_16x16x32_bf16 a[164:167], a[76:79], a[20:23], a[164:167]
    v_mfma_f32_16x16x32_bf16 a[164:167], a[72:75], a[16:19], a[164:167]
    v_mfma_f32_16x16x32_bf16 a[168:171], a[80:83], a[16:19], a[168:171]
    v_mfma_f32_16x16x32_bf16 a[168:171], a[84:87], a[20:23], a[168:171]
    v_mfma_f32_16x16x32_bf16 a[172:175], a[92:95], a[20:23], a[172:175]
    v_mfma_f32_16x16x32_bf16 a[172:175], a[88:91], a[16:19], a[172:175]
    v_mfma_f32_16x16x32_bf16 a[188:191], a[88:91], a[24:27], a[188:191]
    s_add_u32 s65, s59, s55
    v_mfma_f32_16x16x32_bf16 a[188:191], a[92:95], a[28:31], a[188:191]
    v_mfma_f32_16x16x32_bf16 a[184:187], a[84:87], a[28:31], a[184:187]
    buffer_store_dwordx4 v[248:251], v30, s[32:35], s65 offen sc1
    v_mfma_f32_16x16x32_bf16 a[184:187], a[80:83], a[24:27], a[184:187]
    v_mfma_f32_16x16x32_bf16 a[180:183], a[72:75], a[24:27], a[180:183]
    v_mfma_f32_16x16x32_bf16 a[180:183], a[76:79], a[28:31], a[180:183]
    v_mfma_f32_16x16x32_bf16 a[176:179], a[68:71], a[28:31], a[176:179]
    s_waitcnt vmcnt(18) lgkmcnt(0)
    v_mfma_f32_16x16x32_bf16 a[176:179], a[64:67], a[24:27], a[176:179]
    s_barrier
    v_mfma_f32_16x16x32_bf16 v[64:67], a[64:67], a[32:35], v[64:67]
    ds_read_b128 a[0:3], v24 offset:0
    v_mfma_f32_16x16x32_bf16 v[64:67], a[68:71], a[36:39], v[64:67]
    v_mfma_f32_16x16x32_bf16 v[68:71], a[76:79], a[36:39], v[68:71]
    ds_read_b128 a[4:7], v25 offset:0
    v_mfma_f32_16x16x32_bf16 v[68:71], a[72:75], a[32:35], v[68:71]
    v_mfma_f32_16x16x32_bf16 v[72:75], a[80:83], a[32:35], v[72:75]
    ds_read_b128 a[8:11], v24 offset:2048
    v_mfma_f32_16x16x32_bf16 v[72:75], a[84:87], a[36:39], v[72:75]
    v_mfma_f32_16x16x32_bf16 v[76:79], a[92:95], a[36:39], v[76:79]
    ds_read_b128 a[12:15], v25 offset:2048
    v_mfma_f32_16x16x32_bf16 v[76:79], a[88:91], a[32:35], v[76:79]
    v_mfma_f32_16x16x32_bf16 v[92:95], a[88:91], a[40:43], v[92:95]
    ds_read_b128 a[16:19], v24 offset:4096
    v_mfma_f32_16x16x32_bf16 v[92:95], a[92:95], a[44:47], v[92:95]
    v_mfma_f32_16x16x32_bf16 v[88:91], a[84:87], a[44:47], v[88:91]
    ds_read_b128 a[20:23], v25 offset:4096
    v_mfma_f32_16x16x32_bf16 v[88:91], a[80:83], a[40:43], v[88:91]
    v_mfma_f32_16x16x32_bf16 v[84:87], a[72:75], a[40:43], v[84:87]
    ds_read_b128 a[24:27], v24 offset:6144
    v_mfma_f32_16x16x32_bf16 v[84:87], a[76:79], a[44:47], v[84:87]
    v_mfma_f32_16x16x32_bf16 v[80:83], a[68:71], a[44:47], v[80:83]
    ds_read_b128 a[28:31], v25 offset:6144
    v_mfma_f32_16x16x32_bf16 v[80:83], a[64:67], a[40:43], v[80:83]
    v_mfma_f32_16x16x32_bf16 v[96:99], a[64:67], a[48:51], v[96:99]
    v_mfma_f32_16x16x32_bf16 v[96:99], a[68:71], a[52:55], v[96:99]
    v_mfma_f32_16x16x32_bf16 v[100:103], a[76:79], a[52:55], v[100:103]
    v_mfma_f32_16x16x32_bf16 v[100:103], a[72:75], a[48:51], v[100:103]
    v_mfma_f32_16x16x32_bf16 v[104:107], a[80:83], a[48:51], v[104:107]
    v_mfma_f32_16x16x32_bf16 v[104:107], a[84:87], a[52:55], v[104:107]
    v_mfma_f32_16x16x32_bf16 v[108:111], a[92:95], a[52:55], v[108:111]
    v_mfma_f32_16x16x32_bf16 v[108:111], a[88:91], a[48:51], v[108:111]
    v_mfma_f32_16x16x32_bf16 v[124:127], a[88:91], a[56:59], v[124:127]
    v_mfma_f32_16x16x32_bf16 v[124:127], a[92:95], a[60:63], v[124:127]
    v_mfma_f32_16x16x32_bf16 v[120:123], a[84:87], a[60:63], v[120:123]
    v_mfma_f32_16x16x32_bf16 v[120:123], a[80:83], a[56:59], v[120:123]
    v_mfma_f32_16x16x32_bf16 v[116:119], a[72:75], a[56:59], v[116:119]
    v_mfma_f32_16x16x32_bf16 v[116:119], a[76:79], a[60:63], v[116:119]
    v_mfma_f32_16x16x32_bf16 v[112:115], a[68:71], a[60:63], v[112:115]
    s_waitcnt vmcnt(13) lgkmcnt(0)
    v_mfma_f32_16x16x32_bf16 v[112:115], a[64:67], a[56:59], v[112:115]
    s_barrier
    v_mfma_f32_16x16x32_bf16 v[132:135], a[96:99], a[32:35], v[132:135]
    ds_read_b64_tr_b16 a[64:65], v26 offset:0
    v_mfma_f32_16x16x32_bf16 v[132:135], a[100:103], a[36:39], v[132:135]
    ds_read_b64_tr_b16 a[66:67], v26 offset:1024
    v_mfma_f32_16x16x32_bf16 v[140:143], a[108:111], a[36:39], v[140:143]
    ds_read_b64_tr_b16 a[68:69], v26 offset:8192
    v_mfma_f32_16x16x32_bf16 v[140:143], a[104:107], a[32:35], v[140:143]
    ds_read_b64_tr_b16 a[70:71], v26 offset:9216
    v_mfma_f32_16x16x32_bf16 v[148:151], a[112:115], a[32:35], v[148:151]
    ds_read_b64_tr_b16 a[72:73], v27 offset:0
    v_mfma_f32_16x16x32_bf16 v[148:151], a[116:119], a[36:39], v[148:151]
    ds_read_b64_tr_b16 a[74:75], v27 offset:1024
    v_mfma_f32_16x16x32_bf16 v[156:159], a[124:127], a[36:39], v[156:159]
    ds_read_b64_tr_b16 a[76:77], v27 offset:8192
    v_mfma_f32_16x16x32_bf16 v[156:159], a[120:123], a[32:35], v[156:159]
    ds_read_b64_tr_b16 a[78:79], v27 offset:9216
    v_mfma_f32_16x16x32_bf16 v[188:191], a[120:123], a[40:43], v[188:191]
    ds_read_b64_tr_b16 a[80:81], v28 offset:0
    v_mfma_f32_16x16x32_bf16 v[188:191], a[124:127], a[44:47], v[188:191]
    ds_read_b64_tr_b16 a[82:83], v28 offset:1024
    v_mfma_f32_16x16x32_bf16 v[180:183], a[116:119], a[44:47], v[180:183]
    ds_read_b64_tr_b16 a[84:85], v28 offset:8192
    v_mfma_f32_16x16x32_bf16 v[180:183], a[112:115], a[40:43], v[180:183]
    ds_read_b64_tr_b16 a[86:87], v28 offset:9216
    v_mfma_f32_16x16x32_bf16 v[172:175], a[104:107], a[40:43], v[172:175]
    ds_read_b64_tr_b16 a[88:89], v29 offset:0
    v_mfma_f32_16x16x32_bf16 v[172:175], a[108:111], a[44:47], v[172:175]
    ds_read_b64_tr_b16 a[90:91], v29 offset:1024
    v_mfma_f32_16x16x32_bf16 v[164:167], a[100:103], a[44:47], v[164:167]
    ds_read_b64_tr_b16 a[92:93], v29 offset:8192
    v_mfma_f32_16x16x32_bf16 v[164:167], a[96:99], a[40:43], v[164:167]
    ds_read_b64_tr_b16 a[94:95], v29 offset:9216
    v_mfma_f32_16x16x32_bf16 v[196:199], a[96:99], a[48:51], v[196:199]
    v_mfma_f32_16x16x32_bf16 v[196:199], a[100:103], a[52:55], v[196:199]
    v_mfma_f32_16x16x32_bf16 v[204:207], a[108:111], a[52:55], v[204:207]
    v_mfma_f32_16x16x32_bf16 v[204:207], a[104:107], a[48:51], v[204:207]
    v_mfma_f32_16x16x32_bf16 v[212:215], a[112:115], a[48:51], v[212:215]
    v_mfma_f32_16x16x32_bf16 v[212:215], a[116:119], a[52:55], v[212:215]
    v_mfma_f32_16x16x32_bf16 v[220:223], a[124:127], a[52:55], v[220:223]
    v_mfma_f32_16x16x32_bf16 v[220:223], a[120:123], a[48:51], v[220:223]
    v_mfma_f32_16x16x32_bf16 v[252:255], a[120:123], a[56:59], v[252:255]
    v_mfma_f32_16x16x32_bf16 v[252:255], a[124:127], a[60:63], v[252:255]
    v_mfma_f32_16x16x32_bf16 v[244:247], a[116:119], a[60:63], v[244:247]
    v_mfma_f32_16x16x32_bf16 v[244:247], a[112:115], a[56:59], v[244:247]
    v_mfma_f32_16x16x32_bf16 v[236:239], a[104:107], a[56:59], v[236:239]
    v_mfma_f32_16x16x32_bf16 v[236:239], a[108:111], a[60:63], v[236:239]
    v_mfma_f32_16x16x32_bf16 v[228:231], a[100:103], a[60:63], v[228:231]
    s_waitcnt vmcnt(8) lgkmcnt(0)
    v_mfma_f32_16x16x32_bf16 v[228:231], a[96:99], a[56:59], v[228:231]
    s_barrier
    v_mfma_f32_16x16x32_bf16 a[192:195], a[64:67], a[0:3], a[192:195]
    ds_read_b64_tr_b16 a[96:97], v26 offset:16384
    v_mfma_f32_16x16x32_bf16 a[192:195], a[68:71], a[4:7], a[192:195]
    ds_read_b64_tr_b16 a[98:99], v26 offset:17408
    v_mfma_f32_16x16x32_bf16 a[196:199], a[76:79], a[4:7], a[196:199]
    ds_read_b64_tr_b16 a[100:101], v26 offset:24576
    v_mfma_f32_16x16x32_bf16 a[196:199], a[72:75], a[0:3], a[196:199]
    ds_read_b64_tr_b16 a[102:103], v26 offset:25600
    v_mfma_f32_16x16x32_bf16 a[200:203], a[80:83], a[0:3], a[200:203]
    ds_read_b64_tr_b16 a[104:105], v27 offset:16384
    v_mfma_f32_16x16x32_bf16 a[200:203], a[84:87], a[4:7], a[200:203]
    ds_read_b64_tr_b16 a[106:107], v27 offset:17408
    v_mfma_f32_16x16x32_bf16 a[204:207], a[92:95], a[4:7], a[204:207]
    ds_read_b64_tr_b16 a[108:109], v27 offset:24576
    v_mfma_f32_16x16x32_bf16 a[204:207], a[88:91], a[0:3], a[204:207]
    ds_read_b64_tr_b16 a[110:111], v27 offset:25600
    v_mfma_f32_16x16x32_bf16 a[220:223], a[88:91], a[8:11], a[220:223]
    ds_read_b64_tr_b16 a[112:113], v28 offset:16384
    v_mfma_f32_16x16x32_bf16 a[220:223], a[92:95], a[12:15], a[220:223]
    ds_read_b64_tr_b16 a[114:115], v28 offset:17408
    v_mfma_f32_16x16x32_bf16 a[216:219], a[84:87], a[12:15], a[216:219]
    ds_read_b64_tr_b16 a[116:117], v28 offset:24576
    v_mfma_f32_16x16x32_bf16 a[216:219], a[80:83], a[8:11], a[216:219]
    ds_read_b64_tr_b16 a[118:119], v28 offset:25600
    v_mfma_f32_16x16x32_bf16 a[212:215], a[72:75], a[8:11], a[212:215]
    ds_read_b64_tr_b16 a[120:121], v29 offset:16384
    v_mfma_f32_16x16x32_bf16 a[212:215], a[76:79], a[12:15], a[212:215]
    ds_read_b64_tr_b16 a[122:123], v29 offset:17408
    v_mfma_f32_16x16x32_bf16 a[208:211], a[68:71], a[12:15], a[208:211]
    ds_read_b64_tr_b16 a[124:125], v29 offset:24576
    v_mfma_f32_16x16x32_bf16 a[208:211], a[64:67], a[8:11], a[208:211]
    ds_read_b64_tr_b16 a[126:127], v29 offset:25600
    v_mfma_f32_16x16x32_bf16 a[224:227], a[64:67], a[16:19], a[224:227]
    v_mfma_f32_16x16x32_bf16 a[224:227], a[68:71], a[20:23], a[224:227]
    v_mfma_f32_16x16x32_bf16 a[228:231], a[76:79], a[20:23], a[228:231]
    v_mfma_f32_16x16x32_bf16 a[228:231], a[72:75], a[16:19], a[228:231]
    v_mfma_f32_16x16x32_bf16 a[232:235], a[80:83], a[16:19], a[232:235]
    v_mfma_f32_16x16x32_bf16 a[232:235], a[84:87], a[20:23], a[232:235]
    v_mfma_f32_16x16x32_bf16 a[236:239], a[92:95], a[20:23], a[236:239]
    v_mfma_f32_16x16x32_bf16 a[236:239], a[88:91], a[16:19], a[236:239]
    v_mfma_f32_16x16x32_bf16 a[252:255], a[88:91], a[24:27], a[252:255]
    v_mfma_f32_16x16x32_bf16 a[252:255], a[92:95], a[28:31], a[252:255]
    v_mfma_f32_16x16x32_bf16 a[248:251], a[84:87], a[28:31], a[248:251]
    v_mfma_f32_16x16x32_bf16 a[248:251], a[80:83], a[24:27], a[248:251]
    v_mfma_f32_16x16x32_bf16 a[244:247], a[72:75], a[24:27], a[244:247]
    v_mfma_f32_16x16x32_bf16 a[244:247], a[76:79], a[28:31], a[244:247]
    v_mfma_f32_16x16x32_bf16 a[240:243], a[68:71], a[28:31], a[240:243]
    s_waitcnt vmcnt(3) lgkmcnt(0)
    v_mfma_f32_16x16x32_bf16 a[240:243], a[64:67], a[24:27], a[240:243]
    s_barrier
    v_mfma_f32_16x16x32_bf16 a[128:131], a[96:99], a[0:3], a[128:131]
    ds_read_b128 a[32:35], v24 offset:16384
    v_mfma_f32_16x16x32_bf16 a[128:131], a[100:103], a[4:7], a[128:131]
    v_mfma_f32_16x16x32_bf16 a[132:135], a[108:111], a[4:7], a[132:135]
    ds_read_b128 a[36:39], v25 offset:16384
    v_mfma_f32_16x16x32_bf16 a[132:135], a[104:107], a[0:3], a[132:135]
    s_add_u32 s60, s44, 0
    v_accvgpr_read_b32 v32, a192
    v_accvgpr_read_b32 v33, a193
    v_mfma_f32_16x16x32_bf16 a[136:139], a[112:115], a[0:3], a[136:139]
    s_add_u32 s61, s44, 1024
    ds_read_b128 a[40:43], v24 offset:18432
    v_mul_f32 v32, s62, v32
    v_mfma_f32_16x16x32_bf16 a[136:139], a[116:119], a[4:7], a[136:139]
    s_add_u32 s64, s44, 8192
    v_mul_f32 v33, s62, v33
    v_cvt_pk_bf16_f32 v32, v32, v33
    v_mfma_f32_16x16x32_bf16 a[140:143], a[124:127], a[4:7], a[140:143]
    s_add_u32 s65, s44, 9216
    ds_read_b128 a[44:47], v25 offset:18432
    v_mfma_f32_16x16x32_bf16 a[140:143], a[120:123], a[0:3], a[140:143]
    v_accvgpr_read_b32 v34, a194
    v_accvgpr_read_b32 v35, a195
    v_mfma_f32_16x16x32_bf16 a[156:159], a[120:123], a[8:11], a[156:159]
    ds_read_b128 a[48:51], v24 offset:20480
    v_mul_f32 v34, s62, v34
    v_mfma_f32_16x16x32_bf16 a[156:159], a[124:127], a[12:15], a[156:159]
    v_mul_f32 v35, s62, v35
    v_cvt_pk_bf16_f32 v33, v34, v35
    v_mfma_f32_16x16x32_bf16 a[152:155], a[116:119], a[12:15], a[152:155]
    ds_read_b128 a[52:55], v25 offset:20480
    v_accvgpr_read_b32 v34, a196
    v_mfma_f32_16x16x32_bf16 a[152:155], a[112:115], a[8:11], a[152:155]
    v_accvgpr_read_b32 v35, a197
    v_mul_f32 v34, s62, v34
    v_mfma_f32_16x16x32_bf16 a[148:151], a[104:107], a[8:11], a[148:151]
    ds_read_b128 a[56:59], v24 offset:22528
    v_mul_f32 v35, s62, v35
    v_mfma_f32_16x16x32_bf16 a[148:151], a[108:111], a[12:15], a[148:151]
    v_cvt_pk_bf16_f32 v34, v34, v35
    v_accvgpr_read_b32 v4, a198
    v_mfma_f32_16x16x32_bf16 a[144:147], a[100:103], a[12:15], a[144:147]
    ds_read_b128 a[60:63], v25 offset:22528
    v_accvgpr_read_b32 v5, a199
    v_mfma_f32_16x16x32_bf16 a[144:147], a[96:99], a[8:11], a[144:147]
    v_mul_f32 v4, s62, v4
    v_mul_f32 v5, s62, v5
    v_mfma_f32_16x16x32_bf16 a[160:163], a[96:99], a[16:19], a[160:163]
    v_cvt_pk_bf16_f32 v35, v4, v5
    v_accvgpr_read_b32 v36, a200
    v_mfma_f32_16x16x32_bf16 a[160:163], a[100:103], a[20:23], a[160:163]
    buffer_store_dwordx4 v[32:35], v31, s[32:35], s60 offen sc1
    v_mfma_f32_16x16x32_bf16 a[164:167], a[108:111], a[20:23], a[164:167]
    s_add_u32 s60, s44, 16384
    v_accvgpr_read_b32 v37, a201
    v_mul_f32 v36, s62, v36
    v_mfma_f32_16x16x32_bf16 a[164:167], a[104:107], a[16:19], a[164:167]
    v_mul_f32 v37, s62, v37
    v_cvt_pk_bf16_f32 v36, v36, v37
    v_mfma_f32_16x16x32_bf16 a[168:171], a[112:115], a[16:19], a[168:171]
    v_accvgpr_read_b32 v38, a202
    v_accvgpr_read_b32 v39, a203
    v_mfma_f32_16x16x32_bf16 a[168:171], a[116:119], a[20:23], a[168:171]
    v_mul_f32 v38, s62, v38
    v_mul_f32 v39, s62, v39
    v_mfma_f32_16x16x32_bf16 a[172:175], a[124:127], a[20:23], a[172:175]
    v_cvt_pk_bf16_f32 v37, v38, v39
    v_accvgpr_read_b32 v38, a204
    v_mfma_f32_16x16x32_bf16 a[172:175], a[120:123], a[16:19], a[172:175]
    v_accvgpr_read_b32 v39, a205
    v_mul_f32 v38, s62, v38
    v_mfma_f32_16x16x32_bf16 a[188:191], a[120:123], a[24:27], a[188:191]
    v_mul_f32 v39, s62, v39
    v_cvt_pk_bf16_f32 v38, v38, v39
    v_mfma_f32_16x16x32_bf16 a[188:191], a[124:127], a[28:31], a[188:191]
    v_accvgpr_read_b32 v6, a206
    v_accvgpr_read_b32 v7, a207
    v_mfma_f32_16x16x32_bf16 a[184:187], a[116:119], a[28:31], a[184:187]
    v_mul_f32 v6, s62, v6
    v_mul_f32 v7, s62, v7
    v_mfma_f32_16x16x32_bf16 a[184:187], a[112:115], a[24:27], a[184:187]
    v_cvt_pk_bf16_f32 v39, v6, v7
    v_accvgpr_read_b32 v40, a208
    v_mfma_f32_16x16x32_bf16 a[180:183], a[104:107], a[24:27], a[180:183]
    buffer_store_dwordx4 v[36:39], v31, s[32:35], s61 offen sc1
    v_mfma_f32_16x16x32_bf16 a[180:183], a[108:111], a[28:31], a[180:183]
    s_add_u32 s61, s44, 17408
    v_accvgpr_read_b32 v41, a209
    v_mul_f32 v40, s62, v40
    v_mfma_f32_16x16x32_bf16 a[176:179], a[100:103], a[28:31], a[176:179]
    s_waitcnt lgkmcnt(0)
    v_mul_f32 v41, s62, v41
    v_cvt_pk_bf16_f32 v40, v40, v41
    v_mfma_f32_16x16x32_bf16 a[176:179], a[96:99], a[24:27], a[176:179]
    s_barrier
    v_accvgpr_read_b32 v42, a210
    v_accvgpr_read_b32 v43, a211
    v_mfma_f32_16x16x32_bf16 v[64:67], a[96:99], a[32:35], v[64:67]
    v_mul_f32 v42, s62, v42
    v_mul_f32 v43, s62, v43
    v_mfma_f32_16x16x32_bf16 v[64:67], a[100:103], a[36:39], v[64:67]
    v_cvt_pk_bf16_f32 v41, v42, v43
    v_accvgpr_read_b32 v42, a212
    v_mfma_f32_16x16x32_bf16 v[68:71], a[108:111], a[36:39], v[68:71]
    v_accvgpr_read_b32 v43, a213
    v_mul_f32 v42, s62, v42
    v_mfma_f32_16x16x32_bf16 v[68:71], a[104:107], a[32:35], v[68:71]
    v_mul_f32 v43, s62, v43
    v_cvt_pk_bf16_f32 v42, v42, v43
    v_mfma_f32_16x16x32_bf16 v[72:75], a[112:115], a[32:35], v[72:75]
    v_accvgpr_read_b32 v4, a214
    v_accvgpr_read_b32 v5, a215
    v_mfma_f32_16x16x32_bf16 v[72:75], a[116:119], a[36:39], v[72:75]
    v_mul_f32 v4, s62, v4
    v_mul_f32 v5, s62, v5
    v_mfma_f32_16x16x32_bf16 v[76:79], a[124:127], a[36:39], v[76:79]
    v_cvt_pk_bf16_f32 v43, v4, v5
    v_accvgpr_read_b32 v44, a216
    v_mfma_f32_16x16x32_bf16 v[76:79], a[120:123], a[32:35], v[76:79]
    buffer_store_dwordx4 v[40:43], v31, s[32:35], s64 offen sc1
    v_mfma_f32_16x16x32_bf16 v[92:95], a[120:123], a[40:43], v[92:95]
    s_add_u32 s64, s44, 24576
    v_accvgpr_read_b32 v45, a217
    v_mul_f32 v44, s62, v44
    v_mfma_f32_16x16x32_bf16 v[92:95], a[124:127], a[44:47], v[92:95]
    v_mul_f32 v45, s62, v45
    v_cvt_pk_bf16_f32 v44, v44, v45
    v_mfma_f32_16x16x32_bf16 v[88:91], a[116:119], a[44:47], v[88:91]
    v_accvgpr_read_b32 v46, a218
    v_accvgpr_read_b32 v47, a219
    v_mfma_f32_16x16x32_bf16 v[88:91], a[112:115], a[40:43], v[88:91]
    v_mul_f32 v46, s62, v46
    v_mul_f32 v47, s62, v47
    v_mfma_f32_16x16x32_bf16 v[84:87], a[104:107], a[40:43], v[84:87]
    v_cvt_pk_bf16_f32 v45, v46, v47
    v_accvgpr_read_b32 v46, a220
    v_mfma_f32_16x16x32_bf16 v[84:87], a[108:111], a[44:47], v[84:87]
    v_accvgpr_read_b32 v47, a221
    v_mul_f32 v46, s62, v46
    v_mfma_f32_16x16x32_bf16 v[80:83], a[100:103], a[44:47], v[80:83]
    v_mul_f32 v47, s62, v47
    v_cvt_pk_bf16_f32 v46, v46, v47
    v_mfma_f32_16x16x32_bf16 v[80:83], a[96:99], a[40:43], v[80:83]
    v_accvgpr_read_b32 v6, a222
    v_accvgpr_read_b32 v7, a223
    v_mfma_f32_16x16x32_bf16 v[96:99], a[96:99], a[48:51], v[96:99]
    v_mul_f32 v6, s62, v6
    v_mul_f32 v7, s62, v7
    v_mfma_f32_16x16x32_bf16 v[96:99], a[100:103], a[52:55], v[96:99]
    v_cvt_pk_bf16_f32 v47, v6, v7
    v_accvgpr_read_b32 v48, a224
    v_mfma_f32_16x16x32_bf16 v[100:103], a[108:111], a[52:55], v[100:103]
    buffer_store_dwordx4 v[44:47], v31, s[32:35], s65 offen sc1
    v_mfma_f32_16x16x32_bf16 v[100:103], a[104:107], a[48:51], v[100:103]
    s_add_u32 s65, s44, 25600
    v_accvgpr_read_b32 v49, a225
    v_mul_f32 v48, s62, v48
    v_mfma_f32_16x16x32_bf16 v[104:107], a[112:115], a[48:51], v[104:107]
    v_mul_f32 v49, s62, v49
    v_cvt_pk_bf16_f32 v48, v48, v49
    v_mfma_f32_16x16x32_bf16 v[104:107], a[116:119], a[52:55], v[104:107]
    v_accvgpr_read_b32 v50, a226
    v_accvgpr_read_b32 v51, a227
    v_mfma_f32_16x16x32_bf16 v[108:111], a[124:127], a[52:55], v[108:111]
    v_mul_f32 v50, s62, v50
    v_mul_f32 v51, s62, v51
    v_mfma_f32_16x16x32_bf16 v[108:111], a[120:123], a[48:51], v[108:111]
    v_cvt_pk_bf16_f32 v49, v50, v51
    v_accvgpr_read_b32 v50, a228
    v_mfma_f32_16x16x32_bf16 v[124:127], a[120:123], a[56:59], v[124:127]
    v_accvgpr_read_b32 v51, a229
    v_mul_f32 v50, s62, v50
    v_mfma_f32_16x16x32_bf16 v[124:127], a[124:127], a[60:63], v[124:127]
    v_mul_f32 v51, s62, v51
    v_cvt_pk_bf16_f32 v50, v50, v51
    v_mfma_f32_16x16x32_bf16 v[120:123], a[116:119], a[60:63], v[120:123]
    v_accvgpr_read_b32 v4, a230
    v_accvgpr_read_b32 v5, a231
    v_mfma_f32_16x16x32_bf16 v[120:123], a[112:115], a[56:59], v[120:123]
    v_mul_f32 v4, s62, v4
    v_mul_f32 v5, s62, v5
    v_mfma_f32_16x16x32_bf16 v[116:119], a[104:107], a[56:59], v[116:119]
    v_cvt_pk_bf16_f32 v51, v4, v5
    v_accvgpr_read_b32 v52, a232
    v_mfma_f32_16x16x32_bf16 v[116:119], a[108:111], a[60:63], v[116:119]
    buffer_store_dwordx4 v[48:51], v31, s[32:35], s60 offen sc1
    v_mfma_f32_16x16x32_bf16 v[112:115], a[100:103], a[60:63], v[112:115]
    v_accvgpr_read_b32 v53, a233
    v_mul_f32 v52, s62, v52
    v_mfma_f32_16x16x32_bf16 v[112:115], a[96:99], a[56:59], v[112:115]
    v_mul_f32 v53, s62, v53
    v_cvt_pk_bf16_f32 v52, v52, v53
    v_mfma_f32_16x16x32_bf16 v[132:135], a[64:67], a[32:35], v[132:135]
    v_accvgpr_read_b32 v54, a234
    v_accvgpr_read_b32 v55, a235
    v_mfma_f32_16x16x32_bf16 v[132:135], a[68:71], a[36:39], v[132:135]
    v_mul_f32 v54, s62, v54
    v_mul_f32 v55, s62, v55
    v_mfma_f32_16x16x32_bf16 v[140:143], a[76:79], a[36:39], v[140:143]
    v_cvt_pk_bf16_f32 v53, v54, v55
    v_accvgpr_read_b32 v54, a236
    v_mfma_f32_16x16x32_bf16 v[140:143], a[72:75], a[32:35], v[140:143]
    v_accvgpr_read_b32 v55, a237
    v_mul_f32 v54, s62, v54
    v_mfma_f32_16x16x32_bf16 v[148:151], a[80:83], a[32:35], v[148:151]
    v_mul_f32 v55, s62, v55
    v_cvt_pk_bf16_f32 v54, v54, v55
    v_mfma_f32_16x16x32_bf16 v[148:151], a[84:87], a[36:39], v[148:151]
    v_accvgpr_read_b32 v6, a238
    v_accvgpr_read_b32 v7, a239
    v_mfma_f32_16x16x32_bf16 v[156:159], a[92:95], a[36:39], v[156:159]
    v_mul_f32 v6, s62, v6
    v_mul_f32 v7, s62, v7
    v_mfma_f32_16x16x32_bf16 v[156:159], a[88:91], a[32:35], v[156:159]
    v_cvt_pk_bf16_f32 v55, v6, v7
    v_accvgpr_read_b32 v56, a240
    v_mfma_f32_16x16x32_bf16 v[188:191], a[88:91], a[40:43], v[188:191]
    buffer_store_dwordx4 v[52:55], v31, s[32:35], s61 offen sc1
    v_mfma_f32_16x16x32_bf16 v[188:191], a[92:95], a[44:47], v[188:191]
    v_accvgpr_read_b32 v57, a241
    v_mul_f32 v56, s62, v56
    v_mfma_f32_16x16x32_bf16 v[180:183], a[84:87], a[44:47], v[180:183]
    v_mul_f32 v57, s62, v57
    v_cvt_pk_bf16_f32 v56, v56, v57
    v_mfma_f32_16x16x32_bf16 v[180:183], a[80:83], a[40:43], v[180:183]
    v_accvgpr_read_b32 v58, a242
    v_accvgpr_read_b32 v59, a243
    v_mfma_f32_16x16x32_bf16 v[172:175], a[72:75], a[40:43], v[172:175]
    v_mul_f32 v58, s62, v58
    v_mul_f32 v59, s62, v59
    v_mfma_f32_16x16x32_bf16 v[172:175], a[76:79], a[44:47], v[172:175]
    v_cvt_pk_bf16_f32 v57, v58, v59
    v_accvgpr_read_b32 v58, a244
    v_mfma_f32_16x16x32_bf16 v[164:167], a[68:71], a[44:47], v[164:167]
    v_accvgpr_read_b32 v59, a245
    v_mul_f32 v58, s62, v58
    v_mfma_f32_16x16x32_bf16 v[164:167], a[64:67], a[40:43], v[164:167]
    v_mul_f32 v59, s62, v59
    v_cvt_pk_bf16_f32 v58, v58, v59
    v_mfma_f32_16x16x32_bf16 v[196:199], a[64:67], a[48:51], v[196:199]
    v_accvgpr_read_b32 v4, a246
    v_accvgpr_read_b32 v5, a247
    v_mfma_f32_16x16x32_bf16 v[196:199], a[68:71], a[52:55], v[196:199]
    v_mul_f32 v4, s62, v4
    v_mul_f32 v5, s62, v5
    v_mfma_f32_16x16x32_bf16 v[204:207], a[76:79], a[52:55], v[204:207]
    v_cvt_pk_bf16_f32 v59, v4, v5
    v_accvgpr_read_b32 v60, a248
    v_mfma_f32_16x16x32_bf16 v[204:207], a[72:75], a[48:51], v[204:207]
    buffer_store_dwordx4 v[56:59], v31, s[32:35], s64 offen sc1
    v_mfma_f32_16x16x32_bf16 v[212:215], a[80:83], a[48:51], v[212:215]
    v_accvgpr_read_b32 v61, a249
    v_mul_f32 v60, s62, v60
    v_mfma_f32_16x16x32_bf16 v[212:215], a[84:87], a[52:55], v[212:215]
    v_mul_f32 v61, s62, v61
    v_cvt_pk_bf16_f32 v60, v60, v61
    v_mfma_f32_16x16x32_bf16 v[220:223], a[92:95], a[52:55], v[220:223]
    v_accvgpr_read_b32 v62, a250
    v_accvgpr_read_b32 v63, a251
    v_mfma_f32_16x16x32_bf16 v[220:223], a[88:91], a[48:51], v[220:223]
    v_mul_f32 v62, s62, v62
    v_mul_f32 v63, s62, v63
    v_mfma_f32_16x16x32_bf16 v[252:255], a[88:91], a[56:59], v[252:255]
    v_cvt_pk_bf16_f32 v61, v62, v63
    v_accvgpr_read_b32 v62, a252
    v_mfma_f32_16x16x32_bf16 v[252:255], a[92:95], a[60:63], v[252:255]
    v_accvgpr_read_b32 v63, a253
    v_mul_f32 v62, s62, v62
    v_mfma_f32_16x16x32_bf16 v[244:247], a[84:87], a[60:63], v[244:247]
    v_mul_f32 v63, s62, v63
    v_cvt_pk_bf16_f32 v62, v62, v63
    v_mfma_f32_16x16x32_bf16 v[244:247], a[80:83], a[56:59], v[244:247]
    v_accvgpr_read_b32 v6, a254
    v_accvgpr_read_b32 v7, a255
    v_mfma_f32_16x16x32_bf16 v[236:239], a[72:75], a[56:59], v[236:239]
    v_mul_f32 v6, s62, v6
    v_mul_f32 v7, s62, v7
    v_mfma_f32_16x16x32_bf16 v[236:239], a[76:79], a[60:63], v[236:239]
    v_cvt_pk_bf16_f32 v63, v6, v7
    v_mfma_f32_16x16x32_bf16 v[228:231], a[68:71], a[60:63], v[228:231]
    buffer_store_dwordx4 v[60:63], v31, s[32:35], s65 offen sc1
    v_mfma_f32_16x16x32_bf16 v[228:231], a[64:67], a[56:59], v[228:231]
    v_accvgpr_read_b32 v32, a128
    v_accvgpr_read_b32 v33, a129
    v_pk_mul_f32 v[32:33], v[32:33], s[62:63]
    v_cvt_pk_bf16_f32 v32, v32, v33
    v_accvgpr_read_b32 v34, a130
    v_accvgpr_read_b32 v35, a131
    v_pk_mul_f32 v[34:35], v[34:35], s[62:63]
    v_cvt_pk_bf16_f32 v33, v34, v35
    v_accvgpr_read_b32 v34, a132
    v_accvgpr_read_b32 v35, a133
    v_pk_mul_f32 v[34:35], v[34:35], s[62:63]
    v_cvt_pk_bf16_f32 v34, v34, v35
    v_accvgpr_read_b32 v4, a134
    v_accvgpr_read_b32 v5, a135
    v_pk_mul_f32 v[4:5], v[4:5], s[62:63]
    v_cvt_pk_bf16_f32 v35, v4, v5
    s_add_u32 s60, s44, 4096
    buffer_store_dwordx4 v[32:35], v31, s[32:35], s60 offen sc1
    v_accvgpr_read_b32 v36, a136
    v_accvgpr_read_b32 v37, a137
    v_pk_mul_f32 v[36:37], v[36:37], s[62:63]
    v_cvt_pk_bf16_f32 v36, v36, v37
    v_accvgpr_read_b32 v38, a138
    v_accvgpr_read_b32 v39, a139
    v_pk_mul_f32 v[38:39], v[38:39], s[62:63]
    v_cvt_pk_bf16_f32 v37, v38, v39
    v_accvgpr_read_b32 v38, a140
    v_accvgpr_read_b32 v39, a141
    v_pk_mul_f32 v[38:39], v[38:39], s[62:63]
    v_cvt_pk_bf16_f32 v38, v38, v39
    v_accvgpr_read_b32 v6, a142
    v_accvgpr_read_b32 v7, a143
    v_pk_mul_f32 v[6:7], v[6:7], s[62:63]
    v_cvt_pk_bf16_f32 v39, v6, v7
    s_add_u32 s61, s44, 5120
    buffer_store_dwordx4 v[36:39], v31, s[32:35], s61 offen sc1
    v_accvgpr_read_b32 v40, a144
    v_accvgpr_read_b32 v41, a145
    v_pk_mul_f32 v[40:41], v[40:41], s[62:63]
    v_cvt_pk_bf16_f32 v40, v40, v41
    v_accvgpr_read_b32 v42, a146
    v_accvgpr_read_b32 v43, a147
    v_pk_mul_f32 v[42:43], v[42:43], s[62:63]
    v_cvt_pk_bf16_f32 v41, v42, v43
    v_accvgpr_read_b32 v42, a148
    v_accvgpr_read_b32 v43, a149
    v_pk_mul_f32 v[42:43], v[42:43], s[62:63]
    v_cvt_pk_bf16_f32 v42, v42, v43
    v_accvgpr_read_b32 v4, a150
    v_accvgpr_read_b32 v5, a151
    v_pk_mul_f32 v[4:5], v[4:5], s[62:63]
    v_cvt_pk_bf16_f32 v43, v4, v5
    s_add_u32 s64, s44, 12288
    buffer_store_dwordx4 v[40:43], v31, s[32:35], s64 offen sc1
    v_accvgpr_read_b32 v44, a152
    v_accvgpr_read_b32 v45, a153
    v_pk_mul_f32 v[44:45], v[44:45], s[62:63]
    v_cvt_pk_bf16_f32 v44, v44, v45
    v_accvgpr_read_b32 v46, a154
    v_accvgpr_read_b32 v47, a155
    v_pk_mul_f32 v[46:47], v[46:47], s[62:63]
    v_cvt_pk_bf16_f32 v45, v46, v47
    v_accvgpr_read_b32 v46, a156
    v_accvgpr_read_b32 v47, a157
    v_pk_mul_f32 v[46:47], v[46:47], s[62:63]
    v_cvt_pk_bf16_f32 v46, v46, v47
    v_accvgpr_read_b32 v6, a158
    v_accvgpr_read_b32 v7, a159
    v_pk_mul_f32 v[6:7], v[6:7], s[62:63]
    v_cvt_pk_bf16_f32 v47, v6, v7
    s_add_u32 s65, s44, 13312
    buffer_store_dwordx4 v[44:47], v31, s[32:35], s65 offen sc1
    v_accvgpr_read_b32 v48, a160
    v_accvgpr_read_b32 v49, a161
    v_pk_mul_f32 v[48:49], v[48:49], s[62:63]
    v_cvt_pk_bf16_f32 v48, v48, v49
    v_accvgpr_read_b32 v50, a162
    v_accvgpr_read_b32 v51, a163
    v_pk_mul_f32 v[50:51], v[50:51], s[62:63]
    v_cvt_pk_bf16_f32 v49, v50, v51
    v_accvgpr_read_b32 v50, a164
    v_accvgpr_read_b32 v51, a165
    v_pk_mul_f32 v[50:51], v[50:51], s[62:63]
    v_cvt_pk_bf16_f32 v50, v50, v51
    v_accvgpr_read_b32 v4, a166
    v_accvgpr_read_b32 v5, a167
    v_pk_mul_f32 v[4:5], v[4:5], s[62:63]
    v_cvt_pk_bf16_f32 v51, v4, v5
    s_add_u32 s60, s44, 20480
    buffer_store_dwordx4 v[48:51], v31, s[32:35], s60 offen sc1
    v_accvgpr_read_b32 v52, a168
    v_accvgpr_read_b32 v53, a169
    v_pk_mul_f32 v[52:53], v[52:53], s[62:63]
    v_cvt_pk_bf16_f32 v52, v52, v53
    v_accvgpr_read_b32 v54, a170
    v_accvgpr_read_b32 v55, a171
    v_pk_mul_f32 v[54:55], v[54:55], s[62:63]
    v_cvt_pk_bf16_f32 v53, v54, v55
    v_accvgpr_read_b32 v54, a172
    v_accvgpr_read_b32 v55, a173
    v_pk_mul_f32 v[54:55], v[54:55], s[62:63]
    v_cvt_pk_bf16_f32 v54, v54, v55
    v_accvgpr_read_b32 v6, a174
    v_accvgpr_read_b32 v7, a175
    v_pk_mul_f32 v[6:7], v[6:7], s[62:63]
    v_cvt_pk_bf16_f32 v55, v6, v7
    s_add_u32 s61, s44, 21504
    buffer_store_dwordx4 v[52:55], v31, s[32:35], s61 offen sc1
    v_accvgpr_read_b32 v56, a176
    v_accvgpr_read_b32 v57, a177
    v_pk_mul_f32 v[56:57], v[56:57], s[62:63]
    v_cvt_pk_bf16_f32 v56, v56, v57
    v_accvgpr_read_b32 v58, a178
    v_accvgpr_read_b32 v59, a179
    v_pk_mul_f32 v[58:59], v[58:59], s[62:63]
    v_cvt_pk_bf16_f32 v57, v58, v59
    v_accvgpr_read_b32 v58, a180
    v_accvgpr_read_b32 v59, a181
    v_pk_mul_f32 v[58:59], v[58:59], s[62:63]
    v_cvt_pk_bf16_f32 v58, v58, v59
    v_accvgpr_read_b32 v4, a182
    v_accvgpr_read_b32 v5, a183
    v_pk_mul_f32 v[4:5], v[4:5], s[62:63]
    v_cvt_pk_bf16_f32 v59, v4, v5
    s_add_u32 s64, s44, 28672
    buffer_store_dwordx4 v[56:59], v31, s[32:35], s64 offen sc1
    v_accvgpr_read_b32 v60, a184
    v_accvgpr_read_b32 v61, a185
    v_pk_mul_f32 v[60:61], v[60:61], s[62:63]
    v_cvt_pk_bf16_f32 v60, v60, v61
    v_accvgpr_read_b32 v62, a186
    v_accvgpr_read_b32 v63, a187
    v_pk_mul_f32 v[62:63], v[62:63], s[62:63]
    v_cvt_pk_bf16_f32 v61, v62, v63
    v_accvgpr_read_b32 v62, a188
    v_accvgpr_read_b32 v63, a189
    v_pk_mul_f32 v[62:63], v[62:63], s[62:63]
    v_cvt_pk_bf16_f32 v62, v62, v63
    v_accvgpr_read_b32 v6, a190
    v_accvgpr_read_b32 v7, a191
    v_pk_mul_f32 v[6:7], v[6:7], s[62:63]
    v_cvt_pk_bf16_f32 v63, v6, v7
    s_add_u32 s65, s44, 29696
    buffer_store_dwordx4 v[60:63], v31, s[32:35], s65 offen sc1
    v_pk_mul_f32 v[64:65], v[64:65], s[62:63]
    v_cvt_pk_bf16_f32 v64, v64, v65
    v_pk_mul_f32 v[66:67], v[66:67], s[62:63]
    v_cvt_pk_bf16_f32 v65, v66, v67
    v_pk_mul_f32 v[68:69], v[68:69], s[62:63]
    v_cvt_pk_bf16_f32 v66, v68, v69
    v_pk_mul_f32 v[70:71], v[70:71], s[62:63]
    v_cvt_pk_bf16_f32 v67, v70, v71
    s_add_u32 s60, s44, 69632
    buffer_store_dwordx4 v[64:67], v31, s[32:35], s60 offen sc1
    v_pk_mul_f32 v[72:73], v[72:73], s[62:63]
    v_cvt_pk_bf16_f32 v72, v72, v73
    v_pk_mul_f32 v[74:75], v[74:75], s[62:63]
    v_cvt_pk_bf16_f32 v73, v74, v75
    v_pk_mul_f32 v[76:77], v[76:77], s[62:63]
    v_cvt_pk_bf16_f32 v74, v76, v77
    v_pk_mul_f32 v[78:79], v[78:79], s[62:63]
    v_cvt_pk_bf16_f32 v75, v78, v79
    s_add_u32 s61, s44, 70656
    buffer_store_dwordx4 v[72:75], v31, s[32:35], s61 offen sc1
    v_pk_mul_f32 v[80:81], v[80:81], s[62:63]
    v_cvt_pk_bf16_f32 v80, v80, v81
    v_pk_mul_f32 v[82:83], v[82:83], s[62:63]
    v_cvt_pk_bf16_f32 v81, v82, v83
    v_pk_mul_f32 v[84:85], v[84:85], s[62:63]
    v_cvt_pk_bf16_f32 v82, v84, v85
    v_pk_mul_f32 v[86:87], v[86:87], s[62:63]
    v_cvt_pk_bf16_f32 v83, v86, v87
    s_add_u32 s64, s44, 77824
    buffer_store_dwordx4 v[80:83], v31, s[32:35], s64 offen sc1
    v_pk_mul_f32 v[88:89], v[88:89], s[62:63]
    v_cvt_pk_bf16_f32 v88, v88, v89
    v_pk_mul_f32 v[90:91], v[90:91], s[62:63]
    v_cvt_pk_bf16_f32 v89, v90, v91
    v_pk_mul_f32 v[92:93], v[92:93], s[62:63]
    v_cvt_pk_bf16_f32 v90, v92, v93
    v_pk_mul_f32 v[94:95], v[94:95], s[62:63]
    v_cvt_pk_bf16_f32 v91, v94, v95
    s_add_u32 s65, s44, 78848
    buffer_store_dwordx4 v[88:91], v31, s[32:35], s65 offen sc1
    v_pk_mul_f32 v[96:97], v[96:97], s[62:63]
    v_cvt_pk_bf16_f32 v96, v96, v97
    v_pk_mul_f32 v[98:99], v[98:99], s[62:63]
    v_cvt_pk_bf16_f32 v97, v98, v99
    v_pk_mul_f32 v[100:101], v[100:101], s[62:63]
    v_cvt_pk_bf16_f32 v98, v100, v101
    v_pk_mul_f32 v[102:103], v[102:103], s[62:63]
    v_cvt_pk_bf16_f32 v99, v102, v103
    s_add_u32 s60, s44, 86016
    buffer_store_dwordx4 v[96:99], v31, s[32:35], s60 offen sc1
    v_pk_mul_f32 v[104:105], v[104:105], s[62:63]
    v_cvt_pk_bf16_f32 v104, v104, v105
    v_pk_mul_f32 v[106:107], v[106:107], s[62:63]
    v_cvt_pk_bf16_f32 v105, v106, v107
    v_pk_mul_f32 v[108:109], v[108:109], s[62:63]
    v_cvt_pk_bf16_f32 v106, v108, v109
    v_pk_mul_f32 v[110:111], v[110:111], s[62:63]
    v_cvt_pk_bf16_f32 v107, v110, v111
    s_add_u32 s61, s44, 87040
    buffer_store_dwordx4 v[104:107], v31, s[32:35], s61 offen sc1
    v_pk_mul_f32 v[112:113], v[112:113], s[62:63]
    v_cvt_pk_bf16_f32 v112, v112, v113
    v_pk_mul_f32 v[114:115], v[114:115], s[62:63]
    v_cvt_pk_bf16_f32 v113, v114, v115
    v_pk_mul_f32 v[116:117], v[116:117], s[62:63]
    v_cvt_pk_bf16_f32 v114, v116, v117
    v_pk_mul_f32 v[118:119], v[118:119], s[62:63]
    v_cvt_pk_bf16_f32 v115, v118, v119
    s_add_u32 s64, s44, 94208
    buffer_store_dwordx4 v[112:115], v31, s[32:35], s64 offen sc1
    v_pk_mul_f32 v[120:121], v[120:121], s[62:63]
    v_cvt_pk_bf16_f32 v120, v120, v121
    v_pk_mul_f32 v[122:123], v[122:123], s[62:63]
    v_cvt_pk_bf16_f32 v121, v122, v123
    v_pk_mul_f32 v[124:125], v[124:125], s[62:63]
    v_cvt_pk_bf16_f32 v122, v124, v125
    v_pk_mul_f32 v[126:127], v[126:127], s[62:63]
    v_cvt_pk_bf16_f32 v123, v126, v127
    s_add_u32 s65, s44, 95232
    buffer_store_dwordx4 v[120:123], v31, s[32:35], s65 offen sc1
    v_pk_mul_f32 v[132:133], v[132:133], s[62:63]
    v_cvt_pk_bf16_f32 v132, v132, v133
    v_pk_mul_f32 v[134:135], v[134:135], s[62:63]
    v_cvt_pk_bf16_f32 v133, v134, v135
    v_pk_mul_f32 v[140:141], v[140:141], s[62:63]
    v_cvt_pk_bf16_f32 v134, v140, v141
    v_pk_mul_f32 v[142:143], v[142:143], s[62:63]
    v_cvt_pk_bf16_f32 v135, v142, v143
    s_add_u32 s60, s44, 65536
    buffer_store_dwordx4 v[132:135], v31, s[32:35], s60 offen sc1
    v_pk_mul_f32 v[148:149], v[148:149], s[62:63]
    v_cvt_pk_bf16_f32 v148, v148, v149
    v_pk_mul_f32 v[150:151], v[150:151], s[62:63]
    v_cvt_pk_bf16_f32 v149, v150, v151
    v_pk_mul_f32 v[156:157], v[156:157], s[62:63]
    v_cvt_pk_bf16_f32 v150, v156, v157
    v_pk_mul_f32 v[158:159], v[158:159], s[62:63]
    v_cvt_pk_bf16_f32 v151, v158, v159
    s_add_u32 s61, s44, 66560
    buffer_store_dwordx4 v[148:151], v31, s[32:35], s61 offen sc1
    v_pk_mul_f32 v[164:165], v[164:165], s[62:63]
    v_cvt_pk_bf16_f32 v164, v164, v165
    v_pk_mul_f32 v[166:167], v[166:167], s[62:63]
    v_cvt_pk_bf16_f32 v165, v166, v167
    v_pk_mul_f32 v[172:173], v[172:173], s[62:63]
    v_cvt_pk_bf16_f32 v166, v172, v173
    v_pk_mul_f32 v[174:175], v[174:175], s[62:63]
    v_cvt_pk_bf16_f32 v167, v174, v175
    s_add_u32 s64, s44, 73728
    buffer_store_dwordx4 v[164:167], v31, s[32:35], s64 offen sc1
    v_pk_mul_f32 v[180:181], v[180:181], s[62:63]
    v_cvt_pk_bf16_f32 v180, v180, v181
    v_pk_mul_f32 v[182:183], v[182:183], s[62:63]
    v_cvt_pk_bf16_f32 v181, v182, v183
    v_pk_mul_f32 v[188:189], v[188:189], s[62:63]
    v_cvt_pk_bf16_f32 v182, v188, v189
    v_pk_mul_f32 v[190:191], v[190:191], s[62:63]
    v_cvt_pk_bf16_f32 v183, v190, v191
    s_add_u32 s65, s44, 74752
    buffer_store_dwordx4 v[180:183], v31, s[32:35], s65 offen sc1
    v_pk_mul_f32 v[196:197], v[196:197], s[62:63]
    v_cvt_pk_bf16_f32 v196, v196, v197
    v_pk_mul_f32 v[198:199], v[198:199], s[62:63]
    v_cvt_pk_bf16_f32 v197, v198, v199
    v_pk_mul_f32 v[204:205], v[204:205], s[62:63]
    v_cvt_pk_bf16_f32 v198, v204, v205
    v_pk_mul_f32 v[206:207], v[206:207], s[62:63]
    v_cvt_pk_bf16_f32 v199, v206, v207
    s_add_u32 s60, s44, 81920
    buffer_store_dwordx4 v[196:199], v31, s[32:35], s60 offen sc1
    v_pk_mul_f32 v[212:213], v[212:213], s[62:63]
    v_cvt_pk_bf16_f32 v212, v212, v213
    v_pk_mul_f32 v[214:215], v[214:215], s[62:63]
    v_cvt_pk_bf16_f32 v213, v214, v215
    v_pk_mul_f32 v[220:221], v[220:221], s[62:63]
    v_cvt_pk_bf16_f32 v214, v220, v221
    v_pk_mul_f32 v[222:223], v[222:223], s[62:63]
    v_cvt_pk_bf16_f32 v215, v222, v223
    s_add_u32 s61, s44, 82944
    buffer_store_dwordx4 v[212:215], v31, s[32:35], s61 offen sc1
    v_pk_mul_f32 v[228:229], v[228:229], s[62:63]
    v_cvt_pk_bf16_f32 v228, v228, v229
    v_pk_mul_f32 v[230:231], v[230:231], s[62:63]
    v_cvt_pk_bf16_f32 v229, v230, v231
    v_pk_mul_f32 v[236:237], v[236:237], s[62:63]
    v_cvt_pk_bf16_f32 v230, v236, v237
    v_pk_mul_f32 v[238:239], v[238:239], s[62:63]
    v_cvt_pk_bf16_f32 v231, v238, v239
    s_add_u32 s64, s44, 90112
    buffer_store_dwordx4 v[228:231], v31, s[32:35], s64 offen sc1
    v_pk_mul_f32 v[244:245], v[244:245], s[62:63]
    v_cvt_pk_bf16_f32 v244, v244, v245
    v_pk_mul_f32 v[246:247], v[246:247], s[62:63]
    v_cvt_pk_bf16_f32 v245, v246, v247
    v_pk_mul_f32 v[252:253], v[252:253], s[62:63]
    v_cvt_pk_bf16_f32 v246, v252, v253
    v_pk_mul_f32 v[254:255], v[254:255], s[62:63]
    v_cvt_pk_bf16_f32 v247, v254, v255
    s_add_u32 s65, s44, 91136
    buffer_store_dwordx4 v[244:247], v31, s[32:35], s65 offen sc1
    s_endpgm
K1_T2_BQ:
    ds_read_b64_tr_b16 a[192:193], v0 offset:0
    ds_read_b64_tr_b16 a[194:195], v0 offset:4096
    ds_read_b64_tr_b16 a[196:197], v0 offset:32
    ds_read_b64_tr_b16 a[198:199], v0 offset:4128
    ds_read_b64_tr_b16 a[200:201], v0 offset:64
    ds_read_b64_tr_b16 a[202:203], v0 offset:4160
    ds_read_b64_tr_b16 a[204:205], v0 offset:96
    ds_read_b64_tr_b16 a[206:207], v0 offset:4192
    ds_read_b64_tr_b16 a[208:209], v0 offset:128
    ds_read_b64_tr_b16 a[210:211], v0 offset:4224
    ds_read_b64_tr_b16 a[212:213], v0 offset:160
    ds_read_b64_tr_b16 a[214:215], v0 offset:4256
    ds_read_b64_tr_b16 a[216:217], v0 offset:192
    ds_read_b64_tr_b16 a[218:219], v0 offset:4288
    v_cvt_pk_bf16_f32 v128, v128, v129
    v_cvt_pk_bf16_f32 v129, v130, v131
    v_cvt_pk_bf16_f32 v130, v132, v133
    v_cvt_pk_bf16_f32 v131, v134, v135
    v_cvt_pk_bf16_f32 v136, v136, v137
    v_cvt_pk_bf16_f32 v137, v138, v139
    v_cvt_pk_bf16_f32 v138, v140, v141
    v_cvt_pk_bf16_f32 v139, v142, v143
    v_cvt_pk_bf16_f32 v144, v144, v145
    v_cvt_pk_bf16_f32 v145, v146, v147
    v_cvt_pk_bf16_f32 v146, v148, v149
    v_cvt_pk_bf16_f32 v147, v150, v151
    v_cvt_pk_bf16_f32 v152, v152, v153
    v_cvt_pk_bf16_f32 v153, v154, v155
    v_cvt_pk_bf16_f32 v154, v156, v157
    v_cvt_pk_bf16_f32 v155, v158, v159
    v_cvt_pk_bf16_f32 v160, v160, v161
    v_cvt_pk_bf16_f32 v161, v162, v163
    v_cvt_pk_bf16_f32 v162, v164, v165
    v_cvt_pk_bf16_f32 v163, v166, v167
    v_cvt_pk_bf16_f32 v168, v168, v169
    v_cvt_pk_bf16_f32 v169, v170, v171
    v_cvt_pk_bf16_f32 v170, v172, v173
    v_cvt_pk_bf16_f32 v171, v174, v175
    v_cvt_pk_bf16_f32 v176, v176, v177
    v_cvt_pk_bf16_f32 v177, v178, v179
    v_cvt_pk_bf16_f32 v178, v180, v181
    v_cvt_pk_bf16_f32 v179, v182, v183
    v_cvt_pk_bf16_f32 v184, v184, v185
    v_cvt_pk_bf16_f32 v185, v186, v187
    v_cvt_pk_bf16_f32 v186, v188, v189
    v_cvt_pk_bf16_f32 v187, v190, v191
    v_cvt_pk_bf16_f32 v192, v192, v193
    v_cvt_pk_bf16_f32 v193, v194, v195
    v_cvt_pk_bf16_f32 v194, v196, v197
    v_cvt_pk_bf16_f32 v195, v198, v199
    v_cvt_pk_bf16_f32 v200, v200, v201
    v_cvt_pk_bf16_f32 v201, v202, v203
    v_cvt_pk_bf16_f32 v202, v204, v205
    v_cvt_pk_bf16_f32 v203, v206, v207
    v_cvt_pk_bf16_f32 v208, v208, v209
    v_cvt_pk_bf16_f32 v209, v210, v211
    v_cvt_pk_bf16_f32 v210, v212, v213
    v_cvt_pk_bf16_f32 v211, v214, v215
    v_cvt_pk_bf16_f32 v216, v216, v217
    v_cvt_pk_bf16_f32 v217, v218, v219
    v_cvt_pk_bf16_f32 v218, v220, v221
    v_cvt_pk_bf16_f32 v219, v222, v223
    v_cvt_pk_bf16_f32 v224, v224, v225
    v_cvt_pk_bf16_f32 v225, v226, v227
    v_cvt_pk_bf16_f32 v226, v228, v229
    v_cvt_pk_bf16_f32 v227, v230, v231
    v_cvt_pk_bf16_f32 v232, v232, v233
    v_cvt_pk_bf16_f32 v233, v234, v235
    v_cvt_pk_bf16_f32 v234, v236, v237
    v_cvt_pk_bf16_f32 v235, v238, v239
    v_cvt_pk_bf16_f32 v240, v240, v241
    v_cvt_pk_bf16_f32 v241, v242, v243
    v_cvt_pk_bf16_f32 v242, v244, v245
    v_cvt_pk_bf16_f32 v243, v246, v247
    v_cvt_pk_bf16_f32 v248, v248, v249
    v_cvt_pk_bf16_f32 v249, v250, v251
    v_cvt_pk_bf16_f32 v250, v252, v253
    v_cvt_pk_bf16_f32 v251, v254, v255
    s_waitcnt vmcnt(24)
    s_barrier
    v_mfma_f32_16x16x32_bf16 v[64:67], a[64:67], a[0:3], 0
    ds_read_b128 a[32:35], v24 offset:16384
    v_mfma_f32_16x16x32_bf16 v[64:67], a[68:71], a[4:7], v[64:67]
    s_add_u32 m0, s41, 0
    ds_read_b128 a[36:39], v25 offset:16384
    v_mfma_f32_16x16x32_bf16 v[68:71], a[76:79], a[4:7], 0
    buffer_load_dwordx4 v8, s[24:27], s36 offen offset:0  lds
    v_mfma_f32_16x16x32_bf16 v[68:71], a[72:75], a[0:3], v[68:71]
    ds_read_b128 a[40:43], v24 offset:18432
    v_mfma_f32_16x16x32_bf16 v[72:75], a[80:83], a[0:3], 0
    ds_read_b128 a[44:47], v25 offset:18432
    v_mfma_f32_16x16x32_bf16 v[72:75], a[84:87], a[4:7], v[72:75]
    buffer_load_dwordx4 v9, s[24:27], s36 offen offset:1024  lds
    v_mfma_f32_16x16x32_bf16 v[76:79], a[92:95], a[4:7], 0
    ds_read_b128 a[48:51], v24 offset:20480
    v_mfma_f32_16x16x32_bf16 v[76:79], a[88:91], a[0:3], v[76:79]
    ds_read_b128 a[52:55], v25 offset:20480
    v_mfma_f32_16x16x32_bf16 v[92:95], a[88:91], a[8:11], 0
    buffer_load_dwordx4 v10, s[24:27], s36 offen offset:2048  lds
    v_mfma_f32_16x16x32_bf16 v[92:95], a[92:95], a[12:15], v[92:95]
    ds_read_b128 a[56:59], v24 offset:22528
    v_mfma_f32_16x16x32_bf16 v[88:91], a[84:87], a[12:15], 0
    ds_read_b128 a[60:63], v25 offset:22528
    v_mfma_f32_16x16x32_bf16 v[88:91], a[80:83], a[8:11], v[88:91]
    buffer_load_dwordx4 v11, s[24:27], s36 offen offset:3072  lds
    v_mfma_f32_16x16x32_bf16 v[84:87], a[72:75], a[8:11], 0
    v_mfma_f32_16x16x32_bf16 v[84:87], a[76:79], a[12:15], v[84:87]
    v_mfma_f32_16x16x32_bf16 v[80:83], a[68:71], a[12:15], 0
    s_add_u32 s36, s36, 128
    v_mfma_f32_16x16x32_bf16 v[80:83], a[64:67], a[8:11], v[80:83]
    s_add_u32 m0, s41, 65536
    v_mfma_f32_16x16x32_bf16 v[96:99], a[64:67], a[16:19], 0
    buffer_load_dwordx4 v12, s[28:31], s38 offen offset:0  lds
    v_mfma_f32_16x16x32_bf16 v[96:99], a[68:71], a[20:23], v[96:99]
    v_mfma_f32_16x16x32_bf16 v[100:103], a[76:79], a[20:23], 0
    v_mfma_f32_16x16x32_bf16 v[100:103], a[72:75], a[16:19], v[100:103]
    buffer_load_dwordx4 v13, s[28:31], s38 offen offset:1024  lds
    v_mfma_f32_16x16x32_bf16 v[104:107], a[80:83], a[16:19], 0
    v_mfma_f32_16x16x32_bf16 v[104:107], a[84:87], a[20:23], v[104:107]
    v_mfma_f32_16x16x32_bf16 v[108:111], a[92:95], a[20:23], 0
    buffer_load_dwordx4 v14, s[28:31], s38 offen offset:2048  lds
    v_mfma_f32_16x16x32_bf16 v[108:111], a[88:91], a[16:19], v[108:111]
    v_mfma_f32_16x16x32_bf16 v[124:127], a[88:91], a[24:27], 0
    v_mfma_f32_16x16x32_bf16 v[124:127], a[92:95], a[28:31], v[124:127]
    buffer_load_dwordx4 v15, s[28:31], s38 offen offset:3072  lds
    v_mfma_f32_16x16x32_bf16 v[120:123], a[84:87], a[28:31], 0
    v_mfma_f32_16x16x32_bf16 v[120:123], a[80:83], a[24:27], v[120:123]
    v_mfma_f32_16x16x32_bf16 v[116:119], a[72:75], a[24:27], 0
    s_add_u32 s38, s38, s40
    v_mfma_f32_16x16x32_bf16 v[116:119], a[76:79], a[28:31], v[116:119]
    v_mfma_f32_16x16x32_bf16 v[112:115], a[68:71], a[28:31], 0
    v_mfma_f32_16x16x32_bf16 v[112:115], a[64:67], a[24:27], v[112:115]
    s_waitcnt vmcnt(24) lgkmcnt(0)
    s_barrier
    v_mfma_f32_16x16x32_bf16 v[132:135], a[64:67], a[32:35], 0
    ds_read_b64_tr_b16 a[96:97], v26 offset:32768
    ds_read_b64_tr_b16 a[98:99], v26 offset:33792
    v_mfma_f32_16x16x32_bf16 v[132:135], a[68:71], a[36:39], v[132:135]
    s_add_u32 m0, s41, 16384
    ds_read_b64_tr_b16 a[100:101], v26 offset:40960
    v_mfma_f32_16x16x32_bf16 v[140:143], a[76:79], a[36:39], 0
    buffer_load_dwordx4 v8, s[24:27], s37 offen offset:0  lds
    v_mfma_f32_16x16x32_bf16 v[140:143], a[72:75], a[32:35], v[140:143]
    ds_read_b64_tr_b16 a[102:103], v26 offset:41984
    ds_read_b64_tr_b16 a[104:105], v27 offset:32768
    v_mfma_f32_16x16x32_bf16 v[148:151], a[80:83], a[32:35], 0
    ds_read_b64_tr_b16 a[106:107], v27 offset:33792
    ds_read_b64_tr_b16 a[108:109], v27 offset:40960
    v_mfma_f32_16x16x32_bf16 v[148:151], a[84:87], a[36:39], v[148:151]
    buffer_load_dwordx4 v9, s[24:27], s37 offen offset:1024  lds
    v_mfma_f32_16x16x32_bf16 v[156:159], a[92:95], a[36:39], 0
    ds_read_b64_tr_b16 a[110:111], v27 offset:41984
    ds_read_b64_tr_b16 a[112:113], v28 offset:32768
    v_mfma_f32_16x16x32_bf16 v[156:159], a[88:91], a[32:35], v[156:159]
    ds_read_b64_tr_b16 a[114:115], v28 offset:33792
    ds_read_b64_tr_b16 a[116:117], v28 offset:40960
    v_mfma_f32_16x16x32_bf16 v[188:191], a[88:91], a[40:43], 0
    buffer_load_dwordx4 v10, s[24:27], s37 offen offset:2048  lds
    v_mfma_f32_16x16x32_bf16 v[188:191], a[92:95], a[44:47], v[188:191]
    ds_read_b64_tr_b16 a[118:119], v28 offset:41984
    ds_read_b64_tr_b16 a[120:121], v29 offset:32768
    v_mfma_f32_16x16x32_bf16 v[180:183], a[84:87], a[44:47], 0
    ds_read_b64_tr_b16 a[122:123], v29 offset:33792
    ds_read_b64_tr_b16 a[124:125], v29 offset:40960
    v_mfma_f32_16x16x32_bf16 v[180:183], a[80:83], a[40:43], v[180:183]
    buffer_load_dwordx4 v11, s[24:27], s37 offen offset:3072  lds
    v_mfma_f32_16x16x32_bf16 v[172:175], a[72:75], a[40:43], 0
    ds_read_b64_tr_b16 a[126:127], v29 offset:41984
    ds_read_b128 a[0:3], v24 offset:32768
    v_mfma_f32_16x16x32_bf16 v[172:175], a[76:79], a[44:47], v[172:175]
    ds_read_b128 a[4:7], v25 offset:32768
    v_mfma_f32_16x16x32_bf16 v[164:167], a[68:71], a[44:47], 0
    s_add_u32 s37, s37, 128
    ds_read_b128 a[8:11], v24 offset:34816
    v_mfma_f32_16x16x32_bf16 v[164:167], a[64:67], a[40:43], v[164:167]
    ds_read_b128 a[12:15], v25 offset:34816
    v_mfma_f32_16x16x32_bf16 v[196:199], a[64:67], a[48:51], 0
    ds_read_b128 a[16:19], v24 offset:36864
    v_mfma_f32_16x16x32_bf16 v[196:199], a[68:71], a[52:55], v[196:199]
    ds_read_b128 a[20:23], v25 offset:36864
    v_mfma_f32_16x16x32_bf16 v[204:207], a[76:79], a[52:55], 0
    ds_read_b128 a[24:27], v24 offset:38912
    v_mfma_f32_16x16x32_bf16 v[204:207], a[72:75], a[48:51], v[204:207]
    ds_read_b128 a[28:31], v25 offset:38912
    v_mfma_f32_16x16x32_bf16 v[212:215], a[80:83], a[48:51], 0
    v_mfma_f32_16x16x32_bf16 v[212:215], a[84:87], a[52:55], v[212:215]
    v_mfma_f32_16x16x32_bf16 v[220:223], a[92:95], a[52:55], 0
    v_mfma_f32_16x16x32_bf16 v[220:223], a[88:91], a[48:51], v[220:223]
    v_mfma_f32_16x16x32_bf16 v[252:255], a[88:91], a[56:59], 0
    v_mfma_f32_16x16x32_bf16 v[252:255], a[92:95], a[60:63], v[252:255]
    v_mfma_f32_16x16x32_bf16 v[244:247], a[84:87], a[60:63], 0
    v_mfma_f32_16x16x32_bf16 v[244:247], a[80:83], a[56:59], v[244:247]
    v_mfma_f32_16x16x32_bf16 v[236:239], a[72:75], a[56:59], 0
    v_mfma_f32_16x16x32_bf16 v[236:239], a[76:79], a[60:63], v[236:239]
    v_mfma_f32_16x16x32_bf16 v[228:231], a[68:71], a[60:63], 0
    v_mfma_f32_16x16x32_bf16 v[228:231], a[64:67], a[56:59], v[228:231]
    s_waitcnt vmcnt(12) lgkmcnt(0)
    s_barrier
    v_mfma_f32_16x16x32_bf16 v[64:67], a[96:99], a[0:3], v[64:67]
    ds_read_b128 a[32:35], v24 offset:49152
    v_mfma_f32_16x16x32_bf16 v[64:67], a[100:103], a[4:7], v[64:67]
    s_add_u32 m0, s41, 32768
    ds_read_b128 a[36:39], v25 offset:49152
    v_mfma_f32_16x16x32_bf16 v[68:71], a[108:111], a[4:7], v[68:71]
    buffer_load_dwordx4 v8, s[24:27], s36 offen offset:0  lds
    v_mfma_f32_16x16x32_bf16 v[68:71], a[104:107], a[0:3], v[68:71]
    ds_read_b128 a[40:43], v24 offset:51200
    v_mfma_f32_16x16x32_bf16 v[72:75], a[112:115], a[0:3], v[72:75]
    ds_read_b128 a[44:47], v25 offset:51200
    v_mfma_f32_16x16x32_bf16 v[72:75], a[116:119], a[4:7], v[72:75]
    buffer_load_dwordx4 v9, s[24:27], s36 offen offset:1024  lds
    v_mfma_f32_16x16x32_bf16 v[76:79], a[124:127], a[4:7], v[76:79]
    ds_read_b128 a[48:51], v24 offset:53248
    v_mfma_f32_16x16x32_bf16 v[76:79], a[120:123], a[0:3], v[76:79]
    ds_read_b128 a[52:55], v25 offset:53248
    v_mfma_f32_16x16x32_bf16 v[92:95], a[120:123], a[8:11], v[92:95]
    buffer_load_dwordx4 v10, s[24:27], s36 offen offset:2048  lds
    v_mfma_f32_16x16x32_bf16 v[92:95], a[124:127], a[12:15], v[92:95]
    ds_read_b128 a[56:59], v24 offset:55296
    v_mfma_f32_16x16x32_bf16 v[88:91], a[116:119], a[12:15], v[88:91]
    ds_read_b128 a[60:63], v25 offset:55296
    v_mfma_f32_16x16x32_bf16 v[88:91], a[112:115], a[8:11], v[88:91]
    buffer_load_dwordx4 v11, s[24:27], s36 offen offset:3072  lds
    v_mfma_f32_16x16x32_bf16 v[84:87], a[104:107], a[8:11], v[84:87]
    v_mfma_f32_16x16x32_bf16 v[84:87], a[108:111], a[12:15], v[84:87]
    v_mfma_f32_16x16x32_bf16 v[80:83], a[100:103], a[12:15], v[80:83]
    s_add_u32 s36, s36, 128
    v_mfma_f32_16x16x32_bf16 v[80:83], a[96:99], a[8:11], v[80:83]
    s_add_u32 m0, s41, 98304
    v_mfma_f32_16x16x32_bf16 v[96:99], a[96:99], a[16:19], v[96:99]
    buffer_load_dwordx4 v12, s[28:31], s38 offen offset:0  lds
    v_mfma_f32_16x16x32_bf16 v[96:99], a[100:103], a[20:23], v[96:99]
    v_mfma_f32_16x16x32_bf16 v[100:103], a[108:111], a[20:23], v[100:103]
    v_mfma_f32_16x16x32_bf16 v[100:103], a[104:107], a[16:19], v[100:103]
    buffer_load_dwordx4 v13, s[28:31], s38 offen offset:1024  lds
    v_mfma_f32_16x16x32_bf16 v[104:107], a[112:115], a[16:19], v[104:107]
    v_mfma_f32_16x16x32_bf16 v[104:107], a[116:119], a[20:23], v[104:107]
    v_mfma_f32_16x16x32_bf16 v[108:111], a[124:127], a[20:23], v[108:111]
    buffer_load_dwordx4 v14, s[28:31], s38 offen offset:2048  lds
    v_mfma_f32_16x16x32_bf16 v[108:111], a[120:123], a[16:19], v[108:111]
    v_mfma_f32_16x16x32_bf16 v[124:127], a[120:123], a[24:27], v[124:127]
    v_mfma_f32_16x16x32_bf16 v[124:127], a[124:127], a[28:31], v[124:127]
    buffer_load_dwordx4 v15, s[28:31], s38 offen offset:3072  lds
    v_mfma_f32_16x16x32_bf16 v[120:123], a[116:119], a[28:31], v[120:123]
    v_mfma_f32_16x16x32_bf16 v[120:123], a[112:115], a[24:27], v[120:123]
    v_mfma_f32_16x16x32_bf16 v[116:119], a[104:107], a[24:27], v[116:119]
    s_add_u32 s38, s38, s40
    v_mfma_f32_16x16x32_bf16 v[116:119], a[108:111], a[28:31], v[116:119]
    v_mfma_f32_16x16x32_bf16 v[112:115], a[100:103], a[28:31], v[112:115]
    v_mfma_f32_16x16x32_bf16 v[112:115], a[96:99], a[24:27], v[112:115]
    s_waitcnt vmcnt(12) lgkmcnt(0)
    s_barrier
    v_mfma_f32_16x16x32_bf16 v[132:135], a[96:99], a[32:35], v[132:135]
    ds_read_b64_tr_b16 a[64:65], v26 offset:0
    ds_read_b64_tr_b16 a[66:67], v26 offset:1024
    v_mfma_f32_16x16x32_bf16 v[132:135], a[100:103], a[36:39], v[132:135]
    s_add_u32 m0, s41, 49152
    ds_read_b64_tr_b16 a[68:69], v26 offset:8192
    v_mfma_f32_16x16x32_bf16 v[140:143], a[108:111], a[36:39], v[140:143]
    buffer_load_dwordx4 v8, s[24:27], s37 offen offset:0  lds
    v_mfma_f32_16x16x32_bf16 v[140:143], a[104:107], a[32:35], v[140:143]
    ds_read_b64_tr_b16 a[70:71], v26 offset:9216
    ds_read_b64_tr_b16 a[72:73], v27 offset:0
    v_mfma_f32_16x16x32_bf16 v[148:151], a[112:115], a[32:35], v[148:151]
    ds_read_b64_tr_b16 a[74:75], v27 offset:1024
    ds_read_b64_tr_b16 a[76:77], v27 offset:8192
    v_mfma_f32_16x16x32_bf16 v[148:151], a[116:119], a[36:39], v[148:151]
    buffer_load_dwordx4 v9, s[24:27], s37 offen offset:1024  lds
    v_mfma_f32_16x16x32_bf16 v[156:159], a[124:127], a[36:39], v[156:159]
    ds_read_b64_tr_b16 a[78:79], v27 offset:9216
    ds_read_b64_tr_b16 a[80:81], v28 offset:0
    v_mfma_f32_16x16x32_bf16 v[156:159], a[120:123], a[32:35], v[156:159]
    ds_read_b64_tr_b16 a[82:83], v28 offset:1024
    ds_read_b64_tr_b16 a[84:85], v28 offset:8192
    v_mfma_f32_16x16x32_bf16 v[188:191], a[120:123], a[40:43], v[188:191]
    buffer_load_dwordx4 v10, s[24:27], s37 offen offset:2048  lds
    v_mfma_f32_16x16x32_bf16 v[188:191], a[124:127], a[44:47], v[188:191]
    ds_read_b64_tr_b16 a[86:87], v28 offset:9216
    ds_read_b64_tr_b16 a[88:89], v29 offset:0
    v_mfma_f32_16x16x32_bf16 v[180:183], a[116:119], a[44:47], v[180:183]
    ds_read_b64_tr_b16 a[90:91], v29 offset:1024
    ds_read_b64_tr_b16 a[92:93], v29 offset:8192
    v_mfma_f32_16x16x32_bf16 v[180:183], a[112:115], a[40:43], v[180:183]
    buffer_load_dwordx4 v11, s[24:27], s37 offen offset:3072  lds
    v_mfma_f32_16x16x32_bf16 v[172:175], a[104:107], a[40:43], v[172:175]
    ds_read_b64_tr_b16 a[94:95], v29 offset:9216
    ds_read_b128 a[0:3], v24 offset:0
    v_mfma_f32_16x16x32_bf16 v[172:175], a[108:111], a[44:47], v[172:175]
    ds_read_b128 a[4:7], v25 offset:0
    v_mfma_f32_16x16x32_bf16 v[164:167], a[100:103], a[44:47], v[164:167]
    s_add_u32 s37, s37, 128
    ds_read_b128 a[8:11], v24 offset:2048
    v_mfma_f32_16x16x32_bf16 v[164:167], a[96:99], a[40:43], v[164:167]
    ds_read_b128 a[12:15], v25 offset:2048
    v_mfma_f32_16x16x32_bf16 v[196:199], a[96:99], a[48:51], v[196:199]
    ds_read_b128 a[16:19], v24 offset:4096
    v_mfma_f32_16x16x32_bf16 v[196:199], a[100:103], a[52:55], v[196:199]
    ds_read_b128 a[20:23], v25 offset:4096
    v_mfma_f32_16x16x32_bf16 v[204:207], a[108:111], a[52:55], v[204:207]
    ds_read_b128 a[24:27], v24 offset:6144
    v_mfma_f32_16x16x32_bf16 v[204:207], a[104:107], a[48:51], v[204:207]
    ds_read_b128 a[28:31], v25 offset:6144
    v_mfma_f32_16x16x32_bf16 v[212:215], a[112:115], a[48:51], v[212:215]
    v_mfma_f32_16x16x32_bf16 v[212:215], a[116:119], a[52:55], v[212:215]
    v_mfma_f32_16x16x32_bf16 v[220:223], a[124:127], a[52:55], v[220:223]
    v_mfma_f32_16x16x32_bf16 v[220:223], a[120:123], a[48:51], v[220:223]
    v_mfma_f32_16x16x32_bf16 v[252:255], a[120:123], a[56:59], v[252:255]
    v_mfma_f32_16x16x32_bf16 v[252:255], a[124:127], a[60:63], v[252:255]
    v_mfma_f32_16x16x32_bf16 v[244:247], a[116:119], a[60:63], v[244:247]
    v_mfma_f32_16x16x32_bf16 v[244:247], a[112:115], a[56:59], v[244:247]
    v_mfma_f32_16x16x32_bf16 v[236:239], a[104:107], a[56:59], v[236:239]
    v_mfma_f32_16x16x32_bf16 v[236:239], a[108:111], a[60:63], v[236:239]
    v_mfma_f32_16x16x32_bf16 v[228:231], a[100:103], a[60:63], v[228:231]
    v_mfma_f32_16x16x32_bf16 v[228:231], a[96:99], a[56:59], v[228:231]
    s_waitcnt vmcnt(12) lgkmcnt(0)
    s_barrier
    v_mfma_f32_16x16x32_bf16 v[64:67], a[64:67], a[0:3], v[64:67]
    ds_read_b128 a[32:35], v24 offset:16384
    v_mfma_f32_16x16x32_bf16 v[64:67], a[68:71], a[4:7], v[64:67]
    s_add_u32 m0, s41, 0
    ds_read_b128 a[36:39], v25 offset:16384
    v_mfma_f32_16x16x32_bf16 v[68:71], a[76:79], a[4:7], v[68:71]
    buffer_load_dwordx4 v8, s[24:27], s36 offen offset:0  lds
    v_mfma_f32_16x16x32_bf16 v[68:71], a[72:75], a[0:3], v[68:71]
    ds_read_b128 a[40:43], v24 offset:18432
    v_mfma_f32_16x16x32_bf16 v[72:75], a[80:83], a[0:3], v[72:75]
    ds_read_b128 a[44:47], v25 offset:18432
    v_mfma_f32_16x16x32_bf16 v[72:75], a[84:87], a[4:7], v[72:75]
    buffer_load_dwordx4 v9, s[24:27], s36 offen offset:1024  lds
    v_mfma_f32_16x16x32_bf16 v[76:79], a[92:95], a[4:7], v[76:79]
    ds_read_b128 a[48:51], v24 offset:20480
    v_mfma_f32_16x16x32_bf16 v[76:79], a[88:91], a[0:3], v[76:79]
    ds_read_b128 a[52:55], v25 offset:20480
    v_mfma_f32_16x16x32_bf16 v[92:95], a[88:91], a[8:11], v[92:95]
    buffer_load_dwordx4 v10, s[24:27], s36 offen offset:2048  lds
    v_mfma_f32_16x16x32_bf16 v[92:95], a[92:95], a[12:15], v[92:95]
    ds_read_b128 a[56:59], v24 offset:22528
    v_mfma_f32_16x16x32_bf16 v[88:91], a[84:87], a[12:15], v[88:91]
    ds_read_b128 a[60:63], v25 offset:22528
    v_mfma_f32_16x16x32_bf16 v[88:91], a[80:83], a[8:11], v[88:91]
    buffer_load_dwordx4 v11, s[24:27], s36 offen offset:3072  lds
    v_mfma_f32_16x16x32_bf16 v[84:87], a[72:75], a[8:11], v[84:87]
    v_mfma_f32_16x16x32_bf16 v[84:87], a[76:79], a[12:15], v[84:87]
    v_mfma_f32_16x16x32_bf16 v[80:83], a[68:71], a[12:15], v[80:83]
    s_add_u32 s36, s36, 128
    v_mfma_f32_16x16x32_bf16 v[80:83], a[64:67], a[8:11], v[80:83]
    s_add_u32 m0, s41, 65536
    v_mfma_f32_16x16x32_bf16 v[96:99], a[64:67], a[16:19], v[96:99]
    buffer_load_dwordx4 v12, s[28:31], s38 offen offset:0  lds
    v_mfma_f32_16x16x32_bf16 v[96:99], a[68:71], a[20:23], v[96:99]
    v_mfma_f32_16x16x32_bf16 v[100:103], a[76:79], a[20:23], v[100:103]
    v_mfma_f32_16x16x32_bf16 v[100:103], a[72:75], a[16:19], v[100:103]
    buffer_load_dwordx4 v13, s[28:31], s38 offen offset:1024  lds
    v_mfma_f32_16x16x32_bf16 v[104:107], a[80:83], a[16:19], v[104:107]
    v_mfma_f32_16x16x32_bf16 v[104:107], a[84:87], a[20:23], v[104:107]
    v_mfma_f32_16x16x32_bf16 v[108:111], a[92:95], a[20:23], v[108:111]
    buffer_load_dwordx4 v14, s[28:31], s38 offen offset:2048  lds
    v_mfma_f32_16x16x32_bf16 v[108:111], a[88:91], a[16:19], v[108:111]
    v_mfma_f32_16x16x32_bf16 v[124:127], a[88:91], a[24:27], v[124:127]
    v_mfma_f32_16x16x32_bf16 v[124:127], a[92:95], a[28:31], v[124:127]
    buffer_load_dwordx4 v15, s[28:31], s38 offen offset:3072  lds
    v_mfma_f32_16x16x32_bf16 v[120:123], a[84:87], a[28:31], v[120:123]
    v_mfma_f32_16x16x32_bf16 v[120:123], a[80:83], a[24:27], v[120:123]
    v_mfma_f32_16x16x32_bf16 v[116:119], a[72:75], a[24:27], v[116:119]
    s_add_u32 s38, s38, s40
    v_mfma_f32_16x16x32_bf16 v[116:119], a[76:79], a[28:31], v[116:119]
    v_mfma_f32_16x16x32_bf16 v[112:115], a[68:71], a[28:31], v[112:115]
    v_mfma_f32_16x16x32_bf16 v[112:115], a[64:67], a[24:27], v[112:115]
    s_waitcnt vmcnt(12) lgkmcnt(0)
    s_barrier
    v_mfma_f32_16x16x32_bf16 v[132:135], a[64:67], a[32:35], v[132:135]
    ds_read_b64_tr_b16 a[96:97], v26 offset:32768
    ds_read_b64_tr_b16 a[98:99], v26 offset:33792
    v_mfma_f32_16x16x32_bf16 v[132:135], a[68:71], a[36:39], v[132:135]
    s_add_u32 m0, s41, 16384
    ds_read_b64_tr_b16 a[100:101], v26 offset:40960
    v_mfma_f32_16x16x32_bf16 v[140:143], a[76:79], a[36:39], v[140:143]
    buffer_load_dwordx4 v8, s[24:27], s37 offen offset:0  lds
    v_mfma_f32_16x16x32_bf16 v[140:143], a[72:75], a[32:35], v[140:143]
    ds_read_b64_tr_b16 a[102:103], v26 offset:41984
    ds_read_b64_tr_b16 a[104:105], v27 offset:32768
    v_mfma_f32_16x16x32_bf16 v[148:151], a[80:83], a[32:35], v[148:151]
    ds_read_b64_tr_b16 a[106:107], v27 offset:33792
    ds_read_b64_tr_b16 a[108:109], v27 offset:40960
    v_mfma_f32_16x16x32_bf16 v[148:151], a[84:87], a[36:39], v[148:151]
    buffer_load_dwordx4 v9, s[24:27], s37 offen offset:1024  lds
    v_mfma_f32_16x16x32_bf16 v[156:159], a[92:95], a[36:39], v[156:159]
    ds_read_b64_tr_b16 a[110:111], v27 offset:41984
    ds_read_b64_tr_b16 a[112:113], v28 offset:32768
    v_mfma_f32_16x16x32_bf16 v[156:159], a[88:91], a[32:35], v[156:159]
    ds_read_b64_tr_b16 a[114:115], v28 offset:33792
    ds_read_b64_tr_b16 a[116:117], v28 offset:40960
    v_mfma_f32_16x16x32_bf16 v[188:191], a[88:91], a[40:43], v[188:191]
    buffer_load_dwordx4 v10, s[24:27], s37 offen offset:2048  lds
    v_mfma_f32_16x16x32_bf16 v[188:191], a[92:95], a[44:47], v[188:191]
    ds_read_b64_tr_b16 a[118:119], v28 offset:41984
    ds_read_b64_tr_b16 a[120:121], v29 offset:32768
    v_mfma_f32_16x16x32_bf16 v[180:183], a[84:87], a[44:47], v[180:183]
    ds_read_b64_tr_b16 a[122:123], v29 offset:33792
    ds_read_b64_tr_b16 a[124:125], v29 offset:40960
    v_mfma_f32_16x16x32_bf16 v[180:183], a[80:83], a[40:43], v[180:183]
    buffer_load_dwordx4 v11, s[24:27], s37 offen offset:3072  lds
    v_mfma_f32_16x16x32_bf16 v[172:175], a[72:75], a[40:43], v[172:175]
    ds_read_b64_tr_b16 a[126:127], v29 offset:41984
    ds_read_b128 a[0:3], v24 offset:32768
    v_mfma_f32_16x16x32_bf16 v[172:175], a[76:79], a[44:47], v[172:175]
    ds_read_b128 a[4:7], v25 offset:32768
    v_mfma_f32_16x16x32_bf16 v[164:167], a[68:71], a[44:47], v[164:167]
    s_add_u32 s37, s37, 128
    ds_read_b128 a[8:11], v24 offset:34816
    v_mfma_f32_16x16x32_bf16 v[164:167], a[64:67], a[40:43], v[164:167]
    ds_read_b128 a[12:15], v25 offset:34816
    v_mfma_f32_16x16x32_bf16 v[196:199], a[64:67], a[48:51], v[196:199]
    ds_read_b128 a[16:19], v24 offset:36864
    v_mfma_f32_16x16x32_bf16 v[196:199], a[68:71], a[52:55], v[196:199]
    ds_read_b128 a[20:23], v25 offset:36864
    v_mfma_f32_16x16x32_bf16 v[204:207], a[76:79], a[52:55], v[204:207]
    ds_read_b128 a[24:27], v24 offset:38912
    v_mfma_f32_16x16x32_bf16 v[204:207], a[72:75], a[48:51], v[204:207]
    ds_read_b128 a[28:31], v25 offset:38912
    v_mfma_f32_16x16x32_bf16 v[212:215], a[80:83], a[48:51], v[212:215]
    v_mfma_f32_16x16x32_bf16 v[212:215], a[84:87], a[52:55], v[212:215]
    v_mfma_f32_16x16x32_bf16 v[220:223], a[92:95], a[52:55], v[220:223]
    v_mfma_f32_16x16x32_bf16 v[220:223], a[88:91], a[48:51], v[220:223]
    v_mfma_f32_16x16x32_bf16 v[252:255], a[88:91], a[56:59], v[252:255]
    v_mfma_f32_16x16x32_bf16 v[252:255], a[92:95], a[60:63], v[252:255]
    v_mfma_f32_16x16x32_bf16 v[244:247], a[84:87], a[60:63], v[244:247]
    v_mfma_f32_16x16x32_bf16 v[244:247], a[80:83], a[56:59], v[244:247]
    v_mfma_f32_16x16x32_bf16 v[236:239], a[72:75], a[56:59], v[236:239]
    v_mfma_f32_16x16x32_bf16 v[236:239], a[76:79], a[60:63], v[236:239]
    v_mfma_f32_16x16x32_bf16 v[228:231], a[68:71], a[60:63], v[228:231]
    v_mfma_f32_16x16x32_bf16 v[228:231], a[64:67], a[56:59], v[228:231]
    s_waitcnt vmcnt(12) lgkmcnt(0)
    s_barrier
    v_mfma_f32_16x16x32_bf16 v[64:67], a[96:99], a[0:3], v[64:67]
    ds_read_b128 a[32:35], v24 offset:49152
    v_mfma_f32_16x16x32_bf16 v[64:67], a[100:103], a[4:7], v[64:67]
    s_add_u32 m0, s41, 32768
    ds_read_b128 a[36:39], v25 offset:49152
    v_mfma_f32_16x16x32_bf16 v[68:71], a[108:111], a[4:7], v[68:71]
    buffer_load_dwordx4 v8, s[24:27], s36 offen offset:0  lds
    v_mfma_f32_16x16x32_bf16 v[68:71], a[104:107], a[0:3], v[68:71]
    ds_read_b128 a[40:43], v24 offset:51200
    v_mfma_f32_16x16x32_bf16 v[72:75], a[112:115], a[0:3], v[72:75]
    ds_read_b128 a[44:47], v25 offset:51200
    v_mfma_f32_16x16x32_bf16 v[72:75], a[116:119], a[4:7], v[72:75]
    buffer_load_dwordx4 v9, s[24:27], s36 offen offset:1024  lds
    v_mfma_f32_16x16x32_bf16 v[76:79], a[124:127], a[4:7], v[76:79]
    ds_read_b128 a[48:51], v24 offset:53248
    v_mfma_f32_16x16x32_bf16 v[76:79], a[120:123], a[0:3], v[76:79]
    ds_read_b128 a[52:55], v25 offset:53248
    v_mfma_f32_16x16x32_bf16 v[92:95], a[120:123], a[8:11], v[92:95]
    buffer_load_dwordx4 v10, s[24:27], s36 offen offset:2048  lds
    v_mfma_f32_16x16x32_bf16 v[92:95], a[124:127], a[12:15], v[92:95]
    ds_read_b128 a[56:59], v24 offset:55296
    v_mfma_f32_16x16x32_bf16 v[88:91], a[116:119], a[12:15], v[88:91]
    ds_read_b128 a[60:63], v25 offset:55296
    v_mfma_f32_16x16x32_bf16 v[88:91], a[112:115], a[8:11], v[88:91]
    buffer_load_dwordx4 v11, s[24:27], s36 offen offset:3072  lds
    v_mfma_f32_16x16x32_bf16 v[84:87], a[104:107], a[8:11], v[84:87]
    v_mfma_f32_16x16x32_bf16 v[84:87], a[108:111], a[12:15], v[84:87]
    v_mfma_f32_16x16x32_bf16 v[80:83], a[100:103], a[12:15], v[80:83]
    s_add_u32 s36, s36, 128
    v_mfma_f32_16x16x32_bf16 v[80:83], a[96:99], a[8:11], v[80:83]
    s_add_u32 m0, s41, 98304
    v_mfma_f32_16x16x32_bf16 v[96:99], a[96:99], a[16:19], v[96:99]
    buffer_load_dwordx4 v12, s[28:31], s38 offen offset:0  lds
    v_mfma_f32_16x16x32_bf16 v[96:99], a[100:103], a[20:23], v[96:99]
    v_mfma_f32_16x16x32_bf16 v[100:103], a[108:111], a[20:23], v[100:103]
    v_mfma_f32_16x16x32_bf16 v[100:103], a[104:107], a[16:19], v[100:103]
    buffer_load_dwordx4 v13, s[28:31], s38 offen offset:1024  lds
    v_mfma_f32_16x16x32_bf16 v[104:107], a[112:115], a[16:19], v[104:107]
    v_mfma_f32_16x16x32_bf16 v[104:107], a[116:119], a[20:23], v[104:107]
    v_mfma_f32_16x16x32_bf16 v[108:111], a[124:127], a[20:23], v[108:111]
    buffer_load_dwordx4 v14, s[28:31], s38 offen offset:2048  lds
    v_mfma_f32_16x16x32_bf16 v[108:111], a[120:123], a[16:19], v[108:111]
    v_mfma_f32_16x16x32_bf16 v[124:127], a[120:123], a[24:27], v[124:127]
    v_mfma_f32_16x16x32_bf16 v[124:127], a[124:127], a[28:31], v[124:127]
    buffer_load_dwordx4 v15, s[28:31], s38 offen offset:3072  lds
    v_mfma_f32_16x16x32_bf16 v[120:123], a[116:119], a[28:31], v[120:123]
    v_mfma_f32_16x16x32_bf16 v[120:123], a[112:115], a[24:27], v[120:123]
    v_mfma_f32_16x16x32_bf16 v[116:119], a[104:107], a[24:27], v[116:119]
    s_add_u32 s38, s38, s40
    v_mfma_f32_16x16x32_bf16 v[116:119], a[108:111], a[28:31], v[116:119]
    v_mfma_f32_16x16x32_bf16 v[112:115], a[100:103], a[28:31], v[112:115]
    v_mfma_f32_16x16x32_bf16 v[112:115], a[96:99], a[24:27], v[112:115]
    s_waitcnt vmcnt(12) lgkmcnt(0)
    s_barrier
    v_mfma_f32_16x16x32_bf16 v[132:135], a[96:99], a[32:35], v[132:135]
    ds_read_b64_tr_b16 a[64:65], v26 offset:0
    ds_read_b64_tr_b16 a[66:67], v26 offset:1024
    v_mfma_f32_16x16x32_bf16 v[132:135], a[100:103], a[36:39], v[132:135]
    s_add_u32 m0, s41, 49152
    ds_read_b64_tr_b16 a[68:69], v26 offset:8192
    v_mfma_f32_16x16x32_bf16 v[140:143], a[108:111], a[36:39], v[140:143]
    buffer_load_dwordx4 v8, s[24:27], s37 offen offset:0  lds
    v_mfma_f32_16x16x32_bf16 v[140:143], a[104:107], a[32:35], v[140:143]
    ds_read_b64_tr_b16 a[70:71], v26 offset:9216
    ds_read_b64_tr_b16 a[72:73], v27 offset:0
    v_mfma_f32_16x16x32_bf16 v[148:151], a[112:115], a[32:35], v[148:151]
    ds_read_b64_tr_b16 a[74:75], v27 offset:1024
    ds_read_b64_tr_b16 a[76:77], v27 offset:8192
    v_mfma_f32_16x16x32_bf16 v[148:151], a[116:119], a[36:39], v[148:151]
    buffer_load_dwordx4 v9, s[24:27], s37 offen offset:1024  lds
    v_mfma_f32_16x16x32_bf16 v[156:159], a[124:127], a[36:39], v[156:159]
    ds_read_b64_tr_b16 a[78:79], v27 offset:9216
    ds_read_b64_tr_b16 a[80:81], v28 offset:0
    v_mfma_f32_16x16x32_bf16 v[156:159], a[120:123], a[32:35], v[156:159]
    ds_read_b64_tr_b16 a[82:83], v28 offset:1024
    ds_read_b64_tr_b16 a[84:85], v28 offset:8192
    v_mfma_f32_16x16x32_bf16 v[188:191], a[120:123], a[40:43], v[188:191]
    buffer_load_dwordx4 v10, s[24:27], s37 offen offset:2048  lds
    v_mfma_f32_16x16x32_bf16 v[188:191], a[124:127], a[44:47], v[188:191]
    ds_read_b64_tr_b16 a[86:87], v28 offset:9216
    ds_read_b64_tr_b16 a[88:89], v29 offset:0
    v_mfma_f32_16x16x32_bf16 v[180:183], a[116:119], a[44:47], v[180:183]
    ds_read_b64_tr_b16 a[90:91], v29 offset:1024
    ds_read_b64_tr_b16 a[92:93], v29 offset:8192
    v_mfma_f32_16x16x32_bf16 v[180:183], a[112:115], a[40:43], v[180:183]
    buffer_load_dwordx4 v11, s[24:27], s37 offen offset:3072  lds
    v_mfma_f32_16x16x32_bf16 v[172:175], a[104:107], a[40:43], v[172:175]
    ds_read_b64_tr_b16 a[94:95], v29 offset:9216
    ds_read_b128 a[0:3], v24 offset:0
    v_mfma_f32_16x16x32_bf16 v[172:175], a[108:111], a[44:47], v[172:175]
    ds_read_b128 a[4:7], v25 offset:0
    v_mfma_f32_16x16x32_bf16 v[164:167], a[100:103], a[44:47], v[164:167]
    s_add_u32 s37, s37, 128
    ds_read_b128 a[8:11], v24 offset:2048
    v_mfma_f32_16x16x32_bf16 v[164:167], a[96:99], a[40:43], v[164:167]
    ds_read_b128 a[12:15], v25 offset:2048
    v_mfma_f32_16x16x32_bf16 v[196:199], a[96:99], a[48:51], v[196:199]
    ds_read_b128 a[16:19], v24 offset:4096
    v_mfma_f32_16x16x32_bf16 v[196:199], a[100:103], a[52:55], v[196:199]
    ds_read_b128 a[20:23], v25 offset:4096
    v_mfma_f32_16x16x32_bf16 v[204:207], a[108:111], a[52:55], v[204:207]
    ds_read_b128 a[24:27], v24 offset:6144
    v_mfma_f32_16x16x32_bf16 v[204:207], a[104:107], a[48:51], v[204:207]
    ds_read_b128 a[28:31], v25 offset:6144
    v_mfma_f32_16x16x32_bf16 v[212:215], a[112:115], a[48:51], v[212:215]
    v_mfma_f32_16x16x32_bf16 v[212:215], a[116:119], a[52:55], v[212:215]
    v_mfma_f32_16x16x32_bf16 v[220:223], a[124:127], a[52:55], v[220:223]
    v_mfma_f32_16x16x32_bf16 v[220:223], a[120:123], a[48:51], v[220:223]
    v_mfma_f32_16x16x32_bf16 v[252:255], a[120:123], a[56:59], v[252:255]
    v_mfma_f32_16x16x32_bf16 v[252:255], a[124:127], a[60:63], v[252:255]
    v_mfma_f32_16x16x32_bf16 v[244:247], a[116:119], a[60:63], v[244:247]
    v_mfma_f32_16x16x32_bf16 v[244:247], a[112:115], a[56:59], v[244:247]
    v_mfma_f32_16x16x32_bf16 v[236:239], a[104:107], a[56:59], v[236:239]
    v_mfma_f32_16x16x32_bf16 v[236:239], a[108:111], a[60:63], v[236:239]
    v_mfma_f32_16x16x32_bf16 v[228:231], a[100:103], a[60:63], v[228:231]
    v_mfma_f32_16x16x32_bf16 v[228:231], a[96:99], a[56:59], v[228:231]
    s_waitcnt vmcnt(12) lgkmcnt(0)
    s_barrier
    v_mfma_f32_16x16x32_bf16 v[64:67], a[64:67], a[0:3], v[64:67]
    ds_read_b128 a[32:35], v24 offset:16384
    v_mfma_f32_16x16x32_bf16 v[64:67], a[68:71], a[4:7], v[64:67]
    s_add_u32 m0, s41, 0
    ds_read_b128 a[36:39], v25 offset:16384
    v_mfma_f32_16x16x32_bf16 v[68:71], a[76:79], a[4:7], v[68:71]
    buffer_load_dwordx4 v8, s[24:27], s36 offen offset:0  lds
    v_mfma_f32_16x16x32_bf16 v[68:71], a[72:75], a[0:3], v[68:71]
    ds_read_b128 a[40:43], v24 offset:18432
    v_mfma_f32_16x16x32_bf16 v[72:75], a[80:83], a[0:3], v[72:75]
    ds_read_b128 a[44:47], v25 offset:18432
    v_mfma_f32_16x16x32_bf16 v[72:75], a[84:87], a[4:7], v[72:75]
    buffer_load_dwordx4 v9, s[24:27], s36 offen offset:1024  lds
    v_mfma_f32_16x16x32_bf16 v[76:79], a[92:95], a[4:7], v[76:79]
    ds_read_b128 a[48:51], v24 offset:20480
    v_mfma_f32_16x16x32_bf16 v[76:79], a[88:91], a[0:3], v[76:79]
    ds_read_b128 a[52:55], v25 offset:20480
    v_mfma_f32_16x16x32_bf16 v[92:95], a[88:91], a[8:11], v[92:95]
    buffer_load_dwordx4 v10, s[24:27], s36 offen offset:2048  lds
    v_mfma_f32_16x16x32_bf16 v[92:95], a[92:95], a[12:15], v[92:95]
    ds_read_b128 a[56:59], v24 offset:22528
    v_mfma_f32_16x16x32_bf16 v[88:91], a[84:87], a[12:15], v[88:91]
    ds_read_b128 a[60:63], v25 offset:22528
    v_mfma_f32_16x16x32_bf16 v[88:91], a[80:83], a[8:11], v[88:91]
    buffer_load_dwordx4 v11, s[24:27], s36 offen offset:3072  lds
    v_mfma_f32_16x16x32_bf16 v[84:87], a[72:75], a[8:11], v[84:87]
    v_mfma_f32_16x16x32_bf16 v[84:87], a[76:79], a[12:15], v[84:87]
    v_mfma_f32_16x16x32_bf16 v[80:83], a[68:71], a[12:15], v[80:83]
    s_add_u32 s36, s36, 128
    v_mfma_f32_16x16x32_bf16 v[80:83], a[64:67], a[8:11], v[80:83]
    s_add_u32 m0, s41, 65536
    v_mfma_f32_16x16x32_bf16 v[96:99], a[64:67], a[16:19], v[96:99]
    buffer_load_dwordx4 v12, s[28:31], s38 offen offset:0  lds
    v_mfma_f32_16x16x32_bf16 v[96:99], a[68:71], a[20:23], v[96:99]
    v_mfma_f32_16x16x32_bf16 v[100:103], a[76:79], a[20:23], v[100:103]
    v_mfma_f32_16x16x32_bf16 v[100:103], a[72:75], a[16:19], v[100:103]
    buffer_load_dwordx4 v13, s[28:31], s38 offen offset:1024  lds
    v_mfma_f32_16x16x32_bf16 v[104:107], a[80:83], a[16:19], v[104:107]
    v_mfma_f32_16x16x32_bf16 v[104:107], a[84:87], a[20:23], v[104:107]
    v_mfma_f32_16x16x32_bf16 v[108:111], a[92:95], a[20:23], v[108:111]
    buffer_load_dwordx4 v14, s[28:31], s38 offen offset:2048  lds
    v_mfma_f32_16x16x32_bf16 v[108:111], a[88:91], a[16:19], v[108:111]
    v_mfma_f32_16x16x32_bf16 v[124:127], a[88:91], a[24:27], v[124:127]
    v_mfma_f32_16x16x32_bf16 v[124:127], a[92:95], a[28:31], v[124:127]
    buffer_load_dwordx4 v15, s[28:31], s38 offen offset:3072  lds
    v_mfma_f32_16x16x32_bf16 v[120:123], a[84:87], a[28:31], v[120:123]
    v_mfma_f32_16x16x32_bf16 v[120:123], a[80:83], a[24:27], v[120:123]
    v_mfma_f32_16x16x32_bf16 v[116:119], a[72:75], a[24:27], v[116:119]
    s_add_u32 s38, s38, s40
    v_mfma_f32_16x16x32_bf16 v[116:119], a[76:79], a[28:31], v[116:119]
    v_mfma_f32_16x16x32_bf16 v[112:115], a[68:71], a[28:31], v[112:115]
    v_mfma_f32_16x16x32_bf16 v[112:115], a[64:67], a[24:27], v[112:115]
    s_waitcnt vmcnt(12) lgkmcnt(0)
    s_barrier
    v_mfma_f32_16x16x32_bf16 v[132:135], a[64:67], a[32:35], v[132:135]
    ds_read_b64_tr_b16 a[96:97], v26 offset:32768
    ds_read_b64_tr_b16 a[98:99], v26 offset:33792
    v_mfma_f32_16x16x32_bf16 v[132:135], a[68:71], a[36:39], v[132:135]
    s_add_u32 m0, s41, 16384
    ds_read_b64_tr_b16 a[100:101], v26 offset:40960
    v_mfma_f32_16x16x32_bf16 v[140:143], a[76:79], a[36:39], v[140:143]
    buffer_load_dwordx4 v8, s[24:27], s37 offen offset:0  lds
    v_mfma_f32_16x16x32_bf16 v[140:143], a[72:75], a[32:35], v[140:143]
    ds_read_b64_tr_b16 a[102:103], v26 offset:41984
    ds_read_b64_tr_b16 a[104:105], v27 offset:32768
    v_mfma_f32_16x16x32_bf16 v[148:151], a[80:83], a[32:35], v[148:151]
    ds_read_b64_tr_b16 a[106:107], v27 offset:33792
    ds_read_b64_tr_b16 a[108:109], v27 offset:40960
    v_mfma_f32_16x16x32_bf16 v[148:151], a[84:87], a[36:39], v[148:151]
    buffer_load_dwordx4 v9, s[24:27], s37 offen offset:1024  lds
    v_mfma_f32_16x16x32_bf16 v[156:159], a[92:95], a[36:39], v[156:159]
    ds_read_b64_tr_b16 a[110:111], v27 offset:41984
    ds_read_b64_tr_b16 a[112:113], v28 offset:32768
    v_mfma_f32_16x16x32_bf16 v[156:159], a[88:91], a[32:35], v[156:159]
    ds_read_b64_tr_b16 a[114:115], v28 offset:33792
    ds_read_b64_tr_b16 a[116:117], v28 offset:40960
    v_mfma_f32_16x16x32_bf16 v[188:191], a[88:91], a[40:43], v[188:191]
    buffer_load_dwordx4 v10, s[24:27], s37 offen offset:2048  lds
    v_mfma_f32_16x16x32_bf16 v[188:191], a[92:95], a[44:47], v[188:191]
    ds_read_b64_tr_b16 a[118:119], v28 offset:41984
    ds_read_b64_tr_b16 a[120:121], v29 offset:32768
    v_mfma_f32_16x16x32_bf16 v[180:183], a[84:87], a[44:47], v[180:183]
    ds_read_b64_tr_b16 a[122:123], v29 offset:33792
    ds_read_b64_tr_b16 a[124:125], v29 offset:40960
    v_mfma_f32_16x16x32_bf16 v[180:183], a[80:83], a[40:43], v[180:183]
    buffer_load_dwordx4 v11, s[24:27], s37 offen offset:3072  lds
    v_mfma_f32_16x16x32_bf16 v[172:175], a[72:75], a[40:43], v[172:175]
    ds_read_b64_tr_b16 a[126:127], v29 offset:41984
    ds_read_b128 a[0:3], v24 offset:32768
    v_mfma_f32_16x16x32_bf16 v[172:175], a[76:79], a[44:47], v[172:175]
    ds_read_b128 a[4:7], v25 offset:32768
    v_mfma_f32_16x16x32_bf16 v[164:167], a[68:71], a[44:47], v[164:167]
    s_add_u32 s37, s37, 128
    ds_read_b128 a[8:11], v24 offset:34816
    v_mfma_f32_16x16x32_bf16 v[164:167], a[64:67], a[40:43], v[164:167]
    ds_read_b128 a[12:15], v25 offset:34816
    v_mfma_f32_16x16x32_bf16 v[196:199], a[64:67], a[48:51], v[196:199]
    ds_read_b128 a[16:19], v24 offset:36864
    v_mfma_f32_16x16x32_bf16 v[196:199], a[68:71], a[52:55], v[196:199]
    ds_read_b128 a[20:23], v25 offset:36864
    v_mfma_f32_16x16x32_bf16 v[204:207], a[76:79], a[52:55], v[204:207]
    s_add_u32 s64, s56, s48
    ds_read_b128 a[24:27], v24 offset:38912
    v_mfma_f32_16x16x32_bf16 v[204:207], a[72:75], a[48:51], v[204:207]
    ds_read_b128 a[28:31], v25 offset:38912
    v_mfma_f32_16x16x32_bf16 v[212:215], a[80:83], a[48:51], v[212:215]
    buffer_store_dwordx4 v[32:35], v30, s[32:35], s64 offen sc1
    v_mfma_f32_16x16x32_bf16 v[212:215], a[84:87], a[52:55], v[212:215]
    v_mfma_f32_16x16x32_bf16 v[220:223], a[92:95], a[52:55], v[220:223]
    v_mfma_f32_16x16x32_bf16 v[220:223], a[88:91], a[48:51], v[220:223]
    v_mfma_f32_16x16x32_bf16 v[252:255], a[88:91], a[56:59], v[252:255]
    v_mfma_f32_16x16x32_bf16 v[252:255], a[92:95], a[60:63], v[252:255]
    s_add_u32 s65, s56, s49
    v_mfma_f32_16x16x32_bf16 v[244:247], a[84:87], a[60:63], v[244:247]
    buffer_store_dwordx4 v[36:39], v30, s[32:35], s65 offen sc1
    v_mfma_f32_16x16x32_bf16 v[244:247], a[80:83], a[56:59], v[244:247]
    v_mfma_f32_16x16x32_bf16 v[236:239], a[72:75], a[56:59], v[236:239]
    v_mfma_f32_16x16x32_bf16 v[236:239], a[76:79], a[60:63], v[236:239]
    v_mfma_f32_16x16x32_bf16 v[228:231], a[68:71], a[60:63], v[228:231]
    v_mfma_f32_16x16x32_bf16 v[228:231], a[64:67], a[56:59], v[228:231]
    s_waitcnt vmcnt(14) lgkmcnt(0)
    s_barrier
    v_mfma_f32_16x16x32_bf16 v[64:67], a[96:99], a[0:3], v[64:67]
    s_add_u32 s66, s56, s50
    ds_read_b128 a[32:35], v24 offset:49152
    v_mfma_f32_16x16x32_bf16 v[64:67], a[100:103], a[4:7], v[64:67]
    ds_read_b128 a[36:39], v25 offset:49152
    v_mfma_f32_16x16x32_bf16 v[68:71], a[108:111], a[4:7], v[68:71]
    ds_read_b128 a[40:43], v24 offset:51200
    v_mfma_f32_16x16x32_bf16 v[68:71], a[104:107], a[0:3], v[68:71]
    ds_read_b128 a[44:47], v25 offset:51200
    v_mfma_f32_16x16x32_bf16 v[72:75], a[112:115], a[0:3], v[72:75]
    ds_read_b128 a[48:51], v24 offset:53248
    v_mfma_f32_16x16x32_bf16 v[72:75], a[116:119], a[4:7], v[72:75]
    ds_read_b128 a[52:55], v25 offset:53248
    v_mfma_f32_16x16x32_bf16 v[76:79], a[124:127], a[4:7], v[76:79]
    ds_read_b128 a[56:59], v24 offset:55296
    v_mfma_f32_16x16x32_bf16 v[76:79], a[120:123], a[0:3], v[76:79]
    s_add_u32 s67, s56, s51
    ds_read_b128 a[60:63], v25 offset:55296
    v_mfma_f32_16x16x32_bf16 v[92:95], a[120:123], a[8:11], v[92:95]
    buffer_store_dwordx4 v[40:43], v30, s[32:35], s66 offen sc1
    v_mfma_f32_16x16x32_bf16 v[92:95], a[124:127], a[12:15], v[92:95]
    buffer_store_dwordx4 v[44:47], v30, s[32:35], s67 offen sc1
    v_mfma_f32_16x16x32_bf16 v[88:91], a[116:119], a[12:15], v[88:91]
    v_mfma_f32_16x16x32_bf16 v[88:91], a[112:115], a[8:11], v[88:91]
    v_mfma_f32_16x16x32_bf16 v[84:87], a[104:107], a[8:11], v[84:87]
    v_mfma_f32_16x16x32_bf16 v[84:87], a[108:111], a[12:15], v[84:87]
    v_mfma_f32_16x16x32_bf16 v[80:83], a[100:103], a[12:15], v[80:83]
    s_add_u32 s64, s56, s52
    v_mfma_f32_16x16x32_bf16 v[80:83], a[96:99], a[8:11], v[80:83]
    buffer_store_dwordx4 v[48:51], v30, s[32:35], s64 offen sc1
    v_mfma_f32_16x16x32_bf16 v[96:99], a[96:99], a[16:19], v[96:99]
    v_mfma_f32_16x16x32_bf16 v[96:99], a[100:103], a[20:23], v[96:99]
    v_mfma_f32_16x16x32_bf16 v[100:103], a[108:111], a[20:23], v[100:103]
    v_mfma_f32_16x16x32_bf16 v[100:103], a[104:107], a[16:19], v[100:103]
    v_mfma_f32_16x16x32_bf16 v[104:107], a[112:115], a[16:19], v[104:107]
    v_mfma_f32_16x16x32_bf16 v[104:107], a[116:119], a[20:23], v[104:107]
    s_add_u32 s65, s56, s53
    v_mfma_f32_16x16x32_bf16 v[108:111], a[124:127], a[20:23], v[108:111]
    buffer_store_dwordx4 v[52:55], v30, s[32:35], s65 offen sc1
    v_mfma_f32_16x16x32_bf16 v[108:111], a[120:123], a[16:19], v[108:111]
    v_mfma_f32_16x16x32_bf16 v[124:127], a[120:123], a[24:27], v[124:127]
    v_mfma_f32_16x16x32_bf16 v[124:127], a[124:127], a[28:31], v[124:127]
    v_mfma_f32_16x16x32_bf16 v[120:123], a[116:119], a[28:31], v[120:123]
    v_mfma_f32_16x16x32_bf16 v[120:123], a[112:115], a[24:27], v[120:123]
    v_mfma_f32_16x16x32_bf16 v[116:119], a[104:107], a[24:27], v[116:119]
    s_add_u32 s66, s56, s54
    v_mfma_f32_16x16x32_bf16 v[116:119], a[108:111], a[28:31], v[116:119]
    buffer_store_dwordx4 v[56:59], v30, s[32:35], s66 offen sc1
    v_mfma_f32_16x16x32_bf16 v[112:115], a[100:103], a[28:31], v[112:115]
    v_mfma_f32_16x16x32_bf16 v[112:115], a[96:99], a[24:27], v[112:115]
    s_waitcnt vmcnt(11) lgkmcnt(0)
    s_barrier
    v_mfma_f32_16x16x32_bf16 v[132:135], a[96:99], a[32:35], v[132:135]
    ds_read_b64_tr_b16 a[64:65], v26 offset:0
    ds_read_b64_tr_b16 a[66:67], v26 offset:1024
    v_mfma_f32_16x16x32_bf16 v[132:135], a[100:103], a[36:39], v[132:135]
    ds_read_b64_tr_b16 a[68:69], v26 offset:8192
    ds_read_b64_tr_b16 a[70:71], v26 offset:9216
    v_mfma_f32_16x16x32_bf16 v[140:143], a[108:111], a[36:39], v[140:143]
    ds_read_b64_tr_b16 a[72:73], v27 offset:0
    ds_read_b64_tr_b16 a[74:75], v27 offset:1024
    v_mfma_f32_16x16x32_bf16 v[140:143], a[104:107], a[32:35], v[140:143]
    s_add_u32 s67, s56, s55
    ds_read_b64_tr_b16 a[76:77], v27 offset:8192
    ds_read_b64_tr_b16 a[78:79], v27 offset:9216
    v_mfma_f32_16x16x32_bf16 v[148:151], a[112:115], a[32:35], v[148:151]
    ds_read_b64_tr_b16 a[80:81], v28 offset:0
    ds_read_b64_tr_b16 a[82:83], v28 offset:1024
    v_mfma_f32_16x16x32_bf16 v[148:151], a[116:119], a[36:39], v[148:151]
    ds_read_b64_tr_b16 a[84:85], v28 offset:8192
    ds_read_b64_tr_b16 a[86:87], v28 offset:9216
    v_mfma_f32_16x16x32_bf16 v[156:159], a[124:127], a[36:39], v[156:159]
    ds_read_b64_tr_b16 a[88:89], v29 offset:0
    ds_read_b64_tr_b16 a[90:91], v29 offset:1024
    v_mfma_f32_16x16x32_bf16 v[156:159], a[120:123], a[32:35], v[156:159]
    ds_read_b64_tr_b16 a[92:93], v29 offset:8192
    ds_read_b64_tr_b16 a[94:95], v29 offset:9216
    v_mfma_f32_16x16x32_bf16 v[188:191], a[120:123], a[40:43], v[188:191]
    ds_read_b128 a[0:3], v24 offset:0
    v_mfma_f32_16x16x32_bf16 v[188:191], a[124:127], a[44:47], v[188:191]
    ds_read_b128 a[4:7], v25 offset:0
    v_mfma_f32_16x16x32_bf16 v[180:183], a[116:119], a[44:47], v[180:183]
    s_add_u32 s64, s58, s48
    ds_read_b128 a[8:11], v24 offset:2048
    v_mfma_f32_16x16x32_bf16 v[180:183], a[112:115], a[40:43], v[180:183]
    ds_read_b128 a[12:15], v25 offset:2048
    v_mfma_f32_16x16x32_bf16 v[172:175], a[104:107], a[40:43], v[172:175]
    ds_read_b128 a[16:19], v24 offset:4096
    v_mfma_f32_16x16x32_bf16 v[172:175], a[108:111], a[44:47], v[172:175]
    ds_read_b128 a[20:23], v25 offset:4096
    v_mfma_f32_16x16x32_bf16 v[164:167], a[100:103], a[44:47], v[164:167]
    ds_read_b128 a[24:27], v24 offset:6144
    v_mfma_f32_16x16x32_bf16 v[164:167], a[96:99], a[40:43], v[164:167]
    ds_read_b128 a[28:31], v25 offset:6144
    v_mfma_f32_16x16x32_bf16 v[196:199], a[96:99], a[48:51], v[196:199]
    buffer_store_dwordx4 v[60:63], v30, s[32:35], s67 offen sc1
    v_mfma_f32_16x16x32_bf16 v[196:199], a[100:103], a[52:55], v[196:199]
    buffer_store_dwordx4 v[128:131], v30, s[32:35], s64 offen sc1
    v_mfma_f32_16x16x32_bf16 v[204:207], a[108:111], a[52:55], v[204:207]
    s_add_u32 s65, s58, s49
    v_mfma_f32_16x16x32_bf16 v[204:207], a[104:107], a[48:51], v[204:207]
    buffer_store_dwordx4 v[136:139], v30, s[32:35], s65 offen sc1
    v_mfma_f32_16x16x32_bf16 v[212:215], a[112:115], a[48:51], v[212:215]
    v_mfma_f32_16x16x32_bf16 v[212:215], a[116:119], a[52:55], v[212:215]
    v_mfma_f32_16x16x32_bf16 v[220:223], a[124:127], a[52:55], v[220:223]
    v_mfma_f32_16x16x32_bf16 v[220:223], a[120:123], a[48:51], v[220:223]
    v_mfma_f32_16x16x32_bf16 v[252:255], a[120:123], a[56:59], v[252:255]
    s_add_u32 s66, s58, s50
    v_mfma_f32_16x16x32_bf16 v[252:255], a[124:127], a[60:63], v[252:255]
    buffer_store_dwordx4 v[144:147], v30, s[32:35], s66 offen sc1
    v_mfma_f32_16x16x32_bf16 v[244:247], a[116:119], a[60:63], v[244:247]
    v_mfma_f32_16x16x32_bf16 v[244:247], a[112:115], a[56:59], v[244:247]
    v_mfma_f32_16x16x32_bf16 v[236:239], a[104:107], a[56:59], v[236:239]
    v_mfma_f32_16x16x32_bf16 v[236:239], a[108:111], a[60:63], v[236:239]
    v_mfma_f32_16x16x32_bf16 v[228:231], a[100:103], a[60:63], v[228:231]
    v_mfma_f32_16x16x32_bf16 v[228:231], a[96:99], a[56:59], v[228:231]
    s_add_u32 s67, s58, s51
    s_waitcnt vmcnt(11) lgkmcnt(0)
    s_barrier
    v_mfma_f32_16x16x32_bf16 v[64:67], a[64:67], a[0:3], v[64:67]
    ds_read_b128 a[32:35], v24 offset:16384
    v_mfma_f32_16x16x32_bf16 v[64:67], a[68:71], a[4:7], v[64:67]
    ds_read_b128 a[36:39], v25 offset:16384
    v_mfma_f32_16x16x32_bf16 v[68:71], a[76:79], a[4:7], v[68:71]
    ds_read_b128 a[40:43], v24 offset:18432
    v_mfma_f32_16x16x32_bf16 v[68:71], a[72:75], a[0:3], v[68:71]
    ds_read_b128 a[44:47], v25 offset:18432
    v_mfma_f32_16x16x32_bf16 v[72:75], a[80:83], a[0:3], v[72:75]
    ds_read_b128 a[48:51], v24 offset:20480
    v_mfma_f32_16x16x32_bf16 v[72:75], a[84:87], a[4:7], v[72:75]
    ds_read_b128 a[52:55], v25 offset:20480
    v_mfma_f32_16x16x32_bf16 v[76:79], a[92:95], a[4:7], v[76:79]
    s_add_u32 s64, s58, s52
    ds_read_b128 a[56:59], v24 offset:22528
    v_mfma_f32_16x16x32_bf16 v[76:79], a[88:91], a[0:3], v[76:79]
    ds_read_b128 a[60:63], v25 offset:22528
    v_mfma_f32_16x16x32_bf16 v[92:95], a[88:91], a[8:11], v[92:95]
    buffer_store_dwordx4 v[152:155], v30, s[32:35], s67 offen sc1
    v_mfma_f32_16x16x32_bf16 v[92:95], a[92:95], a[12:15], v[92:95]
    buffer_store_dwordx4 v[160:163], v30, s[32:35], s64 offen sc1
    v_mfma_f32_16x16x32_bf16 v[88:91], a[84:87], a[12:15], v[88:91]
    v_mfma_f32_16x16x32_bf16 v[88:91], a[80:83], a[8:11], v[88:91]
    v_mfma_f32_16x16x32_bf16 v[84:87], a[72:75], a[8:11], v[84:87]
    v_mfma_f32_16x16x32_bf16 v[84:87], a[76:79], a[12:15], v[84:87]
    s_add_u32 s65, s58, s53
    v_mfma_f32_16x16x32_bf16 v[80:83], a[68:71], a[12:15], v[80:83]
    buffer_store_dwordx4 v[168:171], v30, s[32:35], s65 offen sc1
    v_mfma_f32_16x16x32_bf16 v[80:83], a[64:67], a[8:11], v[80:83]
    v_mfma_f32_16x16x32_bf16 v[96:99], a[64:67], a[16:19], v[96:99]
    v_mfma_f32_16x16x32_bf16 v[96:99], a[68:71], a[20:23], v[96:99]
    v_mfma_f32_16x16x32_bf16 v[100:103], a[76:79], a[20:23], v[100:103]
    v_mfma_f32_16x16x32_bf16 v[100:103], a[72:75], a[16:19], v[100:103]
    v_mfma_f32_16x16x32_bf16 v[104:107], a[80:83], a[16:19], v[104:107]
    s_add_u32 s66, s58, s54
    v_mfma_f32_16x16x32_bf16 v[104:107], a[84:87], a[20:23], v[104:107]
    buffer_store_dwordx4 v[176:179], v30, s[32:35], s66 offen sc1
    v_mfma_f32_16x16x32_bf16 v[108:111], a[92:95], a[20:23], v[108:111]
    v_mfma_f32_16x16x32_bf16 v[108:111], a[88:91], a[16:19], v[108:111]
    v_mfma_f32_16x16x32_bf16 v[124:127], a[88:91], a[24:27], v[124:127]
    v_mfma_f32_16x16x32_bf16 v[124:127], a[92:95], a[28:31], v[124:127]
    v_mfma_f32_16x16x32_bf16 v[120:123], a[84:87], a[28:31], v[120:123]
    v_mfma_f32_16x16x32_bf16 v[120:123], a[80:83], a[24:27], v[120:123]
    s_add_u32 s67, s58, s55
    v_mfma_f32_16x16x32_bf16 v[116:119], a[72:75], a[24:27], v[116:119]
    buffer_store_dwordx4 v[184:187], v30, s[32:35], s67 offen sc1
    v_mfma_f32_16x16x32_bf16 v[116:119], a[76:79], a[28:31], v[116:119]
    v_mfma_f32_16x16x32_bf16 v[112:115], a[68:71], a[28:31], v[112:115]
    v_mfma_f32_16x16x32_bf16 v[112:115], a[64:67], a[24:27], v[112:115]
    s_waitcnt lgkmcnt(7)
    v_mfma_f32_16x16x32_bf16 v[132:135], a[64:67], a[32:35], v[132:135]
    s_waitcnt lgkmcnt(6)
    v_mfma_f32_16x16x32_bf16 v[132:135], a[68:71], a[36:39], v[132:135]
    v_mfma_f32_16x16x32_bf16 v[140:143], a[76:79], a[36:39], v[140:143]
    s_add_u32 s64, s59, s48
    v_mfma_f32_16x16x32_bf16 v[140:143], a[72:75], a[32:35], v[140:143]
    buffer_store_dwordx4 v[192:195], v30, s[32:35], s64 offen sc1
    v_mfma_f32_16x16x32_bf16 v[148:151], a[80:83], a[32:35], v[148:151]
    v_mfma_f32_16x16x32_bf16 v[148:151], a[84:87], a[36:39], v[148:151]
    v_mfma_f32_16x16x32_bf16 v[156:159], a[92:95], a[36:39], v[156:159]
    v_mfma_f32_16x16x32_bf16 v[156:159], a[88:91], a[32:35], v[156:159]
    s_waitcnt lgkmcnt(5)
    v_mfma_f32_16x16x32_bf16 v[188:191], a[88:91], a[40:43], v[188:191]
    s_waitcnt lgkmcnt(4)
    v_mfma_f32_16x16x32_bf16 v[188:191], a[92:95], a[44:47], v[188:191]
    s_add_u32 s65, s59, s49
    v_mfma_f32_16x16x32_bf16 v[180:183], a[84:87], a[44:47], v[180:183]
    buffer_store_dwordx4 v[200:203], v30, s[32:35], s65 offen sc1
    v_mfma_f32_16x16x32_bf16 v[180:183], a[80:83], a[40:43], v[180:183]
    v_mfma_f32_16x16x32_bf16 v[172:175], a[72:75], a[40:43], v[172:175]
    v_mfma_f32_16x16x32_bf16 v[172:175], a[76:79], a[44:47], v[172:175]
    v_mfma_f32_16x16x32_bf16 v[164:167], a[68:71], a[44:47], v[164:167]
    v_mfma_f32_16x16x32_bf16 v[164:167], a[64:67], a[40:43], v[164:167]
    s_waitcnt lgkmcnt(3)
    v_mfma_f32_16x16x32_bf16 v[196:199], a[64:67], a[48:51], v[196:199]
    s_add_u32 s66, s59, s50
    s_waitcnt lgkmcnt(2)
    v_mfma_f32_16x16x32_bf16 v[196:199], a[68:71], a[52:55], v[196:199]
    buffer_store_dwordx4 v[208:211], v30, s[32:35], s66 offen sc1
    v_mfma_f32_16x16x32_bf16 v[204:207], a[76:79], a[52:55], v[204:207]
    v_mfma_f32_16x16x32_bf16 v[204:207], a[72:75], a[48:51], v[204:207]
    v_mfma_f32_16x16x32_bf16 v[212:215], a[80:83], a[48:51], v[212:215]
    v_mfma_f32_16x16x32_bf16 v[212:215], a[84:87], a[52:55], v[212:215]
    v_mfma_f32_16x16x32_bf16 v[220:223], a[92:95], a[52:55], v[220:223]
    v_mfma_f32_16x16x32_bf16 v[220:223], a[88:91], a[48:51], v[220:223]
    s_add_u32 s67, s59, s51
    s_waitcnt lgkmcnt(1)
    v_mfma_f32_16x16x32_bf16 v[252:255], a[88:91], a[56:59], v[252:255]
    buffer_store_dwordx4 v[216:219], v30, s[32:35], s67 offen sc1
    s_waitcnt lgkmcnt(0)
    v_mfma_f32_16x16x32_bf16 v[252:255], a[92:95], a[60:63], v[252:255]
    v_mfma_f32_16x16x32_bf16 v[244:247], a[84:87], a[60:63], v[244:247]
    v_mfma_f32_16x16x32_bf16 v[244:247], a[80:83], a[56:59], v[244:247]
    v_mfma_f32_16x16x32_bf16 v[236:239], a[72:75], a[56:59], v[236:239]
    v_mfma_f32_16x16x32_bf16 v[236:239], a[76:79], a[60:63], v[236:239]
    v_mfma_f32_16x16x32_bf16 v[228:231], a[68:71], a[60:63], v[228:231]
    v_mfma_f32_16x16x32_bf16 v[228:231], a[64:67], a[56:59], v[228:231]
    s_nop 7
    s_add_u32 s64, s59, s52
    s_mov_b32 s61, 0x3fb8aa3b
    s_mov_b32 s62, 0x358637bd
    v_cmp_gt_u32 vcc, 48, v2
    s_add_u32 s60, s44, 0
    v_mul_f32 v32, s61, v64
    v_mul_f32 v33, s61, v65
    v_mul_f32 v34, s61, v66
    v_mul_f32 v35, s61, v67
    v_mul_f32 v36, s61, v68
    v_mul_f32 v37, s61, v69
    v_mul_f32 v38, s61, v70
    v_mul_f32 v39, s61, v71
    v_exp_f32 v32, v32 clamp
    v_exp_f32 v33, v33 clamp
    v_exp_f32 v34, v34 clamp
    v_exp_f32 v35, v35 clamp
    v_exp_f32 v36, v36 clamp
    v_exp_f32 v37, v37 clamp
    v_exp_f32 v38, v38 clamp
    v_exp_f32 v39, v39 clamp
    v_max_f32 v64, 0, v64
    v_max_f32 v65, 0, v65
    v_max_f32 v66, 0, v66
    v_max_f32 v67, 0, v67
    v_max_f32 v68, 0, v68
    v_max_f32 v69, 0, v69
    v_max_f32 v70, 0, v70
    v_max_f32 v71, 0, v71
    v_add_f32 v32, s62, v32
    v_add_f32 v33, s62, v33
    v_add_f32 v34, s62, v34
    v_add_f32 v35, s62, v35
    v_add_f32 v36, s62, v36
    v_add_f32 v37, s62, v37
    v_add_f32 v38, s62, v38
    buffer_store_dwordx4 v[224:227], v30, s[32:35], s64 offen sc1
    v_add_f32 v39, s62, v39
    v_add_f32 v64, v64, v32
    v_add_f32 v65, v65, v33
    v_add_f32 v66, v66, v34
    v_add_f32 v67, v67, v35
    v_add_f32 v68, v68, v36
    v_add_f32 v69, v69, v37
    v_add_f32 v70, v70, v38
    v_add_f32 v71, v71, v39
    v_cvt_pk_bf16_f32 v64, v64, v65
    v_cvt_pk_bf16_f32 v65, v66, v67
    v_cvt_pk_bf16_f32 v66, v68, v69
    v_cvt_pk_bf16_f32 v67, v70, v71
    v_cndmask_b32 v66, 0, v66, vcc
    v_cndmask_b32 v67, 0, v67, vcc
    buffer_store_dwordx4 v[64:67], v31, s[32:35], s60 offen offset:0
    v_mul_f32 v32, s61, v80
    v_mul_f32 v33, s61, v81
    v_mul_f32 v34, s61, v82
    v_mul_f32 v35, s61, v83
    v_mul_f32 v36, s61, v84
    v_mul_f32 v37, s61, v85
    v_mul_f32 v38, s61, v86
    v_mul_f32 v39, s61, v87
    v_exp_f32 v32, v32 clamp
    v_exp_f32 v33, v33 clamp
    v_exp_f32 v34, v34 clamp
    v_exp_f32 v35, v35 clamp
    v_exp_f32 v36, v36 clamp
    v_exp_f32 v37, v37 clamp
    v_exp_f32 v38, v38 clamp
    v_exp_f32 v39, v39 clamp
    v_max_f32 v80, 0, v80
    v_max_f32 v81, 0, v81
    s_add_u32 s65, s59, s53
    v_max_f32 v82, 0, v82
    v_max_f32 v83, 0, v83
    v_max_f32 v84, 0, v84
    v_max_f32 v85, 0, v85
    v_max_f32 v86, 0, v86
    v_max_f32 v87, 0, v87
    v_add_f32 v32, s62, v32
    v_add_f32 v33, s62, v33
    v_add_f32 v34, s62, v34
    v_add_f32 v35, s62, v35
    v_add_f32 v36, s62, v36
    v_add_f32 v37, s62, v37
    v_add_f32 v38, s62, v38
    v_add_f32 v39, s62, v39
    v_add_f32 v80, v80, v32
    v_add_f32 v81, v81, v33
    v_add_f32 v82, v82, v34
    v_add_f32 v83, v83, v35
    v_add_f32 v84, v84, v36
    v_add_f32 v85, v85, v37
    v_add_f32 v86, v86, v38
    v_add_f32 v87, v87, v39
    v_cvt_pk_bf16_f32 v80, v80, v81
    v_cvt_pk_bf16_f32 v81, v82, v83
    v_cvt_pk_bf16_f32 v82, v84, v85
    v_cvt_pk_bf16_f32 v83, v86, v87
    v_cndmask_b32 v82, 0, v82, vcc
    v_cndmask_b32 v83, 0, v83, vcc
    buffer_store_dwordx4 v[80:83], v31, s[32:35], s60 offen offset:1024
    v_mul_f32 v32, s61, v96
    v_mul_f32 v33, s61, v97
    v_mul_f32 v34, s61, v98
    v_mul_f32 v35, s61, v99
    v_mul_f32 v36, s61, v100
    v_mul_f32 v37, s61, v101
    buffer_store_dwordx4 v[232:235], v30, s[32:35], s65 offen sc1
    v_mul_f32 v38, s61, v102
    v_mul_f32 v39, s61, v103
    v_exp_f32 v32, v32 clamp
    v_exp_f32 v33, v33 clamp
    v_exp_f32 v34, v34 clamp
    v_exp_f32 v35, v35 clamp
    v_exp_f32 v36, v36 clamp
    v_exp_f32 v37, v37 clamp
    v_exp_f32 v38, v38 clamp
    v_exp_f32 v39, v39 clamp
    v_max_f32 v96, 0, v96
    v_max_f32 v97, 0, v97
    v_max_f32 v98, 0, v98
    v_max_f32 v99, 0, v99
    v_max_f32 v100, 0, v100
    v_max_f32 v101, 0, v101
    v_max_f32 v102, 0, v102
    v_max_f32 v103, 0, v103
    v_add_f32 v32, s62, v32
    v_add_f32 v33, s62, v33
    v_add_f32 v34, s62, v34
    v_add_f32 v35, s62, v35
    v_add_f32 v36, s62, v36
    v_add_f32 v37, s62, v37
    v_add_f32 v38, s62, v38
    v_add_f32 v39, s62, v39
    v_add_f32 v96, v96, v32
    v_add_f32 v97, v97, v33
    v_add_f32 v98, v98, v34
    v_add_f32 v99, v99, v35
    v_add_f32 v100, v100, v36
    v_add_f32 v101, v101, v37
    v_add_f32 v102, v102, v38
    v_add_f32 v103, v103, v39
    s_add_u32 s66, s59, s54
    v_cvt_pk_bf16_f32 v96, v96, v97
    v_cvt_pk_bf16_f32 v97, v98, v99
    v_cvt_pk_bf16_f32 v98, v100, v101
    v_cvt_pk_bf16_f32 v99, v102, v103
    v_cndmask_b32 v98, 0, v98, vcc
    v_cndmask_b32 v99, 0, v99, vcc
    buffer_store_dwordx4 v[96:99], v31, s[32:35], s60 offen offset:2048
    v_mul_f32 v32, s61, v112
    v_mul_f32 v33, s61, v113
    v_mul_f32 v34, s61, v114
    v_mul_f32 v35, s61, v115
    v_mul_f32 v36, s61, v116
    v_mul_f32 v37, s61, v117
    v_mul_f32 v38, s61, v118
    v_mul_f32 v39, s61, v119
    v_exp_f32 v32, v32 clamp
    v_exp_f32 v33, v33 clamp
    v_exp_f32 v34, v34 clamp
    v_exp_f32 v35, v35 clamp
    v_exp_f32 v36, v36 clamp
    v_exp_f32 v37, v37 clamp
    v_exp_f32 v38, v38 clamp
    v_exp_f32 v39, v39 clamp
    v_max_f32 v112, 0, v112
    v_max_f32 v113, 0, v113
    v_max_f32 v114, 0, v114
    v_max_f32 v115, 0, v115
    v_max_f32 v116, 0, v116
    v_max_f32 v117, 0, v117
    v_max_f32 v118, 0, v118
    v_max_f32 v119, 0, v119
    v_add_f32 v32, s62, v32
    v_add_f32 v33, s62, v33
    v_add_f32 v34, s62, v34
    v_add_f32 v35, s62, v35
    buffer_store_dwordx4 v[240:243], v30, s[32:35], s66 offen sc1
    v_add_f32 v36, s62, v36
    v_add_f32 v37, s62, v37
    v_add_f32 v38, s62, v38
    v_add_f32 v39, s62, v39
    v_add_f32 v112, v112, v32
    v_add_f32 v113, v113, v33
    v_add_f32 v114, v114, v34
    v_add_f32 v115, v115, v35
    v_add_f32 v116, v116, v36
    v_add_f32 v117, v117, v37
    v_add_f32 v118, v118, v38
    v_add_f32 v119, v119, v39
    v_cvt_pk_bf16_f32 v112, v112, v113
    v_cvt_pk_bf16_f32 v113, v114, v115
    v_cvt_pk_bf16_f32 v114, v116, v117
    v_cvt_pk_bf16_f32 v115, v118, v119
    v_cndmask_b32 v114, 0, v114, vcc
    v_cndmask_b32 v115, 0, v115, vcc
    buffer_store_dwordx4 v[112:115], v31, s[32:35], s60 offen offset:3072
    s_add_u32 s60, s44, 131072
    v_mul_f32 v32, s61, v72
    v_mul_f32 v33, s61, v73
    v_mul_f32 v34, s61, v74
    v_mul_f32 v35, s61, v75
    v_mul_f32 v36, s61, v76
    v_mul_f32 v37, s61, v77
    v_mul_f32 v38, s61, v78
    v_mul_f32 v39, s61, v79
    v_exp_f32 v32, v32 clamp
    v_exp_f32 v33, v33 clamp
    v_exp_f32 v34, v34 clamp
    v_exp_f32 v35, v35 clamp
    v_exp_f32 v36, v36 clamp
    v_exp_f32 v37, v37 clamp
    s_add_u32 s67, s59, s55
    v_exp_f32 v38, v38 clamp
    v_exp_f32 v39, v39 clamp
    v_max_f32 v72, 0, v72
    v_max_f32 v73, 0, v73
    v_max_f32 v74, 0, v74
    v_max_f32 v75, 0, v75
    v_max_f32 v76, 0, v76
    v_max_f32 v77, 0, v77
    v_max_f32 v78, 0, v78
    v_max_f32 v79, 0, v79
    v_add_f32 v32, s62, v32
    v_add_f32 v33, s62, v33
    v_add_f32 v34, s62, v34
    v_add_f32 v35, s62, v35
    v_add_f32 v36, s62, v36
    v_add_f32 v37, s62, v37
    v_add_f32 v38, s62, v38
    v_add_f32 v39, s62, v39
    v_add_f32 v72, v72, v32
    v_add_f32 v73, v73, v33
    v_add_f32 v74, v74, v34
    v_add_f32 v75, v75, v35
    v_add_f32 v76, v76, v36
    v_add_f32 v77, v77, v37
    v_add_f32 v78, v78, v38
    v_add_f32 v79, v79, v39
    v_cvt_pk_bf16_f32 v72, v72, v73
    v_cvt_pk_bf16_f32 v73, v74, v75
    v_cvt_pk_bf16_f32 v74, v76, v77
    v_cvt_pk_bf16_f32 v75, v78, v79
    v_cndmask_b32 v74, 0, v74, vcc
    v_cndmask_b32 v75, 0, v75, vcc
    buffer_store_dwordx4 v[72:75], v31, s[32:35], s60 offen offset:0
    v_mul_f32 v32, s61, v88
    v_mul_f32 v33, s61, v89
    buffer_store_dwordx4 v[248:251], v30, s[32:35], s67 offen sc1
    v_mul_f32 v34, s61, v90
    v_mul_f32 v35, s61, v91
    v_mul_f32 v36, s61, v92
    v_mul_f32 v37, s61, v93
    v_mul_f32 v38, s61, v94
    v_mul_f32 v39, s61, v95
    v_exp_f32 v32, v32 clamp
    v_exp_f32 v33, v33 clamp
    v_exp_f32 v34, v34 clamp
    v_exp_f32 v35, v35 clamp
    v_exp_f32 v36, v36 clamp
    v_exp_f32 v37, v37 clamp
    v_exp_f32 v38, v38 clamp
    v_exp_f32 v39, v39 clamp
    v_max_f32 v88, 0, v88
    v_max_f32 v89, 0, v89
    v_max_f32 v90, 0, v90
    v_max_f32 v91, 0, v91
    v_max_f32 v92, 0, v92
    v_max_f32 v93, 0, v93
    v_max_f32 v94, 0, v94
    v_max_f32 v95, 0, v95
    v_add_f32 v32, s62, v32
    v_add_f32 v33, s62, v33
    v_add_f32 v34, s62, v34
    v_add_f32 v35, s62, v35
    v_add_f32 v36, s62, v36
    v_add_f32 v37, s62, v37
    v_add_f32 v38, s62, v38
    v_add_f32 v39, s62, v39
    v_add_f32 v88, v88, v32
    v_add_f32 v89, v89, v33
    v_add_f32 v90, v90, v34
    v_add_f32 v91, v91, v35
    buffer_store_dwordx4 a[192:195], v1, s[32:35], s100 offen sc1
    v_add_f32 v92, v92, v36
    v_add_f32 v93, v93, v37
    v_add_f32 v94, v94, v38
    v_add_f32 v95, v95, v39
    v_cvt_pk_bf16_f32 v88, v88, v89
    v_cvt_pk_bf16_f32 v89, v90, v91
    v_cvt_pk_bf16_f32 v90, v92, v93
    v_cvt_pk_bf16_f32 v91, v94, v95
    v_cndmask_b32 v90, 0, v90, vcc
    v_cndmask_b32 v91, 0, v91, vcc
    buffer_store_dwordx4 v[88:91], v31, s[32:35], s60 offen offset:1024
    v_mul_f32 v32, s61, v104
    v_mul_f32 v33, s61, v105
    v_mul_f32 v34, s61, v106
    v_mul_f32 v35, s61, v107
    v_mul_f32 v36, s61, v108
    v_mul_f32 v37, s61, v109
    v_mul_f32 v38, s61, v110
    v_mul_f32 v39, s61, v111
    v_exp_f32 v32, v32 clamp
    v_exp_f32 v33, v33 clamp
    v_exp_f32 v34, v34 clamp
    v_exp_f32 v35, v35 clamp
    v_exp_f32 v36, v36 clamp
    v_exp_f32 v37, v37 clamp
    v_exp_f32 v38, v38 clamp
    v_exp_f32 v39, v39 clamp
    v_max_f32 v104, 0, v104
    v_max_f32 v105, 0, v105
    v_max_f32 v106, 0, v106
    v_max_f32 v107, 0, v107
    v_max_f32 v108, 0, v108
    v_max_f32 v109, 0, v109
    v_max_f32 v110, 0, v110
    v_max_f32 v111, 0, v111
    s_add_u32 s100, s100, s101
    v_add_f32 v32, s62, v32
    v_add_f32 v33, s62, v33
    v_add_f32 v34, s62, v34
    v_add_f32 v35, s62, v35
    v_add_f32 v36, s62, v36
    v_add_f32 v37, s62, v37
    v_add_f32 v38, s62, v38
    v_add_f32 v39, s62, v39
    v_add_f32 v104, v104, v32
    v_add_f32 v105, v105, v33
    v_add_f32 v106, v106, v34
    v_add_f32 v107, v107, v35
    v_add_f32 v108, v108, v36
    v_add_f32 v109, v109, v37
    v_add_f32 v110, v110, v38
    v_add_f32 v111, v111, v39
    v_cvt_pk_bf16_f32 v104, v104, v105
    v_cvt_pk_bf16_f32 v105, v106, v107
    v_cvt_pk_bf16_f32 v106, v108, v109
    v_cvt_pk_bf16_f32 v107, v110, v111
    v_cndmask_b32 v106, 0, v106, vcc
    v_cndmask_b32 v107, 0, v107, vcc
    buffer_store_dwordx4 v[104:107], v31, s[32:35], s60 offen offset:2048
    v_mul_f32 v32, s61, v120
    v_mul_f32 v33, s61, v121
    v_mul_f32 v34, s61, v122
    v_mul_f32 v35, s61, v123
    v_mul_f32 v36, s61, v124
    v_mul_f32 v37, s61, v125
    v_mul_f32 v38, s61, v126
    v_mul_f32 v39, s61, v127
    v_exp_f32 v32, v32 clamp
    v_exp_f32 v33, v33 clamp
    v_exp_f32 v34, v34 clamp
    buffer_store_dwordx4 a[196:199], v1, s[32:35], s100 offen sc1
    v_exp_f32 v35, v35 clamp
    v_exp_f32 v36, v36 clamp
    v_exp_f32 v37, v37 clamp
    v_exp_f32 v38, v38 clamp
    v_exp_f32 v39, v39 clamp
    v_max_f32 v120, 0, v120
    v_max_f32 v121, 0, v121
    v_max_f32 v122, 0, v122
    v_max_f32 v123, 0, v123
    v_max_f32 v124, 0, v124
    v_max_f32 v125, 0, v125
    v_max_f32 v126, 0, v126
    v_max_f32 v127, 0, v127
    v_add_f32 v32, s62, v32
    v_add_f32 v33, s62, v33
    v_add_f32 v34, s62, v34
    v_add_f32 v35, s62, v35
    v_add_f32 v36, s62, v36
    v_add_f32 v37, s62, v37
    v_add_f32 v38, s62, v38
    v_add_f32 v39, s62, v39
    v_add_f32 v120, v120, v32
    v_add_f32 v121, v121, v33
    v_add_f32 v122, v122, v34
    v_add_f32 v123, v123, v35
    v_add_f32 v124, v124, v36
    v_add_f32 v125, v125, v37
    v_add_f32 v126, v126, v38
    v_add_f32 v127, v127, v39
    v_cvt_pk_bf16_f32 v120, v120, v121
    v_cvt_pk_bf16_f32 v121, v122, v123
    v_cvt_pk_bf16_f32 v122, v124, v125
    v_cvt_pk_bf16_f32 v123, v126, v127
    v_cndmask_b32 v122, 0, v122, vcc
    v_cndmask_b32 v123, 0, v123, vcc
    s_add_u32 s100, s100, s101
    buffer_store_dwordx4 v[120:123], v31, s[32:35], s60 offen offset:3072
    s_add_u32 s60, s44, 8192
    v_mul_f32 v32, s61, v132
    v_mul_f32 v33, s61, v133
    v_mul_f32 v34, s61, v134
    v_mul_f32 v35, s61, v135
    v_mul_f32 v36, s61, v140
    v_mul_f32 v37, s61, v141
    v_mul_f32 v38, s61, v142
    v_mul_f32 v39, s61, v143
    v_exp_f32 v32, v32 clamp
    v_exp_f32 v33, v33 clamp
    v_exp_f32 v34, v34 clamp
    v_exp_f32 v35, v35 clamp
    v_exp_f32 v36, v36 clamp
    v_exp_f32 v37, v37 clamp
    v_exp_f32 v38, v38 clamp
    v_exp_f32 v39, v39 clamp
    v_max_f32 v132, 0, v132
    v_max_f32 v133, 0, v133
    v_max_f32 v134, 0, v134
    v_max_f32 v135, 0, v135
    v_max_f32 v140, 0, v140
    v_max_f32 v141, 0, v141
    v_max_f32 v142, 0, v142
    v_max_f32 v143, 0, v143
    v_add_f32 v32, s62, v32
    v_add_f32 v33, s62, v33
    v_add_f32 v34, s62, v34
    v_add_f32 v35, s62, v35
    v_add_f32 v36, s62, v36
    v_add_f32 v37, s62, v37
    v_add_f32 v38, s62, v38
    v_add_f32 v39, s62, v39
    buffer_store_dwordx4 a[200:203], v1, s[32:35], s100 offen sc1
    v_add_f32 v132, v132, v32
    v_add_f32 v133, v133, v33
    v_add_f32 v134, v134, v34
    v_add_f32 v135, v135, v35
    v_add_f32 v140, v140, v36
    v_add_f32 v141, v141, v37
    v_add_f32 v142, v142, v38
    v_add_f32 v143, v143, v39
    v_cvt_pk_bf16_f32 v132, v132, v133
    v_cvt_pk_bf16_f32 v133, v134, v135
    v_cvt_pk_bf16_f32 v134, v140, v141
    v_cvt_pk_bf16_f32 v135, v142, v143
    v_cndmask_b32 v134, 0, v134, vcc
    v_cndmask_b32 v135, 0, v135, vcc
    buffer_store_dwordx4 v[132:135], v31, s[32:35], s60 offen offset:0
    v_mul_f32 v32, s61, v164
    v_mul_f32 v33, s61, v165
    v_mul_f32 v34, s61, v166
    v_mul_f32 v35, s61, v167
    v_mul_f32 v36, s61, v172
    v_mul_f32 v37, s61, v173
    v_mul_f32 v38, s61, v174
    v_mul_f32 v39, s61, v175
    v_exp_f32 v32, v32 clamp
    v_exp_f32 v33, v33 clamp
    v_exp_f32 v34, v34 clamp
    v_exp_f32 v35, v35 clamp
    v_exp_f32 v36, v36 clamp
    v_exp_f32 v37, v37 clamp
    v_exp_f32 v38, v38 clamp
    v_exp_f32 v39, v39 clamp
    v_max_f32 v164, 0, v164
    v_max_f32 v165, 0, v165
    v_max_f32 v166, 0, v166
    v_max_f32 v167, 0, v167
    s_add_u32 s100, s100, s101
    v_max_f32 v172, 0, v172
    v_max_f32 v173, 0, v173
    v_max_f32 v174, 0, v174
    v_max_f32 v175, 0, v175
    v_add_f32 v32, s62, v32
    v_add_f32 v33, s62, v33
    v_add_f32 v34, s62, v34
    v_add_f32 v35, s62, v35
    v_add_f32 v36, s62, v36
    v_add_f32 v37, s62, v37
    v_add_f32 v38, s62, v38
    v_add_f32 v39, s62, v39
    v_add_f32 v164, v164, v32
    v_add_f32 v165, v165, v33
    v_add_f32 v166, v166, v34
    v_add_f32 v167, v167, v35
    v_add_f32 v172, v172, v36
    v_add_f32 v173, v173, v37
    v_add_f32 v174, v174, v38
    v_add_f32 v175, v175, v39
    v_cvt_pk_bf16_f32 v164, v164, v165
    v_cvt_pk_bf16_f32 v165, v166, v167
    v_cvt_pk_bf16_f32 v166, v172, v173
    v_cvt_pk_bf16_f32 v167, v174, v175
    v_cndmask_b32 v166, 0, v166, vcc
    v_cndmask_b32 v167, 0, v167, vcc
    buffer_store_dwordx4 v[164:167], v31, s[32:35], s60 offen offset:1024
    v_mul_f32 v32, s61, v196
    v_mul_f32 v33, s61, v197
    v_mul_f32 v34, s61, v198
    v_mul_f32 v35, s61, v199
    v_mul_f32 v36, s61, v204
    v_mul_f32 v37, s61, v205
    v_mul_f32 v38, s61, v206
    buffer_store_dwordx4 a[204:207], v1, s[32:35], s100 offen sc1
    v_mul_f32 v39, s61, v207
    v_exp_f32 v32, v32 clamp
    v_exp_f32 v33, v33 clamp
    v_exp_f32 v34, v34 clamp
    v_exp_f32 v35, v35 clamp
    v_exp_f32 v36, v36 clamp
    v_exp_f32 v37, v37 clamp
    v_exp_f32 v38, v38 clamp
    v_exp_f32 v39, v39 clamp
    v_max_f32 v196, 0, v196
    v_max_f32 v197, 0, v197
    v_max_f32 v198, 0, v198
    v_max_f32 v199, 0, v199
    v_max_f32 v204, 0, v204
    v_max_f32 v205, 0, v205
    v_max_f32 v206, 0, v206
    v_max_f32 v207, 0, v207
    v_add_f32 v32, s62, v32
    v_add_f32 v33, s62, v33
    v_add_f32 v34, s62, v34
    v_add_f32 v35, s62, v35
    v_add_f32 v36, s62, v36
    v_add_f32 v37, s62, v37
    v_add_f32 v38, s62, v38
    v_add_f32 v39, s62, v39
    v_add_f32 v196, v196, v32
    v_add_f32 v197, v197, v33
    v_add_f32 v198, v198, v34
    v_add_f32 v199, v199, v35
    v_add_f32 v204, v204, v36
    v_add_f32 v205, v205, v37
    v_add_f32 v206, v206, v38
    v_add_f32 v207, v207, v39
    v_cvt_pk_bf16_f32 v196, v196, v197
    v_cvt_pk_bf16_f32 v197, v198, v199
    s_add_u32 s100, s100, s101
    v_cvt_pk_bf16_f32 v198, v204, v205
    v_cvt_pk_bf16_f32 v199, v206, v207
    v_cndmask_b32 v198, 0, v198, vcc
    v_cndmask_b32 v199, 0, v199, vcc
    buffer_store_dwordx4 v[196:199], v31, s[32:35], s60 offen offset:2048
    v_mul_f32 v32, s61, v228
    v_mul_f32 v33, s61, v229
    v_mul_f32 v34, s61, v230
    v_mul_f32 v35, s61, v231
    v_mul_f32 v36, s61, v236
    v_mul_f32 v37, s61, v237
    v_mul_f32 v38, s61, v238
    v_mul_f32 v39, s61, v239
    v_exp_f32 v32, v32 clamp
    v_exp_f32 v33, v33 clamp
    v_exp_f32 v34, v34 clamp
    v_exp_f32 v35, v35 clamp
    v_exp_f32 v36, v36 clamp
    v_exp_f32 v37, v37 clamp
    v_exp_f32 v38, v38 clamp
    v_exp_f32 v39, v39 clamp
    v_max_f32 v228, 0, v228
    v_max_f32 v229, 0, v229
    v_max_f32 v230, 0, v230
    v_max_f32 v231, 0, v231
    v_max_f32 v236, 0, v236
    v_max_f32 v237, 0, v237
    v_max_f32 v238, 0, v238
    v_max_f32 v239, 0, v239
    v_add_f32 v32, s62, v32
    v_add_f32 v33, s62, v33
    v_add_f32 v34, s62, v34
    v_add_f32 v35, s62, v35
    v_add_f32 v36, s62, v36
    buffer_store_dwordx4 a[208:211], v1, s[32:35], s100 offen sc1
    v_add_f32 v37, s62, v37
    v_add_f32 v38, s62, v38
    v_add_f32 v39, s62, v39
    v_add_f32 v228, v228, v32
    v_add_f32 v229, v229, v33
    v_add_f32 v230, v230, v34
    v_add_f32 v231, v231, v35
    v_add_f32 v236, v236, v36
    v_add_f32 v237, v237, v37
    v_add_f32 v238, v238, v38
    v_add_f32 v239, v239, v39
    v_cvt_pk_bf16_f32 v228, v228, v229
    v_cvt_pk_bf16_f32 v229, v230, v231
    v_cvt_pk_bf16_f32 v230, v236, v237
    v_cvt_pk_bf16_f32 v231, v238, v239
    v_cndmask_b32 v230, 0, v230, vcc
    v_cndmask_b32 v231, 0, v231, vcc
    buffer_store_dwordx4 v[228:231], v31, s[32:35], s60 offen offset:3072
    s_add_u32 s60, s44, 139264
    v_mul_f32 v32, s61, v148
    v_mul_f32 v33, s61, v149
    v_mul_f32 v34, s61, v150
    v_mul_f32 v35, s61, v151
    v_mul_f32 v36, s61, v156
    v_mul_f32 v37, s61, v157
    v_mul_f32 v38, s61, v158
    v_mul_f32 v39, s61, v159
    v_exp_f32 v32, v32 clamp
    v_exp_f32 v33, v33 clamp
    v_exp_f32 v34, v34 clamp
    v_exp_f32 v35, v35 clamp
    v_exp_f32 v36, v36 clamp
    v_exp_f32 v37, v37 clamp
    v_exp_f32 v38, v38 clamp
    v_exp_f32 v39, v39 clamp
    s_add_u32 s100, s100, s101
    v_max_f32 v148, 0, v148
    v_max_f32 v149, 0, v149
    v_max_f32 v150, 0, v150
    v_max_f32 v151, 0, v151
    v_max_f32 v156, 0, v156
    v_max_f32 v157, 0, v157
    v_max_f32 v158, 0, v158
    v_max_f32 v159, 0, v159
    v_add_f32 v32, s62, v32
    v_add_f32 v33, s62, v33
    v_add_f32 v34, s62, v34
    v_add_f32 v35, s62, v35
    v_add_f32 v36, s62, v36
    v_add_f32 v37, s62, v37
    v_add_f32 v38, s62, v38
    v_add_f32 v39, s62, v39
    v_add_f32 v148, v148, v32
    v_add_f32 v149, v149, v33
    v_add_f32 v150, v150, v34
    v_add_f32 v151, v151, v35
    v_add_f32 v156, v156, v36
    v_add_f32 v157, v157, v37
    v_add_f32 v158, v158, v38
    v_add_f32 v159, v159, v39
    v_cvt_pk_bf16_f32 v148, v148, v149
    v_cvt_pk_bf16_f32 v149, v150, v151
    v_cvt_pk_bf16_f32 v150, v156, v157
    v_cvt_pk_bf16_f32 v151, v158, v159
    v_cndmask_b32 v150, 0, v150, vcc
    v_cndmask_b32 v151, 0, v151, vcc
    buffer_store_dwordx4 v[148:151], v31, s[32:35], s60 offen offset:0
    v_mul_f32 v32, s61, v180
    v_mul_f32 v33, s61, v181
    v_mul_f32 v34, s61, v182
    buffer_store_dwordx4 a[212:215], v1, s[32:35], s100 offen sc1
    v_mul_f32 v35, s61, v183
    v_mul_f32 v36, s61, v188
    v_mul_f32 v37, s61, v189
    v_mul_f32 v38, s61, v190
    v_mul_f32 v39, s61, v191
    v_exp_f32 v32, v32 clamp
    v_exp_f32 v33, v33 clamp
    v_exp_f32 v34, v34 clamp
    v_exp_f32 v35, v35 clamp
    v_exp_f32 v36, v36 clamp
    v_exp_f32 v37, v37 clamp
    v_exp_f32 v38, v38 clamp
    v_exp_f32 v39, v39 clamp
    v_max_f32 v180, 0, v180
    v_max_f32 v181, 0, v181
    v_max_f32 v182, 0, v182
    v_max_f32 v183, 0, v183
    v_max_f32 v188, 0, v188
    v_max_f32 v189, 0, v189
    v_max_f32 v190, 0, v190
    v_max_f32 v191, 0, v191
    v_add_f32 v32, s62, v32
    v_add_f32 v33, s62, v33
    v_add_f32 v34, s62, v34
    v_add_f32 v35, s62, v35
    v_add_f32 v36, s62, v36
    v_add_f32 v37, s62, v37
    v_add_f32 v38, s62, v38
    v_add_f32 v39, s62, v39
    v_add_f32 v180, v180, v32
    v_add_f32 v181, v181, v33
    v_add_f32 v182, v182, v34
    v_add_f32 v183, v183, v35
    v_add_f32 v188, v188, v36
    v_add_f32 v189, v189, v37
    s_add_u32 s100, s100, s101
    v_add_f32 v190, v190, v38
    v_add_f32 v191, v191, v39
    v_cvt_pk_bf16_f32 v180, v180, v181
    v_cvt_pk_bf16_f32 v181, v182, v183
    v_cvt_pk_bf16_f32 v182, v188, v189
    v_cvt_pk_bf16_f32 v183, v190, v191
    v_cndmask_b32 v182, 0, v182, vcc
    v_cndmask_b32 v183, 0, v183, vcc
    buffer_store_dwordx4 v[180:183], v31, s[32:35], s60 offen offset:1024
    v_mul_f32 v32, s61, v212
    v_mul_f32 v33, s61, v213
    v_mul_f32 v34, s61, v214
    v_mul_f32 v35, s61, v215
    v_mul_f32 v36, s61, v220
    v_mul_f32 v37, s61, v221
    v_mul_f32 v38, s61, v222
    v_mul_f32 v39, s61, v223
    v_exp_f32 v32, v32 clamp
    v_exp_f32 v33, v33 clamp
    v_exp_f32 v34, v34 clamp
    v_exp_f32 v35, v35 clamp
    v_exp_f32 v36, v36 clamp
    v_exp_f32 v37, v37 clamp
    v_exp_f32 v38, v38 clamp
    v_exp_f32 v39, v39 clamp
    v_max_f32 v212, 0, v212
    v_max_f32 v213, 0, v213
    v_max_f32 v214, 0, v214
    v_max_f32 v215, 0, v215
    v_max_f32 v220, 0, v220
    v_max_f32 v221, 0, v221
    v_max_f32 v222, 0, v222
    v_max_f32 v223, 0, v223
    v_add_f32 v32, s62, v32
    buffer_store_dwordx4 a[216:219], v1, s[32:35], s100 offen sc1
    v_add_f32 v33, s62, v33
    v_add_f32 v34, s62, v34
    v_add_f32 v35, s62, v35
    v_add_f32 v36, s62, v36
    v_add_f32 v37, s62, v37
    v_add_f32 v38, s62, v38
    v_add_f32 v39, s62, v39
    v_add_f32 v212, v212, v32
    v_add_f32 v213, v213, v33
    v_add_f32 v214, v214, v34
    v_add_f32 v215, v215, v35
    v_add_f32 v220, v220, v36
    v_add_f32 v221, v221, v37
    v_add_f32 v222, v222, v38
    v_add_f32 v223, v223, v39
    v_cvt_pk_bf16_f32 v212, v212, v213
    v_cvt_pk_bf16_f32 v213, v214, v215
    v_cvt_pk_bf16_f32 v214, v220, v221
    v_cvt_pk_bf16_f32 v215, v222, v223
    v_cndmask_b32 v214, 0, v214, vcc
    v_cndmask_b32 v215, 0, v215, vcc
    buffer_store_dwordx4 v[212:215], v31, s[32:35], s60 offen offset:2048
    v_mul_f32 v32, s61, v244
    v_mul_f32 v33, s61, v245
    v_mul_f32 v34, s61, v246
    v_mul_f32 v35, s61, v247
    v_mul_f32 v36, s61, v252
    v_mul_f32 v37, s61, v253
    v_mul_f32 v38, s61, v254
    v_mul_f32 v39, s61, v255
    v_exp_f32 v32, v32 clamp
    v_exp_f32 v33, v33 clamp
    v_exp_f32 v34, v34 clamp
    v_exp_f32 v35, v35 clamp
    v_exp_f32 v36, v36 clamp
    s_add_u32 s100, s100, s101
    v_exp_f32 v37, v37 clamp
    v_exp_f32 v38, v38 clamp
    v_exp_f32 v39, v39 clamp
    v_max_f32 v244, 0, v244
    v_max_f32 v245, 0, v245
    v_max_f32 v246, 0, v246
    v_max_f32 v247, 0, v247
    v_max_f32 v252, 0, v252
    v_max_f32 v253, 0, v253
    v_max_f32 v254, 0, v254
    v_max_f32 v255, 0, v255
    v_add_f32 v32, s62, v32
    v_add_f32 v33, s62, v33
    v_add_f32 v34, s62, v34
    v_add_f32 v35, s62, v35
    v_add_f32 v36, s62, v36
    v_add_f32 v37, s62, v37
    v_add_f32 v38, s62, v38
    v_add_f32 v39, s62, v39
    v_add_f32 v244, v244, v32
    v_add_f32 v245, v245, v33
    v_add_f32 v246, v246, v34
    v_add_f32 v247, v247, v35
    v_add_f32 v252, v252, v36
    v_add_f32 v253, v253, v37
    v_add_f32 v254, v254, v38
    v_add_f32 v255, v255, v39
    v_cvt_pk_bf16_f32 v244, v244, v245
    v_cvt_pk_bf16_f32 v245, v246, v247
    v_cvt_pk_bf16_f32 v246, v252, v253
    v_cvt_pk_bf16_f32 v247, v254, v255
    v_cndmask_b32 v246, 0, v246, vcc
    v_cndmask_b32 v247, 0, v247, vcc
    buffer_store_dwordx4 v[244:247], v31, s[32:35], s60 offen offset:3072
    s_endpgm
K1_T2_BKV:
    ds_read_b64_tr_b16 a[192:193], v0 offset:0
    ds_read_b64_tr_b16 a[194:195], v0 offset:4096
    ds_read_b64_tr_b16 a[196:197], v0 offset:32
    ds_read_b64_tr_b16 a[198:199], v0 offset:4128
    ds_read_b64_tr_b16 a[200:201], v0 offset:64
    ds_read_b64_tr_b16 a[202:203], v0 offset:4160
    ds_read_b64_tr_b16 a[204:205], v0 offset:96
    ds_read_b64_tr_b16 a[206:207], v0 offset:4192
    ds_read_b64_tr_b16 a[208:209], v0 offset:128
    ds_read_b64_tr_b16 a[210:211], v0 offset:4224
    ds_read_b64_tr_b16 a[212:213], v0 offset:160
    ds_read_b64_tr_b16 a[214:215], v0 offset:4256
    ds_read_b64_tr_b16 a[216:217], v0 offset:192
    ds_read_b64_tr_b16 a[218:219], v0 offset:4288
    v_cvt_pk_bf16_f32 v128, v128, v129
    v_cvt_pk_bf16_f32 v129, v130, v131
    v_cvt_pk_bf16_f32 v130, v132, v133
    v_cvt_pk_bf16_f32 v131, v134, v135
    v_cvt_pk_bf16_f32 v136, v136, v137
    v_cvt_pk_bf16_f32 v137, v138, v139
    v_cvt_pk_bf16_f32 v138, v140, v141
    v_cvt_pk_bf16_f32 v139, v142, v143
    v_cvt_pk_bf16_f32 v144, v144, v145
    v_cvt_pk_bf16_f32 v145, v146, v147
    v_cvt_pk_bf16_f32 v146, v148, v149
    v_cvt_pk_bf16_f32 v147, v150, v151
    v_cvt_pk_bf16_f32 v152, v152, v153
    v_cvt_pk_bf16_f32 v153, v154, v155
    v_cvt_pk_bf16_f32 v154, v156, v157
    v_cvt_pk_bf16_f32 v155, v158, v159
    v_cvt_pk_bf16_f32 v160, v160, v161
    v_cvt_pk_bf16_f32 v161, v162, v163
    v_cvt_pk_bf16_f32 v162, v164, v165
    v_cvt_pk_bf16_f32 v163, v166, v167
    v_cvt_pk_bf16_f32 v168, v168, v169
    v_cvt_pk_bf16_f32 v169, v170, v171
    v_cvt_pk_bf16_f32 v170, v172, v173
    v_cvt_pk_bf16_f32 v171, v174, v175
    v_cvt_pk_bf16_f32 v176, v176, v177
    v_cvt_pk_bf16_f32 v177, v178, v179
    v_cvt_pk_bf16_f32 v178, v180, v181
    v_cvt_pk_bf16_f32 v179, v182, v183
    v_cvt_pk_bf16_f32 v184, v184, v185
    v_cvt_pk_bf16_f32 v185, v186, v187
    v_cvt_pk_bf16_f32 v186, v188, v189
    v_cvt_pk_bf16_f32 v187, v190, v191
    v_cvt_pk_bf16_f32 v192, v192, v193
    v_cvt_pk_bf16_f32 v193, v194, v195
    v_cvt_pk_bf16_f32 v194, v196, v197
    v_cvt_pk_bf16_f32 v195, v198, v199
    v_cvt_pk_bf16_f32 v200, v200, v201
    v_cvt_pk_bf16_f32 v201, v202, v203
    v_cvt_pk_bf16_f32 v202, v204, v205
    v_cvt_pk_bf16_f32 v203, v206, v207
    v_cvt_pk_bf16_f32 v208, v208, v209
    v_cvt_pk_bf16_f32 v209, v210, v211
    v_cvt_pk_bf16_f32 v210, v212, v213
    v_cvt_pk_bf16_f32 v211, v214, v215
    v_cvt_pk_bf16_f32 v216, v216, v217
    v_cvt_pk_bf16_f32 v217, v218, v219
    v_cvt_pk_bf16_f32 v218, v220, v221
    v_cvt_pk_bf16_f32 v219, v222, v223
    v_cvt_pk_bf16_f32 v224, v224, v225
    v_cvt_pk_bf16_f32 v225, v226, v227
    v_cvt_pk_bf16_f32 v226, v228, v229
    v_cvt_pk_bf16_f32 v227, v230, v231
    v_cvt_pk_bf16_f32 v232, v232, v233
    v_cvt_pk_bf16_f32 v233, v234, v235
    v_cvt_pk_bf16_f32 v234, v236, v237
    v_cvt_pk_bf16_f32 v235, v238, v239
    v_cvt_pk_bf16_f32 v240, v240, v241
    v_cvt_pk_bf16_f32 v241, v242, v243
    v_cvt_pk_bf16_f32 v242, v244, v245
    v_cvt_pk_bf16_f32 v243, v246, v247
    v_cvt_pk_bf16_f32 v248, v248, v249
    v_cvt_pk_bf16_f32 v249, v250, v251
    v_cvt_pk_bf16_f32 v250, v252, v253
    v_cvt_pk_bf16_f32 v251, v254, v255
    s_waitcnt vmcnt(24)
    s_barrier
    v_mfma_f32_16x16x32_bf16 v[64:67], a[0:3], a[64:67], 0
    ds_read_b128 a[32:35], v24 offset:16384
    v_mfma_f32_16x16x32_bf16 v[64:67], a[4:7], a[68:71], v[64:67]
    s_add_u32 m0, s41, 0
    ds_read_b128 a[36:39], v25 offset:16384
    v_mfma_f32_16x16x32_bf16 v[80:83], a[4:7], a[76:79], 0
    buffer_load_dwordx4 v8, s[24:27], s36 offen offset:0  lds
    v_mfma_f32_16x16x32_bf16 v[80:83], a[0:3], a[72:75], v[80:83]
    ds_read_b128 a[40:43], v24 offset:18432
    v_mfma_f32_16x16x32_bf16 v[96:99], a[0:3], a[80:83], 0
    ds_read_b128 a[44:47], v25 offset:18432
    v_mfma_f32_16x16x32_bf16 v[96:99], a[4:7], a[84:87], v[96:99]
    buffer_load_dwordx4 v9, s[24:27], s36 offen offset:1024  lds
    v_mfma_f32_16x16x32_bf16 v[112:115], a[4:7], a[92:95], 0
    ds_read_b128 a[48:51], v24 offset:20480
    v_mfma_f32_16x16x32_bf16 v[112:115], a[0:3], a[88:91], v[112:115]
    ds_read_b128 a[52:55], v25 offset:20480
    v_mfma_f32_16x16x32_bf16 v[116:119], a[8:11], a[88:91], 0
    buffer_load_dwordx4 v10, s[24:27], s36 offen offset:2048  lds
    v_mfma_f32_16x16x32_bf16 v[116:119], a[12:15], a[92:95], v[116:119]
    ds_read_b128 a[56:59], v24 offset:22528
    v_mfma_f32_16x16x32_bf16 v[100:103], a[12:15], a[84:87], 0
    ds_read_b128 a[60:63], v25 offset:22528
    v_mfma_f32_16x16x32_bf16 v[100:103], a[8:11], a[80:83], v[100:103]
    buffer_load_dwordx4 v11, s[24:27], s36 offen offset:3072  lds
    v_mfma_f32_16x16x32_bf16 v[84:87], a[8:11], a[72:75], 0
    v_mfma_f32_16x16x32_bf16 v[84:87], a[12:15], a[76:79], v[84:87]
    v_mfma_f32_16x16x32_bf16 v[68:71], a[12:15], a[68:71], 0
    s_add_u32 s36, s36, 128
    v_mfma_f32_16x16x32_bf16 v[68:71], a[8:11], a[64:67], v[68:71]
    s_add_u32 m0, s41, 65536
    v_mfma_f32_16x16x32_bf16 v[72:75], a[16:19], a[64:67], 0
    buffer_load_dwordx4 v12, s[28:31], s38 offen offset:0  lds
    v_mfma_f32_16x16x32_bf16 v[72:75], a[20:23], a[68:71], v[72:75]
    v_mfma_f32_16x16x32_bf16 v[88:91], a[20:23], a[76:79], 0
    v_mfma_f32_16x16x32_bf16 v[88:91], a[16:19], a[72:75], v[88:91]
    buffer_load_dwordx4 v13, s[28:31], s38 offen offset:1024  lds
    v_mfma_f32_16x16x32_bf16 v[104:107], a[16:19], a[80:83], 0
    v_mfma_f32_16x16x32_bf16 v[104:107], a[20:23], a[84:87], v[104:107]
    v_mfma_f32_16x16x32_bf16 v[120:123], a[20:23], a[92:95], 0
    buffer_load_dwordx4 v14, s[28:31], s38 offen offset:2048  lds
    v_mfma_f32_16x16x32_bf16 v[120:123], a[16:19], a[88:91], v[120:123]
    v_mfma_f32_16x16x32_bf16 v[124:127], a[24:27], a[88:91], 0
    v_mfma_f32_16x16x32_bf16 v[124:127], a[28:31], a[92:95], v[124:127]
    buffer_load_dwordx4 v15, s[28:31], s38 offen offset:3072  lds
    v_mfma_f32_16x16x32_bf16 v[108:111], a[28:31], a[84:87], 0
    v_mfma_f32_16x16x32_bf16 v[108:111], a[24:27], a[80:83], v[108:111]
    v_mfma_f32_16x16x32_bf16 v[92:95], a[24:27], a[72:75], 0
    s_add_u32 s38, s38, s40
    v_mfma_f32_16x16x32_bf16 v[92:95], a[28:31], a[76:79], v[92:95]
    v_mfma_f32_16x16x32_bf16 v[76:79], a[28:31], a[68:71], 0
    v_mfma_f32_16x16x32_bf16 v[76:79], a[24:27], a[64:67], v[76:79]
    s_waitcnt vmcnt(24) lgkmcnt(0)
    s_barrier
    v_mfma_f32_16x16x32_bf16 v[132:135], a[32:35], a[64:67], 0
    ds_read_b64_tr_b16 a[96:97], v26 offset:32768
    ds_read_b64_tr_b16 a[98:99], v26 offset:33792
    v_mfma_f32_16x16x32_bf16 v[132:135], a[36:39], a[68:71], v[132:135]
    s_add_u32 m0, s41, 16384
    ds_read_b64_tr_b16 a[100:101], v26 offset:40960
    v_mfma_f32_16x16x32_bf16 v[164:167], a[36:39], a[76:79], 0
    buffer_load_dwordx4 v8, s[24:27], s37 offen offset:0  lds
    v_mfma_f32_16x16x32_bf16 v[164:167], a[32:35], a[72:75], v[164:167]
    ds_read_b64_tr_b16 a[102:103], v26 offset:41984
    ds_read_b64_tr_b16 a[104:105], v27 offset:32768
    v_mfma_f32_16x16x32_bf16 v[196:199], a[32:35], a[80:83], 0
    ds_read_b64_tr_b16 a[106:107], v27 offset:33792
    ds_read_b64_tr_b16 a[108:109], v27 offset:40960
    v_mfma_f32_16x16x32_bf16 v[196:199], a[36:39], a[84:87], v[196:199]
    buffer_load_dwordx4 v9, s[24:27], s37 offen offset:1024  lds
    v_mfma_f32_16x16x32_bf16 v[228:231], a[36:39], a[92:95], 0
    ds_read_b64_tr_b16 a[110:111], v27 offset:41984
    ds_read_b64_tr_b16 a[112:113], v28 offset:32768
    v_mfma_f32_16x16x32_bf16 v[228:231], a[32:35], a[88:91], v[228:231]
    ds_read_b64_tr_b16 a[114:115], v28 offset:33792
    ds_read_b64_tr_b16 a[116:117], v28 offset:40960
    v_mfma_f32_16x16x32_bf16 v[236:239], a[40:43], a[88:91], 0
    buffer_load_dwordx4 v10, s[24:27], s37 offen offset:2048  lds
    v_mfma_f32_16x16x32_bf16 v[236:239], a[44:47], a[92:95], v[236:239]
    ds_read_b64_tr_b16 a[118:119], v28 offset:41984
    ds_read_b64_tr_b16 a[120:121], v29 offset:32768
    v_mfma_f32_16x16x32_bf16 v[204:207], a[44:47], a[84:87], 0
    ds_read_b64_tr_b16 a[122:123], v29 offset:33792
    ds_read_b64_tr_b16 a[124:125], v29 offset:40960
    v_mfma_f32_16x16x32_bf16 v[204:207], a[40:43], a[80:83], v[204:207]
    buffer_load_dwordx4 v11, s[24:27], s37 offen offset:3072  lds
    v_mfma_f32_16x16x32_bf16 v[172:175], a[40:43], a[72:75], 0
    ds_read_b64_tr_b16 a[126:127], v29 offset:41984
    ds_read_b128 a[0:3], v24 offset:32768
    v_mfma_f32_16x16x32_bf16 v[172:175], a[44:47], a[76:79], v[172:175]
    ds_read_b128 a[4:7], v25 offset:32768
    v_mfma_f32_16x16x32_bf16 v[140:143], a[44:47], a[68:71], 0
    s_add_u32 s37, s37, 128
    ds_read_b128 a[8:11], v24 offset:34816
    v_mfma_f32_16x16x32_bf16 v[140:143], a[40:43], a[64:67], v[140:143]
    ds_read_b128 a[12:15], v25 offset:34816
    v_mfma_f32_16x16x32_bf16 v[148:151], a[48:51], a[64:67], 0
    ds_read_b128 a[16:19], v24 offset:36864
    v_mfma_f32_16x16x32_bf16 v[148:151], a[52:55], a[68:71], v[148:151]
    ds_read_b128 a[20:23], v25 offset:36864
    v_mfma_f32_16x16x32_bf16 v[180:183], a[52:55], a[76:79], 0
    ds_read_b128 a[24:27], v24 offset:38912
    v_mfma_f32_16x16x32_bf16 v[180:183], a[48:51], a[72:75], v[180:183]
    ds_read_b128 a[28:31], v25 offset:38912
    v_mfma_f32_16x16x32_bf16 v[212:215], a[48:51], a[80:83], 0
    v_mfma_f32_16x16x32_bf16 v[212:215], a[52:55], a[84:87], v[212:215]
    v_mfma_f32_16x16x32_bf16 v[244:247], a[52:55], a[92:95], 0
    v_mfma_f32_16x16x32_bf16 v[244:247], a[48:51], a[88:91], v[244:247]
    v_mfma_f32_16x16x32_bf16 v[252:255], a[56:59], a[88:91], 0
    v_mfma_f32_16x16x32_bf16 v[252:255], a[60:63], a[92:95], v[252:255]
    v_mfma_f32_16x16x32_bf16 v[220:223], a[60:63], a[84:87], 0
    v_mfma_f32_16x16x32_bf16 v[220:223], a[56:59], a[80:83], v[220:223]
    v_mfma_f32_16x16x32_bf16 v[188:191], a[56:59], a[72:75], 0
    v_mfma_f32_16x16x32_bf16 v[188:191], a[60:63], a[76:79], v[188:191]
    v_mfma_f32_16x16x32_bf16 v[156:159], a[60:63], a[68:71], 0
    v_mfma_f32_16x16x32_bf16 v[156:159], a[56:59], a[64:67], v[156:159]
    s_waitcnt vmcnt(12) lgkmcnt(0)
    s_barrier
    v_mfma_f32_16x16x32_bf16 v[64:67], a[0:3], a[96:99], v[64:67]
    ds_read_b128 a[32:35], v24 offset:49152
    v_mfma_f32_16x16x32_bf16 v[64:67], a[4:7], a[100:103], v[64:67]
    s_add_u32 m0, s41, 32768
    ds_read_b128 a[36:39], v25 offset:49152
    v_mfma_f32_16x16x32_bf16 v[80:83], a[4:7], a[108:111], v[80:83]
    buffer_load_dwordx4 v8, s[24:27], s36 offen offset:0  lds
    v_mfma_f32_16x16x32_bf16 v[80:83], a[0:3], a[104:107], v[80:83]
    ds_read_b128 a[40:43], v24 offset:51200
    v_mfma_f32_16x16x32_bf16 v[96:99], a[0:3], a[112:115], v[96:99]
    ds_read_b128 a[44:47], v25 offset:51200
    v_mfma_f32_16x16x32_bf16 v[96:99], a[4:7], a[116:119], v[96:99]
    buffer_load_dwordx4 v9, s[24:27], s36 offen offset:1024  lds
    v_mfma_f32_16x16x32_bf16 v[112:115], a[4:7], a[124:127], v[112:115]
    ds_read_b128 a[48:51], v24 offset:53248
    v_mfma_f32_16x16x32_bf16 v[112:115], a[0:3], a[120:123], v[112:115]
    ds_read_b128 a[52:55], v25 offset:53248
    v_mfma_f32_16x16x32_bf16 v[116:119], a[8:11], a[120:123], v[116:119]
    buffer_load_dwordx4 v10, s[24:27], s36 offen offset:2048  lds
    v_mfma_f32_16x16x32_bf16 v[116:119], a[12:15], a[124:127], v[116:119]
    ds_read_b128 a[56:59], v24 offset:55296
    v_mfma_f32_16x16x32_bf16 v[100:103], a[12:15], a[116:119], v[100:103]
    ds_read_b128 a[60:63], v25 offset:55296
    v_mfma_f32_16x16x32_bf16 v[100:103], a[8:11], a[112:115], v[100:103]
    buffer_load_dwordx4 v11, s[24:27], s36 offen offset:3072  lds
    v_mfma_f32_16x16x32_bf16 v[84:87], a[8:11], a[104:107], v[84:87]
    v_mfma_f32_16x16x32_bf16 v[84:87], a[12:15], a[108:111], v[84:87]
    v_mfma_f32_16x16x32_bf16 v[68:71], a[12:15], a[100:103], v[68:71]
    s_add_u32 s36, s36, 128
    v_mfma_f32_16x16x32_bf16 v[68:71], a[8:11], a[96:99], v[68:71]
    s_add_u32 m0, s41, 98304
    v_mfma_f32_16x16x32_bf16 v[72:75], a[16:19], a[96:99], v[72:75]
    buffer_load_dwordx4 v12, s[28:31], s38 offen offset:0  lds
    v_mfma_f32_16x16x32_bf16 v[72:75], a[20:23], a[100:103], v[72:75]
    v_mfma_f32_16x16x32_bf16 v[88:91], a[20:23], a[108:111], v[88:91]
    v_mfma_f32_16x16x32_bf16 v[88:91], a[16:19], a[104:107], v[88:91]
    buffer_load_dwordx4 v13, s[28:31], s38 offen offset:1024  lds
    v_mfma_f32_16x16x32_bf16 v[104:107], a[16:19], a[112:115], v[104:107]
    v_mfma_f32_16x16x32_bf16 v[104:107], a[20:23], a[116:119], v[104:107]
    v_mfma_f32_16x16x32_bf16 v[120:123], a[20:23], a[124:127], v[120:123]
    buffer_load_dwordx4 v14, s[28:31], s38 offen offset:2048  lds
    v_mfma_f32_16x16x32_bf16 v[120:123], a[16:19], a[120:123], v[120:123]
    v_mfma_f32_16x16x32_bf16 v[124:127], a[24:27], a[120:123], v[124:127]
    v_mfma_f32_16x16x32_bf16 v[124:127], a[28:31], a[124:127], v[124:127]
    buffer_load_dwordx4 v15, s[28:31], s38 offen offset:3072  lds
    v_mfma_f32_16x16x32_bf16 v[108:111], a[28:31], a[116:119], v[108:111]
    v_mfma_f32_16x16x32_bf16 v[108:111], a[24:27], a[112:115], v[108:111]
    v_mfma_f32_16x16x32_bf16 v[92:95], a[24:27], a[104:107], v[92:95]
    s_add_u32 s38, s38, s40
    v_mfma_f32_16x16x32_bf16 v[92:95], a[28:31], a[108:111], v[92:95]
    v_mfma_f32_16x16x32_bf16 v[76:79], a[28:31], a[100:103], v[76:79]
    v_mfma_f32_16x16x32_bf16 v[76:79], a[24:27], a[96:99], v[76:79]
    s_waitcnt vmcnt(12) lgkmcnt(0)
    s_barrier
    v_mfma_f32_16x16x32_bf16 v[132:135], a[32:35], a[96:99], v[132:135]
    ds_read_b64_tr_b16 a[64:65], v26 offset:0
    ds_read_b64_tr_b16 a[66:67], v26 offset:1024
    v_mfma_f32_16x16x32_bf16 v[132:135], a[36:39], a[100:103], v[132:135]
    s_add_u32 m0, s41, 49152
    ds_read_b64_tr_b16 a[68:69], v26 offset:8192
    v_mfma_f32_16x16x32_bf16 v[164:167], a[36:39], a[108:111], v[164:167]
    buffer_load_dwordx4 v8, s[24:27], s37 offen offset:0  lds
    v_mfma_f32_16x16x32_bf16 v[164:167], a[32:35], a[104:107], v[164:167]
    ds_read_b64_tr_b16 a[70:71], v26 offset:9216
    ds_read_b64_tr_b16 a[72:73], v27 offset:0
    v_mfma_f32_16x16x32_bf16 v[196:199], a[32:35], a[112:115], v[196:199]
    ds_read_b64_tr_b16 a[74:75], v27 offset:1024
    ds_read_b64_tr_b16 a[76:77], v27 offset:8192
    v_mfma_f32_16x16x32_bf16 v[196:199], a[36:39], a[116:119], v[196:199]
    buffer_load_dwordx4 v9, s[24:27], s37 offen offset:1024  lds
    v_mfma_f32_16x16x32_bf16 v[228:231], a[36:39], a[124:127], v[228:231]
    ds_read_b64_tr_b16 a[78:79], v27 offset:9216
    ds_read_b64_tr_b16 a[80:81], v28 offset:0
    v_mfma_f32_16x16x32_bf16 v[228:231], a[32:35], a[120:123], v[228:231]
    ds_read_b64_tr_b16 a[82:83], v28 offset:1024
    ds_read_b64_tr_b16 a[84:85], v28 offset:8192
    v_mfma_f32_16x16x32_bf16 v[236:239], a[40:43], a[120:123], v[236:239]
    buffer_load_dwordx4 v10, s[24:27], s37 offen offset:2048  lds
    v_mfma_f32_16x16x32_bf16 v[236:239], a[44:47], a[124:127], v[236:239]
    ds_read_b64_tr_b16 a[86:87], v28 offset:9216
    ds_read_b64_tr_b16 a[88:89], v29 offset:0
    v_mfma_f32_16x16x32_bf16 v[204:207], a[44:47], a[116:119], v[204:207]
    ds_read_b64_tr_b16 a[90:91], v29 offset:1024
    ds_read_b64_tr_b16 a[92:93], v29 offset:8192
    v_mfma_f32_16x16x32_bf16 v[204:207], a[40:43], a[112:115], v[204:207]
    buffer_load_dwordx4 v11, s[24:27], s37 offen offset:3072  lds
    v_mfma_f32_16x16x32_bf16 v[172:175], a[40:43], a[104:107], v[172:175]
    ds_read_b64_tr_b16 a[94:95], v29 offset:9216
    ds_read_b128 a[0:3], v24 offset:0
    v_mfma_f32_16x16x32_bf16 v[172:175], a[44:47], a[108:111], v[172:175]
    ds_read_b128 a[4:7], v25 offset:0
    v_mfma_f32_16x16x32_bf16 v[140:143], a[44:47], a[100:103], v[140:143]
    s_add_u32 s37, s37, 128
    ds_read_b128 a[8:11], v24 offset:2048
    v_mfma_f32_16x16x32_bf16 v[140:143], a[40:43], a[96:99], v[140:143]
    ds_read_b128 a[12:15], v25 offset:2048
    v_mfma_f32_16x16x32_bf16 v[148:151], a[48:51], a[96:99], v[148:151]
    ds_read_b128 a[16:19], v24 offset:4096
    v_mfma_f32_16x16x32_bf16 v[148:151], a[52:55], a[100:103], v[148:151]
    ds_read_b128 a[20:23], v25 offset:4096
    v_mfma_f32_16x16x32_bf16 v[180:183], a[52:55], a[108:111], v[180:183]
    ds_read_b128 a[24:27], v24 offset:6144
    v_mfma_f32_16x16x32_bf16 v[180:183], a[48:51], a[104:107], v[180:183]
    ds_read_b128 a[28:31], v25 offset:6144
    v_mfma_f32_16x16x32_bf16 v[212:215], a[48:51], a[112:115], v[212:215]
    v_mfma_f32_16x16x32_bf16 v[212:215], a[52:55], a[116:119], v[212:215]
    v_mfma_f32_16x16x32_bf16 v[244:247], a[52:55], a[124:127], v[244:247]
    v_mfma_f32_16x16x32_bf16 v[244:247], a[48:51], a[120:123], v[244:247]
    v_mfma_f32_16x16x32_bf16 v[252:255], a[56:59], a[120:123], v[252:255]
    v_mfma_f32_16x16x32_bf16 v[252:255], a[60:63], a[124:127], v[252:255]
    v_mfma_f32_16x16x32_bf16 v[220:223], a[60:63], a[116:119], v[220:223]
    v_mfma_f32_16x16x32_bf16 v[220:223], a[56:59], a[112:115], v[220:223]
    v_mfma_f32_16x16x32_bf16 v[188:191], a[56:59], a[104:107], v[188:191]
    v_mfma_f32_16x16x32_bf16 v[188:191], a[60:63], a[108:111], v[188:191]
    v_mfma_f32_16x16x32_bf16 v[156:159], a[60:63], a[100:103], v[156:159]
    v_mfma_f32_16x16x32_bf16 v[156:159], a[56:59], a[96:99], v[156:159]
    s_waitcnt vmcnt(12) lgkmcnt(0)
    s_barrier
    v_mfma_f32_16x16x32_bf16 v[64:67], a[0:3], a[64:67], v[64:67]
    ds_read_b128 a[32:35], v24 offset:16384
    v_mfma_f32_16x16x32_bf16 v[64:67], a[4:7], a[68:71], v[64:67]
    s_add_u32 m0, s41, 0
    ds_read_b128 a[36:39], v25 offset:16384
    v_mfma_f32_16x16x32_bf16 v[80:83], a[4:7], a[76:79], v[80:83]
    buffer_load_dwordx4 v8, s[24:27], s36 offen offset:0  lds
    v_mfma_f32_16x16x32_bf16 v[80:83], a[0:3], a[72:75], v[80:83]
    ds_read_b128 a[40:43], v24 offset:18432
    v_mfma_f32_16x16x32_bf16 v[96:99], a[0:3], a[80:83], v[96:99]
    ds_read_b128 a[44:47], v25 offset:18432
    v_mfma_f32_16x16x32_bf16 v[96:99], a[4:7], a[84:87], v[96:99]
    buffer_load_dwordx4 v9, s[24:27], s36 offen offset:1024  lds
    v_mfma_f32_16x16x32_bf16 v[112:115], a[4:7], a[92:95], v[112:115]
    ds_read_b128 a[48:51], v24 offset:20480
    v_mfma_f32_16x16x32_bf16 v[112:115], a[0:3], a[88:91], v[112:115]
    ds_read_b128 a[52:55], v25 offset:20480
    v_mfma_f32_16x16x32_bf16 v[116:119], a[8:11], a[88:91], v[116:119]
    buffer_load_dwordx4 v10, s[24:27], s36 offen offset:2048  lds
    v_mfma_f32_16x16x32_bf16 v[116:119], a[12:15], a[92:95], v[116:119]
    ds_read_b128 a[56:59], v24 offset:22528
    v_mfma_f32_16x16x32_bf16 v[100:103], a[12:15], a[84:87], v[100:103]
    ds_read_b128 a[60:63], v25 offset:22528
    v_mfma_f32_16x16x32_bf16 v[100:103], a[8:11], a[80:83], v[100:103]
    buffer_load_dwordx4 v11, s[24:27], s36 offen offset:3072  lds
    v_mfma_f32_16x16x32_bf16 v[84:87], a[8:11], a[72:75], v[84:87]
    v_mfma_f32_16x16x32_bf16 v[84:87], a[12:15], a[76:79], v[84:87]
    v_mfma_f32_16x16x32_bf16 v[68:71], a[12:15], a[68:71], v[68:71]
    s_add_u32 s36, s36, 128
    v_mfma_f32_16x16x32_bf16 v[68:71], a[8:11], a[64:67], v[68:71]
    s_add_u32 m0, s41, 65536
    v_mfma_f32_16x16x32_bf16 v[72:75], a[16:19], a[64:67], v[72:75]
    buffer_load_dwordx4 v12, s[28:31], s38 offen offset:0  lds
    v_mfma_f32_16x16x32_bf16 v[72:75], a[20:23], a[68:71], v[72:75]
    v_mfma_f32_16x16x32_bf16 v[88:91], a[20:23], a[76:79], v[88:91]
    v_mfma_f32_16x16x32_bf16 v[88:91], a[16:19], a[72:75], v[88:91]
    buffer_load_dwordx4 v13, s[28:31], s38 offen offset:1024  lds
    v_mfma_f32_16x16x32_bf16 v[104:107], a[16:19], a[80:83], v[104:107]
    v_mfma_f32_16x16x32_bf16 v[104:107], a[20:23], a[84:87], v[104:107]
    v_mfma_f32_16x16x32_bf16 v[120:123], a[20:23], a[92:95], v[120:123]
    buffer_load_dwordx4 v14, s[28:31], s38 offen offset:2048  lds
    v_mfma_f32_16x16x32_bf16 v[120:123], a[16:19], a[88:91], v[120:123]
    v_mfma_f32_16x16x32_bf16 v[124:127], a[24:27], a[88:91], v[124:127]
    v_mfma_f32_16x16x32_bf16 v[124:127], a[28:31], a[92:95], v[124:127]
    buffer_load_dwordx4 v15, s[28:31], s38 offen offset:3072  lds
    v_mfma_f32_16x16x32_bf16 v[108:111], a[28:31], a[84:87], v[108:111]
    v_mfma_f32_16x16x32_bf16 v[108:111], a[24:27], a[80:83], v[108:111]
    v_mfma_f32_16x16x32_bf16 v[92:95], a[24:27], a[72:75], v[92:95]
    s_add_u32 s38, s38, s40
    v_mfma_f32_16x16x32_bf16 v[92:95], a[28:31], a[76:79], v[92:95]
    v_mfma_f32_16x16x32_bf16 v[76:79], a[28:31], a[68:71], v[76:79]
    v_mfma_f32_16x16x32_bf16 v[76:79], a[24:27], a[64:67], v[76:79]
    s_waitcnt vmcnt(12) lgkmcnt(0)
    s_barrier
    v_mfma_f32_16x16x32_bf16 v[132:135], a[32:35], a[64:67], v[132:135]
    ds_read_b64_tr_b16 a[96:97], v26 offset:32768
    ds_read_b64_tr_b16 a[98:99], v26 offset:33792
    v_mfma_f32_16x16x32_bf16 v[132:135], a[36:39], a[68:71], v[132:135]
    s_add_u32 m0, s41, 16384
    ds_read_b64_tr_b16 a[100:101], v26 offset:40960
    v_mfma_f32_16x16x32_bf16 v[164:167], a[36:39], a[76:79], v[164:167]
    buffer_load_dwordx4 v8, s[24:27], s37 offen offset:0  lds
    v_mfma_f32_16x16x32_bf16 v[164:167], a[32:35], a[72:75], v[164:167]
    ds_read_b64_tr_b16 a[102:103], v26 offset:41984
    ds_read_b64_tr_b16 a[104:105], v27 offset:32768
    v_mfma_f32_16x16x32_bf16 v[196:199], a[32:35], a[80:83], v[196:199]
    ds_read_b64_tr_b16 a[106:107], v27 offset:33792
    ds_read_b64_tr_b16 a[108:109], v27 offset:40960
    v_mfma_f32_16x16x32_bf16 v[196:199], a[36:39], a[84:87], v[196:199]
    buffer_load_dwordx4 v9, s[24:27], s37 offen offset:1024  lds
    v_mfma_f32_16x16x32_bf16 v[228:231], a[36:39], a[92:95], v[228:231]
    ds_read_b64_tr_b16 a[110:111], v27 offset:41984
    ds_read_b64_tr_b16 a[112:113], v28 offset:32768
    v_mfma_f32_16x16x32_bf16 v[228:231], a[32:35], a[88:91], v[228:231]
    ds_read_b64_tr_b16 a[114:115], v28 offset:33792
    ds_read_b64_tr_b16 a[116:117], v28 offset:40960
    v_mfma_f32_16x16x32_bf16 v[236:239], a[40:43], a[88:91], v[236:239]
    buffer_load_dwordx4 v10, s[24:27], s37 offen offset:2048  lds
    v_mfma_f32_16x16x32_bf16 v[236:239], a[44:47], a[92:95], v[236:239]
    ds_read_b64_tr_b16 a[118:119], v28 offset:41984
    ds_read_b64_tr_b16 a[120:121], v29 offset:32768
    v_mfma_f32_16x16x32_bf16 v[204:207], a[44:47], a[84:87], v[204:207]
    ds_read_b64_tr_b16 a[122:123], v29 offset:33792
    ds_read_b64_tr_b16 a[124:125], v29 offset:40960
    v_mfma_f32_16x16x32_bf16 v[204:207], a[40:43], a[80:83], v[204:207]
    buffer_load_dwordx4 v11, s[24:27], s37 offen offset:3072  lds
    v_mfma_f32_16x16x32_bf16 v[172:175], a[40:43], a[72:75], v[172:175]
    ds_read_b64_tr_b16 a[126:127], v29 offset:41984
    ds_read_b128 a[0:3], v24 offset:32768
    v_mfma_f32_16x16x32_bf16 v[172:175], a[44:47], a[76:79], v[172:175]
    ds_read_b128 a[4:7], v25 offset:32768
    v_mfma_f32_16x16x32_bf16 v[140:143], a[44:47], a[68:71], v[140:143]
    s_add_u32 s37, s37, 128
    ds_read_b128 a[8:11], v24 offset:34816
    v_mfma_f32_16x16x32_bf16 v[140:143], a[40:43], a[64:67], v[140:143]
    ds_read_b128 a[12:15], v25 offset:34816
    v_mfma_f32_16x16x32_bf16 v[148:151], a[48:51], a[64:67], v[148:151]
    ds_read_b128 a[16:19], v24 offset:36864
    v_mfma_f32_16x16x32_bf16 v[148:151], a[52:55], a[68:71], v[148:151]
    ds_read_b128 a[20:23], v25 offset:36864
    v_mfma_f32_16x16x32_bf16 v[180:183], a[52:55], a[76:79], v[180:183]
    ds_read_b128 a[24:27], v24 offset:38912
    v_mfma_f32_16x16x32_bf16 v[180:183], a[48:51], a[72:75], v[180:183]
    ds_read_b128 a[28:31], v25 offset:38912
    v_mfma_f32_16x16x32_bf16 v[212:215], a[48:51], a[80:83], v[212:215]
    v_mfma_f32_16x16x32_bf16 v[212:215], a[52:55], a[84:87], v[212:215]
    v_mfma_f32_16x16x32_bf16 v[244:247], a[52:55], a[92:95], v[244:247]
    v_mfma_f32_16x16x32_bf16 v[244:247], a[48:51], a[88:91], v[244:247]
    v_mfma_f32_16x16x32_bf16 v[252:255], a[56:59], a[88:91], v[252:255]
    v_mfma_f32_16x16x32_bf16 v[252:255], a[60:63], a[92:95], v[252:255]
    v_mfma_f32_16x16x32_bf16 v[220:223], a[60:63], a[84:87], v[220:223]
    v_mfma_f32_16x16x32_bf16 v[220:223], a[56:59], a[80:83], v[220:223]
    v_mfma_f32_16x16x32_bf16 v[188:191], a[56:59], a[72:75], v[188:191]
    v_mfma_f32_16x16x32_bf16 v[188:191], a[60:63], a[76:79], v[188:191]
    v_mfma_f32_16x16x32_bf16 v[156:159], a[60:63], a[68:71], v[156:159]
    v_mfma_f32_16x16x32_bf16 v[156:159], a[56:59], a[64:67], v[156:159]
    s_waitcnt vmcnt(12) lgkmcnt(0)
    s_barrier
    v_mfma_f32_16x16x32_bf16 v[64:67], a[0:3], a[96:99], v[64:67]
    ds_read_b128 a[32:35], v24 offset:49152
    v_mfma_f32_16x16x32_bf16 v[64:67], a[4:7], a[100:103], v[64:67]
    s_add_u32 m0, s41, 32768
    ds_read_b128 a[36:39], v25 offset:49152
    v_mfma_f32_16x16x32_bf16 v[80:83], a[4:7], a[108:111], v[80:83]
    buffer_load_dwordx4 v8, s[24:27], s36 offen offset:0  lds
    v_mfma_f32_16x16x32_bf16 v[80:83], a[0:3], a[104:107], v[80:83]
    ds_read_b128 a[40:43], v24 offset:51200
    v_mfma_f32_16x16x32_bf16 v[96:99], a[0:3], a[112:115], v[96:99]
    ds_read_b128 a[44:47], v25 offset:51200
    v_mfma_f32_16x16x32_bf16 v[96:99], a[4:7], a[116:119], v[96:99]
    buffer_load_dwordx4 v9, s[24:27], s36 offen offset:1024  lds
    v_mfma_f32_16x16x32_bf16 v[112:115], a[4:7], a[124:127], v[112:115]
    ds_read_b128 a[48:51], v24 offset:53248
    v_mfma_f32_16x16x32_bf16 v[112:115], a[0:3], a[120:123], v[112:115]
    ds_read_b128 a[52:55], v25 offset:53248
    v_mfma_f32_16x16x32_bf16 v[116:119], a[8:11], a[120:123], v[116:119]
    buffer_load_dwordx4 v10, s[24:27], s36 offen offset:2048  lds
    v_mfma_f32_16x16x32_bf16 v[116:119], a[12:15], a[124:127], v[116:119]
    ds_read_b128 a[56:59], v24 offset:55296
    v_mfma_f32_16x16x32_bf16 v[100:103], a[12:15], a[116:119], v[100:103]
    ds_read_b128 a[60:63], v25 offset:55296
    v_mfma_f32_16x16x32_bf16 v[100:103], a[8:11], a[112:115], v[100:103]
    buffer_load_dwordx4 v11, s[24:27], s36 offen offset:3072  lds
    v_mfma_f32_16x16x32_bf16 v[84:87], a[8:11], a[104:107], v[84:87]
    v_mfma_f32_16x16x32_bf16 v[84:87], a[12:15], a[108:111], v[84:87]
    v_mfma_f32_16x16x32_bf16 v[68:71], a[12:15], a[100:103], v[68:71]
    s_add_u32 s36, s36, 128
    v_mfma_f32_16x16x32_bf16 v[68:71], a[8:11], a[96:99], v[68:71]
    s_add_u32 m0, s41, 98304
    v_mfma_f32_16x16x32_bf16 v[72:75], a[16:19], a[96:99], v[72:75]
    buffer_load_dwordx4 v12, s[28:31], s38 offen offset:0  lds
    v_mfma_f32_16x16x32_bf16 v[72:75], a[20:23], a[100:103], v[72:75]
    v_mfma_f32_16x16x32_bf16 v[88:91], a[20:23], a[108:111], v[88:91]
    v_mfma_f32_16x16x32_bf16 v[88:91], a[16:19], a[104:107], v[88:91]
    buffer_load_dwordx4 v13, s[28:31], s38 offen offset:1024  lds
    v_mfma_f32_16x16x32_bf16 v[104:107], a[16:19], a[112:115], v[104:107]
    v_mfma_f32_16x16x32_bf16 v[104:107], a[20:23], a[116:119], v[104:107]
    v_mfma_f32_16x16x32_bf16 v[120:123], a[20:23], a[124:127], v[120:123]
    buffer_load_dwordx4 v14, s[28:31], s38 offen offset:2048  lds
    v_mfma_f32_16x16x32_bf16 v[120:123], a[16:19], a[120:123], v[120:123]
    v_mfma_f32_16x16x32_bf16 v[124:127], a[24:27], a[120:123], v[124:127]
    v_mfma_f32_16x16x32_bf16 v[124:127], a[28:31], a[124:127], v[124:127]
    buffer_load_dwordx4 v15, s[28:31], s38 offen offset:3072  lds
    v_mfma_f32_16x16x32_bf16 v[108:111], a[28:31], a[116:119], v[108:111]
    v_mfma_f32_16x16x32_bf16 v[108:111], a[24:27], a[112:115], v[108:111]
    v_mfma_f32_16x16x32_bf16 v[92:95], a[24:27], a[104:107], v[92:95]
    s_add_u32 s38, s38, s40
    v_mfma_f32_16x16x32_bf16 v[92:95], a[28:31], a[108:111], v[92:95]
    v_mfma_f32_16x16x32_bf16 v[76:79], a[28:31], a[100:103], v[76:79]
    v_mfma_f32_16x16x32_bf16 v[76:79], a[24:27], a[96:99], v[76:79]
    s_waitcnt vmcnt(12) lgkmcnt(0)
    s_barrier
    v_mfma_f32_16x16x32_bf16 v[132:135], a[32:35], a[96:99], v[132:135]
    ds_read_b64_tr_b16 a[64:65], v26 offset:0
    ds_read_b64_tr_b16 a[66:67], v26 offset:1024
    v_mfma_f32_16x16x32_bf16 v[132:135], a[36:39], a[100:103], v[132:135]
    s_add_u32 m0, s41, 49152
    ds_read_b64_tr_b16 a[68:69], v26 offset:8192
    v_mfma_f32_16x16x32_bf16 v[164:167], a[36:39], a[108:111], v[164:167]
    buffer_load_dwordx4 v8, s[24:27], s37 offen offset:0  lds
    v_mfma_f32_16x16x32_bf16 v[164:167], a[32:35], a[104:107], v[164:167]
    ds_read_b64_tr_b16 a[70:71], v26 offset:9216
    ds_read_b64_tr_b16 a[72:73], v27 offset:0
    v_mfma_f32_16x16x32_bf16 v[196:199], a[32:35], a[112:115], v[196:199]
    ds_read_b64_tr_b16 a[74:75], v27 offset:1024
    ds_read_b64_tr_b16 a[76:77], v27 offset:8192
    v_mfma_f32_16x16x32_bf16 v[196:199], a[36:39], a[116:119], v[196:199]
    buffer_load_dwordx4 v9, s[24:27], s37 offen offset:1024  lds
    v_mfma_f32_16x16x32_bf16 v[228:231], a[36:39], a[124:127], v[228:231]
    ds_read_b64_tr_b16 a[78:79], v27 offset:9216
    ds_read_b64_tr_b16 a[80:81], v28 offset:0
    v_mfma_f32_16x16x32_bf16 v[228:231], a[32:35], a[120:123], v[228:231]
    ds_read_b64_tr_b16 a[82:83], v28 offset:1024
    ds_read_b64_tr_b16 a[84:85], v28 offset:8192
    v_mfma_f32_16x16x32_bf16 v[236:239], a[40:43], a[120:123], v[236:239]
    buffer_load_dwordx4 v10, s[24:27], s37 offen offset:2048  lds
    v_mfma_f32_16x16x32_bf16 v[236:239], a[44:47], a[124:127], v[236:239]
    ds_read_b64_tr_b16 a[86:87], v28 offset:9216
    ds_read_b64_tr_b16 a[88:89], v29 offset:0
    v_mfma_f32_16x16x32_bf16 v[204:207], a[44:47], a[116:119], v[204:207]
    ds_read_b64_tr_b16 a[90:91], v29 offset:1024
    ds_read_b64_tr_b16 a[92:93], v29 offset:8192
    v_mfma_f32_16x16x32_bf16 v[204:207], a[40:43], a[112:115], v[204:207]
    buffer_load_dwordx4 v11, s[24:27], s37 offen offset:3072  lds
    v_mfma_f32_16x16x32_bf16 v[172:175], a[40:43], a[104:107], v[172:175]
    ds_read_b64_tr_b16 a[94:95], v29 offset:9216
    ds_read_b128 a[0:3], v24 offset:0
    v_mfma_f32_16x16x32_bf16 v[172:175], a[44:47], a[108:111], v[172:175]
    ds_read_b128 a[4:7], v25 offset:0
    v_mfma_f32_16x16x32_bf16 v[140:143], a[44:47], a[100:103], v[140:143]
    s_add_u32 s37, s37, 128
    ds_read_b128 a[8:11], v24 offset:2048
    v_mfma_f32_16x16x32_bf16 v[140:143], a[40:43], a[96:99], v[140:143]
    ds_read_b128 a[12:15], v25 offset:2048
    v_mfma_f32_16x16x32_bf16 v[148:151], a[48:51], a[96:99], v[148:151]
    ds_read_b128 a[16:19], v24 offset:4096
    v_mfma_f32_16x16x32_bf16 v[148:151], a[52:55], a[100:103], v[148:151]
    ds_read_b128 a[20:23], v25 offset:4096
    v_mfma_f32_16x16x32_bf16 v[180:183], a[52:55], a[108:111], v[180:183]
    ds_read_b128 a[24:27], v24 offset:6144
    v_mfma_f32_16x16x32_bf16 v[180:183], a[48:51], a[104:107], v[180:183]
    ds_read_b128 a[28:31], v25 offset:6144
    v_mfma_f32_16x16x32_bf16 v[212:215], a[48:51], a[112:115], v[212:215]
    v_mfma_f32_16x16x32_bf16 v[212:215], a[52:55], a[116:119], v[212:215]
    v_mfma_f32_16x16x32_bf16 v[244:247], a[52:55], a[124:127], v[244:247]
    v_mfma_f32_16x16x32_bf16 v[244:247], a[48:51], a[120:123], v[244:247]
    v_mfma_f32_16x16x32_bf16 v[252:255], a[56:59], a[120:123], v[252:255]
    v_mfma_f32_16x16x32_bf16 v[252:255], a[60:63], a[124:127], v[252:255]
    v_mfma_f32_16x16x32_bf16 v[220:223], a[60:63], a[116:119], v[220:223]
    v_mfma_f32_16x16x32_bf16 v[220:223], a[56:59], a[112:115], v[220:223]
    v_mfma_f32_16x16x32_bf16 v[188:191], a[56:59], a[104:107], v[188:191]
    v_mfma_f32_16x16x32_bf16 v[188:191], a[60:63], a[108:111], v[188:191]
    v_mfma_f32_16x16x32_bf16 v[156:159], a[60:63], a[100:103], v[156:159]
    v_mfma_f32_16x16x32_bf16 v[156:159], a[56:59], a[96:99], v[156:159]
    s_waitcnt vmcnt(12) lgkmcnt(0)
    s_barrier
    v_mfma_f32_16x16x32_bf16 v[64:67], a[0:3], a[64:67], v[64:67]
    ds_read_b128 a[32:35], v24 offset:16384
    v_mfma_f32_16x16x32_bf16 v[64:67], a[4:7], a[68:71], v[64:67]
    s_add_u32 m0, s41, 0
    ds_read_b128 a[36:39], v25 offset:16384
    v_mfma_f32_16x16x32_bf16 v[80:83], a[4:7], a[76:79], v[80:83]
    buffer_load_dwordx4 v8, s[24:27], s36 offen offset:0  lds
    v_mfma_f32_16x16x32_bf16 v[80:83], a[0:3], a[72:75], v[80:83]
    ds_read_b128 a[40:43], v24 offset:18432
    v_mfma_f32_16x16x32_bf16 v[96:99], a[0:3], a[80:83], v[96:99]
    ds_read_b128 a[44:47], v25 offset:18432
    v_mfma_f32_16x16x32_bf16 v[96:99], a[4:7], a[84:87], v[96:99]
    buffer_load_dwordx4 v9, s[24:27], s36 offen offset:1024  lds
    v_mfma_f32_16x16x32_bf16 v[112:115], a[4:7], a[92:95], v[112:115]
    ds_read_b128 a[48:51], v24 offset:20480
    v_mfma_f32_16x16x32_bf16 v[112:115], a[0:3], a[88:91], v[112:115]
    ds_read_b128 a[52:55], v25 offset:20480
    v_mfma_f32_16x16x32_bf16 v[116:119], a[8:11], a[88:91], v[116:119]
    buffer_load_dwordx4 v10, s[24:27], s36 offen offset:2048  lds
    v_mfma_f32_16x16x32_bf16 v[116:119], a[12:15], a[92:95], v[116:119]
    ds_read_b128 a[56:59], v24 offset:22528
    v_mfma_f32_16x16x32_bf16 v[100:103], a[12:15], a[84:87], v[100:103]
    ds_read_b128 a[60:63], v25 offset:22528
    v_mfma_f32_16x16x32_bf16 v[100:103], a[8:11], a[80:83], v[100:103]
    buffer_load_dwordx4 v11, s[24:27], s36 offen offset:3072  lds
    v_mfma_f32_16x16x32_bf16 v[84:87], a[8:11], a[72:75], v[84:87]
    v_mfma_f32_16x16x32_bf16 v[84:87], a[12:15], a[76:79], v[84:87]
    v_mfma_f32_16x16x32_bf16 v[68:71], a[12:15], a[68:71], v[68:71]
    s_add_u32 s36, s36, 128
    v_mfma_f32_16x16x32_bf16 v[68:71], a[8:11], a[64:67], v[68:71]
    s_add_u32 m0, s41, 65536
    v_mfma_f32_16x16x32_bf16 v[72:75], a[16:19], a[64:67], v[72:75]
    buffer_load_dwordx4 v12, s[28:31], s38 offen offset:0  lds
    v_mfma_f32_16x16x32_bf16 v[72:75], a[20:23], a[68:71], v[72:75]
    v_mfma_f32_16x16x32_bf16 v[88:91], a[20:23], a[76:79], v[88:91]
    v_mfma_f32_16x16x32_bf16 v[88:91], a[16:19], a[72:75], v[88:91]
    buffer_load_dwordx4 v13, s[28:31], s38 offen offset:1024  lds
    v_mfma_f32_16x16x32_bf16 v[104:107], a[16:19], a[80:83], v[104:107]
    v_mfma_f32_16x16x32_bf16 v[104:107], a[20:23], a[84:87], v[104:107]
    v_mfma_f32_16x16x32_bf16 v[120:123], a[20:23], a[92:95], v[120:123]
    buffer_load_dwordx4 v14, s[28:31], s38 offen offset:2048  lds
    v_mfma_f32_16x16x32_bf16 v[120:123], a[16:19], a[88:91], v[120:123]
    v_mfma_f32_16x16x32_bf16 v[124:127], a[24:27], a[88:91], v[124:127]
    v_mfma_f32_16x16x32_bf16 v[124:127], a[28:31], a[92:95], v[124:127]
    buffer_load_dwordx4 v15, s[28:31], s38 offen offset:3072  lds
    v_mfma_f32_16x16x32_bf16 v[108:111], a[28:31], a[84:87], v[108:111]
    v_mfma_f32_16x16x32_bf16 v[108:111], a[24:27], a[80:83], v[108:111]
    v_mfma_f32_16x16x32_bf16 v[92:95], a[24:27], a[72:75], v[92:95]
    s_add_u32 s38, s38, s40
    v_mfma_f32_16x16x32_bf16 v[92:95], a[28:31], a[76:79], v[92:95]
    v_mfma_f32_16x16x32_bf16 v[76:79], a[28:31], a[68:71], v[76:79]
    v_mfma_f32_16x16x32_bf16 v[76:79], a[24:27], a[64:67], v[76:79]
    s_waitcnt vmcnt(12) lgkmcnt(0)
    s_barrier
    v_mfma_f32_16x16x32_bf16 v[132:135], a[32:35], a[64:67], v[132:135]
    ds_read_b64_tr_b16 a[96:97], v26 offset:32768
    ds_read_b64_tr_b16 a[98:99], v26 offset:33792
    v_mfma_f32_16x16x32_bf16 v[132:135], a[36:39], a[68:71], v[132:135]
    s_add_u32 m0, s41, 16384
    ds_read_b64_tr_b16 a[100:101], v26 offset:40960
    v_mfma_f32_16x16x32_bf16 v[164:167], a[36:39], a[76:79], v[164:167]
    buffer_load_dwordx4 v8, s[24:27], s37 offen offset:0  lds
    v_mfma_f32_16x16x32_bf16 v[164:167], a[32:35], a[72:75], v[164:167]
    ds_read_b64_tr_b16 a[102:103], v26 offset:41984
    ds_read_b64_tr_b16 a[104:105], v27 offset:32768
    v_mfma_f32_16x16x32_bf16 v[196:199], a[32:35], a[80:83], v[196:199]
    ds_read_b64_tr_b16 a[106:107], v27 offset:33792
    ds_read_b64_tr_b16 a[108:109], v27 offset:40960
    v_mfma_f32_16x16x32_bf16 v[196:199], a[36:39], a[84:87], v[196:199]
    buffer_load_dwordx4 v9, s[24:27], s37 offen offset:1024  lds
    v_mfma_f32_16x16x32_bf16 v[228:231], a[36:39], a[92:95], v[228:231]
    ds_read_b64_tr_b16 a[110:111], v27 offset:41984
    ds_read_b64_tr_b16 a[112:113], v28 offset:32768
    v_mfma_f32_16x16x32_bf16 v[228:231], a[32:35], a[88:91], v[228:231]
    ds_read_b64_tr_b16 a[114:115], v28 offset:33792
    ds_read_b64_tr_b16 a[116:117], v28 offset:40960
    v_mfma_f32_16x16x32_bf16 v[236:239], a[40:43], a[88:91], v[236:239]
    buffer_load_dwordx4 v10, s[24:27], s37 offen offset:2048  lds
    v_mfma_f32_16x16x32_bf16 v[236:239], a[44:47], a[92:95], v[236:239]
    ds_read_b64_tr_b16 a[118:119], v28 offset:41984
    ds_read_b64_tr_b16 a[120:121], v29 offset:32768
    v_mfma_f32_16x16x32_bf16 v[204:207], a[44:47], a[84:87], v[204:207]
    ds_read_b64_tr_b16 a[122:123], v29 offset:33792
    ds_read_b64_tr_b16 a[124:125], v29 offset:40960
    v_mfma_f32_16x16x32_bf16 v[204:207], a[40:43], a[80:83], v[204:207]
    buffer_load_dwordx4 v11, s[24:27], s37 offen offset:3072  lds
    v_mfma_f32_16x16x32_bf16 v[172:175], a[40:43], a[72:75], v[172:175]
    ds_read_b64_tr_b16 a[126:127], v29 offset:41984
    ds_read_b128 a[0:3], v24 offset:32768
    v_mfma_f32_16x16x32_bf16 v[172:175], a[44:47], a[76:79], v[172:175]
    ds_read_b128 a[4:7], v25 offset:32768
    v_mfma_f32_16x16x32_bf16 v[140:143], a[44:47], a[68:71], v[140:143]
    s_add_u32 s37, s37, 128
    ds_read_b128 a[8:11], v24 offset:34816
    v_mfma_f32_16x16x32_bf16 v[140:143], a[40:43], a[64:67], v[140:143]
    ds_read_b128 a[12:15], v25 offset:34816
    v_mfma_f32_16x16x32_bf16 v[148:151], a[48:51], a[64:67], v[148:151]
    ds_read_b128 a[16:19], v24 offset:36864
    v_mfma_f32_16x16x32_bf16 v[148:151], a[52:55], a[68:71], v[148:151]
    ds_read_b128 a[20:23], v25 offset:36864
    v_mfma_f32_16x16x32_bf16 v[180:183], a[52:55], a[76:79], v[180:183]
    s_add_u32 s64, s56, s48
    ds_read_b128 a[24:27], v24 offset:38912
    v_mfma_f32_16x16x32_bf16 v[180:183], a[48:51], a[72:75], v[180:183]
    ds_read_b128 a[28:31], v25 offset:38912
    v_mfma_f32_16x16x32_bf16 v[212:215], a[48:51], a[80:83], v[212:215]
    buffer_store_dwordx4 v[32:35], v30, s[32:35], s64 offen sc1
    v_mfma_f32_16x16x32_bf16 v[212:215], a[52:55], a[84:87], v[212:215]
    v_mfma_f32_16x16x32_bf16 v[244:247], a[52:55], a[92:95], v[244:247]
    v_mfma_f32_16x16x32_bf16 v[244:247], a[48:51], a[88:91], v[244:247]
    v_mfma_f32_16x16x32_bf16 v[252:255], a[56:59], a[88:91], v[252:255]
    v_mfma_f32_16x16x32_bf16 v[252:255], a[60:63], a[92:95], v[252:255]
    s_add_u32 s65, s56, s49
    v_mfma_f32_16x16x32_bf16 v[220:223], a[60:63], a[84:87], v[220:223]
    buffer_store_dwordx4 v[36:39], v30, s[32:35], s65 offen sc1
    v_mfma_f32_16x16x32_bf16 v[220:223], a[56:59], a[80:83], v[220:223]
    v_mfma_f32_16x16x32_bf16 v[188:191], a[56:59], a[72:75], v[188:191]
    v_mfma_f32_16x16x32_bf16 v[188:191], a[60:63], a[76:79], v[188:191]
    v_mfma_f32_16x16x32_bf16 v[156:159], a[60:63], a[68:71], v[156:159]
    v_mfma_f32_16x16x32_bf16 v[156:159], a[56:59], a[64:67], v[156:159]
    s_waitcnt vmcnt(14) lgkmcnt(0)
    s_barrier
    v_mfma_f32_16x16x32_bf16 v[64:67], a[0:3], a[96:99], v[64:67]
    s_add_u32 s66, s56, s50
    ds_read_b128 a[32:35], v24 offset:49152
    v_mfma_f32_16x16x32_bf16 v[64:67], a[4:7], a[100:103], v[64:67]
    ds_read_b128 a[36:39], v25 offset:49152
    v_mfma_f32_16x16x32_bf16 v[80:83], a[4:7], a[108:111], v[80:83]
    ds_read_b128 a[40:43], v24 offset:51200
    v_mfma_f32_16x16x32_bf16 v[80:83], a[0:3], a[104:107], v[80:83]
    ds_read_b128 a[44:47], v25 offset:51200
    v_mfma_f32_16x16x32_bf16 v[96:99], a[0:3], a[112:115], v[96:99]
    ds_read_b128 a[48:51], v24 offset:53248
    v_mfma_f32_16x16x32_bf16 v[96:99], a[4:7], a[116:119], v[96:99]
    ds_read_b128 a[52:55], v25 offset:53248
    v_mfma_f32_16x16x32_bf16 v[112:115], a[4:7], a[124:127], v[112:115]
    ds_read_b128 a[56:59], v24 offset:55296
    v_mfma_f32_16x16x32_bf16 v[112:115], a[0:3], a[120:123], v[112:115]
    s_add_u32 s67, s56, s51
    ds_read_b128 a[60:63], v25 offset:55296
    v_mfma_f32_16x16x32_bf16 v[116:119], a[8:11], a[120:123], v[116:119]
    buffer_store_dwordx4 v[40:43], v30, s[32:35], s66 offen sc1
    v_mfma_f32_16x16x32_bf16 v[116:119], a[12:15], a[124:127], v[116:119]
    buffer_store_dwordx4 v[44:47], v30, s[32:35], s67 offen sc1
    v_mfma_f32_16x16x32_bf16 v[100:103], a[12:15], a[116:119], v[100:103]
    v_mfma_f32_16x16x32_bf16 v[100:103], a[8:11], a[112:115], v[100:103]
    v_mfma_f32_16x16x32_bf16 v[84:87], a[8:11], a[104:107], v[84:87]
    v_mfma_f32_16x16x32_bf16 v[84:87], a[12:15], a[108:111], v[84:87]
    v_mfma_f32_16x16x32_bf16 v[68:71], a[12:15], a[100:103], v[68:71]
    s_add_u32 s64, s56, s52
    v_mfma_f32_16x16x32_bf16 v[68:71], a[8:11], a[96:99], v[68:71]
    buffer_store_dwordx4 v[48:51], v30, s[32:35], s64 offen sc1
    v_mfma_f32_16x16x32_bf16 v[72:75], a[16:19], a[96:99], v[72:75]
    v_mfma_f32_16x16x32_bf16 v[72:75], a[20:23], a[100:103], v[72:75]
    v_mfma_f32_16x16x32_bf16 v[88:91], a[20:23], a[108:111], v[88:91]
    v_mfma_f32_16x16x32_bf16 v[88:91], a[16:19], a[104:107], v[88:91]
    v_mfma_f32_16x16x32_bf16 v[104:107], a[16:19], a[112:115], v[104:107]
    v_mfma_f32_16x16x32_bf16 v[104:107], a[20:23], a[116:119], v[104:107]
    s_add_u32 s65, s56, s53
    v_mfma_f32_16x16x32_bf16 v[120:123], a[20:23], a[124:127], v[120:123]
    buffer_store_dwordx4 v[52:55], v30, s[32:35], s65 offen sc1
    v_mfma_f32_16x16x32_bf16 v[120:123], a[16:19], a[120:123], v[120:123]
    v_mfma_f32_16x16x32_bf16 v[124:127], a[24:27], a[120:123], v[124:127]
    v_mfma_f32_16x16x32_bf16 v[124:127], a[28:31], a[124:127], v[124:127]
    v_mfma_f32_16x16x32_bf16 v[108:111], a[28:31], a[116:119], v[108:111]
    v_mfma_f32_16x16x32_bf16 v[108:111], a[24:27], a[112:115], v[108:111]
    v_mfma_f32_16x16x32_bf16 v[92:95], a[24:27], a[104:107], v[92:95]
    s_add_u32 s66, s56, s54
    v_mfma_f32_16x16x32_bf16 v[92:95], a[28:31], a[108:111], v[92:95]
    buffer_store_dwordx4 v[56:59], v30, s[32:35], s66 offen sc1
    v_mfma_f32_16x16x32_bf16 v[76:79], a[28:31], a[100:103], v[76:79]
    v_mfma_f32_16x16x32_bf16 v[76:79], a[24:27], a[96:99], v[76:79]
    s_waitcnt vmcnt(11) lgkmcnt(0)
    s_barrier
    v_mfma_f32_16x16x32_bf16 v[132:135], a[32:35], a[96:99], v[132:135]
    ds_read_b64_tr_b16 a[64:65], v26 offset:0
    ds_read_b64_tr_b16 a[66:67], v26 offset:1024
    v_mfma_f32_16x16x32_bf16 v[132:135], a[36:39], a[100:103], v[132:135]
    ds_read_b64_tr_b16 a[68:69], v26 offset:8192
    ds_read_b64_tr_b16 a[70:71], v26 offset:9216
    v_mfma_f32_16x16x32_bf16 v[164:167], a[36:39], a[108:111], v[164:167]
    ds_read_b64_tr_b16 a[72:73], v27 offset:0
    ds_read_b64_tr_b16 a[74:75], v27 offset:1024
    v_mfma_f32_16x16x32_bf16 v[164:167], a[32:35], a[104:107], v[164:167]
    s_add_u32 s67, s56, s55
    ds_read_b64_tr_b16 a[76:77], v27 offset:8192
    ds_read_b64_tr_b16 a[78:79], v27 offset:9216
    v_mfma_f32_16x16x32_bf16 v[196:199], a[32:35], a[112:115], v[196:199]
    ds_read_b64_tr_b16 a[80:81], v28 offset:0
    ds_read_b64_tr_b16 a[82:83], v28 offset:1024
    v_mfma_f32_16x16x32_bf16 v[196:199], a[36:39], a[116:119], v[196:199]
    ds_read_b64_tr_b16 a[84:85], v28 offset:8192
    ds_read_b64_tr_b16 a[86:87], v28 offset:9216
    v_mfma_f32_16x16x32_bf16 v[228:231], a[36:39], a[124:127], v[228:231]
    ds_read_b64_tr_b16 a[88:89], v29 offset:0
    ds_read_b64_tr_b16 a[90:91], v29 offset:1024
    v_mfma_f32_16x16x32_bf16 v[228:231], a[32:35], a[120:123], v[228:231]
    ds_read_b64_tr_b16 a[92:93], v29 offset:8192
    ds_read_b64_tr_b16 a[94:95], v29 offset:9216
    v_mfma_f32_16x16x32_bf16 v[236:239], a[40:43], a[120:123], v[236:239]
    ds_read_b128 a[0:3], v24 offset:0
    v_mfma_f32_16x16x32_bf16 v[236:239], a[44:47], a[124:127], v[236:239]
    ds_read_b128 a[4:7], v25 offset:0
    v_mfma_f32_16x16x32_bf16 v[204:207], a[44:47], a[116:119], v[204:207]
    s_add_u32 s64, s58, s48
    ds_read_b128 a[8:11], v24 offset:2048
    v_mfma_f32_16x16x32_bf16 v[204:207], a[40:43], a[112:115], v[204:207]
    ds_read_b128 a[12:15], v25 offset:2048
    v_mfma_f32_16x16x32_bf16 v[172:175], a[40:43], a[104:107], v[172:175]
    ds_read_b128 a[16:19], v24 offset:4096
    v_mfma_f32_16x16x32_bf16 v[172:175], a[44:47], a[108:111], v[172:175]
    ds_read_b128 a[20:23], v25 offset:4096
    v_mfma_f32_16x16x32_bf16 v[140:143], a[44:47], a[100:103], v[140:143]
    ds_read_b128 a[24:27], v24 offset:6144
    v_mfma_f32_16x16x32_bf16 v[140:143], a[40:43], a[96:99], v[140:143]
    ds_read_b128 a[28:31], v25 offset:6144
    v_mfma_f32_16x16x32_bf16 v[148:151], a[48:51], a[96:99], v[148:151]
    buffer_store_dwordx4 v[60:63], v30, s[32:35], s67 offen sc1
    v_mfma_f32_16x16x32_bf16 v[148:151], a[52:55], a[100:103], v[148:151]
    buffer_store_dwordx4 v[128:131], v30, s[32:35], s64 offen sc1
    v_mfma_f32_16x16x32_bf16 v[180:183], a[52:55], a[108:111], v[180:183]
    s_add_u32 s65, s58, s49
    v_mfma_f32_16x16x32_bf16 v[180:183], a[48:51], a[104:107], v[180:183]
    buffer_store_dwordx4 v[136:139], v30, s[32:35], s65 offen sc1
    v_mfma_f32_16x16x32_bf16 v[212:215], a[48:51], a[112:115], v[212:215]
    v_mfma_f32_16x16x32_bf16 v[212:215], a[52:55], a[116:119], v[212:215]
    v_mfma_f32_16x16x32_bf16 v[244:247], a[52:55], a[124:127], v[244:247]
    v_mfma_f32_16x16x32_bf16 v[244:247], a[48:51], a[120:123], v[244:247]
    v_mfma_f32_16x16x32_bf16 v[252:255], a[56:59], a[120:123], v[252:255]
    s_add_u32 s66, s58, s50
    v_mfma_f32_16x16x32_bf16 v[252:255], a[60:63], a[124:127], v[252:255]
    buffer_store_dwordx4 v[144:147], v30, s[32:35], s66 offen sc1
    v_mfma_f32_16x16x32_bf16 v[220:223], a[60:63], a[116:119], v[220:223]
    v_mfma_f32_16x16x32_bf16 v[220:223], a[56:59], a[112:115], v[220:223]
    v_mfma_f32_16x16x32_bf16 v[188:191], a[56:59], a[104:107], v[188:191]
    v_mfma_f32_16x16x32_bf16 v[188:191], a[60:63], a[108:111], v[188:191]
    v_mfma_f32_16x16x32_bf16 v[156:159], a[60:63], a[100:103], v[156:159]
    v_mfma_f32_16x16x32_bf16 v[156:159], a[56:59], a[96:99], v[156:159]
    s_add_u32 s67, s58, s51
    s_waitcnt vmcnt(11) lgkmcnt(0)
    s_barrier
    v_mfma_f32_16x16x32_bf16 v[64:67], a[0:3], a[64:67], v[64:67]
    ds_read_b128 a[32:35], v24 offset:16384
    v_mfma_f32_16x16x32_bf16 v[64:67], a[4:7], a[68:71], v[64:67]
    ds_read_b128 a[36:39], v25 offset:16384
    v_mfma_f32_16x16x32_bf16 v[80:83], a[4:7], a[76:79], v[80:83]
    ds_read_b128 a[40:43], v24 offset:18432
    v_mfma_f32_16x16x32_bf16 v[80:83], a[0:3], a[72:75], v[80:83]
    ds_read_b128 a[44:47], v25 offset:18432
    v_mfma_f32_16x16x32_bf16 v[96:99], a[0:3], a[80:83], v[96:99]
    ds_read_b128 a[48:51], v24 offset:20480
    v_mfma_f32_16x16x32_bf16 v[96:99], a[4:7], a[84:87], v[96:99]
    ds_read_b128 a[52:55], v25 offset:20480
    v_mfma_f32_16x16x32_bf16 v[112:115], a[4:7], a[92:95], v[112:115]
    s_add_u32 s64, s58, s52
    ds_read_b128 a[56:59], v24 offset:22528
    v_mfma_f32_16x16x32_bf16 v[112:115], a[0:3], a[88:91], v[112:115]
    ds_read_b128 a[60:63], v25 offset:22528
    v_mfma_f32_16x16x32_bf16 v[116:119], a[8:11], a[88:91], v[116:119]
    buffer_store_dwordx4 v[152:155], v30, s[32:35], s67 offen sc1
    v_mfma_f32_16x16x32_bf16 v[116:119], a[12:15], a[92:95], v[116:119]
    buffer_store_dwordx4 v[160:163], v30, s[32:35], s64 offen sc1
    v_mfma_f32_16x16x32_bf16 v[100:103], a[12:15], a[84:87], v[100:103]
    v_mfma_f32_16x16x32_bf16 v[100:103], a[8:11], a[80:83], v[100:103]
    v_mfma_f32_16x16x32_bf16 v[84:87], a[8:11], a[72:75], v[84:87]
    v_mfma_f32_16x16x32_bf16 v[84:87], a[12:15], a[76:79], v[84:87]
    s_add_u32 s65, s58, s53
    v_mfma_f32_16x16x32_bf16 v[68:71], a[12:15], a[68:71], v[68:71]
    buffer_store_dwordx4 v[168:171], v30, s[32:35], s65 offen sc1
    v_mfma_f32_16x16x32_bf16 v[68:71], a[8:11], a[64:67], v[68:71]
    v_mfma_f32_16x16x32_bf16 v[72:75], a[16:19], a[64:67], v[72:75]
    v_mfma_f32_16x16x32_bf16 v[72:75], a[20:23], a[68:71], v[72:75]
    v_mfma_f32_16x16x32_bf16 v[88:91], a[20:23], a[76:79], v[88:91]
    v_mfma_f32_16x16x32_bf16 v[88:91], a[16:19], a[72:75], v[88:91]
    v_mfma_f32_16x16x32_bf16 v[104:107], a[16:19], a[80:83], v[104:107]
    s_add_u32 s66, s58, s54
    v_mfma_f32_16x16x32_bf16 v[104:107], a[20:23], a[84:87], v[104:107]
    buffer_store_dwordx4 v[176:179], v30, s[32:35], s66 offen sc1
    v_mfma_f32_16x16x32_bf16 v[120:123], a[20:23], a[92:95], v[120:123]
    v_mfma_f32_16x16x32_bf16 v[120:123], a[16:19], a[88:91], v[120:123]
    v_mfma_f32_16x16x32_bf16 v[124:127], a[24:27], a[88:91], v[124:127]
    v_mfma_f32_16x16x32_bf16 v[124:127], a[28:31], a[92:95], v[124:127]
    v_mfma_f32_16x16x32_bf16 v[108:111], a[28:31], a[84:87], v[108:111]
    v_mfma_f32_16x16x32_bf16 v[108:111], a[24:27], a[80:83], v[108:111]
    s_add_u32 s67, s58, s55
    v_mfma_f32_16x16x32_bf16 v[92:95], a[24:27], a[72:75], v[92:95]
    buffer_store_dwordx4 v[184:187], v30, s[32:35], s67 offen sc1
    v_mfma_f32_16x16x32_bf16 v[92:95], a[28:31], a[76:79], v[92:95]
    v_mfma_f32_16x16x32_bf16 v[76:79], a[28:31], a[68:71], v[76:79]
    v_mfma_f32_16x16x32_bf16 v[76:79], a[24:27], a[64:67], v[76:79]
    s_waitcnt lgkmcnt(7)
    v_mfma_f32_16x16x32_bf16 v[132:135], a[32:35], a[64:67], v[132:135]
    s_waitcnt lgkmcnt(6)
    v_mfma_f32_16x16x32_bf16 v[132:135], a[36:39], a[68:71], v[132:135]
    v_mfma_f32_16x16x32_bf16 v[164:167], a[36:39], a[76:79], v[164:167]
    s_add_u32 s64, s59, s48
    v_mfma_f32_16x16x32_bf16 v[164:167], a[32:35], a[72:75], v[164:167]
    buffer_store_dwordx4 v[192:195], v30, s[32:35], s64 offen sc1
    v_mfma_f32_16x16x32_bf16 v[196:199], a[32:35], a[80:83], v[196:199]
    v_mfma_f32_16x16x32_bf16 v[196:199], a[36:39], a[84:87], v[196:199]
    v_mfma_f32_16x16x32_bf16 v[228:231], a[36:39], a[92:95], v[228:231]
    v_mfma_f32_16x16x32_bf16 v[228:231], a[32:35], a[88:91], v[228:231]
    s_waitcnt lgkmcnt(5)
    v_mfma_f32_16x16x32_bf16 v[236:239], a[40:43], a[88:91], v[236:239]
    s_waitcnt lgkmcnt(4)
    v_mfma_f32_16x16x32_bf16 v[236:239], a[44:47], a[92:95], v[236:239]
    s_add_u32 s65, s59, s49
    v_mfma_f32_16x16x32_bf16 v[204:207], a[44:47], a[84:87], v[204:207]
    buffer_store_dwordx4 v[200:203], v30, s[32:35], s65 offen sc1
    v_mfma_f32_16x16x32_bf16 v[204:207], a[40:43], a[80:83], v[204:207]
    v_mfma_f32_16x16x32_bf16 v[172:175], a[40:43], a[72:75], v[172:175]
    v_mfma_f32_16x16x32_bf16 v[172:175], a[44:47], a[76:79], v[172:175]
    v_mfma_f32_16x16x32_bf16 v[140:143], a[44:47], a[68:71], v[140:143]
    v_mfma_f32_16x16x32_bf16 v[140:143], a[40:43], a[64:67], v[140:143]
    s_waitcnt lgkmcnt(3)
    v_mfma_f32_16x16x32_bf16 v[148:151], a[48:51], a[64:67], v[148:151]
    s_add_u32 s66, s59, s50
    s_waitcnt lgkmcnt(2)
    v_mfma_f32_16x16x32_bf16 v[148:151], a[52:55], a[68:71], v[148:151]
    buffer_store_dwordx4 v[208:211], v30, s[32:35], s66 offen sc1
    v_mfma_f32_16x16x32_bf16 v[180:183], a[52:55], a[76:79], v[180:183]
    v_mfma_f32_16x16x32_bf16 v[180:183], a[48:51], a[72:75], v[180:183]
    v_mfma_f32_16x16x32_bf16 v[212:215], a[48:51], a[80:83], v[212:215]
    v_mfma_f32_16x16x32_bf16 v[212:215], a[52:55], a[84:87], v[212:215]
    v_mfma_f32_16x16x32_bf16 v[244:247], a[52:55], a[92:95], v[244:247]
    v_mfma_f32_16x16x32_bf16 v[244:247], a[48:51], a[88:91], v[244:247]
    s_add_u32 s67, s59, s51
    s_waitcnt lgkmcnt(1)
    v_mfma_f32_16x16x32_bf16 v[252:255], a[56:59], a[88:91], v[252:255]
    buffer_store_dwordx4 v[216:219], v30, s[32:35], s67 offen sc1
    s_waitcnt lgkmcnt(0)
    v_mfma_f32_16x16x32_bf16 v[252:255], a[60:63], a[92:95], v[252:255]
    v_mfma_f32_16x16x32_bf16 v[220:223], a[60:63], a[84:87], v[220:223]
    v_mfma_f32_16x16x32_bf16 v[220:223], a[56:59], a[80:83], v[220:223]
    v_mfma_f32_16x16x32_bf16 v[188:191], a[56:59], a[72:75], v[188:191]
    v_mfma_f32_16x16x32_bf16 v[188:191], a[60:63], a[76:79], v[188:191]
    v_mfma_f32_16x16x32_bf16 v[156:159], a[60:63], a[68:71], v[156:159]
    v_mfma_f32_16x16x32_bf16 v[156:159], a[56:59], a[64:67], v[156:159]
    s_nop 7
    s_mov_b32 s61, 0x3fb8aa3b
    s_mov_b32 s62, 0x358637bd
    v_and_b32 v3, 15, v2
    v_cmp_gt_u32 vcc, 12, v3
    v_mov_b32 v4, 0x3f803f80
    v_mul_f32 v32, s61, v64
    v_mul_f32 v33, s61, v65
    v_mul_f32 v34, s61, v66
    v_mul_f32 v35, s61, v67
    v_mul_f32 v36, s61, v68
    v_mul_f32 v37, s61, v69
    v_mul_f32 v38, s61, v70
    v_mul_f32 v39, s61, v71
    v_exp_f32 v32, v32 clamp
    v_exp_f32 v33, v33 clamp
    v_exp_f32 v34, v34 clamp
    v_exp_f32 v35, v35 clamp
    v_exp_f32 v36, v36 clamp
    v_exp_f32 v37, v37 clamp
    v_exp_f32 v38, v38 clamp
    v_exp_f32 v39, v39 clamp
    v_max_f32 v64, 0, v64
    v_max_f32 v65, 0, v65
    v_max_f32 v66, 0, v66
    v_max_f32 v67, 0, v67
    v_max_f32 v68, 0, v68
    v_max_f32 v69, 0, v69
    v_max_f32 v70, 0, v70
    v_max_f32 v71, 0, v71
    v_add_f32 v32, s62, v32
    v_add_f32 v33, s62, v33
    v_add_f32 v34, s62, v34
    v_add_f32 v35, s62, v35
    v_add_f32 v36, s62, v36
    v_add_f32 v37, s62, v37
    v_add_f32 v38, s62, v38
    v_add_f32 v39, s62, v39
    v_add_f32 v64, v64, v32
    v_add_f32 v65, v65, v33
    v_add_f32 v66, v66, v34
    v_add_f32 v67, v67, v35
    v_add_f32 v68, v68, v36
    v_add_f32 v69, v69, v37
    v_add_f32 v70, v70, v38
    v_add_f32 v71, v71, v39
    v_cvt_pk_bf16_f32 v64, v64, v65
    v_cvt_pk_bf16_f32 v65, v66, v67
    v_cvt_pk_bf16_f32 v66, v68, v69
    v_cvt_pk_bf16_f32 v67, v70, v71
    v_mul_f32 v32, s61, v80
    v_mul_f32 v33, s61, v81
    v_mul_f32 v34, s61, v82
    v_mul_f32 v35, s61, v83
    v_mul_f32 v36, s61, v84
    v_mul_f32 v37, s61, v85
    v_mul_f32 v38, s61, v86
    v_mul_f32 v39, s61, v87
    v_exp_f32 v32, v32 clamp
    v_exp_f32 v33, v33 clamp
    v_exp_f32 v34, v34 clamp
    v_exp_f32 v35, v35 clamp
    v_exp_f32 v36, v36 clamp
    v_exp_f32 v37, v37 clamp
    v_exp_f32 v38, v38 clamp
    v_exp_f32 v39, v39 clamp
    v_max_f32 v80, 0, v80
    v_max_f32 v81, 0, v81
    v_max_f32 v82, 0, v82
    v_max_f32 v83, 0, v83
    v_max_f32 v84, 0, v84
    v_max_f32 v85, 0, v85
    v_max_f32 v86, 0, v86
    v_max_f32 v87, 0, v87
    v_add_f32 v32, s62, v32
    v_add_f32 v33, s62, v33
    v_add_f32 v34, s62, v34
    v_add_f32 v35, s62, v35
    v_add_f32 v36, s62, v36
    v_add_f32 v37, s62, v37
    v_add_f32 v38, s62, v38
    v_add_f32 v39, s62, v39
    v_add_f32 v80, v80, v32
    v_add_f32 v81, v81, v33
    v_add_f32 v82, v82, v34
    v_add_f32 v83, v83, v35
    v_add_f32 v84, v84, v36
    v_add_f32 v85, v85, v37
    v_add_f32 v86, v86, v38
    v_add_f32 v87, v87, v39
    v_cvt_pk_bf16_f32 v80, v80, v81
    v_cvt_pk_bf16_f32 v81, v82, v83
    v_cvt_pk_bf16_f32 v82, v84, v85
    v_cvt_pk_bf16_f32 v83, v86, v87
    v_cvt_pk_bf16_f32 v96, v96, v97
    v_cvt_pk_bf16_f32 v97, v98, v99
    v_cvt_pk_bf16_f32 v98, v100, v101
    v_cvt_pk_bf16_f32 v99, v102, v103
    v_cvt_pk_bf16_f32 v112, v112, v113
    v_cvt_pk_bf16_f32 v113, v114, v115
    v_cvt_pk_bf16_f32 v114, v116, v117
    v_cvt_pk_bf16_f32 v115, v118, v119
    v_cndmask_b32 v112, v4, v112, vcc
    v_cndmask_b32 v113, v4, v113, vcc
    v_cndmask_b32 v114, v4, v114, vcc
    v_cndmask_b32 v115, v4, v115, vcc
    v_mul_f32 v32, s61, v72
    v_mul_f32 v33, s61, v73
    v_mul_f32 v34, s61, v74
    v_mul_f32 v35, s61, v75
    v_mul_f32 v36, s61, v76
    v_mul_f32 v37, s61, v77
    v_mul_f32 v38, s61, v78
    v_mul_f32 v39, s61, v79
    v_exp_f32 v32, v32 clamp
    v_exp_f32 v33, v33 clamp
    v_exp_f32 v34, v34 clamp
    v_exp_f32 v35, v35 clamp
    v_exp_f32 v36, v36 clamp
    v_exp_f32 v37, v37 clamp
    v_exp_f32 v38, v38 clamp
    v_exp_f32 v39, v39 clamp
    v_max_f32 v72, 0, v72
    v_max_f32 v73, 0, v73
    v_max_f32 v74, 0, v74
    v_max_f32 v75, 0, v75
    v_max_f32 v76, 0, v76
    v_max_f32 v77, 0, v77
    v_max_f32 v78, 0, v78
    v_max_f32 v79, 0, v79
    v_add_f32 v32, s62, v32
    v_add_f32 v33, s62, v33
    v_add_f32 v34, s62, v34
    v_add_f32 v35, s62, v35
    v_add_f32 v36, s62, v36
    v_add_f32 v37, s62, v37
    v_add_f32 v38, s62, v38
    v_add_f32 v39, s62, v39
    v_add_f32 v72, v72, v32
    v_add_f32 v73, v73, v33
    v_add_f32 v74, v74, v34
    v_add_f32 v75, v75, v35
    v_add_f32 v76, v76, v36
    v_add_f32 v77, v77, v37
    v_add_f32 v78, v78, v38
    v_add_f32 v79, v79, v39
    v_cvt_pk_bf16_f32 v72, v72, v73
    v_cvt_pk_bf16_f32 v73, v74, v75
    v_cvt_pk_bf16_f32 v74, v76, v77
    v_cvt_pk_bf16_f32 v75, v78, v79
    v_mul_f32 v32, s61, v88
    v_mul_f32 v33, s61, v89
    v_mul_f32 v34, s61, v90
    v_mul_f32 v35, s61, v91
    v_mul_f32 v36, s61, v92
    v_mul_f32 v37, s61, v93
    v_mul_f32 v38, s61, v94
    v_mul_f32 v39, s61, v95
    v_exp_f32 v32, v32 clamp
    v_exp_f32 v33, v33 clamp
    v_exp_f32 v34, v34 clamp
    v_exp_f32 v35, v35 clamp
    v_exp_f32 v36, v36 clamp
    v_exp_f32 v37, v37 clamp
    v_exp_f32 v38, v38 clamp
    v_exp_f32 v39, v39 clamp
    v_max_f32 v88, 0, v88
    v_max_f32 v89, 0, v89
    v_max_f32 v90, 0, v90
    v_max_f32 v91, 0, v91
    v_max_f32 v92, 0, v92
    v_max_f32 v93, 0, v93
    v_max_f32 v94, 0, v94
    v_max_f32 v95, 0, v95
    v_add_f32 v32, s62, v32
    v_add_f32 v33, s62, v33
    v_add_f32 v34, s62, v34
    v_add_f32 v35, s62, v35
    v_add_f32 v36, s62, v36
    v_add_f32 v37, s62, v37
    v_add_f32 v38, s62, v38
    v_add_f32 v39, s62, v39
    v_add_f32 v88, v88, v32
    v_add_f32 v89, v89, v33
    v_add_f32 v90, v90, v34
    v_add_f32 v91, v91, v35
    v_add_f32 v92, v92, v36
    v_add_f32 v93, v93, v37
    v_add_f32 v94, v94, v38
    v_add_f32 v95, v95, v39
    v_cvt_pk_bf16_f32 v88, v88, v89
    v_cvt_pk_bf16_f32 v89, v90, v91
    v_cvt_pk_bf16_f32 v90, v92, v93
    v_cvt_pk_bf16_f32 v91, v94, v95
    v_cvt_pk_bf16_f32 v104, v104, v105
    v_cvt_pk_bf16_f32 v105, v106, v107
    v_cvt_pk_bf16_f32 v106, v108, v109
    v_cvt_pk_bf16_f32 v107, v110, v111
    v_cvt_pk_bf16_f32 v120, v120, v121
    v_cvt_pk_bf16_f32 v121, v122, v123
    v_cvt_pk_bf16_f32 v122, v124, v125
    v_cvt_pk_bf16_f32 v123, v126, v127
    v_cndmask_b32 v120, v4, v120, vcc
    v_cndmask_b32 v121, v4, v121, vcc
    v_cndmask_b32 v122, v4, v122, vcc
    v_cndmask_b32 v123, v4, v123, vcc
    v_mul_f32 v32, s61, v132
    v_mul_f32 v33, s61, v133
    v_mul_f32 v34, s61, v134
    v_mul_f32 v35, s61, v135
    v_mul_f32 v36, s61, v140
    v_mul_f32 v37, s61, v141
    v_mul_f32 v38, s61, v142
    v_mul_f32 v39, s61, v143
    v_exp_f32 v32, v32 clamp
    v_exp_f32 v33, v33 clamp
    v_exp_f32 v34, v34 clamp
    v_exp_f32 v35, v35 clamp
    v_exp_f32 v36, v36 clamp
    v_exp_f32 v37, v37 clamp
    v_exp_f32 v38, v38 clamp
    v_exp_f32 v39, v39 clamp
    v_max_f32 v132, 0, v132
    v_max_f32 v133, 0, v133
    v_max_f32 v134, 0, v134
    v_max_f32 v135, 0, v135
    v_max_f32 v140, 0, v140
    v_max_f32 v141, 0, v141
    v_max_f32 v142, 0, v142
    v_max_f32 v143, 0, v143
    v_add_f32 v32, s62, v32
    v_add_f32 v33, s62, v33
    v_add_f32 v34, s62, v34
    v_add_f32 v35, s62, v35
    v_add_f32 v36, s62, v36
    v_add_f32 v37, s62, v37
    v_add_f32 v38, s62, v38
    v_add_f32 v39, s62, v39
    v_add_f32 v132, v132, v32
    v_add_f32 v133, v133, v33
    v_add_f32 v134, v134, v34
    v_add_f32 v135, v135, v35
    v_add_f32 v140, v140, v36
    v_add_f32 v141, v141, v37
    v_add_f32 v142, v142, v38
    v_add_f32 v143, v143, v39
    v_cvt_pk_bf16_f32 v132, v132, v133
    v_cvt_pk_bf16_f32 v133, v134, v135
    v_cvt_pk_bf16_f32 v134, v140, v141
    v_cvt_pk_bf16_f32 v135, v142, v143
    v_mul_f32 v32, s61, v164
    v_mul_f32 v33, s61, v165
    v_mul_f32 v34, s61, v166
    v_mul_f32 v35, s61, v167
    v_mul_f32 v36, s61, v172
    v_mul_f32 v37, s61, v173
    v_mul_f32 v38, s61, v174
    v_mul_f32 v39, s61, v175
    v_exp_f32 v32, v32 clamp
    v_exp_f32 v33, v33 clamp
    v_exp_f32 v34, v34 clamp
    v_exp_f32 v35, v35 clamp
    v_exp_f32 v36, v36 clamp
    v_exp_f32 v37, v37 clamp
    v_exp_f32 v38, v38 clamp
    v_exp_f32 v39, v39 clamp
    v_max_f32 v164, 0, v164
    v_max_f32 v165, 0, v165
    v_max_f32 v166, 0, v166
    v_max_f32 v167, 0, v167
    v_max_f32 v172, 0, v172
    v_max_f32 v173, 0, v173
    v_max_f32 v174, 0, v174
    v_max_f32 v175, 0, v175
    v_add_f32 v32, s62, v32
    v_add_f32 v33, s62, v33
    v_add_f32 v34, s62, v34
    v_add_f32 v35, s62, v35
    v_add_f32 v36, s62, v36
    v_add_f32 v37, s62, v37
    v_add_f32 v38, s62, v38
    v_add_f32 v39, s62, v39
    v_add_f32 v164, v164, v32
    v_add_f32 v165, v165, v33
    v_add_f32 v166, v166, v34
    v_add_f32 v167, v167, v35
    v_add_f32 v172, v172, v36
    v_add_f32 v173, v173, v37
    v_add_f32 v174, v174, v38
    v_add_f32 v175, v175, v39
    v_cvt_pk_bf16_f32 v164, v164, v165
    v_cvt_pk_bf16_f32 v165, v166, v167
    v_cvt_pk_bf16_f32 v166, v172, v173
    v_cvt_pk_bf16_f32 v167, v174, v175
    v_cvt_pk_bf16_f32 v196, v196, v197
    v_cvt_pk_bf16_f32 v197, v198, v199
    v_cvt_pk_bf16_f32 v198, v204, v205
    v_cvt_pk_bf16_f32 v199, v206, v207
    v_cvt_pk_bf16_f32 v228, v228, v229
    v_cvt_pk_bf16_f32 v229, v230, v231
    v_cvt_pk_bf16_f32 v230, v236, v237
    v_cvt_pk_bf16_f32 v231, v238, v239
    v_cndmask_b32 v228, v4, v228, vcc
    v_cndmask_b32 v229, v4, v229, vcc
    v_cndmask_b32 v230, v4, v230, vcc
    v_cndmask_b32 v231, v4, v231, vcc
    v_mul_f32 v32, s61, v148
    v_mul_f32 v33, s61, v149
    v_mul_f32 v34, s61, v150
    v_mul_f32 v35, s61, v151
    v_mul_f32 v36, s61, v156
    v_mul_f32 v37, s61, v157
    v_mul_f32 v38, s61, v158
    v_mul_f32 v39, s61, v159
    v_exp_f32 v32, v32 clamp
    v_exp_f32 v33, v33 clamp
    v_exp_f32 v34, v34 clamp
    v_exp_f32 v35, v35 clamp
    v_exp_f32 v36, v36 clamp
    v_exp_f32 v37, v37 clamp
    v_exp_f32 v38, v38 clamp
    v_exp_f32 v39, v39 clamp
    v_max_f32 v148, 0, v148
    v_max_f32 v149, 0, v149
    v_max_f32 v150, 0, v150
    v_max_f32 v151, 0, v151
    v_max_f32 v156, 0, v156
    v_max_f32 v157, 0, v157
    v_max_f32 v158, 0, v158
    v_max_f32 v159, 0, v159
    v_add_f32 v32, s62, v32
    v_add_f32 v33, s62, v33
    v_add_f32 v34, s62, v34
    v_add_f32 v35, s62, v35
    v_add_f32 v36, s62, v36
    v_add_f32 v37, s62, v37
    v_add_f32 v38, s62, v38
    v_add_f32 v39, s62, v39
    v_add_f32 v148, v148, v32
    v_add_f32 v149, v149, v33
    v_add_f32 v150, v150, v34
    v_add_f32 v151, v151, v35
    v_add_f32 v156, v156, v36
    v_add_f32 v157, v157, v37
    v_add_f32 v158, v158, v38
    v_add_f32 v159, v159, v39
    v_cvt_pk_bf16_f32 v148, v148, v149
    v_cvt_pk_bf16_f32 v149, v150, v151
    v_cvt_pk_bf16_f32 v150, v156, v157
    v_cvt_pk_bf16_f32 v151, v158, v159
    v_mul_f32 v32, s61, v180
    v_mul_f32 v33, s61, v181
    v_mul_f32 v34, s61, v182
    v_mul_f32 v35, s61, v183
    v_mul_f32 v36, s61, v188
    v_mul_f32 v37, s61, v189
    v_mul_f32 v38, s61, v190
    v_mul_f32 v39, s61, v191
    v_exp_f32 v32, v32 clamp
    v_exp_f32 v33, v33 clamp
    v_exp_f32 v34, v34 clamp
    v_exp_f32 v35, v35 clamp
    v_exp_f32 v36, v36 clamp
    v_exp_f32 v37, v37 clamp
    v_exp_f32 v38, v38 clamp
    v_exp_f32 v39, v39 clamp
    v_max_f32 v180, 0, v180
    v_max_f32 v181, 0, v181
    v_max_f32 v182, 0, v182
    v_max_f32 v183, 0, v183
    v_max_f32 v188, 0, v188
    v_max_f32 v189, 0, v189
    v_max_f32 v190, 0, v190
    v_max_f32 v191, 0, v191
    v_add_f32 v32, s62, v32
    v_add_f32 v33, s62, v33
    v_add_f32 v34, s62, v34
    v_add_f32 v35, s62, v35
    v_add_f32 v36, s62, v36
    v_add_f32 v37, s62, v37
    v_add_f32 v38, s62, v38
    v_add_f32 v39, s62, v39
    v_add_f32 v180, v180, v32
    v_add_f32 v181, v181, v33
    v_add_f32 v182, v182, v34
    v_add_f32 v183, v183, v35
    v_add_f32 v188, v188, v36
    v_add_f32 v189, v189, v37
    v_add_f32 v190, v190, v38
    v_add_f32 v191, v191, v39
    v_cvt_pk_bf16_f32 v180, v180, v181
    v_cvt_pk_bf16_f32 v181, v182, v183
    v_cvt_pk_bf16_f32 v182, v188, v189
    v_cvt_pk_bf16_f32 v183, v190, v191
    v_cvt_pk_bf16_f32 v212, v212, v213
    v_cvt_pk_bf16_f32 v213, v214, v215
    v_cvt_pk_bf16_f32 v214, v220, v221
    v_cvt_pk_bf16_f32 v215, v222, v223
    v_cvt_pk_bf16_f32 v244, v244, v245
    v_cvt_pk_bf16_f32 v245, v246, v247
    v_cvt_pk_bf16_f32 v246, v252, v253
    v_cvt_pk_bf16_f32 v247, v254, v255
    v_cndmask_b32 v244, v4, v244, vcc
    v_cndmask_b32 v245, v4, v245, vcc
    v_cndmask_b32 v246, v4, v246, vcc
    v_cndmask_b32 v247, v4, v247, vcc
    v_mfma_f32_16x16x32_bf16 v[48:51], v[64:67], v[96:99], 0
    v_mfma_f32_16x16x32_bf16 v[52:55], v[80:83], v[96:99], 0
    v_mfma_f32_16x16x32_bf16 v[56:59], v[64:67], v[112:115], 0
    v_mfma_f32_16x16x32_bf16 v[60:63], v[80:83], v[112:115], 0
    v_mfma_f32_16x16x32_bf16 v[48:51], v[72:75], v[104:107], v[48:51]
    v_mfma_f32_16x16x32_bf16 v[52:55], v[88:91], v[104:107], v[52:55]
    v_mfma_f32_16x16x32_bf16 v[56:59], v[72:75], v[120:123], v[56:59]
    v_mfma_f32_16x16x32_bf16 v[60:63], v[88:91], v[120:123], v[60:63]
    v_mfma_f32_16x16x32_bf16 v[48:51], v[132:135], v[196:199], v[48:51]
    v_mfma_f32_16x16x32_bf16 v[52:55], v[164:167], v[196:199], v[52:55]
    v_mfma_f32_16x16x32_bf16 v[56:59], v[132:135], v[228:231], v[56:59]
    v_mfma_f32_16x16x32_bf16 v[60:63], v[164:167], v[228:231], v[60:63]
    v_mfma_f32_16x16x32_bf16 v[48:51], v[148:151], v[212:215], v[48:51]
    v_mfma_f32_16x16x32_bf16 v[52:55], v[180:183], v[212:215], v[52:55]
    v_mfma_f32_16x16x32_bf16 v[56:59], v[148:151], v[244:247], v[56:59]
    v_mfma_f32_16x16x32_bf16 v[60:63], v[180:183], v[244:247], v[60:63]
    s_nop 4
    buffer_store_dwordx4 v[48:51], v31, s[32:35], s44 offen offset:0 sc1
    buffer_store_dwordx4 v[52:55], v31, s[32:35], s44 offen offset:1024 sc1
    buffer_store_dwordx4 v[56:59], v31, s[32:35], s44 offen offset:2048 sc1
    buffer_store_dwordx4 v[60:63], v31, s[32:35], s44 offen offset:3072 sc1
    s_load_dwordx2 s[6:7], s[0:1], 88
    s_sub_u32 s23, s22, 16
    s_lshl_b32 s3, s23, 2
    v_mov_b32 v3, s3
    v_mov_b32 v4, 1
    v_mov_b32 v5, 0
    s_waitcnt vmcnt(0) lgkmcnt(0)
    s_mov_b32 s24, s6
    s_and_b32 s25, s7, 0xffff
    s_mov_b32 s26, 256
    s_barrier
    s_cmp_lg_u32 s20, 0
    s_cbranch_scc1 K1_KV_W
    s_mov_b64 exec, 1
    buffer_atomic_add v4, v3, s[24:27], 0 offen sc0 sc1
    s_mov_b64 exec, -1
K1_KV_W:
    s_add_u32 s64, s59, s52
    buffer_store_dwordx4 v[224:227], v30, s[32:35], s64 offen sc1
    s_add_u32 s65, s59, s53
    buffer_store_dwordx4 v[232:235], v30, s[32:35], s65 offen sc1
    s_add_u32 s66, s59, s54
    buffer_store_dwordx4 v[240:243], v30, s[32:35], s66 offen sc1
    s_add_u32 s67, s59, s55
    buffer_store_dwordx4 v[248:251], v30, s[32:35], s67 offen sc1
    buffer_store_dwordx4 a[192:195], v1, s[32:35], s100 offen sc1
    s_add_u32 s100, s100, s101
    buffer_store_dwordx4 a[196:199], v1, s[32:35], s100 offen sc1
    s_add_u32 s100, s100, s101
    buffer_store_dwordx4 a[200:203], v1, s[32:35], s100 offen sc1
    s_add_u32 s100, s100, s101
    buffer_store_dwordx4 a[204:207], v1, s[32:35], s100 offen sc1
    s_add_u32 s100, s100, s101
    buffer_store_dwordx4 a[208:211], v1, s[32:35], s100 offen sc1
    s_add_u32 s100, s100, s101
    buffer_store_dwordx4 a[212:215], v1, s[32:35], s100 offen sc1
    s_add_u32 s100, s100, s101
    buffer_store_dwordx4 a[216:219], v1, s[32:35], s100 offen sc1
    s_add_u32 s100, s100, s101
    s_cmp_lg_u32 s20, 0
    s_cbranch_scc1 K1_KV_W2
    s_waitcnt vmcnt(11)
    s_mov_b64 exec, 1
    ds_write_b32 v5, v4
    s_mov_b64 exec, -1
    s_waitcnt lgkmcnt(0)
K1_KV_W2:
    s_barrier
    ds_read_b32 v4, v5
    s_waitcnt lgkmcnt(0)
    v_readfirstlane_b32 s3, v4
    s_lshr_b32 s10, s20, 1
    s_and_b32 s11, s20, 1
    s_cmp_lg_u32 s3, 7
    s_cbranch_scc1 K1_KV_DONE
    s_lshl_b32 s12, s23, 1
    s_add_u32 s10, s10, s12
    s_lshl_b32 s12, s11, 11
    s_lshl_b32 s13, s10, 16
    s_add_u32 s12, s12, s13
    s_add_u32 s12, s12, 69206016
    v_lshlrev_b32 v3, 4, v2
    buffer_load_dwordx4 v[64:67], v3, s[32:35], s12 offen offset:0 sc1
    buffer_load_dwordx4 v[68:71], v3, s[32:35], s12 offen offset:1024 sc1
    s_add_u32 s12, s12, 4096
    buffer_load_dwordx4 v[72:75], v3, s[32:35], s12 offen offset:0 sc1
    buffer_load_dwordx4 v[76:79], v3, s[32:35], s12 offen offset:1024 sc1
    s_add_u32 s12, s12, 4096
    buffer_load_dwordx4 v[80:83], v3, s[32:35], s12 offen offset:0 sc1
    buffer_load_dwordx4 v[84:87], v3, s[32:35], s12 offen offset:1024 sc1
    s_add_u32 s12, s12, 4096
    buffer_load_dwordx4 v[88:91], v3, s[32:35], s12 offen offset:0 sc1
    buffer_load_dwordx4 v[92:95], v3, s[32:35], s12 offen offset:1024 sc1
    s_add_u32 s12, s12, 4096
    buffer_load_dwordx4 v[96:99], v3, s[32:35], s12 offen offset:0 sc1
    buffer_load_dwordx4 v[100:103], v3, s[32:35], s12 offen offset:1024 sc1
    s_add_u32 s12, s12, 4096
    buffer_load_dwordx4 v[104:107], v3, s[32:35], s12 offen offset:0 sc1
    buffer_load_dwordx4 v[108:111], v3, s[32:35], s12 offen offset:1024 sc1
    s_add_u32 s12, s12, 4096
    buffer_load_dwordx4 v[112:115], v3, s[32:35], s12 offen offset:0 sc1
    buffer_load_dwordx4 v[116:119], v3, s[32:35], s12 offen offset:1024 sc1
    s_add_u32 s12, s12, 4096
    buffer_load_dwordx4 v[120:123], v3, s[32:35], s12 offen offset:0 sc1
    buffer_load_dwordx4 v[124:127], v3, s[32:35], s12 offen offset:1024 sc1
    s_add_u32 s12, s12, 4096
    buffer_load_dwordx4 v[128:131], v3, s[32:35], s12 offen offset:0 sc1
    buffer_load_dwordx4 v[132:135], v3, s[32:35], s12 offen offset:1024 sc1
    s_add_u32 s12, s12, 4096
    buffer_load_dwordx4 v[136:139], v3, s[32:35], s12 offen offset:0 sc1
    buffer_load_dwordx4 v[140:143], v3, s[32:35], s12 offen offset:1024 sc1
    s_add_u32 s12, s12, 4096
    buffer_load_dwordx4 v[144:147], v3, s[32:35], s12 offen offset:0 sc1
    buffer_load_dwordx4 v[148:151], v3, s[32:35], s12 offen offset:1024 sc1
    s_add_u32 s12, s12, 4096
    buffer_load_dwordx4 v[152:155], v3, s[32:35], s12 offen offset:0 sc1
    buffer_load_dwordx4 v[156:159], v3, s[32:35], s12 offen offset:1024 sc1
    s_add_u32 s12, s12, 4096
    buffer_load_dwordx4 v[160:163], v3, s[32:35], s12 offen offset:0 sc1
    buffer_load_dwordx4 v[164:167], v3, s[32:35], s12 offen offset:1024 sc1
    s_add_u32 s12, s12, 4096
    buffer_load_dwordx4 v[168:171], v3, s[32:35], s12 offen offset:0 sc1
    buffer_load_dwordx4 v[172:175], v3, s[32:35], s12 offen offset:1024 sc1
    s_add_u32 s12, s12, 4096
    buffer_load_dwordx4 v[176:179], v3, s[32:35], s12 offen offset:0 sc1
    buffer_load_dwordx4 v[180:183], v3, s[32:35], s12 offen offset:1024 sc1
    s_add_u32 s12, s12, 4096
    buffer_load_dwordx4 v[184:187], v3, s[32:35], s12 offen offset:0 sc1
    buffer_load_dwordx4 v[188:191], v3, s[32:35], s12 offen offset:1024 sc1
    s_add_u32 s12, s12, 4096
    v_and_b32 v4, 48, v2
    v_add_u32 v4, 12, v4
    v_lshlrev_b32 v4, 2, v4
    s_waitcnt vmcnt(29)
    v_add_f32 v64, v64, v72
    v_add_f32 v65, v65, v73
    v_add_f32 v66, v66, v74
    v_add_f32 v67, v67, v75
    s_waitcnt vmcnt(28)
    v_add_f32 v68, v68, v76
    v_add_f32 v69, v69, v77
    v_add_f32 v70, v70, v78
    v_add_f32 v71, v71, v79
    s_waitcnt vmcnt(27)
    v_add_f32 v64, v64, v80
    v_add_f32 v65, v65, v81
    v_add_f32 v66, v66, v82
    v_add_f32 v67, v67, v83
    s_waitcnt vmcnt(26)
    v_add_f32 v68, v68, v84
    v_add_f32 v69, v69, v85
    v_add_f32 v70, v70, v86
    v_add_f32 v71, v71, v87
    s_waitcnt vmcnt(25)
    v_add_f32 v64, v64, v88
    v_add_f32 v65, v65, v89
    v_add_f32 v66, v66, v90
    v_add_f32 v67, v67, v91
    s_waitcnt vmcnt(24)
    v_add_f32 v68, v68, v92
    v_add_f32 v69, v69, v93
    v_add_f32 v70, v70, v94
    v_add_f32 v71, v71, v95
    s_waitcnt vmcnt(23)
    v_add_f32 v64, v64, v96
    v_add_f32 v65, v65, v97
    v_add_f32 v66, v66, v98
    v_add_f32 v67, v67, v99
    s_waitcnt vmcnt(22)
    v_add_f32 v68, v68, v100
    v_add_f32 v69, v69, v101
    v_add_f32 v70, v70, v102
    v_add_f32 v71, v71, v103
    s_waitcnt vmcnt(21)
    v_add_f32 v64, v64, v104
    v_add_f32 v65, v65, v105
    v_add_f32 v66, v66, v106
    v_add_f32 v67, v67, v107
    s_waitcnt vmcnt(20)
    v_add_f32 v68, v68, v108
    v_add_f32 v69, v69, v109
    v_add_f32 v70, v70, v110
    v_add_f32 v71, v71, v111
    s_waitcnt vmcnt(19)
    v_add_f32 v64, v64, v112
    v_add_f32 v65, v65, v113
    v_add_f32 v66, v66, v114
    v_add_f32 v67, v67, v115
    s_waitcnt vmcnt(18)
    v_add_f32 v68, v68, v116
    v_add_f32 v69, v69, v117
    v_add_f32 v70, v70, v118
    v_add_f32 v71, v71, v119
    s_waitcnt vmcnt(17)
    v_add_f32 v64, v64, v120
    v_add_f32 v65, v65, v121
    v_add_f32 v66, v66, v122
    v_add_f32 v67, v67, v123
    s_waitcnt vmcnt(16)
    v_add_f32 v68, v68, v124
    v_add_f32 v69, v69, v125
    v_add_f32 v70, v70, v126
    v_add_f32 v71, v71, v127
    s_waitcnt vmcnt(15)
    v_add_f32 v64, v64, v128
    v_add_f32 v65, v65, v129
    v_add_f32 v66, v66, v130
    v_add_f32 v67, v67, v131
    s_waitcnt vmcnt(14)
    v_add_f32 v68, v68, v132
    v_add_f32 v69, v69, v133
    v_add_f32 v70, v70, v134
    v_add_f32 v71, v71, v135
    s_waitcnt vmcnt(13)
    v_add_f32 v64, v64, v136
    v_add_f32 v65, v65, v137
    v_add_f32 v66, v66, v138
    v_add_f32 v67, v67, v139
    s_waitcnt vmcnt(12)
    v_add_f32 v68, v68, v140
    v_add_f32 v69, v69, v141
    v_add_f32 v70, v70, v142
    v_add_f32 v71, v71, v143
    s_waitcnt vmcnt(11)
    v_add_f32 v64, v64, v144
    v_add_f32 v65, v65, v145
    v_add_f32 v66, v66, v146
    v_add_f32 v67, v67, v147
    s_waitcnt vmcnt(10)
    v_add_f32 v68, v68, v148
    v_add_f32 v69, v69, v149
    v_add_f32 v70, v70, v150
    v_add_f32 v71, v71, v151
    s_waitcnt vmcnt(9)
    v_add_f32 v64, v64, v152
    v_add_f32 v65, v65, v153
    v_add_f32 v66, v66, v154
    v_add_f32 v67, v67, v155
    s_waitcnt vmcnt(8)
    v_add_f32 v68, v68, v156
    v_add_f32 v69, v69, v157
    v_add_f32 v70, v70, v158
    v_add_f32 v71, v71, v159
    s_waitcnt vmcnt(7)
    v_add_f32 v64, v64, v160
    v_add_f32 v65, v65, v161
    v_add_f32 v66, v66, v162
    v_add_f32 v67, v67, v163
    s_waitcnt vmcnt(6)
    v_add_f32 v68, v68, v164
    v_add_f32 v69, v69, v165
    v_add_f32 v70, v70, v166
    v_add_f32 v71, v71, v167
    s_waitcnt vmcnt(5)
    v_add_f32 v64, v64, v168
    v_add_f32 v65, v65, v169
    v_add_f32 v66, v66, v170
    v_add_f32 v67, v67, v171
    s_waitcnt vmcnt(4)
    v_add_f32 v68, v68, v172
    v_add_f32 v69, v69, v173
    v_add_f32 v70, v70, v174
    v_add_f32 v71, v71, v175
    s_waitcnt vmcnt(3)
    v_add_f32 v64, v64, v176
    v_add_f32 v65, v65, v177
    v_add_f32 v66, v66, v178
    v_add_f32 v67, v67, v179
    s_waitcnt vmcnt(2)
    v_add_f32 v68, v68, v180
    v_add_f32 v69, v69, v181
    v_add_f32 v70, v70, v182
    v_add_f32 v71, v71, v183
    s_waitcnt vmcnt(1)
    v_add_f32 v64, v64, v184
    v_add_f32 v65, v65, v185
    v_add_f32 v66, v66, v186
    v_add_f32 v67, v67, v187
    s_waitcnt vmcnt(0)
    v_add_f32 v68, v68, v188
    v_add_f32 v69, v69, v189
    v_add_f32 v70, v70, v190
    v_add_f32 v71, v71, v191
    v_cvt_pk_bf16_f32 v64, v64, v65
    v_cvt_pk_bf16_f32 v65, v66, v67
    v_cvt_pk_bf16_f32 v66, v68, v69
    v_cvt_pk_bf16_f32 v67, v70, v71
    s_mul_i32 s10, s10, 3
    s_add_u32 s10, s10, s11
    s_lshl_b32 s10, s10, 10
    s_add_u32 s10, s10, 70254592
    buffer_store_dwordx4 v[64:67], v3, s[32:35], s10 offen
    s_cmp_eq_u32 s11, 0
    s_cbranch_scc1 K1_KV_DONE
    ds_bpermute_b32 v72, v4, v64
    ds_bpermute_b32 v73, v4, v65
    ds_bpermute_b32 v74, v4, v66
    ds_bpermute_b32 v75, v4, v67
    s_waitcnt lgkmcnt(0)
    buffer_store_dwordx4 v[72:75], v3, s[32:35], s10 offen offset:1024
K1_KV_DONE:
    s_endpgm
K1_GATE:
    s_sub_u32 s3, s22, 28
    s_lshl_b32 s3, s3, 3
    s_add_u32 s3, s3, s21
    s_lshl_b32 s3, s3, 2
    s_add_u32 s3, s3, s20
    s_load_dwordx2 s[36:37], s[0:1], 40
    s_load_dwordx2 s[38:39], s[0:1], 64
    ds_read_b64_tr_b16 a[192:193], v0 offset:0
    ds_read_b64_tr_b16 a[194:195], v0 offset:4096
    ds_read_b64_tr_b16 a[196:197], v0 offset:32
    ds_read_b64_tr_b16 a[198:199], v0 offset:4128
    ds_read_b64_tr_b16 a[200:201], v0 offset:64
    ds_read_b64_tr_b16 a[202:203], v0 offset:4160
    ds_read_b64_tr_b16 a[204:205], v0 offset:96
    ds_read_b64_tr_b16 a[206:207], v0 offset:4192
    ds_read_b64_tr_b16 a[208:209], v0 offset:128
    ds_read_b64_tr_b16 a[210:211], v0 offset:4224
    ds_read_b64_tr_b16 a[212:213], v0 offset:160
    ds_read_b64_tr_b16 a[214:215], v0 offset:4256
    ds_read_b64_tr_b16 a[216:217], v0 offset:192
    ds_read_b64_tr_b16 a[218:219], v0 offset:4288
    v_cvt_pk_bf16_f32 v128, v128, v129
    v_cvt_pk_bf16_f32 v129, v130, v131
    v_cvt_pk_bf16_f32 v130, v132, v133
    v_cvt_pk_bf16_f32 v131, v134, v135
    v_cvt_pk_bf16_f32 v136, v136, v137
    v_cvt_pk_bf16_f32 v137, v138, v139
    v_cvt_pk_bf16_f32 v138, v140, v141
    v_cvt_pk_bf16_f32 v139, v142, v143
    v_cvt_pk_bf16_f32 v144, v144, v145
    v_cvt_pk_bf16_f32 v145, v146, v147
    v_cvt_pk_bf16_f32 v146, v148, v149
    v_cvt_pk_bf16_f32 v147, v150, v151
    v_cvt_pk_bf16_f32 v152, v152, v153
    v_cvt_pk_bf16_f32 v153, v154, v155
    v_cvt_pk_bf16_f32 v154, v156, v157
    v_cvt_pk_bf16_f32 v155, v158, v159
    v_cvt_pk_bf16_f32 v160, v160, v161
    v_cvt_pk_bf16_f32 v161, v162, v163
    v_cvt_pk_bf16_f32 v162, v164, v165
    v_cvt_pk_bf16_f32 v163, v166, v167
    v_cvt_pk_bf16_f32 v168, v168, v169
    v_cvt_pk_bf16_f32 v169, v170, v171
    v_cvt_pk_bf16_f32 v170, v172, v173
    v_cvt_pk_bf16_f32 v171, v174, v175
    v_cvt_pk_bf16_f32 v176, v176, v177
    v_cvt_pk_bf16_f32 v177, v178, v179
    v_cvt_pk_bf16_f32 v178, v180, v181
    v_cvt_pk_bf16_f32 v179, v182, v183
    v_cvt_pk_bf16_f32 v184, v184, v185
    v_cvt_pk_bf16_f32 v185, v186, v187
    v_cvt_pk_bf16_f32 v186, v188, v189
    v_cvt_pk_bf16_f32 v187, v190, v191
    v_cvt_pk_bf16_f32 v192, v192, v193
    v_cvt_pk_bf16_f32 v193, v194, v195
    v_cvt_pk_bf16_f32 v194, v196, v197
    v_cvt_pk_bf16_f32 v195, v198, v199
    v_cvt_pk_bf16_f32 v200, v200, v201
    v_cvt_pk_bf16_f32 v201, v202, v203
    v_cvt_pk_bf16_f32 v202, v204, v205
    v_cvt_pk_bf16_f32 v203, v206, v207
    v_cvt_pk_bf16_f32 v208, v208, v209
    v_cvt_pk_bf16_f32 v209, v210, v211
    v_cvt_pk_bf16_f32 v210, v212, v213
    v_cvt_pk_bf16_f32 v211, v214, v215
    v_cvt_pk_bf16_f32 v216, v216, v217
    v_cvt_pk_bf16_f32 v217, v218, v219
    v_cvt_pk_bf16_f32 v218, v220, v221
    v_cvt_pk_bf16_f32 v219, v222, v223
    v_cvt_pk_bf16_f32 v224, v224, v225
    v_cvt_pk_bf16_f32 v225, v226, v227
    v_cvt_pk_bf16_f32 v226, v228, v229
    v_cvt_pk_bf16_f32 v227, v230, v231
    v_cvt_pk_bf16_f32 v232, v232, v233
    v_cvt_pk_bf16_f32 v233, v234, v235
    v_cvt_pk_bf16_f32 v234, v236, v237
    v_cvt_pk_bf16_f32 v235, v238, v239
    v_cvt_pk_bf16_f32 v240, v240, v241
    v_cvt_pk_bf16_f32 v241, v242, v243
    v_cvt_pk_bf16_f32 v242, v244, v245
    v_cvt_pk_bf16_f32 v243, v246, v247
    v_cvt_pk_bf16_f32 v248, v248, v249
    v_cvt_pk_bf16_f32 v249, v250, v251
    v_cvt_pk_bf16_f32 v250, v252, v253
    v_cvt_pk_bf16_f32 v251, v254, v255
    s_mov_b32 s24, s4
    s_and_b32 s25, s5, 0xffff
    s_mov_b32 s26, 1835008
    s_mov_b32 s28, s16
    s_and_b32 s29, s17, 0xffff
    s_mov_b32 s30, 896
    v_and_b32 v3, 7, v2
    v_lshlrev_b32 v3, 4, v3
    v_lshrrev_b32 v4, 3, v2
    v_mul_u32_u24 v5, 896, v4
    v_add_u32 v5, v5, v3
    s_mul_i32 s23, s3, 14336
    s_add_u32 s47, s23, 7168
    s_waitcnt vmcnt(16) lgkmcnt(0)
    buffer_load_dwordx4 v[132:135], v3, s[28:31], 0 offen offset:0
    buffer_load_dwordx4 v[64:67], v5, s[24:27], s23 offen offset:0
    buffer_load_dwordx4 v[92:95], v5, s[24:27], s47 offen offset:0
    buffer_load_dwordx4 v[140:143], v3, s[28:31], 0 offen offset:128
    buffer_load_dwordx4 v[68:71], v5, s[24:27], s23 offen offset:128
    buffer_load_dwordx4 v[96:99], v5, s[24:27], s47 offen offset:128
    buffer_load_dwordx4 v[148:151], v3, s[28:31], 0 offen offset:256
    buffer_load_dwordx4 v[72:75], v5, s[24:27], s23 offen offset:256
    buffer_load_dwordx4 v[100:103], v5, s[24:27], s47 offen offset:256
    buffer_load_dwordx4 v[156:159], v3, s[28:31], 0 offen offset:384
    buffer_load_dwordx4 v[76:79], v5, s[24:27], s23 offen offset:384
    buffer_load_dwordx4 v[104:107], v5, s[24:27], s47 offen offset:384
    buffer_load_dwordx4 v[164:167], v3, s[28:31], 0 offen offset:512
    buffer_load_dwordx4 v[80:83], v5, s[24:27], s23 offen offset:512
    buffer_load_dwordx4 v[108:111], v5, s[24:27], s47 offen offset:512
    buffer_load_dwordx4 v[172:175], v3, s[28:31], 0 offen offset:640
    buffer_load_dwordx4 v[84:87], v5, s[24:27], s23 offen offset:640
    buffer_load_dwordx4 v[112:115], v5, s[24:27], s47 offen offset:640
    buffer_load_dwordx4 v[180:183], v3, s[28:31], 0 offen offset:768
    buffer_load_dwordx4 v[88:91], v5, s[24:27], s23 offen offset:768
    buffer_load_dwordx4 v[116:119], v5, s[24:27], s47 offen offset:768
    s_mov_b32 s8, s100
    s_mov_b32 s9, s101
    s_add_u32 s11, s3, 512
    s_mul_i32 s12, s11, 1821
    s_lshr_b32 s12, s12, 16
    s_mul_i32 s13, s12, 36
    s_sub_u32 s13, s11, s13
    s_lshr_b32 s7, s13, 1
    s_and_b32 s13, s13, 1
    s_lshl_b32 s6, s12, 3
    s_add_u32 s6, s6, s7
    s_xor_b32 s10, s12, 1
    s_lshl_b32 s10, s10, 3
    s_add_u32 s10, s10, s7
    s_sub_u32 s10, s10, 10
    s_cmp_lt_u32 s7, 8
    s_cselect_b32 s6, s6, s10
    s_lshl_b32 s6, s6, 5
    s_andn2_b32 s10, s12, 1
    s_add_u32 s10, s10, s7
    s_sub_u32 s10, s10, 8
    s_mul_i32 s10, s10, 28
    s_mov_b32 s98, 401408
    s_lshr_b32 s99, s7, 1
    s_cmp_lg_u32 s99, 4
    s_cselect_b32 s6, s6, s10
    s_cselect_b32 s96, s36, s38
    s_cselect_b32 s97, s37, s39
    s_cselect_b32 s98, 3670016, s98
    s_and_b32 s97, s97, 0xffff
    s_mul_i32 s6, s6, 896
    s_and_b32 s10, s12, 1
    s_lshl_b32 s10, s10, 1
    s_add_u32 s10, s10, s13
    s_mul_i32 s10, s10, 224
    s_add_u32 s6, s6, s10
    s_mul_i32 s10, s99, 28
    s_mul_i32 s13, s13, 14
    s_add_u32 s10, s10, s13
    s_add_u32 s13, s13, s99
    s_lshl_b32 s13, s13, 1
    s_add_u32 s13, s13, 182
    s_mov_b32 s101, 2048
    s_cmp_ge_u32 s99, 7
    s_cselect_b32 s10, s13, s10
    s_cselect_b32 s101, 4096, s101
    s_and_b32 s7, s7, 1
    s_add_u32 s10, s10, s7
    s_lshl_b32 s12, s12, 8
    s_add_u32 s10, s10, s12
    s_lshl_b32 s10, s10, 10
    s_mov_b32 s99, 0x20000
    s_add_u32 s100, s10, 96468992
    s_cmp_lt_u32 s11, 576
    s_cselect_b32 s100, s100, 0x7f000000
    s_cselect_b32 s6, s6, 0x7f000000
    v_lshrrev_b32 v4, 4, v2
    v_and_b32 v5, 15, v2
    v_mul_u32_u24 v6, 896, v4
    v_lshl_add_u32 v6, v5, 4, v6
    s_lshl_b32 s10, s20, 13
    s_add_u32 s10, s10, 131072
    s_add_u32 m0, s10, 0
    s_add_u32 s7, s6, 0
    buffer_load_dwordx4 v6, s[96:99], s7 offen lds
    s_add_u32 m0, s10, 1024
    s_add_u32 s7, s6, 3584
    buffer_load_dwordx4 v6, s[96:99], s7 offen lds
    s_add_u32 m0, s10, 2048
    s_add_u32 s7, s6, 7168
    buffer_load_dwordx4 v6, s[96:99], s7 offen lds
    s_add_u32 m0, s10, 3072
    s_add_u32 s7, s6, 10752
    buffer_load_dwordx4 v6, s[96:99], s7 offen lds
    s_add_u32 m0, s10, 4096
    s_add_u32 s7, s6, 14336
    buffer_load_dwordx4 v6, s[96:99], s7 offen lds
    s_add_u32 m0, s10, 5120
    s_add_u32 s7, s6, 17920
    buffer_load_dwordx4 v6, s[96:99], s7 offen lds
    s_add_u32 m0, s10, 6144
    s_add_u32 s7, s6, 21504
    buffer_load_dwordx4 v6, s[96:99], s7 offen lds
    s_add_u32 m0, s10, 7168
    s_add_u32 s7, s6, 25088
    buffer_load_dwordx4 v6, s[96:99], s7 offen lds
    s_getpc_b64 s[12:13]
K1_PC2:
    s_add_u32 s12, s12, attn_kernel-K1_PC2
    s_addc_u32 s13, s13, 0
    s_and_b32 s13, s13, 0xffff
    s_mov_b32 s14, CODE_END-attn_kernel
    s_mov_b32 s15, 0x20000
    v_lshlrev_b32 v3, 7, v2
    s_lshl_b32 s23, s20, 13
    buffer_load_dword v8, v3, s[12:15], s23 offen
    s_add_u32 s23, s23, 32768
    buffer_load_dword v9, v3, s[12:15], s23 offen
    v_mov_b32 v6, 0
    v_mov_b32 v7, 0
    buffer_store_dwordx4 a[192:195], v1, s[32:35], s8 offen sc1
    s_waitcnt vmcnt(31)
    v_lshlrev_b32 v17, 16, v132
    v_and_b32 v19, 0xffff0000, v132
    s_waitcnt vmcnt(30)
    v_lshlrev_b32 v16, 16, v64
    v_and_b32 v18, 0xffff0000, v64
    v_fmac_f32 v6, v16, v17
    s_add_u32 s8, s8, s9
    v_fmac_f32 v6, v18, v19
    s_waitcnt vmcnt(29)
    v_lshlrev_b32 v16, 16, v92
    v_and_b32 v18, 0xffff0000, v92
    v_fmac_f32 v7, v16, v17
    v_fmac_f32 v7, v18, v19
    buffer_store_dwordx4 a[196:199], v1, s[32:35], s8 offen sc1
    v_lshlrev_b32 v17, 16, v133
    v_and_b32 v19, 0xffff0000, v133
    v_lshlrev_b32 v16, 16, v65
    v_and_b32 v18, 0xffff0000, v65
    s_add_u32 s8, s8, s9
    v_fmac_f32 v6, v16, v17
    v_fmac_f32 v6, v18, v19
    v_lshlrev_b32 v16, 16, v93
    v_and_b32 v18, 0xffff0000, v93
    v_fmac_f32 v7, v16, v17
    buffer_store_dwordx4 a[200:203], v1, s[32:35], s8 offen sc1
    v_fmac_f32 v7, v18, v19
    v_lshlrev_b32 v17, 16, v134
    v_and_b32 v19, 0xffff0000, v134
    v_lshlrev_b32 v16, 16, v66
    s_add_u32 s8, s8, s9
    v_and_b32 v18, 0xffff0000, v66
    v_fmac_f32 v6, v16, v17
    v_fmac_f32 v6, v18, v19
    v_lshlrev_b32 v16, 16, v94
    v_and_b32 v18, 0xffff0000, v94
    buffer_store_dwordx4 a[204:207], v1, s[32:35], s8 offen sc1
    v_fmac_f32 v7, v16, v17
    v_fmac_f32 v7, v18, v19
    v_lshlrev_b32 v17, 16, v135
    v_and_b32 v19, 0xffff0000, v135
    s_add_u32 s8, s8, s9
    v_lshlrev_b32 v16, 16, v67
    v_and_b32 v18, 0xffff0000, v67
    v_fmac_f32 v6, v16, v17
    v_fmac_f32 v6, v18, v19
    v_lshlrev_b32 v16, 16, v95
    buffer_store_dwordx4 a[208:211], v1, s[32:35], s8 offen sc1
    v_and_b32 v18, 0xffff0000, v95
    v_fmac_f32 v7, v16, v17
    v_fmac_f32 v7, v18, v19
    s_waitcnt vmcnt(32)
    v_lshlrev_b32 v17, 16, v140
    s_add_u32 s8, s8, s9
    v_and_b32 v19, 0xffff0000, v140
    s_waitcnt vmcnt(31)
    v_lshlrev_b32 v16, 16, v68
    v_and_b32 v18, 0xffff0000, v68
    v_fmac_f32 v6, v16, v17
    v_fmac_f32 v6, v18, v19
    buffer_store_dwordx4 a[212:215], v1, s[32:35], s8 offen sc1
    s_waitcnt vmcnt(31)
    v_lshlrev_b32 v16, 16, v96
    v_and_b32 v18, 0xffff0000, v96
    v_fmac_f32 v7, v16, v17
    v_fmac_f32 v7, v18, v19
    s_add_u32 s8, s8, s9
    v_lshlrev_b32 v17, 16, v141
    v_and_b32 v19, 0xffff0000, v141
    v_lshlrev_b32 v16, 16, v69
    v_and_b32 v18, 0xffff0000, v69
    v_fmac_f32 v6, v16, v17
    buffer_store_dwordx4 a[216:219], v1, s[32:35], s8 offen sc1
    v_fmac_f32 v6, v18, v19
    v_lshlrev_b32 v16, 16, v97
    v_and_b32 v18, 0xffff0000, v97
    v_fmac_f32 v7, v16, v17
    s_add_u32 s8, s8, s9
    v_fmac_f32 v7, v18, v19
    v_lshlrev_b32 v17, 16, v142
    v_and_b32 v19, 0xffff0000, v142
    v_lshlrev_b32 v16, 16, v70
    v_and_b32 v18, 0xffff0000, v70
    s_add_u32 s60, s56, s48
    v_fmac_f32 v6, v16, v17
    v_fmac_f32 v6, v18, v19
    v_lshlrev_b32 v16, 16, v98
    v_and_b32 v18, 0xffff0000, v98
    buffer_store_dwordx4 v[32:35], v30, s[32:35], s60 offen sc1
    v_fmac_f32 v7, v16, v17
    v_fmac_f32 v7, v18, v19
    v_lshlrev_b32 v17, 16, v143
    v_and_b32 v19, 0xffff0000, v143
    v_lshlrev_b32 v16, 16, v71
    s_add_u32 s61, s56, s49
    v_and_b32 v18, 0xffff0000, v71
    v_fmac_f32 v6, v16, v17
    v_fmac_f32 v6, v18, v19
    v_lshlrev_b32 v16, 16, v99
    buffer_store_dwordx4 v[36:39], v30, s[32:35], s61 offen sc1
    v_and_b32 v18, 0xffff0000, v99
    v_fmac_f32 v7, v16, v17
    v_fmac_f32 v7, v18, v19
    s_waitcnt vmcnt(33)
    v_lshlrev_b32 v17, 16, v148
    v_and_b32 v19, 0xffff0000, v148
    s_add_u32 s64, s56, s50
    s_waitcnt vmcnt(32)
    v_lshlrev_b32 v16, 16, v72
    v_and_b32 v18, 0xffff0000, v72
    v_fmac_f32 v6, v16, v17
    v_fmac_f32 v6, v18, v19
    buffer_store_dwordx4 v[40:43], v30, s[32:35], s64 offen sc1
    s_waitcnt vmcnt(32)
    v_lshlrev_b32 v16, 16, v100
    v_and_b32 v18, 0xffff0000, v100
    v_fmac_f32 v7, v16, v17
    v_fmac_f32 v7, v18, v19
    v_lshlrev_b32 v17, 16, v149
    s_add_u32 s65, s56, s51
    v_and_b32 v19, 0xffff0000, v149
    v_lshlrev_b32 v16, 16, v73
    v_and_b32 v18, 0xffff0000, v73
    v_fmac_f32 v6, v16, v17
    buffer_store_dwordx4 v[44:47], v30, s[32:35], s65 offen sc1
    v_fmac_f32 v6, v18, v19
    v_lshlrev_b32 v16, 16, v101
    v_and_b32 v18, 0xffff0000, v101
    v_fmac_f32 v7, v16, v17
    v_fmac_f32 v7, v18, v19
    s_add_u32 s60, s56, s52
    v_lshlrev_b32 v17, 16, v150
    v_and_b32 v19, 0xffff0000, v150
    v_lshlrev_b32 v16, 16, v74
    v_and_b32 v18, 0xffff0000, v74
    buffer_store_dwordx4 v[48:51], v30, s[32:35], s60 offen sc1
    v_fmac_f32 v6, v16, v17
    v_fmac_f32 v6, v18, v19
    v_lshlrev_b32 v16, 16, v102
    v_and_b32 v18, 0xffff0000, v102
    v_fmac_f32 v7, v16, v17
    s_add_u32 s61, s56, s53
    v_fmac_f32 v7, v18, v19
    v_lshlrev_b32 v17, 16, v151
    v_and_b32 v19, 0xffff0000, v151
    v_lshlrev_b32 v16, 16, v75
    buffer_store_dwordx4 v[52:55], v30, s[32:35], s61 offen sc1
    v_and_b32 v18, 0xffff0000, v75
    v_fmac_f32 v6, v16, v17
    v_fmac_f32 v6, v18, v19
    v_lshlrev_b32 v16, 16, v103
    v_and_b32 v18, 0xffff0000, v103
    s_add_u32 s64, s56, s54
    v_fmac_f32 v7, v16, v17
    v_fmac_f32 v7, v18, v19
    s_waitcnt vmcnt(34)
    v_lshlrev_b32 v17, 16, v156
    v_and_b32 v19, 0xffff0000, v156
    buffer_store_dwordx4 v[56:59], v30, s[32:35], s64 offen sc1
    s_waitcnt vmcnt(34)
    v_lshlrev_b32 v16, 16, v76
    v_and_b32 v18, 0xffff0000, v76
    v_fmac_f32 v6, v16, v17
    v_fmac_f32 v6, v18, v19
    s_waitcnt vmcnt(33)
    v_lshlrev_b32 v16, 16, v104
    s_add_u32 s65, s56, s55
    v_and_b32 v18, 0xffff0000, v104
    v_fmac_f32 v7, v16, v17
    v_fmac_f32 v7, v18, v19
    v_lshlrev_b32 v17, 16, v157
    buffer_store_dwordx4 v[60:63], v30, s[32:35], s65 offen sc1
    v_and_b32 v19, 0xffff0000, v157
    v_lshlrev_b32 v16, 16, v77
    v_and_b32 v18, 0xffff0000, v77
    v_fmac_f32 v6, v16, v17
    v_fmac_f32 v6, v18, v19
    s_add_u32 s60, s58, s48
    v_lshlrev_b32 v16, 16, v105
    v_and_b32 v18, 0xffff0000, v105
    v_fmac_f32 v7, v16, v17
    v_fmac_f32 v7, v18, v19
    buffer_store_dwordx4 v[128:131], v30, s[32:35], s60 offen sc1
    v_lshlrev_b32 v17, 16, v158
    v_and_b32 v19, 0xffff0000, v158
    v_lshlrev_b32 v16, 16, v78
    v_and_b32 v18, 0xffff0000, v78
    v_fmac_f32 v6, v16, v17
    s_add_u32 s61, s58, s49
    v_fmac_f32 v6, v18, v19
    v_lshlrev_b32 v16, 16, v106
    v_and_b32 v18, 0xffff0000, v106
    v_fmac_f32 v7, v16, v17
    v_fmac_f32 v7, v18, v19
    buffer_store_dwordx4 v[136:139], v30, s[32:35], s61 offen sc1
    v_lshlrev_b32 v17, 16, v159
    v_and_b32 v19, 0xffff0000, v159
    v_lshlrev_b32 v16, 16, v79
    v_and_b32 v18, 0xffff0000, v79
    s_add_u32 s64, s58, s50
    v_fmac_f32 v6, v16, v17
    v_fmac_f32 v6, v18, v19
    v_lshlrev_b32 v16, 16, v107
    v_and_b32 v18, 0xffff0000, v107
    v_fmac_f32 v7, v16, v17
    buffer_store_dwordx4 v[144:147], v30, s[32:35], s64 offen sc1
    v_fmac_f32 v7, v18, v19
    s_waitcnt vmcnt(36)
    v_lshlrev_b32 v17, 16, v164
    v_and_b32 v19, 0xffff0000, v164
    s_waitcnt vmcnt(35)
    v_lshlrev_b32 v16, 16, v80
    s_add_u32 s65, s58, s51
    v_and_b32 v18, 0xffff0000, v80
    v_fmac_f32 v6, v16, v17
    v_fmac_f32 v6, v18, v19
    s_waitcnt vmcnt(34)
    v_lshlrev_b32 v16, 16, v108
    v_and_b32 v18, 0xffff0000, v108
    buffer_store_dwordx4 v[152:155], v30, s[32:35], s65 offen sc1
    v_fmac_f32 v7, v16, v17
    v_fmac_f32 v7, v18, v19
    v_lshlrev_b32 v17, 16, v165
    v_and_b32 v19, 0xffff0000, v165
    s_add_u32 s60, s58, s52
    v_lshlrev_b32 v16, 16, v81
    v_and_b32 v18, 0xffff0000, v81
    v_fmac_f32 v6, v16, v17
    v_fmac_f32 v6, v18, v19
    v_lshlrev_b32 v16, 16, v109
    buffer_store_dwordx4 v[160:163], v30, s[32:35], s60 offen sc1
    v_and_b32 v18, 0xffff0000, v109
    v_fmac_f32 v7, v16, v17
    v_fmac_f32 v7, v18, v19
    v_lshlrev_b32 v17, 16, v166
    s_add_u32 s61, s58, s53
    v_and_b32 v19, 0xffff0000, v166
    v_lshlrev_b32 v16, 16, v82
    v_and_b32 v18, 0xffff0000, v82
    v_fmac_f32 v6, v16, v17
    v_fmac_f32 v6, v18, v19
    buffer_store_dwordx4 v[168:171], v30, s[32:35], s61 offen sc1
    v_lshlrev_b32 v16, 16, v110
    v_and_b32 v18, 0xffff0000, v110
    v_fmac_f32 v7, v16, v17
    v_fmac_f32 v7, v18, v19
    s_add_u32 s64, s58, s54
    v_lshlrev_b32 v17, 16, v167
    v_and_b32 v19, 0xffff0000, v167
    v_lshlrev_b32 v16, 16, v83
    v_and_b32 v18, 0xffff0000, v83
    v_fmac_f32 v6, v16, v17
    buffer_store_dwordx4 v[176:179], v30, s[32:35], s64 offen sc1
    v_fmac_f32 v6, v18, v19
    v_lshlrev_b32 v16, 16, v111
    v_and_b32 v18, 0xffff0000, v111
    v_fmac_f32 v7, v16, v17
    s_add_u32 s65, s58, s55
    v_fmac_f32 v7, v18, v19
    s_waitcnt vmcnt(37)
    v_lshlrev_b32 v17, 16, v172
    v_and_b32 v19, 0xffff0000, v172
    s_waitcnt vmcnt(36)
    v_lshlrev_b32 v16, 16, v84
    v_and_b32 v18, 0xffff0000, v84
    buffer_store_dwordx4 v[184:187], v30, s[32:35], s65 offen sc1
    v_fmac_f32 v6, v16, v17
    v_fmac_f32 v6, v18, v19
    s_waitcnt vmcnt(36)
    v_lshlrev_b32 v16, 16, v112
    v_and_b32 v18, 0xffff0000, v112
    s_add_u32 s60, s59, s48
    v_fmac_f32 v7, v16, v17
    v_fmac_f32 v7, v18, v19
    v_lshlrev_b32 v17, 16, v173
    v_and_b32 v19, 0xffff0000, v173
    v_lshlrev_b32 v16, 16, v85
    buffer_store_dwordx4 v[192:195], v30, s[32:35], s60 offen sc1
    v_and_b32 v18, 0xffff0000, v85
    v_fmac_f32 v6, v16, v17
    v_fmac_f32 v6, v18, v19
    v_lshlrev_b32 v16, 16, v113
    s_add_u32 s61, s59, s49
    v_and_b32 v18, 0xffff0000, v113
    v_fmac_f32 v7, v16, v17
    v_fmac_f32 v7, v18, v19
    v_lshlrev_b32 v17, 16, v174
    v_and_b32 v19, 0xffff0000, v174
    buffer_store_dwordx4 v[200:203], v30, s[32:35], s61 offen sc1
    v_lshlrev_b32 v16, 16, v86
    v_and_b32 v18, 0xffff0000, v86
    v_fmac_f32 v6, v16, v17
    v_fmac_f32 v6, v18, v19
    s_add_u32 s64, s59, s50
    v_lshlrev_b32 v16, 16, v114
    v_and_b32 v18, 0xffff0000, v114
    v_fmac_f32 v7, v16, v17
    v_fmac_f32 v7, v18, v19
    v_lshlrev_b32 v17, 16, v175
    buffer_store_dwordx4 v[208:211], v30, s[32:35], s64 offen sc1
    v_and_b32 v19, 0xffff0000, v175
    v_lshlrev_b32 v16, 16, v87
    v_and_b32 v18, 0xffff0000, v87
    v_fmac_f32 v6, v16, v17
    s_add_u32 s65, s59, s51
    v_fmac_f32 v6, v18, v19
    v_lshlrev_b32 v16, 16, v115
    v_and_b32 v18, 0xffff0000, v115
    v_fmac_f32 v7, v16, v17
    v_fmac_f32 v7, v18, v19
    buffer_store_dwordx4 v[216:219], v30, s[32:35], s65 offen sc1
    s_waitcnt vmcnt(39)
    v_lshlrev_b32 v17, 16, v180
    v_and_b32 v19, 0xffff0000, v180
    s_waitcnt vmcnt(38)
    v_lshlrev_b32 v16, 16, v88
    v_and_b32 v18, 0xffff0000, v88
    s_add_u32 s60, s59, s52
    v_fmac_f32 v6, v16, v17
    v_fmac_f32 v6, v18, v19
    s_waitcnt vmcnt(37)
    v_lshlrev_b32 v16, 16, v116
    v_and_b32 v18, 0xffff0000, v116
    v_fmac_f32 v7, v16, v17
    buffer_store_dwordx4 v[224:227], v30, s[32:35], s60 offen sc1
    v_fmac_f32 v7, v18, v19
    v_lshlrev_b32 v17, 16, v181
    v_and_b32 v19, 0xffff0000, v181
    v_lshlrev_b32 v16, 16, v89
    s_add_u32 s61, s59, s53
    v_and_b32 v18, 0xffff0000, v89
    v_fmac_f32 v6, v16, v17
    v_fmac_f32 v6, v18, v19
    v_lshlrev_b32 v16, 16, v117
    v_and_b32 v18, 0xffff0000, v117
    buffer_store_dwordx4 v[232:235], v30, s[32:35], s61 offen sc1
    v_fmac_f32 v7, v16, v17
    v_fmac_f32 v7, v18, v19
    v_lshlrev_b32 v17, 16, v182
    v_and_b32 v19, 0xffff0000, v182
    s_add_u32 s64, s59, s54
    v_lshlrev_b32 v16, 16, v90
    v_and_b32 v18, 0xffff0000, v90
    v_fmac_f32 v6, v16, v17
    v_fmac_f32 v6, v18, v19
    v_lshlrev_b32 v16, 16, v118
    buffer_store_dwordx4 v[240:243], v30, s[32:35], s64 offen sc1
    v_and_b32 v18, 0xffff0000, v118
    v_fmac_f32 v7, v16, v17
    v_fmac_f32 v7, v18, v19
    v_lshlrev_b32 v17, 16, v183
    s_add_u32 s65, s59, s55
    v_and_b32 v19, 0xffff0000, v183
    v_lshlrev_b32 v16, 16, v91
    v_and_b32 v18, 0xffff0000, v91
    v_fmac_f32 v6, v16, v17
    v_fmac_f32 v6, v18, v19
    buffer_store_dwordx4 v[248:251], v30, s[32:35], s65 offen sc1
    v_lshlrev_b32 v16, 16, v119
    v_and_b32 v18, 0xffff0000, v119
    v_fmac_f32 v7, v16, v17
    v_fmac_f32 v7, v18, v19
    s_waitcnt vmcnt(33)
    ds_read_b64_tr_b16 a[224:225], v0 offset:0
    ds_read_b64_tr_b16 a[226:227], v0 offset:4096
    ds_read_b64_tr_b16 a[228:229], v0 offset:32
    ds_read_b64_tr_b16 a[230:231], v0 offset:4128
    ds_read_b64_tr_b16 a[232:233], v0 offset:64
    ds_read_b64_tr_b16 a[234:235], v0 offset:4160
    ds_read_b64_tr_b16 a[236:237], v0 offset:96
    ds_read_b64_tr_b16 a[238:239], v0 offset:4192
    ds_read_b64_tr_b16 a[240:241], v0 offset:128
    ds_read_b64_tr_b16 a[242:243], v0 offset:4224
    ds_read_b64_tr_b16 a[244:245], v0 offset:160
    ds_read_b64_tr_b16 a[246:247], v0 offset:4256
    ds_read_b64_tr_b16 a[248:249], v0 offset:192
    ds_read_b64_tr_b16 a[250:251], v0 offset:4288
    s_waitcnt lgkmcnt(12)
    buffer_store_dwordx4 a[224:227], v1, s[32:35], s100 offen sc1
    s_add_u32 s100, s100, s101
    s_waitcnt lgkmcnt(10)
    buffer_store_dwordx4 a[228:231], v1, s[32:35], s100 offen sc1
    s_add_u32 s100, s100, s101
    s_waitcnt lgkmcnt(8)
    buffer_store_dwordx4 a[232:235], v1, s[32:35], s100 offen sc1
    s_add_u32 s100, s100, s101
    s_waitcnt lgkmcnt(6)
    buffer_store_dwordx4 a[236:239], v1, s[32:35], s100 offen sc1
    s_add_u32 s100, s100, s101
    s_waitcnt lgkmcnt(4)
    buffer_store_dwordx4 a[240:243], v1, s[32:35], s100 offen sc1
    s_add_u32 s100, s100, s101
    s_waitcnt lgkmcnt(2)
    buffer_store_dwordx4 a[244:247], v1, s[32:35], s100 offen sc1
    s_add_u32 s100, s100, s101
    s_waitcnt lgkmcnt(0)
    buffer_store_dwordx4 a[248:251], v1, s[32:35], s100 offen sc1
    s_add_u32 s100, s100, s101
    v_add_f32_dpp v6, v6, v6 quad_perm:[1,0,3,2] row_mask:0xf bank_mask:0xf
    s_nop 1
    v_add_f32_dpp v6, v6, v6 quad_perm:[2,3,0,1] row_mask:0xf bank_mask:0xf
    s_nop 1
    v_add_f32_dpp v6, v6, v6 row_half_mirror row_mask:0xf bank_mask:0xf
    v_mul_f32 v6, 0xbfb8aa3b, v6
    v_exp_f32 v6, v6
    s_nop 0
    v_add_f32 v6, 1.0, v6
    v_rcp_f32 v6, v6
    v_add_f32_dpp v7, v7, v7 quad_perm:[1,0,3,2] row_mask:0xf bank_mask:0xf
    s_nop 1
    v_add_f32_dpp v7, v7, v7 quad_perm:[2,3,0,1] row_mask:0xf bank_mask:0xf
    s_nop 1
    v_add_f32_dpp v7, v7, v7 row_half_mirror row_mask:0xf bank_mask:0xf
    v_mul_f32 v7, 0xbfb8aa3b, v7
    v_exp_f32 v7, v7
    s_nop 0
    v_add_f32 v7, 1.0, v7
    v_rcp_f32 v7, v7
    v_lshrrev_b32 v4, 3, v2
    v_lshlrev_b32 v4, 2, v4
    s_lshl_b32 s23, s3, 6
    s_add_u32 s23, s23, 70320128
    buffer_store_dword v6, v4, s[32:35], s23 offen
    buffer_store_dword v7, v4, s[32:35], s23 offen offset:32
    v_mov_b32 v6, 0
    v_mov_b32 v4, 0
    s_add_u32 s23, s23, 65536
    buffer_store_dword v6, v4, s[32:35], s23 offen
    v_lshlrev_b32 v4, 2, v2
    s_lshl_b32 s23, s3, 8
    s_add_u32 s23, s23, 70451200
    buffer_store_dword v6, v4, s[32:35], s23 offen
    s_add_u32 s23, s23, 32768
    buffer_store_dword v6, v4, s[32:35], s23 offen
    v_mov_b32 v12, 0
    v_mov_b32 v13, 0
    v_mov_b32 v14, 0
    v_mov_b32 v15, 0
    v_lshlrev_b32 v4, 4, v2
    s_lshl_b32 s23, s3, 10
    s_add_u32 s23, s23, 70647808
    buffer_store_dwordx4 v[12:15], v4, s[32:35], s23 offen
    s_endpgm
K1_END:
    s_endpgm
.globl attn_kernel
.p2align 8
.type attn_kernel,@function
attn_kernel:
    s_cmp_ge_u32 s2, 256
    s_cbranch_scc1 K2_END
    s_load_dwordx2 s[4:5], s[0:1], 96
    v_lshrrev_b32 v1, 6, v0
    v_and_b32 v2, 63, v0
    v_readfirstlane_b32 s20, v1
    v_lshlrev_b32 v8, 4, v2
    v_lshl_add_u32 v6, v1, 13, v8
    v_add_u32 v7, 4096, v6
    s_lshl_b32 s44, s20, 13
    s_and_b32 s3, s2, 7
    s_lshl_b32 s3, s3, 1
    s_bfe_u32 s21, s2, 0x10003
    s_add_u32 s21, s21, s3
    s_bfe_u32 s23, s2, 0x10004
    s_lshr_b32 s22, s2, 5
    s_lshl_b32 s46, s21, 3
    s_add_u32 s46, s46, s22
    s_lshl_b32 s7, s21, 20
    s_add_u32 s39, s7, 16777216
    s_add_u32 s40, s7, 33554432
    s_lshl_b32 s13, s22, 1
    s_sub_u32 s10, 32, s13
    s_min_u32 s11, s10, 18
    s_sub_u32 s12, s10, s11
    s_cmp_eq_u32 s23, 0
    s_cselect_b32 s12, 0, s12
    s_sub_u32 s8, 15, s22
    s_add_u32 s9, s13, 2
    s_cmp_eq_u32 s23, 0
    s_cselect_b32 s14, s8, s22
    s_cselect_b32 s37, s11, s9
    s_add_u32 s37, s37, s12
    s_cmp_eq_u32 s12, 0
    s_cselect_b32 s8, s14, s8
    s_cselect_b32 s47, 0, s11
    s_cselect_b32 s36, 0x1000, s12
    s_add_u32 s49, s36, s13
    s_lshl_b32 s9, s8, 1
    s_sub_u32 s41, s9, s47
    s_lshl_b32 s14, s47, 15
    s_add_u32 s32, s39, s14
    s_add_u32 s34, s40, s14
    s_mov_b32 s33, 0
    s_mov_b32 s35, 0
    s_lshl_b32 s15, s20, 14
    s_add_u32 s15, s15, s7
    s_lshl_b32 s14, s8, 16
    s_add_u32 s60, s15, s14
    s_lshl_b32 s14, s22, 16
    s_add_u32 s42, s15, s14
    s_lshl_b32 s14, s20, 5
    s_lshl_b32 s48, s22, 7
    s_add_u32 s48, s48, s14
    s_lshl_b32 s61, s8, 7
    s_add_u32 s61, s61, s14
    s_cmp_eq_u32 s23, 0
    s_cselect_b32 s14, s8, s22
    s_lshl_b32 s14, s14, 13
    s_lshl_b32 s45, s20, 11
    s_add_u32 s45, s45, s14
    s_lshl_b32 s14, s21, 20
    s_add_u32 s45, s45, s14
    s_add_u32 s45, s45, 50331648
    s_lshl_b32 s65, s21, 18
    s_add_u32 s65, s65, 96468992
    s_lshr_b32 s14, s21, 1
    s_mul_i32 s66, s14, 6144
    s_add_u32 s66, s66, 70254592
    s_lshl_b32 s67, s14, 18
    s_and_b32 s14, s45, 0x1ffff
    s_add_u32 s67, s67, s14
    s_add_u32 s67, s67, 67108864
    s_waitcnt lgkmcnt(0)
    s_mov_b32 s24, s4
    s_and_b32 s25, s5, 0xffff
    s_mov_b32 s26, 101711872
    s_mov_b32 s27, 0x20000
    s_mov_b32 s31, 0
    s_add_u32 m0, s31, s44
    s_nop 0
    buffer_load_dwordx4 v6, s[24:27], s32 offen offset:0 lds
    buffer_load_dwordx4 v6, s[24:27], s32 offen offset:1024 lds
    buffer_load_dwordx4 v6, s[24:27], s32 offen offset:2048 lds
    buffer_load_dwordx4 v6, s[24:27], s32 offen offset:3072 lds
    s_add_u32 m0, m0, 4096
    s_nop 0
    buffer_load_dwordx4 v7, s[24:27], s32 offen offset:0 lds
    buffer_load_dwordx4 v7, s[24:27], s32 offen offset:1024 lds
    buffer_load_dwordx4 v7, s[24:27], s32 offen offset:2048 lds
    buffer_load_dwordx4 v7, s[24:27], s32 offen offset:3072 lds
    s_add_u32 s33, s33, 1
    s_add_u32 s32, s32, 32768
    s_cmp_eq_u32 s33, s36
    s_cselect_b32 s32, s39, s32
    s_cmp_eq_u32 s33, s37
    s_cselect_b32 s32, s65, s32
    s_add_u32 s50, s60, 0
    v_xor_b32 v12, 16, v2
    v_lshlrev_b32 v12, 2, v12
    v_xor_b32 v13, 32, v2
    v_lshlrev_b32 v13, 2, v13
    v_lshrrev_b32 v3, 4, v2
    s_add_u32 s51, s60, 8192
    v_lshlrev_b32 v3, 2, v3
    v_and_b32 v11, 15, v2
    v_sub_u32 v11, v11, v3
    v_add_u32 v11, s61, v11
    v_mov_b32 v32, 0x3f803f80
    buffer_load_dwordx4 a[0:3], v8, s[24:27], s50 offen offset:0
    v_mov_b32 v33, 0x3f803f80
    v_mov_b32 v34, 0x3f803f80
    v_mov_b32 v35, 0x3f803f80
    v_mov_b32 v16, 0
    buffer_load_dwordx4 a[32:35], v8, s[24:27], s51 offen offset:0
    v_mov_b32 v17, 0
    v_mov_b32 v18, 0
    v_mov_b32 v19, 0
    v_mov_b32 v20, 0
    v_mov_b32 v21, 0
    buffer_load_dwordx4 a[4:7], v8, s[24:27], s50 offen offset:1024
    v_mov_b32 v22, 0
    v_mov_b32 v23, 0
    v_mov_b32 v9, v8
    v_mov_b32 v15, 0xff800000
    buffer_load_dwordx4 a[36:39], v8, s[24:27], s51 offen offset:1024
    v_mov_b64 v[128:129], 0
    v_mov_b64 v[130:131], 0
    v_mov_b64 v[132:133], 0
    v_mov_b64 v[134:135], 0
    v_mov_b64 v[136:137], 0
    buffer_load_dwordx4 a[8:11], v8, s[24:27], s50 offen offset:2048
    v_mov_b64 v[138:139], 0
    v_mov_b64 v[140:141], 0
    v_mov_b64 v[142:143], 0
    v_mov_b64 v[144:145], 0
    buffer_load_dwordx4 a[40:43], v8, s[24:27], s51 offen offset:2048
    v_mov_b64 v[146:147], 0
    v_mov_b64 v[148:149], 0
    v_mov_b64 v[150:151], 0
    v_mov_b64 v[152:153], 0
    v_mov_b64 v[154:155], 0
    buffer_load_dwordx4 a[12:15], v8, s[24:27], s50 offen offset:3072
    v_mov_b64 v[156:157], 0
    v_mov_b64 v[158:159], 0
    v_mov_b64 v[160:161], 0
    v_mov_b64 v[162:163], 0
    buffer_load_dwordx4 a[44:47], v8, s[24:27], s51 offen offset:3072
    v_mov_b64 v[164:165], 0
    v_mov_b64 v[166:167], 0
    v_mov_b64 v[168:169], 0
    v_mov_b64 v[170:171], 0
    v_mov_b64 v[172:173], 0
    s_add_u32 s50, s60, 4096
    v_mov_b64 v[174:175], 0
    v_mov_b64 v[176:177], 0
    v_mov_b64 v[178:179], 0
    v_mov_b64 v[180:181], 0
    v_mov_b64 v[182:183], 0
    s_add_u32 s51, s60, 12288
    v_mov_b64 v[184:185], 0
    v_mov_b64 v[186:187], 0
    v_mov_b64 v[188:189], 0
    v_mov_b64 v[190:191], 0
    buffer_load_dwordx4 a[16:19], v8, s[24:27], s50 offen offset:0
    v_mov_b64 v[192:193], 0
    v_mov_b64 v[194:195], 0
    v_mov_b64 v[196:197], 0
    v_mov_b64 v[198:199], 0
    v_mov_b64 v[200:201], 0
    buffer_load_dwordx4 a[48:51], v8, s[24:27], s51 offen offset:0
    v_mov_b64 v[202:203], 0
    v_mov_b64 v[204:205], 0
    v_mov_b64 v[206:207], 0
    v_mov_b64 v[208:209], 0
    buffer_load_dwordx4 a[20:23], v8, s[24:27], s50 offen offset:1024
    v_mov_b64 v[210:211], 0
    v_mov_b64 v[212:213], 0
    v_mov_b64 v[214:215], 0
    v_mov_b64 v[216:217], 0
    v_mov_b64 v[218:219], 0
    buffer_load_dwordx4 a[52:55], v8, s[24:27], s51 offen offset:1024
    v_mov_b64 v[220:221], 0
    v_mov_b64 v[222:223], 0
    v_mov_b64 v[224:225], 0
    v_mov_b64 v[226:227], 0
    buffer_load_dwordx4 a[24:27], v8, s[24:27], s50 offen offset:2048
    v_mov_b64 v[228:229], 0
    v_mov_b64 v[230:231], 0
    v_mov_b64 v[232:233], 0
    v_mov_b64 v[234:235], 0
    v_mov_b64 v[236:237], 0
    buffer_load_dwordx4 a[56:59], v8, s[24:27], s51 offen offset:2048
    v_mov_b64 v[238:239], 0
    v_mov_b64 v[240:241], 0
    v_mov_b64 v[242:243], 0
    v_mov_b64 v[244:245], 0
    buffer_load_dwordx4 a[28:31], v8, s[24:27], s50 offen offset:3072
    v_mov_b64 v[246:247], 0
    v_mov_b64 v[248:249], 0
    v_mov_b64 v[250:251], 0
    v_mov_b64 v[252:253], 0
    v_mov_b64 v[254:255], 0
    buffer_load_dwordx4 a[60:63], v8, s[24:27], s51 offen offset:3072
    v_mov_b64 v[24:25], 0
    v_mov_b64 v[26:27], 0
    v_mov_b64 v[28:29], 0
    v_mov_b64 v[30:31], 0
    s_cmp_gt_u32 s10, 18
    s_cselect_b32 s19, 1, 0
    s_cmp_eq_u32 s23, 0
    s_cselect_b32 s19, s19, 0
    s_lshl_b32 s100, s46, 6
    s_add_u32 s100, s100, 70385664
    s_mov_b32 s101, 0
    v_mov_b32 v1, 0
    s_mov_b32 s38, -1
    s_mov_b32 s43, 0xf149f2ca
    s_mov_b32 s29, 65536
    s_sub_u32 s16, s36, 2
    s_min_i32 s17, s36, s37
    s_min_i32 s17, s17, s41
    s_sub_u32 s17, s17, 1
    s_lshl_b32 s50, s19, 1
    s_sub_u32 s17, s17, s50
    s_mov_b32 s18, 0
    s_waitcnt vmcnt(16)
    s_barrier
    ds_read_b128 a[68:71], v9 offset:1024
    ds_read_b128 a[64:67], v9 offset:0
    ds_read_b128 a[76:79], v9 offset:9216
    ds_read_b128 a[72:75], v9 offset:8192
    ds_read_b128 a[84:87], v9 offset:17408
    ds_read_b128 a[80:83], v9 offset:16384
    ds_read_b128 a[92:95], v9 offset:25600
    ds_read_b128 a[88:91], v9 offset:24576
    s_waitcnt vmcnt(15) lgkmcnt(6)
    v_mfma_f32_16x16x32_bf16 v[72:75], a[64:67], a[0:3], v[16:19]
    s_mov_b32 s31, 32768
    ds_read_b128 a[100:103], v9 offset:3072
    s_waitcnt vmcnt(13)
    v_mfma_f32_16x16x32_bf16 v[72:75], a[68:71], a[4:7], v[72:75]
    s_add_u32 m0, s31, s44
    v_mfma_f32_16x16x32_bf16 v[76:79], a[64:67], a[32:35], v[20:23]
    s_waitcnt lgkmcnt(5)
    ds_read_b128 a[96:99], v9 offset:2048
    s_waitcnt vmcnt(12)
    v_mfma_f32_16x16x32_bf16 v[76:79], a[68:71], a[36:39], v[76:79]
    buffer_load_dwordx4 v6, s[24:27], s32 offen offset:0 lds
    v_mfma_f32_16x16x32_bf16 v[80:83], a[72:75], a[0:3], v[16:19]
    ds_read_b128 a[108:111], v9 offset:11264
    v_mfma_f32_16x16x32_bf16 v[80:83], a[76:79], a[4:7], v[80:83]
    buffer_load_dwordx4 v6, s[24:27], s32 offen offset:1024 lds
    v_mfma_f32_16x16x32_bf16 v[84:87], a[72:75], a[32:35], v[20:23]
    s_waitcnt lgkmcnt(5)
    ds_read_b128 a[104:107], v9 offset:10240
    v_mfma_f32_16x16x32_bf16 v[84:87], a[76:79], a[36:39], v[84:87]
    buffer_load_dwordx4 v6, s[24:27], s32 offen offset:2048 lds
    v_mfma_f32_16x16x32_bf16 v[88:91], a[80:83], a[0:3], v[16:19]
    ds_read_b128 a[116:119], v9 offset:19456
    v_mfma_f32_16x16x32_bf16 v[88:91], a[84:87], a[4:7], v[88:91]
    buffer_load_dwordx4 v6, s[24:27], s32 offen offset:3072 lds
    v_mfma_f32_16x16x32_bf16 v[92:95], a[80:83], a[32:35], v[20:23]
    s_waitcnt lgkmcnt(5)
    ds_read_b128 a[112:115], v9 offset:18432
    v_mfma_f32_16x16x32_bf16 v[92:95], a[84:87], a[36:39], v[92:95]
    s_add_u32 m0, m0, 4096
    v_mfma_f32_16x16x32_bf16 v[96:99], a[88:91], a[0:3], v[16:19]
    ds_read_b128 a[124:127], v9 offset:27648
    v_mfma_f32_16x16x32_bf16 v[96:99], a[92:95], a[4:7], v[96:99]
    buffer_load_dwordx4 v7, s[24:27], s32 offen offset:0 lds
    v_mfma_f32_16x16x32_bf16 v[100:103], a[88:91], a[32:35], v[20:23]
    s_waitcnt lgkmcnt(5)
    ds_read_b128 a[120:123], v9 offset:26624
    v_mfma_f32_16x16x32_bf16 v[100:103], a[92:95], a[36:39], v[100:103]
    buffer_load_dwordx4 v7, s[24:27], s32 offen offset:1024 lds
    s_waitcnt vmcnt(17)
    v_mfma_f32_16x16x32_bf16 v[72:75], a[96:99], a[8:11], v[72:75]
    ds_read_b128 a[68:71], v9 offset:5120
    s_waitcnt vmcnt(15)
    v_mfma_f32_16x16x32_bf16 v[72:75], a[100:103], a[12:15], v[72:75]
    buffer_load_dwordx4 v7, s[24:27], s32 offen offset:2048 lds
    v_mfma_f32_16x16x32_bf16 v[76:79], a[96:99], a[40:43], v[76:79]
    s_waitcnt lgkmcnt(5)
    ds_read_b128 a[64:67], v9 offset:4096
    s_waitcnt vmcnt(15)
    v_mfma_f32_16x16x32_bf16 v[76:79], a[100:103], a[44:47], v[76:79]
    buffer_load_dwordx4 v7, s[24:27], s32 offen offset:3072 lds
    v_mfma_f32_16x16x32_bf16 v[80:83], a[104:107], a[8:11], v[80:83]
    s_add_u32 s33, s33, 1
    ds_read_b128 a[76:79], v9 offset:13312
    v_mfma_f32_16x16x32_bf16 v[80:83], a[108:111], a[12:15], v[80:83]
    v_mfma_f32_16x16x32_bf16 v[84:87], a[104:107], a[40:43], v[84:87]
    s_waitcnt lgkmcnt(5)
    s_add_u32 s32, s32, 32768
    ds_read_b128 a[72:75], v9 offset:12288
    v_mfma_f32_16x16x32_bf16 v[84:87], a[108:111], a[44:47], v[84:87]
    v_mfma_f32_16x16x32_bf16 v[88:91], a[112:115], a[8:11], v[88:91]
    s_cmp_eq_u32 s33, s36
    ds_read_b128 a[84:87], v9 offset:21504
    v_mfma_f32_16x16x32_bf16 v[88:91], a[116:119], a[12:15], v[88:91]
    v_mfma_f32_16x16x32_bf16 v[92:95], a[112:115], a[40:43], v[92:95]
    s_waitcnt lgkmcnt(5)
    s_cselect_b32 s32, s39, s32
    ds_read_b128 a[80:83], v9 offset:20480
    v_mfma_f32_16x16x32_bf16 v[92:95], a[116:119], a[44:47], v[92:95]
    v_mfma_f32_16x16x32_bf16 v[96:99], a[120:123], a[8:11], v[96:99]
    s_cmp_eq_u32 s33, s37
    ds_read_b128 a[92:95], v9 offset:29696
    v_mfma_f32_16x16x32_bf16 v[96:99], a[124:127], a[12:15], v[96:99]
    v_mfma_f32_16x16x32_bf16 v[100:103], a[120:123], a[40:43], v[100:103]
    s_waitcnt lgkmcnt(5)
    s_cselect_b32 s32, s65, s32
    ds_read_b128 a[88:91], v9 offset:28672
    v_mfma_f32_16x16x32_bf16 v[100:103], a[124:127], a[44:47], v[100:103]
    s_mov_b32 s30, 65536
    s_waitcnt vmcnt(15)
    v_mfma_f32_16x16x32_bf16 v[72:75], a[64:67], a[16:19], v[72:75]
    ds_read_b128 a[100:103], v9 offset:7168
    s_waitcnt vmcnt(13)
    v_mfma_f32_16x16x32_bf16 v[72:75], a[68:71], a[20:23], v[72:75]
    s_add_u32 m0, s30, s44
    v_mfma_f32_16x16x32_bf16 v[76:79], a[64:67], a[48:51], v[76:79]
    s_waitcnt lgkmcnt(5)
    ds_read_b128 a[96:99], v9 offset:6144
    s_waitcnt vmcnt(12)
    v_mfma_f32_16x16x32_bf16 v[76:79], a[68:71], a[52:55], v[76:79]
    buffer_load_dwordx4 v6, s[24:27], s34 offen offset:0 lds
    v_mfma_f32_16x16x32_bf16 v[80:83], a[72:75], a[16:19], v[80:83]
    ds_read_b128 a[108:111], v9 offset:15360
    v_mfma_f32_16x16x32_bf16 v[80:83], a[76:79], a[20:23], v[80:83]
    buffer_load_dwordx4 v6, s[24:27], s34 offen offset:1024 lds
    v_mfma_f32_16x16x32_bf16 v[84:87], a[72:75], a[48:51], v[84:87]
    s_waitcnt lgkmcnt(5)
    ds_read_b128 a[104:107], v9 offset:14336
    v_mfma_f32_16x16x32_bf16 v[84:87], a[76:79], a[52:55], v[84:87]
    buffer_load_dwordx4 v6, s[24:27], s34 offen offset:2048 lds
    v_mfma_f32_16x16x32_bf16 v[88:91], a[80:83], a[16:19], v[88:91]
    ds_read_b128 a[116:119], v9 offset:23552
    v_mfma_f32_16x16x32_bf16 v[88:91], a[84:87], a[20:23], v[88:91]
    buffer_load_dwordx4 v6, s[24:27], s34 offen offset:3072 lds
    v_mfma_f32_16x16x32_bf16 v[92:95], a[80:83], a[48:51], v[92:95]
    s_waitcnt lgkmcnt(5)
    ds_read_b128 a[112:115], v9 offset:22528
    v_mfma_f32_16x16x32_bf16 v[92:95], a[84:87], a[52:55], v[92:95]
    s_add_u32 m0, m0, 4096
    v_mfma_f32_16x16x32_bf16 v[96:99], a[88:91], a[16:19], v[96:99]
    ds_read_b128 a[124:127], v9 offset:31744
    v_mfma_f32_16x16x32_bf16 v[96:99], a[92:95], a[20:23], v[96:99]
    buffer_load_dwordx4 v7, s[24:27], s34 offen offset:0 lds
    v_mfma_f32_16x16x32_bf16 v[100:103], a[88:91], a[48:51], v[100:103]
    s_waitcnt lgkmcnt(5)
    ds_read_b128 a[120:123], v9 offset:30720
    v_mfma_f32_16x16x32_bf16 v[100:103], a[92:95], a[52:55], v[100:103]
    buffer_load_dwordx4 v7, s[24:27], s34 offen offset:1024 lds
    s_waitcnt vmcnt(17)
    v_mfma_f32_16x16x32_bf16 v[72:75], a[96:99], a[24:27], v[72:75]
    buffer_load_dwordx4 v7, s[24:27], s34 offen offset:2048 lds
    s_waitcnt vmcnt(16)
    v_mfma_f32_16x16x32_bf16 v[72:75], a[100:103], a[28:31], v[72:75]
    v_mfma_f32_16x16x32_bf16 v[76:79], a[96:99], a[56:59], v[76:79]
    s_waitcnt lgkmcnt(4)
    s_waitcnt vmcnt(15)
    v_mfma_f32_16x16x32_bf16 v[76:79], a[100:103], a[60:63], v[76:79]
    buffer_load_dwordx4 v7, s[24:27], s34 offen offset:3072 lds
    v_mfma_f32_16x16x32_bf16 v[80:83], a[104:107], a[24:27], v[80:83]
    s_add_u32 s35, s35, 1
    v_mfma_f32_16x16x32_bf16 v[80:83], a[108:111], a[28:31], v[80:83]
    v_mfma_f32_16x16x32_bf16 v[84:87], a[104:107], a[56:59], v[84:87]
    s_waitcnt lgkmcnt(2)
    s_add_u32 s34, s34, 32768
    v_mfma_f32_16x16x32_bf16 v[84:87], a[108:111], a[60:63], v[84:87]
    v_mfma_f32_16x16x32_bf16 v[88:91], a[112:115], a[24:27], v[88:91]
    s_cmp_eq_u32 s35, s36
    v_mfma_f32_16x16x32_bf16 v[88:91], a[116:119], a[28:31], v[88:91]
    v_mfma_f32_16x16x32_bf16 v[92:95], a[112:115], a[56:59], v[92:95]
    s_waitcnt lgkmcnt(0)
    s_cselect_b32 s34, s40, s34
    v_mfma_f32_16x16x32_bf16 v[92:95], a[116:119], a[60:63], v[92:95]
    v_mfma_f32_16x16x32_bf16 v[96:99], a[120:123], a[24:27], v[96:99]
    s_cmp_eq_u32 s35, s37
    v_mfma_f32_16x16x32_bf16 v[96:99], a[124:127], a[28:31], v[96:99]
    v_mfma_f32_16x16x32_bf16 v[100:103], a[120:123], a[56:59], v[100:103]
    s_cselect_b32 s34, s65, s34
    v_mfma_f32_16x16x32_bf16 v[100:103], a[124:127], a[60:63], v[100:103]
    s_cmp_le_i32 s41, 0
    s_cbranch_scc1 K2P_MASK
K2P_MASKR:
    s_mov_b32 s28, 32768
    s_mov_b32 s30, 131072
    v_add_u32 v9, s28, v8
    s_mov_b32 s31, 98304
    s_add_u32 m0, s31, s44
    s_nop 4
    v_max3_f32 v120, v72, v73, v74
    v_max3_f32 v120, v120, v75, v80
    v_max3_f32 v120, v120, v81, v82
    v_max3_f32 v120, v120, v83, v88
    v_max3_f32 v120, v120, v89, v90
    v_max3_f32 v120, v120, v91, v96
    v_max3_f32 v120, v120, v97, v98
    buffer_load_dwordx4 v6, s[24:27], s32 offen offset:0 lds
    v_max_f32 v120, v120, v99
    v_max3_f32 v121, v76, v77, v78
    v_max3_f32 v121, v121, v79, v84
    v_max3_f32 v121, v121, v85, v86
    v_max3_f32 v121, v121, v87, v92
    v_max3_f32 v121, v121, v93, v94
    v_max3_f32 v121, v121, v95, v100
    buffer_load_dwordx4 v6, s[24:27], s32 offen offset:1024 lds
    v_max3_f32 v121, v121, v101, v102
    v_max_f32 v121, v121, v103
    ds_bpermute_b32 v122, v12, v120
    ds_bpermute_b32 v123, v12, v121
    s_waitcnt lgkmcnt(1)
    v_max_f32 v120, v120, v122
    s_waitcnt lgkmcnt(0)
    v_max_f32 v121, v121, v123
    ds_bpermute_b32 v122, v13, v120
    ds_bpermute_b32 v123, v13, v121
    buffer_load_dwordx4 v6, s[24:27], s32 offen offset:2048 lds
    s_waitcnt lgkmcnt(1)
    v_max_f32 v120, v120, v122
    s_waitcnt lgkmcnt(0)
    v_max_f32 v121, v121, v123
    v_add_f32 v120, 0x40e00000, v120
    v_max_f32 v120, s43, v120
    v_sub_f32 v16, v16, v120
    v_sub_f32 v17, v17, v120
    v_sub_f32 v18, v18, v120
    buffer_load_dwordx4 v6, s[24:27], s32 offen offset:3072 lds
    v_sub_f32 v19, v19, v120
    v_sub_f32 v72, v72, v120
    v_sub_f32 v73, v73, v120
    v_sub_f32 v74, v74, v120
    v_sub_f32 v75, v75, v120
    v_sub_f32 v80, v80, v120
    v_sub_f32 v81, v81, v120
    s_add_u32 m0, m0, 4096
    v_sub_f32 v82, v82, v120
    v_sub_f32 v83, v83, v120
    v_sub_f32 v88, v88, v120
    v_sub_f32 v89, v89, v120
    v_sub_f32 v90, v90, v120
    v_sub_f32 v91, v91, v120
    v_sub_f32 v96, v96, v120
    v_sub_f32 v97, v97, v120
    buffer_load_dwordx4 v7, s[24:27], s32 offen offset:0 lds
    v_sub_f32 v98, v98, v120
    v_sub_f32 v99, v99, v120
    v_add_f32 v121, 0x40e00000, v121
    v_max_f32 v121, s43, v121
    v_sub_f32 v20, v20, v121
    v_sub_f32 v21, v21, v121
    v_sub_f32 v22, v22, v121
    buffer_load_dwordx4 v7, s[24:27], s32 offen offset:1024 lds
    v_sub_f32 v23, v23, v121
    v_sub_f32 v76, v76, v121
    v_sub_f32 v77, v77, v121
    v_sub_f32 v78, v78, v121
    v_sub_f32 v79, v79, v121
    v_sub_f32 v84, v84, v121
    v_sub_f32 v85, v85, v121
    buffer_load_dwordx4 v7, s[24:27], s32 offen offset:2048 lds
    v_sub_f32 v86, v86, v121
    v_sub_f32 v87, v87, v121
    v_sub_f32 v92, v92, v121
    v_sub_f32 v93, v93, v121
    v_sub_f32 v94, v94, v121
    v_sub_f32 v95, v95, v121
    v_sub_f32 v100, v100, v121
    v_sub_f32 v101, v101, v121
    buffer_load_dwordx4 v7, s[24:27], s32 offen offset:3072 lds
    v_sub_f32 v102, v102, v121
    v_sub_f32 v103, v103, v121
    v_exp_f32 v40, v72
    v_exp_f32 v41, v73
    v_exp_f32 v42, v74
    v_exp_f32 v43, v75
    v_cvt_pk_bf16_f32 v56, v40, v41
    s_add_u32 s33, s33, 1
    v_exp_f32 v44, v76
    v_exp_f32 v45, v77
    v_cvt_pk_bf16_f32 v57, v42, v43
    v_exp_f32 v46, v78
    v_exp_f32 v47, v79
    v_cvt_pk_bf16_f32 v60, v44, v45
    v_exp_f32 v48, v80
    v_exp_f32 v49, v81
    s_add_u32 s32, s32, 32768
    v_cvt_pk_bf16_f32 v61, v46, v47
    v_exp_f32 v50, v82
    v_exp_f32 v51, v83
    v_cvt_pk_bf16_f32 v58, v48, v49
    v_exp_f32 v52, v84
    v_exp_f32 v53, v85
    v_cvt_pk_bf16_f32 v59, v50, v51
    s_cmp_eq_u32 s33, s36
    v_exp_f32 v54, v86
    v_exp_f32 v55, v87
    v_cvt_pk_bf16_f32 v62, v52, v53
    v_exp_f32 v40, v88
    v_exp_f32 v41, v89
    v_cvt_pk_bf16_f32 v63, v54, v55
    v_exp_f32 v42, v90
    s_cselect_b32 s32, s39, s32
    v_exp_f32 v43, v91
    v_cvt_pk_bf16_f32 v64, v40, v41
    v_exp_f32 v44, v92
    v_exp_f32 v45, v93
    v_cvt_pk_bf16_f32 v65, v42, v43
    v_exp_f32 v46, v94
    v_exp_f32 v47, v95
    v_cvt_pk_bf16_f32 v68, v44, v45
    s_cmp_eq_u32 s33, s37
    v_exp_f32 v48, v96
    v_exp_f32 v49, v97
    v_cvt_pk_bf16_f32 v69, v46, v47
    v_exp_f32 v50, v98
    v_exp_f32 v51, v99
    v_cvt_pk_bf16_f32 v66, v48, v49
    v_exp_f32 v52, v100
    s_cselect_b32 s32, s65, s32
    v_exp_f32 v53, v101
    v_cvt_pk_bf16_f32 v67, v50, v51
    v_exp_f32 v54, v102
    v_exp_f32 v55, v103
    v_cvt_pk_bf16_f32 v70, v52, v53
    v_cvt_pk_bf16_f32 v71, v54, v55
    s_nop 4
    s_mov_b32 s31, 0
    s_waitcnt vmcnt(16)
    s_barrier
    ds_read_b128 a[68:71], v9 offset:1024
    ds_read_b128 a[64:67], v9 offset:0
    ds_read_b128 a[76:79], v9 offset:3072
    ds_read_b128 a[72:75], v9 offset:2048
    ds_read_b128 a[84:87], v9 offset:5120
    ds_read_b128 a[80:83], v9 offset:4096
    ds_read_b128 a[92:95], v9 offset:7168
    ds_read_b128 a[88:91], v9 offset:6144
    s_waitcnt lgkmcnt(6)
    s_mov_b32 s43, 0
    s_mov_b32 s38, 0
    s_cmp_eq_u32 s36, 1
    s_cbranch_scc1 K2P_SEG2
    s_branch K2_NEXT
K2_HB:
    s_cmp_eq_u32 s38, s36
    s_cbranch_scc1 K2_SEGEND
    s_mov_b32 s18, 1
    s_cbranch_vccnz K2_RARE
    s_mov_b32 s18, 0
K2_HB2:
    s_add_u32 s50, s38, 1
    s_cmp_eq_u32 s50, s36
    s_cbranch_scc1 K2_SEG2
    s_sub_u32 s50, s38, 1
    s_cmp_eq_u32 s50, s36
    s_cbranch_scc1 K2_PUBLISH
K2_NEXT:
    s_add_u32 s50, s38, 1
    s_cmp_ge_u32 s50, s37
    s_cbranch_scc1 K2_FINAL
    s_cmp_ge_i32 s50, s41
    s_cbranch_scc1 K2_LOOPM
    s_cmp_lg_u32 s67, 0
    s_cbranch_scc1 K2_LOOPX
    s_cmp_eq_u32 s19, 0
    s_cbranch_scc1 K2_LOOP
    s_add_u32 s50, s38, 3
    s_cmp_lt_u32 s50, s37
    s_cbranch_scc1 K2_LOOP
    s_cmp_gt_u32 s50, s37
    s_cbranch_scc1 K2_EARLY
    buffer_load_dword v0, v1, s[24:27], s100 offen sc1
    s_branch K2_LOOP
K2_EARLY:
    s_waitcnt vmcnt(16)
    s_waitcnt vmcnt(0)
    v_readfirstlane_b32 s101, v0
    s_nop 0
    s_cmp_eq_u32 s101, 0
    s_cbranch_scc1 K2_LOOP
    s_branch K2_LOOPY
K2_SEG2:
    s_nop 7
    s_waitcnt vmcnt(6)
    v_mov_b32 v36, v16
    v_mov_b32 v16, 0
    v_mov_b32 v17, 0
    v_mov_b32 v18, 0
    v_mov_b32 v19, 0
    v_mov_b32 v37, v20
    v_mov_b32 v20, 0
    v_mov_b32 v21, 0
    v_mov_b32 v22, 0
    v_mov_b32 v23, 0
    s_sub_u32 s47, 0, s36
    s_mov_b32 s41, s49
    v_lshrrev_b32 v120, 4, v2
    v_lshlrev_b32 v120, 2, v120
    v_and_b32 v11, 15, v2
    v_sub_u32 v11, v11, v120
    v_add_u32 v11, s48, v11
    s_nop 4
    s_branch K2_NEXT
K2_PUBLISH:
    s_sub_u32 s17, s41, 1
    s_waitcnt vmcnt(16)
    s_barrier
    s_cmp_lg_u32 s20, 0
    s_cbranch_scc1 K2_NEXT
    s_lshl_b32 s51, s46, 6
    s_add_u32 s51, s51, 70385664
    v_min_u32 v3, 1, v2
    v_lshlrev_b32 v3, 30, v3
    v_mov_b32 v4, 1
    buffer_store_dword v4, v3, s[24:27], s51 offen sc1
    s_branch K2_NEXT
.p2align 6
K2_LOOPX:
    s_add_u32 s4, s67, 0
    s_add_u32 s5, s67, 131072
    s_mov_b32 s67, 0
    v_add_u32 v3, 4096, v8
    v_mfma_f32_16x16x32_bf16 v[72:75], a[64:67], a[0:3], v[16:19]
    s_add_u32 m0, s30, s44
    ds_read_b128 a[100:103], v9 offset:9216
    v_mov_b32 v104, v56
    v_mfma_f32_16x16x32_bf16 v[72:75], a[68:71], a[4:7], v[72:75]
    buffer_load_dwordx4 v6, s[24:27], s34 offen offset:0 lds
    v_mfma_f32_16x16x32_bf16 v[76:79], a[64:67], a[32:35], v[20:23]
    ds_read_b128 a[96:99], v9 offset:8192
    v_mov_b32 v105, v57
    v_mfma_f32_16x16x32_bf16 v[76:79], a[68:71], a[36:39], v[76:79]
    s_waitcnt lgkmcnt(6)
    v_mfma_f32_16x16x32_bf16 v[76:79], a[72:75], a[40:43], v[76:79]
    ds_read_b128 a[108:111], v9 offset:11264
    v_mov_b32 v108, v60
    v_mfma_f32_16x16x32_bf16 v[76:79], a[76:79], a[44:47], v[76:79]
    buffer_load_dwordx4 a[128:131], v8, s[24:27], s66 offen offset:0
    v_mfma_f32_16x16x32_bf16 v[72:75], a[76:79], a[12:15], v[72:75]
    s_waitcnt lgkmcnt(5)
    ds_read_b128 a[104:107], v9 offset:10240
    v_mov_b32 v109, v61
    v_mfma_f32_16x16x32_bf16 v[72:75], a[72:75], a[8:11], v[72:75]
    buffer_load_dwordx4 v6, s[24:27], s34 offen offset:1024 lds
    v_mfma_f32_16x16x32_bf16 v[72:75], a[80:83], a[16:19], v[72:75]
    ds_read_b128 a[116:119], v9 offset:13312
    v_mov_b32 v106, v58
    v_mfma_f32_16x16x32_bf16 v[72:75], a[84:87], a[20:23], v[72:75]
    v_mfma_f32_16x16x32_bf16 v[76:79], a[84:87], a[52:55], v[76:79]
    ds_read_b128 a[112:115], v9 offset:12288
    v_mov_b32 v107, v59
    v_mfma_f32_16x16x32_bf16 v[76:79], a[80:83], a[48:51], v[76:79]
    s_waitcnt lgkmcnt(6)
    v_mfma_f32_16x16x32_bf16 v[76:79], a[88:91], a[56:59], v[76:79]
    ds_read_b128 a[124:127], v9 offset:15360
    v_mov_b32 v110, v62
    v_mfma_f32_16x16x32_bf16 v[76:79], a[92:95], a[60:63], v[76:79]
    buffer_load_dwordx4 v6, s[24:27], s34 offen offset:2048 lds
    v_mfma_f32_16x16x32_bf16 v[72:75], a[92:95], a[28:31], v[72:75]
    ds_read_b128 a[120:123], v9 offset:14336
    v_mov_b32 v111, v63
    v_mfma_f32_16x16x32_bf16 v[72:75], a[88:91], a[24:27], v[72:75]
    s_waitcnt lgkmcnt(6)
    v_mfma_f32_16x16x32_bf16 v[80:83], a[96:99], a[0:3], v[16:19]
    ds_read_b128 a[68:71], v9 offset:17408
    v_mov_b32 v112, v64
    v_mfma_f32_16x16x32_bf16 v[80:83], a[100:103], a[4:7], v[80:83]
    buffer_load_dwordx4 a[132:135], v8, s[24:27], s66 offen offset:1024
    v_mfma_f32_16x16x32_bf16 v[84:87], a[96:99], a[32:35], v[20:23]
    s_waitcnt lgkmcnt(5)
    ds_read_b128 a[64:67], v9 offset:16384
    v_mov_b32 v113, v65
    v_mfma_f32_16x16x32_bf16 v[84:87], a[100:103], a[36:39], v[84:87]
    buffer_load_dwordx4 v6, s[24:27], s34 offen offset:3072 lds
    v_mfma_f32_16x16x32_bf16 v[84:87], a[104:107], a[40:43], v[84:87]
    s_add_u32 m0, m0, 4096
    ds_read_b128 a[76:79], v9 offset:19456
    v_mov_b32 v116, v68
    v_mfma_f32_16x16x32_bf16 v[84:87], a[108:111], a[44:47], v[84:87]
    v_exp_f32 v40, v72
    v_mfma_f32_16x16x32_bf16 v[80:83], a[108:111], a[12:15], v[80:83]
    ds_read_b128 a[72:75], v9 offset:18432
    v_mov_b32 v117, v69
    v_mfma_f32_16x16x32_bf16 v[80:83], a[104:107], a[8:11], v[80:83]
    s_waitcnt lgkmcnt(6)
    v_exp_f32 v41, v73
    v_mfma_f32_16x16x32_bf16 v[80:83], a[112:115], a[16:19], v[80:83]
    ds_read_b128 a[84:87], v9 offset:21504
    v_mov_b32 v114, v66
    v_mfma_f32_16x16x32_bf16 v[80:83], a[116:119], a[20:23], v[80:83]
    buffer_load_dwordx4 v7, s[24:27], s34 offen offset:0 lds
    v_mfma_f32_16x16x32_bf16 v[84:87], a[116:119], a[52:55], v[84:87]
    ds_read_b128 a[80:83], v9 offset:20480
    v_mov_b32 v115, v67
    v_mfma_f32_16x16x32_bf16 v[84:87], a[112:115], a[48:51], v[84:87]
    s_waitcnt lgkmcnt(6)
    v_exp_f32 v42, v74
    v_mfma_f32_16x16x32_bf16 v[84:87], a[120:123], a[56:59], v[84:87]
    ds_read_b128 a[92:95], v9 offset:23552
    v_mov_b32 v118, v70
    v_mfma_f32_16x16x32_bf16 v[84:87], a[124:127], a[60:63], v[84:87]
    buffer_load_dwordx4 a[136:139], v8, s[24:27], s66 offen offset:2048
    v_mfma_f32_16x16x32_bf16 v[80:83], a[124:127], a[28:31], v[80:83]
    s_waitcnt lgkmcnt(5)
    ds_read_b128 a[88:91], v9 offset:22528
    v_mov_b32 v119, v71
    v_mfma_f32_16x16x32_bf16 v[80:83], a[120:123], a[24:27], v[80:83]
    buffer_load_dwordx4 v7, s[24:27], s34 offen offset:1024 lds
    v_mfma_f32_16x16x32_bf16 v[88:91], a[64:67], a[0:3], v[16:19]
    ds_read_b128 a[100:103], v9 offset:25600
    v_add_u32 v10, s29, v8
    v_mfma_f32_16x16x32_bf16 v[88:91], a[68:71], a[4:7], v[88:91]
    v_exp_f32 v43, v75
    v_mfma_f32_16x16x32_bf16 v[92:95], a[64:67], a[32:35], v[20:23]
    ds_read_b128 a[96:99], v9 offset:24576
    v_cvt_pk_bf16_f32 v56, v40, v41
    v_mfma_f32_16x16x32_bf16 v[92:95], a[68:71], a[36:39], v[92:95]
    s_waitcnt lgkmcnt(6)
    v_exp_f32 v44, v76
    v_mfma_f32_16x16x32_bf16 v[92:95], a[72:75], a[40:43], v[92:95]
    ds_read_b128 a[108:111], v9 offset:27648
    v_cvt_pk_bf16_f32 v57, v42, v43
    v_mfma_f32_16x16x32_bf16 v[92:95], a[76:79], a[44:47], v[92:95]
    buffer_load_dwordx4 v7, s[24:27], s34 offen offset:2048 lds
    v_mfma_f32_16x16x32_bf16 v[88:91], a[76:79], a[12:15], v[88:91]
    ds_read_b128 a[104:107], v9 offset:26624
    v_or_b32 v14, v56, v57
    v_mfma_f32_16x16x32_bf16 v[88:91], a[72:75], a[8:11], v[88:91]
    s_waitcnt lgkmcnt(6)
    v_exp_f32 v45, v77
    v_mfma_f32_16x16x32_bf16 v[88:91], a[80:83], a[16:19], v[88:91]
    ds_read_b128 a[116:119], v9 offset:29696
    v_cvt_pk_bf16_f32 v60, v44, v45
    v_mfma_f32_16x16x32_bf16 v[88:91], a[84:87], a[20:23], v[88:91]
    buffer_load_dwordx4 a[140:143], v8, s[24:27], s66 offen offset:3072
    v_mfma_f32_16x16x32_bf16 v[92:95], a[84:87], a[52:55], v[92:95]
    s_waitcnt lgkmcnt(5)
    ds_read_b128 a[112:115], v9 offset:28672
    v_mfma_f32_16x16x32_bf16 v[92:95], a[80:83], a[48:51], v[92:95]
    buffer_load_dwordx4 v7, s[24:27], s34 offen offset:3072 lds
    v_mfma_f32_16x16x32_bf16 v[92:95], a[88:91], a[56:59], v[92:95]
    s_add_u32 m0, s31, s44
    ds_read_b128 a[124:127], v9 offset:31744
    v_mfma_f32_16x16x32_bf16 v[92:95], a[92:95], a[60:63], v[92:95]
    s_waitcnt lgkmcnt(5)
    v_exp_f32 v46, v78
    v_mfma_f32_16x16x32_bf16 v[88:91], a[92:95], a[28:31], v[88:91]
    s_waitcnt vmcnt(20)
    ds_read_b128 a[120:123], v9 offset:30720
    v_mfma_f32_16x16x32_bf16 v[88:91], a[88:91], a[24:27], v[88:91]
    s_barrier
    v_exp_f32 v47, v79
    v_mfma_f32_16x16x32_bf16 v[96:99], a[96:99], a[0:3], v[16:19]
    s_add_u32 s35, s35, 1
    ds_read_b128 a[68:71], v10 offset:16384
    v_cvt_pk_bf16_f32 v61, v46, v47
    v_mfma_f32_16x16x32_bf16 v[96:99], a[100:103], a[4:7], v[96:99]
    s_add_u32 s34, s34, 32768
    v_exp_f32 v48, v80
    v_mfma_f32_16x16x32_bf16 v[100:103], a[96:99], a[32:35], v[20:23]
    s_cmp_eq_u32 s35, s36
    ds_read_b128 a[64:67], v10 offset:0
    v_or3_b32 v14, v60, v61, v14
    v_mfma_f32_16x16x32_bf16 v[100:103], a[100:103], a[36:39], v[100:103]
    s_waitcnt lgkmcnt(6)
    v_exp_f32 v49, v81
    v_mfma_f32_16x16x32_bf16 v[100:103], a[104:107], a[40:43], v[100:103]
    s_cselect_b32 s34, s40, s34
    ds_read_b128 a[76:79], v10 offset:17408
    v_cvt_pk_bf16_f32 v58, v48, v49
    v_mfma_f32_16x16x32_bf16 v[100:103], a[108:111], a[44:47], v[100:103]
    buffer_load_dwordx4 v6, s[24:27], s32 offen offset:0 lds
    v_mfma_f32_16x16x32_bf16 v[96:99], a[108:111], a[12:15], v[96:99]
    s_cmp_eq_u32 s35, s37
    ds_read_b128 a[72:75], v10 offset:1024
    v_mfma_f32_16x16x32_bf16 v[96:99], a[104:107], a[8:11], v[96:99]
    s_waitcnt lgkmcnt(6)
    v_exp_f32 v50, v82
    v_mfma_f32_16x16x32_bf16 v[96:99], a[112:115], a[16:19], v[96:99]
    s_cselect_b32 s34, s65, s34
    ds_read_b128 a[84:87], v10 offset:18432
    v_mfma_f32_16x16x32_bf16 v[96:99], a[116:119], a[20:23], v[96:99]
    buffer_load_dwordx4 a[144:147], v3, s[24:27], s66 offen offset:0
    v_mfma_f32_16x16x32_bf16 v[100:103], a[116:119], a[52:55], v[100:103]
    ds_read_b128 a[80:83], v10 offset:2048
    v_mfma_f32_16x16x32_bf16 v[100:103], a[112:115], a[48:51], v[100:103]
    s_waitcnt lgkmcnt(6)
    v_exp_f32 v51, v83
    v_mfma_f32_16x16x32_bf16 v[100:103], a[120:123], a[56:59], v[100:103]
    ds_read_b128 a[92:95], v10 offset:19456
    v_cvt_pk_bf16_f32 v59, v50, v51
    v_mfma_f32_16x16x32_bf16 v[100:103], a[124:127], a[60:63], v[100:103]
    buffer_load_dwordx4 v6, s[24:27], s32 offen offset:1024 lds
    v_mfma_f32_16x16x32_bf16 v[96:99], a[124:127], a[28:31], v[96:99]
    ds_read_b128 a[88:91], v10 offset:3072
    v_or3_b32 v14, v58, v59, v14
    v_mfma_f32_16x16x32_bf16 v[96:99], a[120:123], a[24:27], v[96:99]
    s_waitcnt lgkmcnt(6)
    v_exp_f32 v52, v84
    v_mfma_f32_16x16x32_bf16 v[128:131], a[64:67], v[104:107], v[128:131]
    s_mov_b32 s30, s28
    ds_read_b128 a[100:103], v10 offset:20480
    v_mfma_f32_16x16x32_bf16 v[128:131], a[68:71], v[112:115], v[128:131]
    s_add_u32 s28, s28, 65536
    v_exp_f32 v53, v85
    v_mfma_f32_16x16x32_bf16 v[192:195], a[68:71], v[116:119], v[192:195]
    s_cmp_ge_u32 s28, 163840
    ds_read_b128 a[96:99], v10 offset:4096
    v_mfma_f32_16x16x32_bf16 v[192:195], a[64:67], v[108:111], v[192:195]
    s_waitcnt lgkmcnt(6)
    v_exp_f32 v54, v86
    v_mfma_f32_16x16x32_bf16 v[196:199], a[72:75], v[108:111], v[196:199]
    s_cselect_b32 s50, 163840, 0
    ds_read_b128 a[108:111], v10 offset:21504
    v_mfma_f32_16x16x32_bf16 v[196:199], a[76:79], v[116:119], v[196:199]
    buffer_load_dwordx4 v6, s[24:27], s32 offen offset:2048 lds
    v_mfma_f32_16x16x32_bf16 v[132:135], a[76:79], v[112:115], v[132:135]
    s_sub_u32 s28, s28, s50
    ds_read_b128 a[104:107], v10 offset:5120
    v_cvt_pk_bf16_f32 v62, v52, v53
    v_mfma_f32_16x16x32_bf16 v[132:135], a[72:75], v[104:107], v[132:135]
    buffer_load_dwordx4 a[148:151], v3, s[24:27], s66 offen offset:1024
    v_mfma_f32_16x16x32_bf16 v[24:27], v[32:35], v[104:107], v[24:27]
    buffer_load_dwordx4 a[152:155], v8, s[24:27], s4 offen offset:0
    v_mfma_f32_16x16x32_bf16 v[24:27], v[32:35], v[112:115], v[24:27]
    v_exp_f32 v55, v87
    v_mfma_f32_16x16x32_bf16 v[28:31], v[32:35], v[108:111], v[28:31]
    v_exp_f32 v40, v88
    v_mfma_f32_16x16x32_bf16 v[28:31], v[32:35], v[116:119], v[28:31]
    s_waitcnt lgkmcnt(6)
    v_exp_f32 v41, v89
    v_mfma_f32_16x16x32_bf16 v[136:139], a[80:83], v[104:107], v[136:139]
    ds_read_b128 a[116:119], v10 offset:22528
    v_add_u32 v9, s28, v8
    v_mfma_f32_16x16x32_bf16 v[136:139], a[84:87], v[112:115], v[136:139]
    buffer_load_dwordx4 v6, s[24:27], s32 offen offset:3072 lds
    v_mfma_f32_16x16x32_bf16 v[200:203], a[84:87], v[116:119], v[200:203]
    s_add_u32 m0, m0, 4096
    ds_read_b128 a[112:115], v10 offset:6144
    v_mfma_f32_16x16x32_bf16 v[200:203], a[80:83], v[108:111], v[200:203]
    s_waitcnt lgkmcnt(6)
    v_exp_f32 v42, v90
    v_mfma_f32_16x16x32_bf16 v[204:207], a[88:91], v[108:111], v[204:207]
    ds_read_b128 a[124:127], v10 offset:23552
    v_cvt_pk_bf16_f32 v63, v54, v55
    v_mfma_f32_16x16x32_bf16 v[204:207], a[92:95], v[116:119], v[204:207]
    v_exp_f32 v43, v91
    v_mfma_f32_16x16x32_bf16 v[140:143], a[92:95], v[112:115], v[140:143]
    ds_read_b128 a[120:123], v10 offset:7168
    v_or3_b32 v14, v62, v63, v14
    v_mfma_f32_16x16x32_bf16 v[140:143], a[88:91], v[104:107], v[140:143]
    s_waitcnt lgkmcnt(6)
    v_exp_f32 v44, v92
    v_mfma_f32_16x16x32_bf16 v[144:147], a[96:99], v[104:107], v[144:147]
    ds_read_b128 a[68:71], v10 offset:24576
    v_cvt_pk_bf16_f32 v64, v40, v41
    v_mfma_f32_16x16x32_bf16 v[144:147], a[100:103], v[112:115], v[144:147]
    buffer_load_dwordx4 v7, s[24:27], s32 offen offset:0 lds
    v_mfma_f32_16x16x32_bf16 v[208:211], a[100:103], v[116:119], v[208:211]
    s_mov_b32 s31, s29
    ds_read_b128 a[64:67], v10 offset:8192
    v_cvt_pk_bf16_f32 v65, v42, v43
    v_mfma_f32_16x16x32_bf16 v[208:211], a[96:99], v[108:111], v[208:211]
    s_waitcnt lgkmcnt(6)
    v_exp_f32 v45, v93
    v_mfma_f32_16x16x32_bf16 v[212:215], a[104:107], v[108:111], v[212:215]
    s_add_u32 s29, s29, 65536
    ds_read_b128 a[76:79], v10 offset:25600
    v_mfma_f32_16x16x32_bf16 v[212:215], a[108:111], v[116:119], v[212:215]
    s_cmp_ge_u32 s29, 163840
    v_exp_f32 v46, v94
    v_mfma_f32_16x16x32_bf16 v[148:151], a[108:111], v[112:115], v[148:151]
    s_cselect_b32 s50, 163840, 0
    ds_read_b128 a[72:75], v10 offset:9216
    v_mfma_f32_16x16x32_bf16 v[148:151], a[104:107], v[104:107], v[148:151]
    s_waitcnt lgkmcnt(6)
    v_exp_f32 v47, v95
    v_mfma_f32_16x16x32_bf16 v[152:155], a[112:115], v[104:107], v[152:155]
    s_sub_u32 s29, s29, s50
    ds_read_b128 a[84:87], v10 offset:26624
    v_or3_b32 v14, v64, v65, v14
    v_mfma_f32_16x16x32_bf16 v[152:155], a[116:119], v[112:115], v[152:155]
    buffer_load_dwordx4 v7, s[24:27], s32 offen offset:1024 lds
    v_mfma_f32_16x16x32_bf16 v[216:219], a[116:119], v[116:119], v[216:219]
    ds_read_b128 a[80:83], v10 offset:10240
    v_cvt_pk_bf16_f32 v68, v44, v45
    v_mfma_f32_16x16x32_bf16 v[216:219], a[112:115], v[108:111], v[216:219]
    s_waitcnt lgkmcnt(6)
    v_exp_f32 v48, v96
    v_mfma_f32_16x16x32_bf16 v[220:223], a[120:123], v[108:111], v[220:223]
    ds_read_b128 a[92:95], v10 offset:27648
    v_cvt_pk_bf16_f32 v69, v46, v47
    v_mfma_f32_16x16x32_bf16 v[220:223], a[124:127], v[116:119], v[220:223]
    buffer_load_dwordx4 a[156:159], v8, s[24:27], s4 offen offset:1024
    v_mfma_f32_16x16x32_bf16 v[156:159], a[124:127], v[112:115], v[156:159]
    ds_read_b128 a[88:91], v10 offset:11264
    v_or3_b32 v14, v68, v69, v14
    v_mfma_f32_16x16x32_bf16 v[156:159], a[120:123], v[104:107], v[156:159]
    s_waitcnt lgkmcnt(6)
    v_exp_f32 v49, v97
    v_mfma_f32_16x16x32_bf16 v[160:163], a[64:67], v[104:107], v[160:163]
    ds_read_b128 a[100:103], v10 offset:28672
    v_mfma_f32_16x16x32_bf16 v[160:163], a[68:71], v[112:115], v[160:163]
    buffer_load_dwordx4 v7, s[24:27], s32 offen offset:2048 lds
    v_mfma_f32_16x16x32_bf16 v[224:227], a[68:71], v[116:119], v[224:227]
    ds_read_b128 a[96:99], v10 offset:12288
    v_cvt_pk_bf16_f32 v66, v48, v49
    v_mfma_f32_16x16x32_bf16 v[224:227], a[64:67], v[108:111], v[224:227]
    s_waitcnt lgkmcnt(6)
    v_exp_f32 v50, v98
    v_mfma_f32_16x16x32_bf16 v[228:231], a[72:75], v[108:111], v[228:231]
    ds_read_b128 a[108:111], v10 offset:29696
    v_mfma_f32_16x16x32_bf16 v[228:231], a[76:79], v[116:119], v[228:231]
    buffer_load_dwordx4 a[160:163], v8, s[24:27], s5 offen offset:0
    v_mfma_f32_16x16x32_bf16 v[164:167], a[76:79], v[112:115], v[164:167]
    ds_read_b128 a[104:107], v10 offset:13312
    v_mfma_f32_16x16x32_bf16 v[164:167], a[72:75], v[104:107], v[164:167]
    s_waitcnt lgkmcnt(6)
    v_exp_f32 v51, v99
    v_mfma_f32_16x16x32_bf16 v[168:171], a[80:83], v[104:107], v[168:171]
    ds_read_b128 a[116:119], v10 offset:30720
    v_cvt_pk_bf16_f32 v67, v50, v51
    v_mfma_f32_16x16x32_bf16 v[168:171], a[84:87], v[112:115], v[168:171]
    buffer_load_dwordx4 v7, s[24:27], s32 offen offset:3072 lds
    v_mfma_f32_16x16x32_bf16 v[232:235], a[84:87], v[116:119], v[232:235]
    s_add_u32 s33, s33, 1
    ds_read_b128 a[112:115], v10 offset:14336
    v_or3_b32 v14, v66, v67, v14
    v_mfma_f32_16x16x32_bf16 v[232:235], a[80:83], v[108:111], v[232:235]
    s_waitcnt lgkmcnt(6)
    v_exp_f32 v52, v100
    v_mfma_f32_16x16x32_bf16 v[236:239], a[88:91], v[108:111], v[236:239]
    s_add_u32 s32, s32, 32768
    ds_read_b128 a[124:127], v10 offset:31744
    v_mfma_f32_16x16x32_bf16 v[236:239], a[92:95], v[116:119], v[236:239]
    s_waitcnt lgkmcnt(5)
    v_exp_f32 v53, v101
    v_mfma_f32_16x16x32_bf16 v[172:175], a[92:95], v[112:115], v[172:175]
    s_waitcnt vmcnt(25)
    ds_read_b128 a[120:123], v10 offset:15360
    v_cvt_pk_bf16_f32 v70, v52, v53
    v_mfma_f32_16x16x32_bf16 v[172:175], a[88:91], v[104:107], v[172:175]
    s_barrier
    v_exp_f32 v54, v102
    v_mfma_f32_16x16x32_bf16 v[176:179], a[96:99], v[104:107], v[176:179]
    s_cmp_eq_u32 s33, s36
    ds_read_b128 a[68:71], v9 offset:1024
    v_mfma_f32_16x16x32_bf16 v[176:179], a[100:103], v[112:115], v[176:179]
    s_cselect_b32 s32, s39, s32
    v_exp_f32 v55, v103
    v_mfma_f32_16x16x32_bf16 v[240:243], a[100:103], v[116:119], v[240:243]
    s_cmp_eq_u32 s33, s37
    ds_read_b128 a[64:67], v9 offset:0
    v_cvt_pk_bf16_f32 v71, v54, v55
    v_mfma_f32_16x16x32_bf16 v[240:243], a[96:99], v[108:111], v[240:243]
    s_waitcnt lgkmcnt(6)
    v_or3_b32 v14, v70, v71, v14
    v_and_b32 v14, 0x40004000, v14
    v_mfma_f32_16x16x32_bf16 v[244:247], a[104:107], v[108:111], v[244:247]
    s_cselect_b32 s32, s65, s32
    ds_read_b128 a[76:79], v9 offset:3072
    v_cmp_ne_u32 vcc, 0, v14
    v_mfma_f32_16x16x32_bf16 v[244:247], a[108:111], v[116:119], v[244:247]
    s_add_u32 s38, s38, 1
    v_mfma_f32_16x16x32_bf16 v[180:183], a[108:111], v[112:115], v[180:183]
    s_cmp_ge_i32 s38, s17
    ds_read_b128 a[72:75], v9 offset:2048
    v_mfma_f32_16x16x32_bf16 v[180:183], a[104:107], v[104:107], v[180:183]
    s_waitcnt lgkmcnt(6)
    v_mfma_f32_16x16x32_bf16 v[184:187], a[112:115], v[104:107], v[184:187]
    ds_read_b128 a[84:87], v9 offset:5120
    v_mfma_f32_16x16x32_bf16 v[184:187], a[116:119], v[112:115], v[184:187]
    buffer_load_dwordx4 a[164:167], v8, s[24:27], s5 offen offset:1024
    v_mfma_f32_16x16x32_bf16 v[248:251], a[116:119], v[116:119], v[248:251]
    ds_read_b128 a[80:83], v9 offset:4096
    v_mfma_f32_16x16x32_bf16 v[248:251], a[112:115], v[108:111], v[248:251]
    s_waitcnt lgkmcnt(6)
    v_mfma_f32_16x16x32_bf16 v[252:255], a[120:123], v[108:111], v[252:255]
    ds_read_b128 a[92:95], v9 offset:7168
    v_mfma_f32_16x16x32_bf16 v[252:255], a[124:127], v[116:119], v[252:255]
    v_mfma_f32_16x16x32_bf16 v[188:191], a[124:127], v[112:115], v[188:191]
    ds_read_b128 a[88:91], v9 offset:6144
    v_mfma_f32_16x16x32_bf16 v[188:191], a[120:123], v[104:107], v[188:191]
    s_waitcnt lgkmcnt(6)
    s_branch K2_HB
.p2align 6
K2_LOOP:
    v_mfma_f32_16x16x32_bf16 v[72:75], a[64:67], a[0:3], v[16:19]
    s_add_u32 m0, s30, s44
    ds_read_b128 a[100:103], v9 offset:9216
    v_mov_b32 v104, v56
    v_mfma_f32_16x16x32_bf16 v[72:75], a[68:71], a[4:7], v[72:75]
    buffer_load_dwordx4 v6, s[24:27], s34 offen offset:0 lds
    v_mfma_f32_16x16x32_bf16 v[76:79], a[64:67], a[32:35], v[20:23]
    ds_read_b128 a[96:99], v9 offset:8192
    v_mov_b32 v105, v57
    v_mfma_f32_16x16x32_bf16 v[76:79], a[68:71], a[36:39], v[76:79]
    s_waitcnt lgkmcnt(6)
    v_mfma_f32_16x16x32_bf16 v[76:79], a[72:75], a[40:43], v[76:79]
    ds_read_b128 a[108:111], v9 offset:11264
    v_mov_b32 v108, v60
    v_mfma_f32_16x16x32_bf16 v[76:79], a[76:79], a[44:47], v[76:79]
    v_mfma_f32_16x16x32_bf16 v[72:75], a[76:79], a[12:15], v[72:75]
    s_waitcnt lgkmcnt(5)
    ds_read_b128 a[104:107], v9 offset:10240
    v_mov_b32 v109, v61
    v_mfma_f32_16x16x32_bf16 v[72:75], a[72:75], a[8:11], v[72:75]
    buffer_load_dwordx4 v6, s[24:27], s34 offen offset:1024 lds
    v_mfma_f32_16x16x32_bf16 v[72:75], a[80:83], a[16:19], v[72:75]
    ds_read_b128 a[116:119], v9 offset:13312
    v_mov_b32 v106, v58
    v_mfma_f32_16x16x32_bf16 v[72:75], a[84:87], a[20:23], v[72:75]
    v_mfma_f32_16x16x32_bf16 v[76:79], a[84:87], a[52:55], v[76:79]
    ds_read_b128 a[112:115], v9 offset:12288
    v_mov_b32 v107, v59
    v_mfma_f32_16x16x32_bf16 v[76:79], a[80:83], a[48:51], v[76:79]
    s_waitcnt lgkmcnt(6)
    v_mfma_f32_16x16x32_bf16 v[76:79], a[88:91], a[56:59], v[76:79]
    ds_read_b128 a[124:127], v9 offset:15360
    v_mov_b32 v110, v62
    v_mfma_f32_16x16x32_bf16 v[76:79], a[92:95], a[60:63], v[76:79]
    buffer_load_dwordx4 v6, s[24:27], s34 offen offset:2048 lds
    v_mfma_f32_16x16x32_bf16 v[72:75], a[92:95], a[28:31], v[72:75]
    ds_read_b128 a[120:123], v9 offset:14336
    v_mov_b32 v111, v63
    v_mfma_f32_16x16x32_bf16 v[72:75], a[88:91], a[24:27], v[72:75]
    s_waitcnt lgkmcnt(6)
    v_mfma_f32_16x16x32_bf16 v[80:83], a[96:99], a[0:3], v[16:19]
    ds_read_b128 a[68:71], v9 offset:17408
    v_mov_b32 v112, v64
    v_mfma_f32_16x16x32_bf16 v[80:83], a[100:103], a[4:7], v[80:83]
    v_mfma_f32_16x16x32_bf16 v[84:87], a[96:99], a[32:35], v[20:23]
    s_waitcnt lgkmcnt(5)
    ds_read_b128 a[64:67], v9 offset:16384
    v_mov_b32 v113, v65
    v_mfma_f32_16x16x32_bf16 v[84:87], a[100:103], a[36:39], v[84:87]
    buffer_load_dwordx4 v6, s[24:27], s34 offen offset:3072 lds
    v_mfma_f32_16x16x32_bf16 v[84:87], a[104:107], a[40:43], v[84:87]
    s_add_u32 m0, m0, 4096
    ds_read_b128 a[76:79], v9 offset:19456
    v_mov_b32 v116, v68
    v_mfma_f32_16x16x32_bf16 v[84:87], a[108:111], a[44:47], v[84:87]
    v_exp_f32 v40, v72
    v_mfma_f32_16x16x32_bf16 v[80:83], a[108:111], a[12:15], v[80:83]
    ds_read_b128 a[72:75], v9 offset:18432
    v_mov_b32 v117, v69
    v_mfma_f32_16x16x32_bf16 v[80:83], a[104:107], a[8:11], v[80:83]
    s_waitcnt lgkmcnt(6)
    v_exp_f32 v41, v73
    v_mfma_f32_16x16x32_bf16 v[80:83], a[112:115], a[16:19], v[80:83]
    ds_read_b128 a[84:87], v9 offset:21504
    v_mov_b32 v114, v66
    v_mfma_f32_16x16x32_bf16 v[80:83], a[116:119], a[20:23], v[80:83]
    buffer_load_dwordx4 v7, s[24:27], s34 offen offset:0 lds
    v_mfma_f32_16x16x32_bf16 v[84:87], a[116:119], a[52:55], v[84:87]
    ds_read_b128 a[80:83], v9 offset:20480
    v_mov_b32 v115, v67
    v_mfma_f32_16x16x32_bf16 v[84:87], a[112:115], a[48:51], v[84:87]
    s_waitcnt lgkmcnt(6)
    v_exp_f32 v42, v74
    v_mfma_f32_16x16x32_bf16 v[84:87], a[120:123], a[56:59], v[84:87]
    ds_read_b128 a[92:95], v9 offset:23552
    v_mov_b32 v118, v70
    v_mfma_f32_16x16x32_bf16 v[84:87], a[124:127], a[60:63], v[84:87]
    v_exp_f32 v43, v75
    v_mfma_f32_16x16x32_bf16 v[80:83], a[124:127], a[28:31], v[80:83]
    s_waitcnt lgkmcnt(5)
    ds_read_b128 a[88:91], v9 offset:22528
    v_mov_b32 v119, v71
    v_mfma_f32_16x16x32_bf16 v[80:83], a[120:123], a[24:27], v[80:83]
    buffer_load_dwordx4 v7, s[24:27], s34 offen offset:1024 lds
    v_mfma_f32_16x16x32_bf16 v[88:91], a[64:67], a[0:3], v[16:19]
    ds_read_b128 a[100:103], v9 offset:25600
    v_add_u32 v10, s29, v8
    v_mfma_f32_16x16x32_bf16 v[88:91], a[68:71], a[4:7], v[88:91]
    v_exp_f32 v44, v76
    v_mfma_f32_16x16x32_bf16 v[92:95], a[64:67], a[32:35], v[20:23]
    ds_read_b128 a[96:99], v9 offset:24576
    v_cvt_pk_bf16_f32 v56, v40, v41
    v_mfma_f32_16x16x32_bf16 v[92:95], a[68:71], a[36:39], v[92:95]
    s_waitcnt lgkmcnt(6)
    v_exp_f32 v45, v77
    v_mfma_f32_16x16x32_bf16 v[92:95], a[72:75], a[40:43], v[92:95]
    ds_read_b128 a[108:111], v9 offset:27648
    v_cvt_pk_bf16_f32 v57, v42, v43
    v_mfma_f32_16x16x32_bf16 v[92:95], a[76:79], a[44:47], v[92:95]
    buffer_load_dwordx4 v7, s[24:27], s34 offen offset:2048 lds
    v_mfma_f32_16x16x32_bf16 v[88:91], a[76:79], a[12:15], v[88:91]
    ds_read_b128 a[104:107], v9 offset:26624
    v_or_b32 v14, v56, v57
    v_mfma_f32_16x16x32_bf16 v[88:91], a[72:75], a[8:11], v[88:91]
    s_waitcnt lgkmcnt(6)
    v_exp_f32 v46, v78
    v_mfma_f32_16x16x32_bf16 v[88:91], a[80:83], a[16:19], v[88:91]
    ds_read_b128 a[116:119], v9 offset:29696
    v_cvt_pk_bf16_f32 v60, v44, v45
    v_mfma_f32_16x16x32_bf16 v[88:91], a[84:87], a[20:23], v[88:91]
    v_exp_f32 v47, v79
    v_mfma_f32_16x16x32_bf16 v[92:95], a[84:87], a[52:55], v[92:95]
    s_waitcnt lgkmcnt(5)
    ds_read_b128 a[112:115], v9 offset:28672
    v_mfma_f32_16x16x32_bf16 v[92:95], a[80:83], a[48:51], v[92:95]
    buffer_load_dwordx4 v7, s[24:27], s34 offen offset:3072 lds
    v_mfma_f32_16x16x32_bf16 v[92:95], a[88:91], a[56:59], v[92:95]
    s_add_u32 m0, s31, s44
    ds_read_b128 a[124:127], v9 offset:31744
    v_mfma_f32_16x16x32_bf16 v[92:95], a[92:95], a[60:63], v[92:95]
    s_waitcnt lgkmcnt(5)
    v_exp_f32 v48, v80
    v_mfma_f32_16x16x32_bf16 v[88:91], a[92:95], a[28:31], v[88:91]
    s_waitcnt vmcnt(16)
    ds_read_b128 a[120:123], v9 offset:30720
    v_cvt_pk_bf16_f32 v61, v46, v47
    v_mfma_f32_16x16x32_bf16 v[88:91], a[88:91], a[24:27], v[88:91]
    s_barrier
    v_exp_f32 v49, v81
    v_mfma_f32_16x16x32_bf16 v[96:99], a[96:99], a[0:3], v[16:19]
    s_add_u32 s35, s35, 1
    ds_read_b128 a[68:71], v10 offset:16384
    v_or3_b32 v14, v60, v61, v14
    v_mfma_f32_16x16x32_bf16 v[96:99], a[100:103], a[4:7], v[96:99]
    s_add_u32 s34, s34, 32768
    v_exp_f32 v50, v82
    v_mfma_f32_16x16x32_bf16 v[100:103], a[96:99], a[32:35], v[20:23]
    s_cmp_eq_u32 s35, s36
    ds_read_b128 a[64:67], v10 offset:0
    v_mfma_f32_16x16x32_bf16 v[100:103], a[100:103], a[36:39], v[100:103]
    s_waitcnt lgkmcnt(6)
    v_exp_f32 v51, v83
    v_mfma_f32_16x16x32_bf16 v[100:103], a[104:107], a[40:43], v[100:103]
    s_cselect_b32 s34, s40, s34
    ds_read_b128 a[76:79], v10 offset:17408
    v_cvt_pk_bf16_f32 v58, v48, v49
    v_mfma_f32_16x16x32_bf16 v[100:103], a[108:111], a[44:47], v[100:103]
    buffer_load_dwordx4 v6, s[24:27], s32 offen offset:0 lds
    v_mfma_f32_16x16x32_bf16 v[96:99], a[108:111], a[12:15], v[96:99]
    s_cmp_eq_u32 s35, s37
    ds_read_b128 a[72:75], v10 offset:1024
    v_mfma_f32_16x16x32_bf16 v[96:99], a[104:107], a[8:11], v[96:99]
    s_waitcnt lgkmcnt(6)
    v_exp_f32 v52, v84
    v_mfma_f32_16x16x32_bf16 v[96:99], a[112:115], a[16:19], v[96:99]
    s_cselect_b32 s34, s65, s34
    ds_read_b128 a[84:87], v10 offset:18432
    v_mfma_f32_16x16x32_bf16 v[96:99], a[116:119], a[20:23], v[96:99]
    v_exp_f32 v53, v85
    v_mfma_f32_16x16x32_bf16 v[100:103], a[116:119], a[52:55], v[100:103]
    ds_read_b128 a[80:83], v10 offset:2048
    v_cvt_pk_bf16_f32 v59, v50, v51
    v_mfma_f32_16x16x32_bf16 v[100:103], a[112:115], a[48:51], v[100:103]
    s_waitcnt lgkmcnt(6)
    v_or3_b32 v14, v58, v59, v14
    v_mfma_f32_16x16x32_bf16 v[100:103], a[120:123], a[56:59], v[100:103]
    ds_read_b128 a[92:95], v10 offset:19456
    v_mfma_f32_16x16x32_bf16 v[100:103], a[124:127], a[60:63], v[100:103]
    buffer_load_dwordx4 v6, s[24:27], s32 offen offset:1024 lds
    v_mfma_f32_16x16x32_bf16 v[96:99], a[124:127], a[28:31], v[96:99]
    ds_read_b128 a[88:91], v10 offset:3072
    v_mfma_f32_16x16x32_bf16 v[96:99], a[120:123], a[24:27], v[96:99]
    s_waitcnt lgkmcnt(6)
    v_exp_f32 v54, v86
    v_mfma_f32_16x16x32_bf16 v[128:131], a[64:67], v[104:107], v[128:131]
    s_mov_b32 s30, s28
    ds_read_b128 a[100:103], v10 offset:20480
    v_cvt_pk_bf16_f32 v62, v52, v53
    v_mfma_f32_16x16x32_bf16 v[128:131], a[68:71], v[112:115], v[128:131]
    s_add_u32 s28, s28, 65536
    v_exp_f32 v55, v87
    v_mfma_f32_16x16x32_bf16 v[192:195], a[68:71], v[116:119], v[192:195]
    s_cmp_ge_u32 s28, 163840
    ds_read_b128 a[96:99], v10 offset:4096
    v_mfma_f32_16x16x32_bf16 v[192:195], a[64:67], v[108:111], v[192:195]
    s_waitcnt lgkmcnt(6)
    v_exp_f32 v40, v88
    v_mfma_f32_16x16x32_bf16 v[196:199], a[72:75], v[108:111], v[196:199]
    s_cselect_b32 s50, 163840, 0
    ds_read_b128 a[108:111], v10 offset:21504
    v_mfma_f32_16x16x32_bf16 v[196:199], a[76:79], v[116:119], v[196:199]
    buffer_load_dwordx4 v6, s[24:27], s32 offen offset:2048 lds
    v_mfma_f32_16x16x32_bf16 v[132:135], a[76:79], v[112:115], v[132:135]
    s_sub_u32 s28, s28, s50
    ds_read_b128 a[104:107], v10 offset:5120
    v_cvt_pk_bf16_f32 v63, v54, v55
    v_mfma_f32_16x16x32_bf16 v[132:135], a[72:75], v[104:107], v[132:135]
    v_exp_f32 v41, v89
    v_mfma_f32_16x16x32_bf16 v[24:27], v[32:35], v[104:107], v[24:27]
    v_add_u32 v9, s28, v8
    v_or3_b32 v14, v62, v63, v14
    v_mfma_f32_16x16x32_bf16 v[24:27], v[32:35], v[112:115], v[24:27]
    v_exp_f32 v42, v90
    v_mfma_f32_16x16x32_bf16 v[28:31], v[32:35], v[108:111], v[28:31]
    v_mfma_f32_16x16x32_bf16 v[28:31], v[32:35], v[116:119], v[28:31]
    s_waitcnt lgkmcnt(6)
    v_exp_f32 v43, v91
    v_mfma_f32_16x16x32_bf16 v[136:139], a[80:83], v[104:107], v[136:139]
    ds_read_b128 a[116:119], v10 offset:22528
    v_mfma_f32_16x16x32_bf16 v[136:139], a[84:87], v[112:115], v[136:139]
    buffer_load_dwordx4 v6, s[24:27], s32 offen offset:3072 lds
    v_mfma_f32_16x16x32_bf16 v[200:203], a[84:87], v[116:119], v[200:203]
    s_add_u32 m0, m0, 4096
    ds_read_b128 a[112:115], v10 offset:6144
    v_mfma_f32_16x16x32_bf16 v[200:203], a[80:83], v[108:111], v[200:203]
    s_waitcnt lgkmcnt(6)
    v_exp_f32 v44, v92
    v_mfma_f32_16x16x32_bf16 v[204:207], a[88:91], v[108:111], v[204:207]
    ds_read_b128 a[124:127], v10 offset:23552
    v_cvt_pk_bf16_f32 v64, v40, v41
    v_mfma_f32_16x16x32_bf16 v[204:207], a[92:95], v[116:119], v[204:207]
    v_exp_f32 v45, v93
    v_mfma_f32_16x16x32_bf16 v[140:143], a[92:95], v[112:115], v[140:143]
    ds_read_b128 a[120:123], v10 offset:7168
    v_cvt_pk_bf16_f32 v65, v42, v43
    v_mfma_f32_16x16x32_bf16 v[140:143], a[88:91], v[104:107], v[140:143]
    s_waitcnt lgkmcnt(6)
    v_mfma_f32_16x16x32_bf16 v[144:147], a[96:99], v[104:107], v[144:147]
    ds_read_b128 a[68:71], v10 offset:24576
    v_or3_b32 v14, v64, v65, v14
    v_mfma_f32_16x16x32_bf16 v[144:147], a[100:103], v[112:115], v[144:147]
    buffer_load_dwordx4 v7, s[24:27], s32 offen offset:0 lds
    v_mfma_f32_16x16x32_bf16 v[208:211], a[100:103], v[116:119], v[208:211]
    s_mov_b32 s31, s29
    ds_read_b128 a[64:67], v10 offset:8192
    v_mfma_f32_16x16x32_bf16 v[208:211], a[96:99], v[108:111], v[208:211]
    s_waitcnt lgkmcnt(6)
    v_exp_f32 v46, v94
    v_mfma_f32_16x16x32_bf16 v[212:215], a[104:107], v[108:111], v[212:215]
    s_add_u32 s29, s29, 65536
    ds_read_b128 a[76:79], v10 offset:25600
    v_mfma_f32_16x16x32_bf16 v[212:215], a[108:111], v[116:119], v[212:215]
    s_cmp_ge_u32 s29, 163840
    v_exp_f32 v47, v95
    v_mfma_f32_16x16x32_bf16 v[148:151], a[108:111], v[112:115], v[148:151]
    s_cselect_b32 s50, 163840, 0
    ds_read_b128 a[72:75], v10 offset:9216
    v_mfma_f32_16x16x32_bf16 v[148:151], a[104:107], v[104:107], v[148:151]
    s_waitcnt lgkmcnt(6)
    v_exp_f32 v48, v96
    v_mfma_f32_16x16x32_bf16 v[152:155], a[112:115], v[104:107], v[152:155]
    s_sub_u32 s29, s29, s50
    ds_read_b128 a[84:87], v10 offset:26624
    v_cvt_pk_bf16_f32 v68, v44, v45
    v_mfma_f32_16x16x32_bf16 v[152:155], a[116:119], v[112:115], v[152:155]
    buffer_load_dwordx4 v7, s[24:27], s32 offen offset:1024 lds
    v_mfma_f32_16x16x32_bf16 v[216:219], a[116:119], v[116:119], v[216:219]
    ds_read_b128 a[80:83], v10 offset:10240
    v_mfma_f32_16x16x32_bf16 v[216:219], a[112:115], v[108:111], v[216:219]
    s_waitcnt lgkmcnt(6)
    v_exp_f32 v49, v97
    v_mfma_f32_16x16x32_bf16 v[220:223], a[120:123], v[108:111], v[220:223]
    ds_read_b128 a[92:95], v10 offset:27648
    v_cvt_pk_bf16_f32 v69, v46, v47
    v_mfma_f32_16x16x32_bf16 v[220:223], a[124:127], v[116:119], v[220:223]
    v_or3_b32 v14, v68, v69, v14
    v_mfma_f32_16x16x32_bf16 v[156:159], a[124:127], v[112:115], v[156:159]
    ds_read_b128 a[88:91], v10 offset:11264
    v_mfma_f32_16x16x32_bf16 v[156:159], a[120:123], v[104:107], v[156:159]
    s_waitcnt lgkmcnt(6)
    v_exp_f32 v50, v98
    v_mfma_f32_16x16x32_bf16 v[160:163], a[64:67], v[104:107], v[160:163]
    ds_read_b128 a[100:103], v10 offset:28672
    v_mfma_f32_16x16x32_bf16 v[160:163], a[68:71], v[112:115], v[160:163]
    buffer_load_dwordx4 v7, s[24:27], s32 offen offset:2048 lds
    v_mfma_f32_16x16x32_bf16 v[224:227], a[68:71], v[116:119], v[224:227]
    ds_read_b128 a[96:99], v10 offset:12288
    v_cvt_pk_bf16_f32 v66, v48, v49
    v_mfma_f32_16x16x32_bf16 v[224:227], a[64:67], v[108:111], v[224:227]
    s_waitcnt lgkmcnt(6)
    v_exp_f32 v51, v99
    v_mfma_f32_16x16x32_bf16 v[228:231], a[72:75], v[108:111], v[228:231]
    ds_read_b128 a[108:111], v10 offset:29696
    v_mfma_f32_16x16x32_bf16 v[228:231], a[76:79], v[116:119], v[228:231]
    v_exp_f32 v52, v100
    v_mfma_f32_16x16x32_bf16 v[164:167], a[76:79], v[112:115], v[164:167]
    ds_read_b128 a[104:107], v10 offset:13312
    v_mfma_f32_16x16x32_bf16 v[164:167], a[72:75], v[104:107], v[164:167]
    s_waitcnt lgkmcnt(6)
    v_exp_f32 v53, v101
    v_mfma_f32_16x16x32_bf16 v[168:171], a[80:83], v[104:107], v[168:171]
    ds_read_b128 a[116:119], v10 offset:30720
    v_cvt_pk_bf16_f32 v67, v50, v51
    v_mfma_f32_16x16x32_bf16 v[168:171], a[84:87], v[112:115], v[168:171]
    buffer_load_dwordx4 v7, s[24:27], s32 offen offset:3072 lds
    v_mfma_f32_16x16x32_bf16 v[232:235], a[84:87], v[116:119], v[232:235]
    s_add_u32 s33, s33, 1
    ds_read_b128 a[112:115], v10 offset:14336
    v_or3_b32 v14, v66, v67, v14
    v_mfma_f32_16x16x32_bf16 v[232:235], a[80:83], v[108:111], v[232:235]
    s_waitcnt lgkmcnt(6)
    v_exp_f32 v54, v102
    v_mfma_f32_16x16x32_bf16 v[236:239], a[88:91], v[108:111], v[236:239]
    s_add_u32 s32, s32, 32768
    ds_read_b128 a[124:127], v10 offset:31744
    v_mfma_f32_16x16x32_bf16 v[236:239], a[92:95], v[116:119], v[236:239]
    s_waitcnt lgkmcnt(5)
    v_exp_f32 v55, v103
    v_mfma_f32_16x16x32_bf16 v[172:175], a[92:95], v[112:115], v[172:175]
    s_waitcnt vmcnt(16)
    ds_read_b128 a[120:123], v10 offset:15360
    v_cvt_pk_bf16_f32 v70, v52, v53
    v_mfma_f32_16x16x32_bf16 v[172:175], a[88:91], v[104:107], v[172:175]
    s_barrier
    v_mfma_f32_16x16x32_bf16 v[176:179], a[96:99], v[104:107], v[176:179]
    s_cmp_eq_u32 s33, s36
    ds_read_b128 a[68:71], v9 offset:1024
    v_cvt_pk_bf16_f32 v71, v54, v55
    v_mfma_f32_16x16x32_bf16 v[176:179], a[100:103], v[112:115], v[176:179]
    s_cselect_b32 s32, s39, s32
    v_mfma_f32_16x16x32_bf16 v[240:243], a[100:103], v[116:119], v[240:243]
    s_cmp_eq_u32 s33, s37
    ds_read_b128 a[64:67], v9 offset:0
    v_or3_b32 v14, v70, v71, v14
    v_mfma_f32_16x16x32_bf16 v[240:243], a[96:99], v[108:111], v[240:243]
    s_waitcnt lgkmcnt(6)
    v_and_b32 v14, 0x40004000, v14
    v_cmp_ne_u32 vcc, 0, v14
    v_mfma_f32_16x16x32_bf16 v[244:247], a[104:107], v[108:111], v[244:247]
    s_cselect_b32 s32, s65, s32
    ds_read_b128 a[76:79], v9 offset:3072
    v_mfma_f32_16x16x32_bf16 v[244:247], a[108:111], v[116:119], v[244:247]
    s_add_u32 s38, s38, 1
    v_mfma_f32_16x16x32_bf16 v[180:183], a[108:111], v[112:115], v[180:183]
    s_cmp_ge_i32 s38, s17
    ds_read_b128 a[72:75], v9 offset:2048
    v_mfma_f32_16x16x32_bf16 v[180:183], a[104:107], v[104:107], v[180:183]
    s_waitcnt lgkmcnt(6)
    v_mfma_f32_16x16x32_bf16 v[184:187], a[112:115], v[104:107], v[184:187]
    ds_read_b128 a[84:87], v9 offset:5120
    v_mfma_f32_16x16x32_bf16 v[184:187], a[116:119], v[112:115], v[184:187]
    v_mfma_f32_16x16x32_bf16 v[248:251], a[116:119], v[116:119], v[248:251]
    ds_read_b128 a[80:83], v9 offset:4096
    v_mfma_f32_16x16x32_bf16 v[248:251], a[112:115], v[108:111], v[248:251]
    s_waitcnt lgkmcnt(6)
    v_mfma_f32_16x16x32_bf16 v[252:255], a[120:123], v[108:111], v[252:255]
    ds_read_b128 a[92:95], v9 offset:7168
    v_mfma_f32_16x16x32_bf16 v[252:255], a[124:127], v[116:119], v[252:255]
    v_mfma_f32_16x16x32_bf16 v[188:191], a[124:127], v[112:115], v[188:191]
    ds_read_b128 a[88:91], v9 offset:6144
    v_mfma_f32_16x16x32_bf16 v[188:191], a[120:123], v[104:107], v[188:191]
    s_waitcnt lgkmcnt(6)
    s_cbranch_scc1 K2_HB
    s_cbranch_vccz K2_LOOP
K2_RARE:
    s_nop 7
    s_waitcnt lgkmcnt(0)
    v_max3_f32 v120, v72, v73, v74
    v_max3_f32 v120, v120, v75, v80
    v_max3_f32 v120, v120, v81, v82
    v_max3_f32 v120, v120, v83, v88
    v_max3_f32 v120, v120, v89, v90
    v_max3_f32 v120, v120, v91, v96
    v_max3_f32 v120, v120, v97, v98
    v_max_f32 v120, v120, v99
    v_max3_f32 v121, v76, v77, v78
    v_max3_f32 v121, v121, v79, v84
    v_max3_f32 v121, v121, v85, v86
    v_max3_f32 v121, v121, v87, v92
    v_max3_f32 v121, v121, v93, v94
    v_max3_f32 v121, v121, v95, v100
    v_max3_f32 v121, v121, v101, v102
    v_max_f32 v121, v121, v103
    ds_bpermute_b32 v122, v12, v120
    ds_bpermute_b32 v123, v12, v121
    s_waitcnt lgkmcnt(1)
    v_max_f32 v120, v120, v122
    s_waitcnt lgkmcnt(0)
    v_max_f32 v121, v121, v123
    ds_bpermute_b32 v122, v13, v120
    ds_bpermute_b32 v123, v13, v121
    s_waitcnt lgkmcnt(1)
    v_max_f32 v120, v120, v122
    s_waitcnt lgkmcnt(0)
    v_max_f32 v121, v121, v123
    v_add_f32 v120, 0x40e00000, v120
    v_max_f32 v120, s43, v120
    v_sub_f32 v16, v16, v120
    v_sub_f32 v17, v17, v120
    v_sub_f32 v18, v18, v120
    v_sub_f32 v19, v19, v120
    v_sub_f32 v72, v72, v120
    v_sub_f32 v73, v73, v120
    v_sub_f32 v74, v74, v120
    v_sub_f32 v75, v75, v120
    v_sub_f32 v80, v80, v120
    v_sub_f32 v81, v81, v120
    v_sub_f32 v82, v82, v120
    v_sub_f32 v83, v83, v120
    v_sub_f32 v88, v88, v120
    v_sub_f32 v89, v89, v120
    v_sub_f32 v90, v90, v120
    v_sub_f32 v91, v91, v120
    v_sub_f32 v96, v96, v120
    v_sub_f32 v97, v97, v120
    v_sub_f32 v98, v98, v120
    v_sub_f32 v99, v99, v120
    v_add_f32 v121, 0x40e00000, v121
    v_max_f32 v121, s43, v121
    v_sub_f32 v20, v20, v121
    v_sub_f32 v21, v21, v121
    v_sub_f32 v22, v22, v121
    v_sub_f32 v23, v23, v121
    v_sub_f32 v76, v76, v121
    v_sub_f32 v77, v77, v121
    v_sub_f32 v78, v78, v121
    v_sub_f32 v79, v79, v121
    v_sub_f32 v84, v84, v121
    v_sub_f32 v85, v85, v121
    v_sub_f32 v86, v86, v121
    v_sub_f32 v87, v87, v121
    v_sub_f32 v92, v92, v121
    v_sub_f32 v93, v93, v121
    v_sub_f32 v94, v94, v121
    v_sub_f32 v95, v95, v121
    v_sub_f32 v100, v100, v121
    v_sub_f32 v101, v101, v121
    v_sub_f32 v102, v102, v121
    v_sub_f32 v103, v103, v121
    v_exp_f32 v122, -v120
    v_exp_f32 v123, -v121
    v_mul_f32 v24, v24, v122
    v_mul_f32 v25, v25, v122
    v_mul_f32 v26, v26, v122
    v_mul_f32 v27, v27, v122
    v_mul_f32 v128, v128, v122
    v_mul_f32 v129, v129, v122
    v_mul_f32 v130, v130, v122
    v_mul_f32 v131, v131, v122
    v_mul_f32 v132, v132, v122
    v_mul_f32 v133, v133, v122
    v_mul_f32 v134, v134, v122
    v_mul_f32 v135, v135, v122
    v_mul_f32 v136, v136, v122
    v_mul_f32 v137, v137, v122
    v_mul_f32 v138, v138, v122
    v_mul_f32 v139, v139, v122
    v_mul_f32 v140, v140, v122
    v_mul_f32 v141, v141, v122
    v_mul_f32 v142, v142, v122
    v_mul_f32 v143, v143, v122
    v_mul_f32 v144, v144, v122
    v_mul_f32 v145, v145, v122
    v_mul_f32 v146, v146, v122
    v_mul_f32 v147, v147, v122
    v_mul_f32 v148, v148, v122
    v_mul_f32 v149, v149, v122
    v_mul_f32 v150, v150, v122
    v_mul_f32 v151, v151, v122
    v_mul_f32 v152, v152, v122
    v_mul_f32 v153, v153, v122
    v_mul_f32 v154, v154, v122
    v_mul_f32 v155, v155, v122
    v_mul_f32 v156, v156, v122
    v_mul_f32 v157, v157, v122
    v_mul_f32 v158, v158, v122
    v_mul_f32 v159, v159, v122
    v_mul_f32 v160, v160, v122
    v_mul_f32 v161, v161, v122
    v_mul_f32 v162, v162, v122
    v_mul_f32 v163, v163, v122
    v_mul_f32 v164, v164, v122
    v_mul_f32 v165, v165, v122
    v_mul_f32 v166, v166, v122
    v_mul_f32 v167, v167, v122
    v_mul_f32 v168, v168, v122
    v_mul_f32 v169, v169, v122
    v_mul_f32 v170, v170, v122
    v_mul_f32 v171, v171, v122
    v_mul_f32 v172, v172, v122
    v_mul_f32 v173, v173, v122
    v_mul_f32 v174, v174, v122
    v_mul_f32 v175, v175, v122
    v_mul_f32 v176, v176, v122
    v_mul_f32 v177, v177, v122
    v_mul_f32 v178, v178, v122
    v_mul_f32 v179, v179, v122
    v_mul_f32 v180, v180, v122
    v_mul_f32 v181, v181, v122
    v_mul_f32 v182, v182, v122
    v_mul_f32 v183, v183, v122
    v_mul_f32 v184, v184, v122
    v_mul_f32 v185, v185, v122
    v_mul_f32 v186, v186, v122
    v_mul_f32 v187, v187, v122
    v_mul_f32 v188, v188, v122
    v_mul_f32 v189, v189, v122
    v_mul_f32 v190, v190, v122
    v_mul_f32 v191, v191, v122
    v_mul_f32 v28, v28, v123
    v_mul_f32 v29, v29, v123
    v_mul_f32 v30, v30, v123
    v_mul_f32 v31, v31, v123
    v_mul_f32 v192, v192, v123
    v_mul_f32 v193, v193, v123
    v_mul_f32 v194, v194, v123
    v_mul_f32 v195, v195, v123
    v_mul_f32 v196, v196, v123
    v_mul_f32 v197, v197, v123
    v_mul_f32 v198, v198, v123
    v_mul_f32 v199, v199, v123
    v_mul_f32 v200, v200, v123
    v_mul_f32 v201, v201, v123
    v_mul_f32 v202, v202, v123
    v_mul_f32 v203, v203, v123
    v_mul_f32 v204, v204, v123
    v_mul_f32 v205, v205, v123
    v_mul_f32 v206, v206, v123
    v_mul_f32 v207, v207, v123
    v_mul_f32 v208, v208, v123
    v_mul_f32 v209, v209, v123
    v_mul_f32 v210, v210, v123
    v_mul_f32 v211, v211, v123
    v_mul_f32 v212, v212, v123
    v_mul_f32 v213, v213, v123
    v_mul_f32 v214, v214, v123
    v_mul_f32 v215, v215, v123
    v_mul_f32 v216, v216, v123
    v_mul_f32 v217, v217, v123
    v_mul_f32 v218, v218, v123
    v_mul_f32 v219, v219, v123
    v_mul_f32 v220, v220, v123
    v_mul_f32 v221, v221, v123
    v_mul_f32 v222, v222, v123
    v_mul_f32 v223, v223, v123
    v_mul_f32 v224, v224, v123
    v_mul_f32 v225, v225, v123
    v_mul_f32 v226, v226, v123
    v_mul_f32 v227, v227, v123
    v_mul_f32 v228, v228, v123
    v_mul_f32 v229, v229, v123
    v_mul_f32 v230, v230, v123
    v_mul_f32 v231, v231, v123
    v_mul_f32 v232, v232, v123
    v_mul_f32 v233, v233, v123
    v_mul_f32 v234, v234, v123
    v_mul_f32 v235, v235, v123
    v_mul_f32 v236, v236, v123
    v_mul_f32 v237, v237, v123
    v_mul_f32 v238, v238, v123
    v_mul_f32 v239, v239, v123
    v_mul_f32 v240, v240, v123
    v_mul_f32 v241, v241, v123
    v_mul_f32 v242, v242, v123
    v_mul_f32 v243, v243, v123
    v_mul_f32 v244, v244, v123
    v_mul_f32 v245, v245, v123
    v_mul_f32 v246, v246, v123
    v_mul_f32 v247, v247, v123
    v_mul_f32 v248, v248, v123
    v_mul_f32 v249, v249, v123
    v_mul_f32 v250, v250, v123
    v_mul_f32 v251, v251, v123
    v_mul_f32 v252, v252, v123
    v_mul_f32 v253, v253, v123
    v_mul_f32 v254, v254, v123
    v_mul_f32 v255, v255, v123
    v_exp_f32 v40, v72
    v_exp_f32 v41, v73
    v_exp_f32 v42, v74
    v_exp_f32 v43, v75
    v_cvt_pk_bf16_f32 v56, v40, v41
    v_exp_f32 v44, v76
    v_exp_f32 v45, v77
    v_cvt_pk_bf16_f32 v57, v42, v43
    v_exp_f32 v46, v78
    v_exp_f32 v47, v79
    v_cvt_pk_bf16_f32 v60, v44, v45
    v_exp_f32 v48, v80
    v_exp_f32 v49, v81
    v_cvt_pk_bf16_f32 v61, v46, v47
    v_exp_f32 v50, v82
    v_exp_f32 v51, v83
    v_cvt_pk_bf16_f32 v58, v48, v49
    v_exp_f32 v52, v84
    v_exp_f32 v53, v85
    v_cvt_pk_bf16_f32 v59, v50, v51
    v_exp_f32 v54, v86
    v_exp_f32 v55, v87
    v_cvt_pk_bf16_f32 v62, v52, v53
    v_exp_f32 v40, v88
    v_exp_f32 v41, v89
    v_cvt_pk_bf16_f32 v63, v54, v55
    v_exp_f32 v42, v90
    v_exp_f32 v43, v91
    v_cvt_pk_bf16_f32 v64, v40, v41
    v_exp_f32 v44, v92
    v_exp_f32 v45, v93
    v_cvt_pk_bf16_f32 v65, v42, v43
    v_exp_f32 v46, v94
    v_exp_f32 v47, v95
    v_cvt_pk_bf16_f32 v68, v44, v45
    v_exp_f32 v48, v96
    v_exp_f32 v49, v97
    v_cvt_pk_bf16_f32 v69, v46, v47
    v_exp_f32 v50, v98
    v_exp_f32 v51, v99
    v_cvt_pk_bf16_f32 v66, v48, v49
    v_exp_f32 v52, v100
    v_exp_f32 v53, v101
    v_cvt_pk_bf16_f32 v67, v50, v51
    v_exp_f32 v54, v102
    v_exp_f32 v55, v103
    v_cvt_pk_bf16_f32 v70, v52, v53
    v_cvt_pk_bf16_f32 v71, v54, v55
    s_nop 4
    s_cmp_eq_u32 s18, 0
    s_cbranch_scc1 K2_LOOP
    s_mov_b32 s18, 0
    s_branch K2_HB2
.p2align 6
K2_LOOPM:
    v_mfma_f32_16x16x32_bf16 v[72:75], a[64:67], a[0:3], v[16:19]
    s_add_u32 m0, s30, s44
    ds_read_b128 a[100:103], v9 offset:9216
    v_mov_b32 v104, v56
    v_mfma_f32_16x16x32_bf16 v[72:75], a[68:71], a[4:7], v[72:75]
    buffer_load_dwordx4 v6, s[24:27], s34 offen offset:0 lds
    v_mfma_f32_16x16x32_bf16 v[76:79], a[64:67], a[32:35], v[20:23]
    s_add_u32 s50, s38, s47
    ds_read_b128 a[96:99], v9 offset:8192
    v_mov_b32 v105, v57
    v_mfma_f32_16x16x32_bf16 v[76:79], a[68:71], a[36:39], v[76:79]
    s_waitcnt lgkmcnt(6)
    v_mov_b32 v108, v60
    v_mov_b32 v109, v61
    v_mfma_f32_16x16x32_bf16 v[76:79], a[72:75], a[40:43], v[76:79]
    s_add_u32 s50, s50, 1
    ds_read_b128 a[108:111], v9 offset:11264
    v_mov_b32 v106, v58
    v_mfma_f32_16x16x32_bf16 v[76:79], a[76:79], a[44:47], v[76:79]
    s_lshl_b32 s50, s50, 6
    v_mov_b32 v107, v59
    v_mov_b32 v110, v62
    v_mfma_f32_16x16x32_bf16 v[72:75], a[76:79], a[12:15], v[72:75]
    s_waitcnt lgkmcnt(5)
    ds_read_b128 a[104:107], v9 offset:10240
    v_mov_b32 v111, v63
    v_mfma_f32_16x16x32_bf16 v[72:75], a[72:75], a[8:11], v[72:75]
    buffer_load_dwordx4 v6, s[24:27], s34 offen offset:1024 lds
    v_mfma_f32_16x16x32_bf16 v[72:75], a[80:83], a[16:19], v[72:75]
    ds_read_b128 a[116:119], v9 offset:13312
    v_subrev_u32 v5, s50, v11
    v_mfma_f32_16x16x32_bf16 v[72:75], a[84:87], a[20:23], v[72:75]
    v_cmp_gt_i32 s[12:13], 0, v5
    v_cmp_gt_i32 s[14:15], 1, v5
    v_mfma_f32_16x16x32_bf16 v[76:79], a[84:87], a[52:55], v[76:79]
    ds_read_b128 a[112:115], v9 offset:12288
    v_cmp_gt_i32 s[52:53], 2, v5
    v_mfma_f32_16x16x32_bf16 v[76:79], a[80:83], a[48:51], v[76:79]
    s_waitcnt lgkmcnt(6)
    v_cmp_gt_i32 s[54:55], 3, v5
    v_cmp_gt_i32 s[4:5], -16, v5
    v_mfma_f32_16x16x32_bf16 v[76:79], a[88:91], a[56:59], v[76:79]
    ds_read_b128 a[124:127], v9 offset:15360
    v_cmp_gt_i32 s[6:7], -15, v5
    v_mfma_f32_16x16x32_bf16 v[76:79], a[92:95], a[60:63], v[76:79]
    buffer_load_dwordx4 v6, s[24:27], s34 offen offset:2048 lds
    v_mfma_f32_16x16x32_bf16 v[72:75], a[92:95], a[28:31], v[72:75]
    ds_read_b128 a[120:123], v9 offset:14336
    v_cmp_gt_i32 s[8:9], -14, v5
    v_mfma_f32_16x16x32_bf16 v[72:75], a[88:91], a[24:27], v[72:75]
    s_waitcnt lgkmcnt(6)
    v_cmp_gt_i32 s[10:11], -13, v5
    v_cmp_gt_i32 s[56:57], 16, v5
    v_mfma_f32_16x16x32_bf16 v[80:83], a[96:99], a[0:3], v[16:19]
    ds_read_b128 a[68:71], v9 offset:17408
    v_cmp_gt_i32 s[58:59], 17, v5
    v_mfma_f32_16x16x32_bf16 v[80:83], a[100:103], a[4:7], v[80:83]
    v_cmp_gt_i32 s[60:61], 18, v5
    v_cmp_gt_i32 s[62:63], 19, v5
    v_mfma_f32_16x16x32_bf16 v[84:87], a[96:99], a[32:35], v[20:23]
    s_waitcnt lgkmcnt(5)
    ds_read_b128 a[64:67], v9 offset:16384
    v_mov_b32 v112, v64
    v_mfma_f32_16x16x32_bf16 v[84:87], a[100:103], a[36:39], v[84:87]
    buffer_load_dwordx4 v6, s[24:27], s34 offen offset:3072 lds
    v_mfma_f32_16x16x32_bf16 v[84:87], a[104:107], a[40:43], v[84:87]
    s_add_u32 m0, m0, 4096
    ds_read_b128 a[76:79], v9 offset:19456
    v_mov_b32 v113, v65
    v_mfma_f32_16x16x32_bf16 v[84:87], a[108:111], a[44:47], v[84:87]
    v_mov_b32 v116, v68
    v_mov_b32 v117, v69
    v_mfma_f32_16x16x32_bf16 v[80:83], a[108:111], a[12:15], v[80:83]
    ds_read_b128 a[72:75], v9 offset:18432
    v_mov_b32 v114, v66
    v_mfma_f32_16x16x32_bf16 v[80:83], a[104:107], a[8:11], v[80:83]
    s_waitcnt lgkmcnt(6)
    v_mov_b32 v115, v67
    v_mov_b32 v118, v70
    v_mfma_f32_16x16x32_bf16 v[80:83], a[112:115], a[16:19], v[80:83]
    ds_read_b128 a[84:87], v9 offset:21504
    v_mov_b32 v119, v71
    v_mfma_f32_16x16x32_bf16 v[80:83], a[116:119], a[20:23], v[80:83]
    buffer_load_dwordx4 v7, s[24:27], s34 offen offset:0 lds
    v_mfma_f32_16x16x32_bf16 v[84:87], a[116:119], a[52:55], v[84:87]
    ds_read_b128 a[80:83], v9 offset:20480
    v_add_u32 v10, s29, v8
    v_mfma_f32_16x16x32_bf16 v[84:87], a[112:115], a[48:51], v[84:87]
    s_waitcnt lgkmcnt(6)
    v_cndmask_b32 v72, v72, v15, s[12:13]
    v_cndmask_b32 v73, v73, v15, s[14:15]
    v_mfma_f32_16x16x32_bf16 v[84:87], a[120:123], a[56:59], v[84:87]
    ds_read_b128 a[92:95], v9 offset:23552
    v_cndmask_b32 v74, v74, v15, s[52:53]
    v_mfma_f32_16x16x32_bf16 v[84:87], a[124:127], a[60:63], v[84:87]
    v_exp_f32 v40, v72
    v_mfma_f32_16x16x32_bf16 v[80:83], a[124:127], a[28:31], v[80:83]
    s_waitcnt lgkmcnt(5)
    ds_read_b128 a[88:91], v9 offset:22528
    v_cndmask_b32 v75, v75, v15, s[54:55]
    v_mfma_f32_16x16x32_bf16 v[80:83], a[120:123], a[24:27], v[80:83]
    buffer_load_dwordx4 v7, s[24:27], s34 offen offset:1024 lds
    v_mfma_f32_16x16x32_bf16 v[88:91], a[64:67], a[0:3], v[16:19]
    ds_read_b128 a[100:103], v9 offset:25600
    v_cndmask_b32 v76, v76, v15, s[4:5]
    v_mfma_f32_16x16x32_bf16 v[88:91], a[68:71], a[4:7], v[88:91]
    v_exp_f32 v41, v73
    v_mfma_f32_16x16x32_bf16 v[92:95], a[64:67], a[32:35], v[20:23]
    ds_read_b128 a[96:99], v9 offset:24576
    v_cvt_pk_bf16_f32 v56, v40, v41
    v_mfma_f32_16x16x32_bf16 v[92:95], a[68:71], a[36:39], v[92:95]
    s_waitcnt lgkmcnt(6)
    v_exp_f32 v42, v74
    v_mfma_f32_16x16x32_bf16 v[92:95], a[72:75], a[40:43], v[92:95]
    ds_read_b128 a[108:111], v9 offset:27648
    v_cndmask_b32 v77, v77, v15, s[6:7]
    v_mfma_f32_16x16x32_bf16 v[92:95], a[76:79], a[44:47], v[92:95]
    buffer_load_dwordx4 v7, s[24:27], s34 offen offset:2048 lds
    v_mfma_f32_16x16x32_bf16 v[88:91], a[76:79], a[12:15], v[88:91]
    ds_read_b128 a[104:107], v9 offset:26624
    v_cndmask_b32 v78, v78, v15, s[8:9]
    v_mfma_f32_16x16x32_bf16 v[88:91], a[72:75], a[8:11], v[88:91]
    s_waitcnt lgkmcnt(6)
    v_exp_f32 v43, v75
    v_mfma_f32_16x16x32_bf16 v[88:91], a[80:83], a[16:19], v[88:91]
    ds_read_b128 a[116:119], v9 offset:29696
    v_cndmask_b32 v79, v79, v15, s[10:11]
    v_mfma_f32_16x16x32_bf16 v[88:91], a[84:87], a[20:23], v[88:91]
    v_exp_f32 v44, v76
    v_mfma_f32_16x16x32_bf16 v[92:95], a[84:87], a[52:55], v[92:95]
    s_waitcnt lgkmcnt(5)
    ds_read_b128 a[112:115], v9 offset:28672
    v_cmp_gt_i32 s[4:5], 32, v5
    v_mfma_f32_16x16x32_bf16 v[92:95], a[80:83], a[48:51], v[92:95]
    buffer_load_dwordx4 v7, s[24:27], s34 offen offset:3072 lds
    v_mfma_f32_16x16x32_bf16 v[92:95], a[88:91], a[56:59], v[92:95]
    s_add_u32 m0, s31, s44
    ds_read_b128 a[124:127], v9 offset:31744
    v_cmp_gt_i32 s[6:7], 33, v5
    v_mfma_f32_16x16x32_bf16 v[92:95], a[92:95], a[60:63], v[92:95]
    s_waitcnt lgkmcnt(5)
    v_exp_f32 v45, v77
    v_mfma_f32_16x16x32_bf16 v[88:91], a[92:95], a[28:31], v[88:91]
    s_waitcnt vmcnt(16)
    ds_read_b128 a[120:123], v9 offset:30720
    v_cmp_gt_i32 s[8:9], 34, v5
    v_mfma_f32_16x16x32_bf16 v[88:91], a[88:91], a[24:27], v[88:91]
    s_barrier
    v_exp_f32 v46, v78
    v_mfma_f32_16x16x32_bf16 v[96:99], a[96:99], a[0:3], v[16:19]
    s_add_u32 s35, s35, 1
    ds_read_b128 a[68:71], v10 offset:16384
    v_cmp_gt_i32 s[10:11], 35, v5
    v_mfma_f32_16x16x32_bf16 v[96:99], a[100:103], a[4:7], v[96:99]
    s_add_u32 s34, s34, 32768
    v_exp_f32 v47, v79
    v_mfma_f32_16x16x32_bf16 v[100:103], a[96:99], a[32:35], v[20:23]
    s_cmp_eq_u32 s35, s36
    ds_read_b128 a[64:67], v10 offset:0
    v_cvt_pk_bf16_f32 v57, v42, v43
    v_mfma_f32_16x16x32_bf16 v[100:103], a[100:103], a[36:39], v[100:103]
    s_waitcnt lgkmcnt(6)
    v_or_b32 v14, v56, v57
    v_cvt_pk_bf16_f32 v60, v44, v45
    v_mfma_f32_16x16x32_bf16 v[100:103], a[104:107], a[40:43], v[100:103]
    s_cselect_b32 s34, s40, s34
    ds_read_b128 a[76:79], v10 offset:17408
    v_cndmask_b32 v80, v80, v15, s[56:57]
    v_mfma_f32_16x16x32_bf16 v[100:103], a[108:111], a[44:47], v[100:103]
    buffer_load_dwordx4 v6, s[24:27], s32 offen offset:0 lds
    v_mfma_f32_16x16x32_bf16 v[96:99], a[108:111], a[12:15], v[96:99]
    s_cmp_eq_u32 s35, s37
    ds_read_b128 a[72:75], v10 offset:1024
    v_cndmask_b32 v81, v81, v15, s[58:59]
    v_mfma_f32_16x16x32_bf16 v[96:99], a[104:107], a[8:11], v[96:99]
    s_waitcnt lgkmcnt(6)
    v_exp_f32 v48, v80
    v_mfma_f32_16x16x32_bf16 v[96:99], a[112:115], a[16:19], v[96:99]
    s_cselect_b32 s34, s65, s34
    ds_read_b128 a[84:87], v10 offset:18432
    v_cndmask_b32 v82, v82, v15, s[60:61]
    v_mfma_f32_16x16x32_bf16 v[96:99], a[116:119], a[20:23], v[96:99]
    v_exp_f32 v49, v81
    v_mfma_f32_16x16x32_bf16 v[100:103], a[116:119], a[52:55], v[100:103]
    ds_read_b128 a[80:83], v10 offset:2048
    v_cndmask_b32 v83, v83, v15, s[62:63]
    v_mfma_f32_16x16x32_bf16 v[100:103], a[112:115], a[48:51], v[100:103]
    s_waitcnt lgkmcnt(6)
    v_exp_f32 v50, v82
    v_mfma_f32_16x16x32_bf16 v[100:103], a[120:123], a[56:59], v[100:103]
    s_cmp_eq_u32 s38, s16
    ds_read_b128 a[92:95], v10 offset:19456
    v_cvt_pk_bf16_f32 v61, v46, v47
    v_mfma_f32_16x16x32_bf16 v[100:103], a[124:127], a[60:63], v[100:103]
    buffer_load_dwordx4 v6, s[24:27], s32 offen offset:1024 lds
    v_mfma_f32_16x16x32_bf16 v[96:99], a[124:127], a[28:31], v[96:99]
    ds_read_b128 a[88:91], v10 offset:3072
    v_or3_b32 v14, v60, v61, v14
    v_mfma_f32_16x16x32_bf16 v[96:99], a[120:123], a[24:27], v[96:99]
    s_waitcnt lgkmcnt(6)
    v_exp_f32 v51, v83
    s_cbranch_scc1 K2L_LQ
K2L_LQR:
    v_mfma_f32_16x16x32_bf16 v[128:131], a[64:67], v[104:107], v[128:131]
    s_mov_b32 s30, s28
    ds_read_b128 a[100:103], v10 offset:20480
    v_cvt_pk_bf16_f32 v58, v48, v49
    v_mfma_f32_16x16x32_bf16 v[128:131], a[68:71], v[112:115], v[128:131]
    s_add_u32 s28, s28, 65536
    v_cndmask_b32 v84, v84, v15, s[12:13]
    v_mfma_f32_16x16x32_bf16 v[192:195], a[68:71], v[116:119], v[192:195]
    s_cmp_ge_u32 s28, 163840
    ds_read_b128 a[96:99], v10 offset:4096
    v_mfma_f32_16x16x32_bf16 v[192:195], a[64:67], v[108:111], v[192:195]
    s_waitcnt lgkmcnt(6)
    v_exp_f32 v52, v84
    v_mfma_f32_16x16x32_bf16 v[196:199], a[72:75], v[108:111], v[196:199]
    s_cselect_b32 s50, 163840, 0
    ds_read_b128 a[108:111], v10 offset:21504
    v_mfma_f32_16x16x32_bf16 v[196:199], a[76:79], v[116:119], v[196:199]
    buffer_load_dwordx4 v6, s[24:27], s32 offen offset:2048 lds
    v_mfma_f32_16x16x32_bf16 v[132:135], a[76:79], v[112:115], v[132:135]
    s_sub_u32 s28, s28, s50
    ds_read_b128 a[104:107], v10 offset:5120
    v_cndmask_b32 v85, v85, v15, s[14:15]
    v_mfma_f32_16x16x32_bf16 v[132:135], a[72:75], v[104:107], v[132:135]
    v_exp_f32 v53, v85
    v_mfma_f32_16x16x32_bf16 v[24:27], v[32:35], v[104:107], v[24:27]
    v_add_u32 v9, s28, v8
    v_cndmask_b32 v86, v86, v15, s[52:53]
    v_mfma_f32_16x16x32_bf16 v[24:27], v[32:35], v[112:115], v[24:27]
    v_exp_f32 v54, v86
    v_mfma_f32_16x16x32_bf16 v[28:31], v[32:35], v[108:111], v[28:31]
    v_cndmask_b32 v87, v87, v15, s[54:55]
    v_cmp_gt_i32 s[12:13], 48, v5
    v_mfma_f32_16x16x32_bf16 v[28:31], v[32:35], v[116:119], v[28:31]
    s_waitcnt lgkmcnt(6)
    v_exp_f32 v55, v87
    v_mfma_f32_16x16x32_bf16 v[136:139], a[80:83], v[104:107], v[136:139]
    ds_read_b128 a[116:119], v10 offset:22528
    v_cmp_gt_i32 s[14:15], 49, v5
    v_mfma_f32_16x16x32_bf16 v[136:139], a[84:87], v[112:115], v[136:139]
    buffer_load_dwordx4 v6, s[24:27], s32 offen offset:3072 lds
    v_mfma_f32_16x16x32_bf16 v[200:203], a[84:87], v[116:119], v[200:203]
    s_add_u32 m0, m0, 4096
    ds_read_b128 a[112:115], v10 offset:6144
    v_mfma_f32_16x16x32_bf16 v[200:203], a[80:83], v[108:111], v[200:203]
    s_waitcnt lgkmcnt(6)
    v_cmp_gt_i32 s[52:53], 50, v5
    v_cmp_gt_i32 s[54:55], 51, v5
    v_mfma_f32_16x16x32_bf16 v[204:207], a[88:91], v[108:111], v[204:207]
    ds_read_b128 a[124:127], v10 offset:23552
    v_cvt_pk_bf16_f32 v59, v50, v51
    v_mfma_f32_16x16x32_bf16 v[204:207], a[92:95], v[116:119], v[204:207]
    v_or3_b32 v14, v58, v59, v14
    v_cvt_pk_bf16_f32 v62, v52, v53
    v_mfma_f32_16x16x32_bf16 v[140:143], a[92:95], v[112:115], v[140:143]
    ds_read_b128 a[120:123], v10 offset:7168
    v_cndmask_b32 v88, v88, v15, s[4:5]
    v_mfma_f32_16x16x32_bf16 v[140:143], a[88:91], v[104:107], v[140:143]
    s_waitcnt lgkmcnt(6)
    v_exp_f32 v40, v88
    v_mfma_f32_16x16x32_bf16 v[144:147], a[96:99], v[104:107], v[144:147]
    ds_read_b128 a[68:71], v10 offset:24576
    v_cndmask_b32 v89, v89, v15, s[6:7]
    v_mfma_f32_16x16x32_bf16 v[144:147], a[100:103], v[112:115], v[144:147]
    buffer_load_dwordx4 v7, s[24:27], s32 offen offset:0 lds
    v_mfma_f32_16x16x32_bf16 v[208:211], a[100:103], v[116:119], v[208:211]
    s_mov_b32 s31, s29
    ds_read_b128 a[64:67], v10 offset:8192
    v_cndmask_b32 v90, v90, v15, s[8:9]
    v_mfma_f32_16x16x32_bf16 v[208:211], a[96:99], v[108:111], v[208:211]
    s_waitcnt lgkmcnt(6)
    v_exp_f32 v41, v89
    v_mfma_f32_16x16x32_bf16 v[212:215], a[104:107], v[108:111], v[212:215]
    s_add_u32 s29, s29, 65536
    ds_read_b128 a[76:79], v10 offset:25600
    v_mfma_f32_16x16x32_bf16 v[212:215], a[108:111], v[116:119], v[212:215]
    s_cmp_ge_u32 s29, 163840
    v_exp_f32 v42, v90
    v_mfma_f32_16x16x32_bf16 v[148:151], a[108:111], v[112:115], v[148:151]
    s_cselect_b32 s50, 163840, 0
    ds_read_b128 a[72:75], v10 offset:9216
    v_mfma_f32_16x16x32_bf16 v[148:151], a[104:107], v[104:107], v[148:151]
    s_waitcnt lgkmcnt(6)
    v_cndmask_b32 v91, v91, v15, s[10:11]
    v_cvt_pk_bf16_f32 v63, v54, v55
    v_mfma_f32_16x16x32_bf16 v[152:155], a[112:115], v[104:107], v[152:155]
    s_sub_u32 s29, s29, s50
    ds_read_b128 a[84:87], v10 offset:26624
    v_or3_b32 v14, v62, v63, v14
    v_mfma_f32_16x16x32_bf16 v[152:155], a[116:119], v[112:115], v[152:155]
    buffer_load_dwordx4 v7, s[24:27], s32 offen offset:1024 lds
    v_mfma_f32_16x16x32_bf16 v[216:219], a[116:119], v[116:119], v[216:219]
    ds_read_b128 a[80:83], v10 offset:10240
    v_cvt_pk_bf16_f32 v64, v40, v41
    v_mfma_f32_16x16x32_bf16 v[216:219], a[112:115], v[108:111], v[216:219]
    s_waitcnt lgkmcnt(6)
    v_exp_f32 v43, v91
    v_mfma_f32_16x16x32_bf16 v[220:223], a[120:123], v[108:111], v[220:223]
    ds_read_b128 a[92:95], v10 offset:27648
    v_cndmask_b32 v92, v92, v15, s[56:57]
    v_mfma_f32_16x16x32_bf16 v[220:223], a[124:127], v[116:119], v[220:223]
    v_exp_f32 v44, v92
    v_mfma_f32_16x16x32_bf16 v[156:159], a[124:127], v[112:115], v[156:159]
    ds_read_b128 a[88:91], v10 offset:11264
    v_cndmask_b32 v93, v93, v15, s[58:59]
    v_mfma_f32_16x16x32_bf16 v[156:159], a[120:123], v[104:107], v[156:159]
    s_waitcnt lgkmcnt(6)
    v_exp_f32 v45, v93
    v_mfma_f32_16x16x32_bf16 v[160:163], a[64:67], v[104:107], v[160:163]
    ds_read_b128 a[100:103], v10 offset:28672
    v_cndmask_b32 v94, v94, v15, s[60:61]
    v_mfma_f32_16x16x32_bf16 v[160:163], a[68:71], v[112:115], v[160:163]
    buffer_load_dwordx4 v7, s[24:27], s32 offen offset:2048 lds
    v_mfma_f32_16x16x32_bf16 v[224:227], a[68:71], v[116:119], v[224:227]
    ds_read_b128 a[96:99], v10 offset:12288
    v_cndmask_b32 v95, v95, v15, s[62:63]
    v_mfma_f32_16x16x32_bf16 v[224:227], a[64:67], v[108:111], v[224:227]
    s_waitcnt lgkmcnt(6)
    v_exp_f32 v46, v94
    v_mfma_f32_16x16x32_bf16 v[228:231], a[72:75], v[108:111], v[228:231]
    ds_read_b128 a[108:111], v10 offset:29696
    v_cvt_pk_bf16_f32 v65, v42, v43
    v_mfma_f32_16x16x32_bf16 v[228:231], a[76:79], v[116:119], v[228:231]
    v_exp_f32 v47, v95
    v_mfma_f32_16x16x32_bf16 v[164:167], a[76:79], v[112:115], v[164:167]
    ds_read_b128 a[104:107], v10 offset:13312
    v_or3_b32 v14, v64, v65, v14
    v_mfma_f32_16x16x32_bf16 v[164:167], a[72:75], v[104:107], v[164:167]
    s_waitcnt lgkmcnt(6)
    v_cvt_pk_bf16_f32 v68, v44, v45
    v_cndmask_b32 v96, v96, v15, s[12:13]
    v_mfma_f32_16x16x32_bf16 v[168:171], a[80:83], v[104:107], v[168:171]
    ds_read_b128 a[116:119], v10 offset:30720
    v_cndmask_b32 v97, v97, v15, s[14:15]
    v_mfma_f32_16x16x32_bf16 v[168:171], a[84:87], v[112:115], v[168:171]
    buffer_load_dwordx4 v7, s[24:27], s32 offen offset:3072 lds
    v_mfma_f32_16x16x32_bf16 v[232:235], a[84:87], v[116:119], v[232:235]
    s_add_u32 s33, s33, 1
    ds_read_b128 a[112:115], v10 offset:14336
    v_cndmask_b32 v98, v98, v15, s[52:53]
    v_mfma_f32_16x16x32_bf16 v[232:235], a[80:83], v[108:111], v[232:235]
    s_waitcnt lgkmcnt(6)
    v_exp_f32 v48, v96
    v_mfma_f32_16x16x32_bf16 v[236:239], a[88:91], v[108:111], v[236:239]
    s_add_u32 s32, s32, 32768
    ds_read_b128 a[124:127], v10 offset:31744
    v_mfma_f32_16x16x32_bf16 v[236:239], a[92:95], v[116:119], v[236:239]
    s_waitcnt lgkmcnt(5)
    v_exp_f32 v49, v97
    v_mfma_f32_16x16x32_bf16 v[172:175], a[92:95], v[112:115], v[172:175]
    s_waitcnt vmcnt(16)
    ds_read_b128 a[120:123], v10 offset:15360
    v_cndmask_b32 v99, v99, v15, s[54:55]
    v_mfma_f32_16x16x32_bf16 v[172:175], a[88:91], v[104:107], v[172:175]
    s_barrier
    v_exp_f32 v50, v98
    v_mfma_f32_16x16x32_bf16 v[176:179], a[96:99], v[104:107], v[176:179]
    s_cmp_eq_u32 s33, s36
    ds_read_b128 a[68:71], v9 offset:1024
    v_cvt_pk_bf16_f32 v69, v46, v47
    v_mfma_f32_16x16x32_bf16 v[176:179], a[100:103], v[112:115], v[176:179]
    s_cselect_b32 s32, s39, s32
    v_exp_f32 v51, v99
    v_mfma_f32_16x16x32_bf16 v[240:243], a[100:103], v[116:119], v[240:243]
    s_cmp_eq_u32 s33, s37
    ds_read_b128 a[64:67], v9 offset:0
    v_or3_b32 v14, v68, v69, v14
    v_mfma_f32_16x16x32_bf16 v[240:243], a[96:99], v[108:111], v[240:243]
    s_waitcnt lgkmcnt(6)
    v_cvt_pk_bf16_f32 v66, v48, v49
    v_cndmask_b32 v100, v100, v15, s[4:5]
    v_mfma_f32_16x16x32_bf16 v[244:247], a[104:107], v[108:111], v[244:247]
    s_cselect_b32 s32, s65, s32
    ds_read_b128 a[76:79], v9 offset:3072
    v_cndmask_b32 v101, v101, v15, s[6:7]
    v_mfma_f32_16x16x32_bf16 v[244:247], a[108:111], v[116:119], v[244:247]
    s_add_u32 s38, s38, 1
    v_exp_f32 v52, v100
    v_mfma_f32_16x16x32_bf16 v[180:183], a[108:111], v[112:115], v[180:183]
    ds_read_b128 a[72:75], v9 offset:2048
    v_cndmask_b32 v102, v102, v15, s[8:9]
    v_mfma_f32_16x16x32_bf16 v[180:183], a[104:107], v[104:107], v[180:183]
    s_waitcnt lgkmcnt(6)
    v_exp_f32 v53, v101
    v_mfma_f32_16x16x32_bf16 v[184:187], a[112:115], v[104:107], v[184:187]
    ds_read_b128 a[84:87], v9 offset:5120
    v_cndmask_b32 v103, v103, v15, s[10:11]
    v_mfma_f32_16x16x32_bf16 v[184:187], a[116:119], v[112:115], v[184:187]
    v_exp_f32 v54, v102
    v_mfma_f32_16x16x32_bf16 v[248:251], a[116:119], v[116:119], v[248:251]
    ds_read_b128 a[80:83], v9 offset:4096
    v_cvt_pk_bf16_f32 v67, v50, v51
    v_mfma_f32_16x16x32_bf16 v[248:251], a[112:115], v[108:111], v[248:251]
    s_waitcnt lgkmcnt(6)
    v_exp_f32 v55, v103
    v_mfma_f32_16x16x32_bf16 v[252:255], a[120:123], v[108:111], v[252:255]
    ds_read_b128 a[92:95], v9 offset:7168
    v_or3_b32 v14, v66, v67, v14
    v_mfma_f32_16x16x32_bf16 v[252:255], a[124:127], v[116:119], v[252:255]
    v_cvt_pk_bf16_f32 v70, v52, v53
    v_cvt_pk_bf16_f32 v71, v54, v55
    v_mfma_f32_16x16x32_bf16 v[188:191], a[124:127], v[112:115], v[188:191]
    ds_read_b128 a[88:91], v9 offset:6144
    v_or3_b32 v14, v70, v71, v14
    v_and_b32 v14, 0x40004000, v14
    v_cmp_ne_u32 vcc, 0, v14
    v_mfma_f32_16x16x32_bf16 v[188:191], a[120:123], v[104:107], v[188:191]
    s_waitcnt lgkmcnt(6)
    s_branch K2_HB
K2L_LQ:
    s_add_u32 s50, s42, 0
    s_add_u32 s51, s42, 8192
    buffer_load_dwordx4 a[0:3], v8, s[24:27], s50 offen offset:0
    buffer_load_dwordx4 a[32:35], v8, s[24:27], s51 offen offset:0
    buffer_load_dwordx4 a[4:7], v8, s[24:27], s50 offen offset:1024
    buffer_load_dwordx4 a[36:39], v8, s[24:27], s51 offen offset:1024
    buffer_load_dwordx4 a[8:11], v8, s[24:27], s50 offen offset:2048
    buffer_load_dwordx4 a[40:43], v8, s[24:27], s51 offen offset:2048
    buffer_load_dwordx4 a[12:15], v8, s[24:27], s50 offen offset:3072
    buffer_load_dwordx4 a[44:47], v8, s[24:27], s51 offen offset:3072
    s_add_u32 s50, s42, 4096
    s_add_u32 s51, s42, 12288
    buffer_load_dwordx4 a[16:19], v8, s[24:27], s50 offen offset:0
    buffer_load_dwordx4 a[48:51], v8, s[24:27], s51 offen offset:0
    buffer_load_dwordx4 a[20:23], v8, s[24:27], s50 offen offset:1024
    buffer_load_dwordx4 a[52:55], v8, s[24:27], s51 offen offset:1024
    buffer_load_dwordx4 a[24:27], v8, s[24:27], s50 offen offset:2048
    buffer_load_dwordx4 a[56:59], v8, s[24:27], s51 offen offset:2048
    buffer_load_dwordx4 a[28:31], v8, s[24:27], s50 offen offset:3072
    buffer_load_dwordx4 a[60:63], v8, s[24:27], s51 offen offset:3072
    s_branch K2L_LQR
K2_SEGEND:
    s_nop 7
    s_waitcnt lgkmcnt(0)
    v_max_f32 v120, 0x0da24260, v24
    v_rcp_f32 v120, v120
    v_log_f32 v122, v24
    s_nop 0
    v_sub_f32 v122, v122, v36
    v_max_f32 v121, 0x0da24260, v28
    v_rcp_f32 v121, v121
    v_log_f32 v123, v28
    s_nop 0
    v_sub_f32 v123, v123, v37
    s_lshl_b32 s51, s46, 16
    s_lshl_b32 s52, s20, 14
    s_add_u32 s51, s51, s52
    s_add_u32 s51, s51, 71303168
    s_lshl_b32 s52, s46, 9
    s_lshl_b32 s53, s20, 7
    s_add_u32 s52, s52, s53
    s_add_u32 s52, s52, 70516736
    v_and_b32 v3, 15, v2
    v_lshlrev_b32 v3, 2, v3
    v_lshrrev_b32 v4, 4, v2
    v_lshl_or_b32 v3, v4, 28, v3
    buffer_store_dword v122, v3, s[24:27], s52 offen offset:0 sc1
    buffer_store_dword v123, v3, s[24:27], s52 offen offset:64 sc1
    v_pk_mul_f32 v[128:129], v[128:129], v[120:121] op_sel_hi:[1,0]
    v_pk_mul_f32 v[130:131], v[130:131], v[120:121] op_sel_hi:[1,0]
    v_pk_mul_f32 v[132:133], v[132:133], v[120:121] op_sel_hi:[1,0]
    v_pk_mul_f32 v[134:135], v[134:135], v[120:121] op_sel_hi:[1,0]
    v_cvt_pk_bf16_f32 v128, v128, v129
    v_cvt_pk_bf16_f32 v129, v130, v131
    v_cvt_pk_bf16_f32 v130, v132, v133
    v_cvt_pk_bf16_f32 v131, v134, v135
    s_add_u32 s50, s51, 0
    buffer_store_dwordx4 v[128:131], v8, s[24:27], s50 offen sc1
    v_pk_mul_f32 v[192:193], v[192:193], v[120:121] op_sel:[0,1] op_sel_hi:[1,1]
    v_pk_mul_f32 v[194:195], v[194:195], v[120:121] op_sel:[0,1] op_sel_hi:[1,1]
    v_pk_mul_f32 v[196:197], v[196:197], v[120:121] op_sel:[0,1] op_sel_hi:[1,1]
    v_pk_mul_f32 v[198:199], v[198:199], v[120:121] op_sel:[0,1] op_sel_hi:[1,1]
    v_cvt_pk_bf16_f32 v192, v192, v193
    v_cvt_pk_bf16_f32 v193, v194, v195
    v_cvt_pk_bf16_f32 v194, v196, v197
    v_cvt_pk_bf16_f32 v195, v198, v199
    s_add_u32 s50, s51, 8192
    buffer_store_dwordx4 v[192:195], v8, s[24:27], s50 offen sc1
    v_pk_mul_f32 v[136:137], v[136:137], v[120:121] op_sel_hi:[1,0]
    v_pk_mul_f32 v[138:139], v[138:139], v[120:121] op_sel_hi:[1,0]
    v_pk_mul_f32 v[140:141], v[140:141], v[120:121] op_sel_hi:[1,0]
    v_pk_mul_f32 v[142:143], v[142:143], v[120:121] op_sel_hi:[1,0]
    v_cvt_pk_bf16_f32 v136, v136, v137
    v_cvt_pk_bf16_f32 v137, v138, v139
    v_cvt_pk_bf16_f32 v138, v140, v141
    v_cvt_pk_bf16_f32 v139, v142, v143
    s_add_u32 s50, s51, 1024
    buffer_store_dwordx4 v[136:139], v8, s[24:27], s50 offen sc1
    v_pk_mul_f32 v[200:201], v[200:201], v[120:121] op_sel:[0,1] op_sel_hi:[1,1]
    v_pk_mul_f32 v[202:203], v[202:203], v[120:121] op_sel:[0,1] op_sel_hi:[1,1]
    v_pk_mul_f32 v[204:205], v[204:205], v[120:121] op_sel:[0,1] op_sel_hi:[1,1]
    v_pk_mul_f32 v[206:207], v[206:207], v[120:121] op_sel:[0,1] op_sel_hi:[1,1]
    v_cvt_pk_bf16_f32 v200, v200, v201
    v_cvt_pk_bf16_f32 v201, v202, v203
    v_cvt_pk_bf16_f32 v202, v204, v205
    v_cvt_pk_bf16_f32 v203, v206, v207
    s_add_u32 s50, s51, 9216
    buffer_store_dwordx4 v[200:203], v8, s[24:27], s50 offen sc1
    v_pk_mul_f32 v[144:145], v[144:145], v[120:121] op_sel_hi:[1,0]
    v_pk_mul_f32 v[146:147], v[146:147], v[120:121] op_sel_hi:[1,0]
    v_pk_mul_f32 v[148:149], v[148:149], v[120:121] op_sel_hi:[1,0]
    v_pk_mul_f32 v[150:151], v[150:151], v[120:121] op_sel_hi:[1,0]
    v_cvt_pk_bf16_f32 v144, v144, v145
    v_cvt_pk_bf16_f32 v145, v146, v147
    v_cvt_pk_bf16_f32 v146, v148, v149
    v_cvt_pk_bf16_f32 v147, v150, v151
    s_add_u32 s50, s51, 2048
    buffer_store_dwordx4 v[144:147], v8, s[24:27], s50 offen sc1
    v_pk_mul_f32 v[208:209], v[208:209], v[120:121] op_sel:[0,1] op_sel_hi:[1,1]
    v_pk_mul_f32 v[210:211], v[210:211], v[120:121] op_sel:[0,1] op_sel_hi:[1,1]
    v_pk_mul_f32 v[212:213], v[212:213], v[120:121] op_sel:[0,1] op_sel_hi:[1,1]
    v_pk_mul_f32 v[214:215], v[214:215], v[120:121] op_sel:[0,1] op_sel_hi:[1,1]
    v_cvt_pk_bf16_f32 v208, v208, v209
    v_cvt_pk_bf16_f32 v209, v210, v211
    v_cvt_pk_bf16_f32 v210, v212, v213
    v_cvt_pk_bf16_f32 v211, v214, v215
    s_add_u32 s50, s51, 10240
    buffer_store_dwordx4 v[208:211], v8, s[24:27], s50 offen sc1
    v_pk_mul_f32 v[152:153], v[152:153], v[120:121] op_sel_hi:[1,0]
    v_pk_mul_f32 v[154:155], v[154:155], v[120:121] op_sel_hi:[1,0]
    v_pk_mul_f32 v[156:157], v[156:157], v[120:121] op_sel_hi:[1,0]
    v_pk_mul_f32 v[158:159], v[158:159], v[120:121] op_sel_hi:[1,0]
    v_cvt_pk_bf16_f32 v152, v152, v153
    v_cvt_pk_bf16_f32 v153, v154, v155
    v_cvt_pk_bf16_f32 v154, v156, v157
    v_cvt_pk_bf16_f32 v155, v158, v159
    s_add_u32 s50, s51, 3072
    buffer_store_dwordx4 v[152:155], v8, s[24:27], s50 offen sc1
    v_pk_mul_f32 v[216:217], v[216:217], v[120:121] op_sel:[0,1] op_sel_hi:[1,1]
    v_pk_mul_f32 v[218:219], v[218:219], v[120:121] op_sel:[0,1] op_sel_hi:[1,1]
    v_pk_mul_f32 v[220:221], v[220:221], v[120:121] op_sel:[0,1] op_sel_hi:[1,1]
    v_pk_mul_f32 v[222:223], v[222:223], v[120:121] op_sel:[0,1] op_sel_hi:[1,1]
    v_cvt_pk_bf16_f32 v216, v216, v217
    v_cvt_pk_bf16_f32 v217, v218, v219
    v_cvt_pk_bf16_f32 v218, v220, v221
    v_cvt_pk_bf16_f32 v219, v222, v223
    s_add_u32 s50, s51, 11264
    buffer_store_dwordx4 v[216:219], v8, s[24:27], s50 offen sc1
    v_pk_mul_f32 v[160:161], v[160:161], v[120:121] op_sel_hi:[1,0]
    v_pk_mul_f32 v[162:163], v[162:163], v[120:121] op_sel_hi:[1,0]
    v_pk_mul_f32 v[164:165], v[164:165], v[120:121] op_sel_hi:[1,0]
    v_pk_mul_f32 v[166:167], v[166:167], v[120:121] op_sel_hi:[1,0]
    v_cvt_pk_bf16_f32 v160, v160, v161
    v_cvt_pk_bf16_f32 v161, v162, v163
    v_cvt_pk_bf16_f32 v162, v164, v165
    v_cvt_pk_bf16_f32 v163, v166, v167
    s_add_u32 s50, s51, 4096
    buffer_store_dwordx4 v[160:163], v8, s[24:27], s50 offen sc1
    v_pk_mul_f32 v[224:225], v[224:225], v[120:121] op_sel:[0,1] op_sel_hi:[1,1]
    v_pk_mul_f32 v[226:227], v[226:227], v[120:121] op_sel:[0,1] op_sel_hi:[1,1]
    v_pk_mul_f32 v[228:229], v[228:229], v[120:121] op_sel:[0,1] op_sel_hi:[1,1]
    v_pk_mul_f32 v[230:231], v[230:231], v[120:121] op_sel:[0,1] op_sel_hi:[1,1]
    v_cvt_pk_bf16_f32 v224, v224, v225
    v_cvt_pk_bf16_f32 v225, v226, v227
    v_cvt_pk_bf16_f32 v226, v228, v229
    v_cvt_pk_bf16_f32 v227, v230, v231
    s_add_u32 s50, s51, 12288
    buffer_store_dwordx4 v[224:227], v8, s[24:27], s50 offen sc1
    v_pk_mul_f32 v[168:169], v[168:169], v[120:121] op_sel_hi:[1,0]
    v_pk_mul_f32 v[170:171], v[170:171], v[120:121] op_sel_hi:[1,0]
    v_pk_mul_f32 v[172:173], v[172:173], v[120:121] op_sel_hi:[1,0]
    v_pk_mul_f32 v[174:175], v[174:175], v[120:121] op_sel_hi:[1,0]
    v_cvt_pk_bf16_f32 v168, v168, v169
    v_cvt_pk_bf16_f32 v169, v170, v171
    v_cvt_pk_bf16_f32 v170, v172, v173
    v_cvt_pk_bf16_f32 v171, v174, v175
    s_add_u32 s50, s51, 5120
    buffer_store_dwordx4 v[168:171], v8, s[24:27], s50 offen sc1
    v_pk_mul_f32 v[232:233], v[232:233], v[120:121] op_sel:[0,1] op_sel_hi:[1,1]
    v_pk_mul_f32 v[234:235], v[234:235], v[120:121] op_sel:[0,1] op_sel_hi:[1,1]
    v_pk_mul_f32 v[236:237], v[236:237], v[120:121] op_sel:[0,1] op_sel_hi:[1,1]
    v_pk_mul_f32 v[238:239], v[238:239], v[120:121] op_sel:[0,1] op_sel_hi:[1,1]
    v_cvt_pk_bf16_f32 v232, v232, v233
    v_cvt_pk_bf16_f32 v233, v234, v235
    v_cvt_pk_bf16_f32 v234, v236, v237
    v_cvt_pk_bf16_f32 v235, v238, v239
    s_add_u32 s50, s51, 13312
    buffer_store_dwordx4 v[232:235], v8, s[24:27], s50 offen sc1
    v_pk_mul_f32 v[176:177], v[176:177], v[120:121] op_sel_hi:[1,0]
    v_pk_mul_f32 v[178:179], v[178:179], v[120:121] op_sel_hi:[1,0]
    v_pk_mul_f32 v[180:181], v[180:181], v[120:121] op_sel_hi:[1,0]
    v_pk_mul_f32 v[182:183], v[182:183], v[120:121] op_sel_hi:[1,0]
    v_cvt_pk_bf16_f32 v176, v176, v177
    v_cvt_pk_bf16_f32 v177, v178, v179
    v_cvt_pk_bf16_f32 v178, v180, v181
    v_cvt_pk_bf16_f32 v179, v182, v183
    s_add_u32 s50, s51, 6144
    buffer_store_dwordx4 v[176:179], v8, s[24:27], s50 offen sc1
    v_pk_mul_f32 v[240:241], v[240:241], v[120:121] op_sel:[0,1] op_sel_hi:[1,1]
    v_pk_mul_f32 v[242:243], v[242:243], v[120:121] op_sel:[0,1] op_sel_hi:[1,1]
    v_pk_mul_f32 v[244:245], v[244:245], v[120:121] op_sel:[0,1] op_sel_hi:[1,1]
    v_pk_mul_f32 v[246:247], v[246:247], v[120:121] op_sel:[0,1] op_sel_hi:[1,1]
    v_cvt_pk_bf16_f32 v240, v240, v241
    v_cvt_pk_bf16_f32 v241, v242, v243
    v_cvt_pk_bf16_f32 v242, v244, v245
    v_cvt_pk_bf16_f32 v243, v246, v247
    s_add_u32 s50, s51, 14336
    buffer_store_dwordx4 v[240:243], v8, s[24:27], s50 offen sc1
    v_pk_mul_f32 v[184:185], v[184:185], v[120:121] op_sel_hi:[1,0]
    v_pk_mul_f32 v[186:187], v[186:187], v[120:121] op_sel_hi:[1,0]
    v_pk_mul_f32 v[188:189], v[188:189], v[120:121] op_sel_hi:[1,0]
    v_pk_mul_f32 v[190:191], v[190:191], v[120:121] op_sel_hi:[1,0]
    v_cvt_pk_bf16_f32 v184, v184, v185
    v_cvt_pk_bf16_f32 v185, v186, v187
    v_cvt_pk_bf16_f32 v186, v188, v189
    v_cvt_pk_bf16_f32 v187, v190, v191
    s_add_u32 s50, s51, 7168
    buffer_store_dwordx4 v[184:187], v8, s[24:27], s50 offen sc1
    v_pk_mul_f32 v[248:249], v[248:249], v[120:121] op_sel:[0,1] op_sel_hi:[1,1]
    v_pk_mul_f32 v[250:251], v[250:251], v[120:121] op_sel:[0,1] op_sel_hi:[1,1]
    v_pk_mul_f32 v[252:253], v[252:253], v[120:121] op_sel:[0,1] op_sel_hi:[1,1]
    v_pk_mul_f32 v[254:255], v[254:255], v[120:121] op_sel:[0,1] op_sel_hi:[1,1]
    v_cvt_pk_bf16_f32 v248, v248, v249
    v_cvt_pk_bf16_f32 v249, v250, v251
    v_cvt_pk_bf16_f32 v250, v252, v253
    v_cvt_pk_bf16_f32 v251, v254, v255
    s_add_u32 s50, s51, 15360
    buffer_store_dwordx4 v[248:251], v8, s[24:27], s50 offen sc1
    s_nop 4
    v_mov_b64 v[128:129], 0
    v_mov_b64 v[130:131], 0
    v_mov_b64 v[132:133], 0
    v_mov_b64 v[134:135], 0
    v_mov_b64 v[136:137], 0
    v_mov_b64 v[138:139], 0
    v_mov_b64 v[140:141], 0
    v_mov_b64 v[142:143], 0
    v_mov_b64 v[144:145], 0
    v_mov_b64 v[146:147], 0
    v_mov_b64 v[148:149], 0
    v_mov_b64 v[150:151], 0
    v_mov_b64 v[152:153], 0
    v_mov_b64 v[154:155], 0
    v_mov_b64 v[156:157], 0
    v_mov_b64 v[158:159], 0
    v_mov_b64 v[160:161], 0
    v_mov_b64 v[162:163], 0
    v_mov_b64 v[164:165], 0
    v_mov_b64 v[166:167], 0
    v_mov_b64 v[168:169], 0
    v_mov_b64 v[170:171], 0
    v_mov_b64 v[172:173], 0
    v_mov_b64 v[174:175], 0
    v_mov_b64 v[176:177], 0
    v_mov_b64 v[178:179], 0
    v_mov_b64 v[180:181], 0
    v_mov_b64 v[182:183], 0
    v_mov_b64 v[184:185], 0
    v_mov_b64 v[186:187], 0
    v_mov_b64 v[188:189], 0
    v_mov_b64 v[190:191], 0
    v_mov_b64 v[192:193], 0
    v_mov_b64 v[194:195], 0
    v_mov_b64 v[196:197], 0
    v_mov_b64 v[198:199], 0
    v_mov_b64 v[200:201], 0
    v_mov_b64 v[202:203], 0
    v_mov_b64 v[204:205], 0
    v_mov_b64 v[206:207], 0
    v_mov_b64 v[208:209], 0
    v_mov_b64 v[210:211], 0
    v_mov_b64 v[212:213], 0
    v_mov_b64 v[214:215], 0
    v_mov_b64 v[216:217], 0
    v_mov_b64 v[218:219], 0
    v_mov_b64 v[220:221], 0
    v_mov_b64 v[222:223], 0
    v_mov_b64 v[224:225], 0
    v_mov_b64 v[226:227], 0
    v_mov_b64 v[228:229], 0
    v_mov_b64 v[230:231], 0
    v_mov_b64 v[232:233], 0
    v_mov_b64 v[234:235], 0
    v_mov_b64 v[236:237], 0
    v_mov_b64 v[238:239], 0
    v_mov_b64 v[240:241], 0
    v_mov_b64 v[242:243], 0
    v_mov_b64 v[244:245], 0
    v_mov_b64 v[246:247], 0
    v_mov_b64 v[248:249], 0
    v_mov_b64 v[250:251], 0
    v_mov_b64 v[252:253], 0
    v_mov_b64 v[254:255], 0
    v_mov_b64 v[24:25], 0
    v_mov_b64 v[26:27], 0
    v_mov_b64 v[28:29], 0
    v_mov_b64 v[30:31], 0
    s_mov_b32 s43, 0xf149f2ca
    s_nop 3
    v_max3_f32 v120, v72, v73, v74
    v_max3_f32 v120, v120, v75, v80
    v_max3_f32 v120, v120, v81, v82
    v_max3_f32 v120, v120, v83, v88
    v_max3_f32 v120, v120, v89, v90
    v_max3_f32 v120, v120, v91, v96
    v_max3_f32 v120, v120, v97, v98
    v_max_f32 v120, v120, v99
    v_max3_f32 v121, v76, v77, v78
    v_max3_f32 v121, v121, v79, v84
    v_max3_f32 v121, v121, v85, v86
    v_max3_f32 v121, v121, v87, v92
    v_max3_f32 v121, v121, v93, v94
    v_max3_f32 v121, v121, v95, v100
    v_max3_f32 v121, v121, v101, v102
    v_max_f32 v121, v121, v103
    ds_bpermute_b32 v122, v12, v120
    ds_bpermute_b32 v123, v12, v121
    s_waitcnt lgkmcnt(1)
    v_max_f32 v120, v120, v122
    s_waitcnt lgkmcnt(0)
    v_max_f32 v121, v121, v123
    ds_bpermute_b32 v122, v13, v120
    ds_bpermute_b32 v123, v13, v121
    s_waitcnt lgkmcnt(1)
    v_max_f32 v120, v120, v122
    s_waitcnt lgkmcnt(0)
    v_max_f32 v121, v121, v123
    v_add_f32 v120, 0x40e00000, v120
    v_max_f32 v120, s43, v120
    v_sub_f32 v16, v16, v120
    v_sub_f32 v17, v17, v120
    v_sub_f32 v18, v18, v120
    v_sub_f32 v19, v19, v120
    v_sub_f32 v72, v72, v120
    v_sub_f32 v73, v73, v120
    v_sub_f32 v74, v74, v120
    v_sub_f32 v75, v75, v120
    v_sub_f32 v80, v80, v120
    v_sub_f32 v81, v81, v120
    v_sub_f32 v82, v82, v120
    v_sub_f32 v83, v83, v120
    v_sub_f32 v88, v88, v120
    v_sub_f32 v89, v89, v120
    v_sub_f32 v90, v90, v120
    v_sub_f32 v91, v91, v120
    v_sub_f32 v96, v96, v120
    v_sub_f32 v97, v97, v120
    v_sub_f32 v98, v98, v120
    v_sub_f32 v99, v99, v120
    v_add_f32 v121, 0x40e00000, v121
    v_max_f32 v121, s43, v121
    v_sub_f32 v20, v20, v121
    v_sub_f32 v21, v21, v121
    v_sub_f32 v22, v22, v121
    v_sub_f32 v23, v23, v121
    v_sub_f32 v76, v76, v121
    v_sub_f32 v77, v77, v121
    v_sub_f32 v78, v78, v121
    v_sub_f32 v79, v79, v121
    v_sub_f32 v84, v84, v121
    v_sub_f32 v85, v85, v121
    v_sub_f32 v86, v86, v121
    v_sub_f32 v87, v87, v121
    v_sub_f32 v92, v92, v121
    v_sub_f32 v93, v93, v121
    v_sub_f32 v94, v94, v121
    v_sub_f32 v95, v95, v121
    v_sub_f32 v100, v100, v121
    v_sub_f32 v101, v101, v121
    v_sub_f32 v102, v102, v121
    v_sub_f32 v103, v103, v121
    v_exp_f32 v40, v72
    v_exp_f32 v41, v73
    v_exp_f32 v42, v74
    v_exp_f32 v43, v75
    v_cvt_pk_bf16_f32 v56, v40, v41
    v_exp_f32 v44, v76
    v_exp_f32 v45, v77
    v_cvt_pk_bf16_f32 v57, v42, v43
    v_exp_f32 v46, v78
    v_exp_f32 v47, v79
    v_cvt_pk_bf16_f32 v60, v44, v45
    v_exp_f32 v48, v80
    v_exp_f32 v49, v81
    v_cvt_pk_bf16_f32 v61, v46, v47
    v_exp_f32 v50, v82
    v_exp_f32 v51, v83
    v_cvt_pk_bf16_f32 v58, v48, v49
    v_exp_f32 v52, v84
    v_exp_f32 v53, v85
    v_cvt_pk_bf16_f32 v59, v50, v51
    v_exp_f32 v54, v86
    v_exp_f32 v55, v87
    v_cvt_pk_bf16_f32 v62, v52, v53
    v_exp_f32 v40, v88
    v_exp_f32 v41, v89
    v_cvt_pk_bf16_f32 v63, v54, v55
    v_exp_f32 v42, v90
    v_exp_f32 v43, v91
    v_cvt_pk_bf16_f32 v64, v40, v41
    v_exp_f32 v44, v92
    v_exp_f32 v45, v93
    v_cvt_pk_bf16_f32 v65, v42, v43
    v_exp_f32 v46, v94
    v_exp_f32 v47, v95
    v_cvt_pk_bf16_f32 v68, v44, v45
    v_exp_f32 v48, v96
    v_exp_f32 v49, v97
    v_cvt_pk_bf16_f32 v69, v46, v47
    v_exp_f32 v50, v98
    v_exp_f32 v51, v99
    v_cvt_pk_bf16_f32 v66, v48, v49
    v_exp_f32 v52, v100
    v_exp_f32 v53, v101
    v_cvt_pk_bf16_f32 v67, v50, v51
    v_exp_f32 v54, v102
    v_exp_f32 v55, v103
    v_cvt_pk_bf16_f32 v70, v52, v53
    v_cvt_pk_bf16_f32 v71, v54, v55
    s_nop 4
    s_mov_b32 s43, 0
    s_branch K2_NEXT
.p2align 6
K2_LOOPY:
    s_lshl_b32 s51, s46, 16
    s_lshl_b32 s52, s20, 14
    s_add_u32 s51, s51, s52
    s_add_u32 s51, s51, 71303168
    s_lshl_b32 s52, s46, 9
    s_lshl_b32 s53, s20, 7
    s_add_u32 s52, s52, s53
    s_add_u32 s52, s52, 70516736
    v_and_b32 v3, 15, v2
    v_lshlrev_b32 v3, 2, v3
    s_add_u32 s4, s51, 0
    s_add_u32 s5, s51, 4096
    s_add_u32 s6, s51, 8192
    s_add_u32 s7, s51, 12288
    s_mov_b32 s8, s52
    v_mfma_f32_16x16x32_bf16 v[72:75], a[64:67], a[0:3], v[16:19]
    s_add_u32 m0, s30, s44
    ds_read_b128 a[100:103], v9 offset:9216
    v_mov_b32 v104, v56
    v_mfma_f32_16x16x32_bf16 v[72:75], a[68:71], a[4:7], v[72:75]
    buffer_load_dwordx4 v6, s[24:27], s34 offen offset:0 lds
    v_mfma_f32_16x16x32_bf16 v[76:79], a[64:67], a[32:35], v[20:23]
    ds_read_b128 a[96:99], v9 offset:8192
    v_mov_b32 v105, v57
    v_mfma_f32_16x16x32_bf16 v[76:79], a[68:71], a[36:39], v[76:79]
    s_waitcnt lgkmcnt(6)
    v_mfma_f32_16x16x32_bf16 v[76:79], a[72:75], a[40:43], v[76:79]
    ds_read_b128 a[108:111], v9 offset:11264
    v_mov_b32 v108, v60
    v_mfma_f32_16x16x32_bf16 v[76:79], a[76:79], a[44:47], v[76:79]
    buffer_load_dword v36, v3, s[24:27], s8 offen offset:0 sc1
    v_mfma_f32_16x16x32_bf16 v[72:75], a[76:79], a[12:15], v[72:75]
    s_waitcnt lgkmcnt(5)
    ds_read_b128 a[104:107], v9 offset:10240
    v_mov_b32 v109, v61
    v_mfma_f32_16x16x32_bf16 v[72:75], a[72:75], a[8:11], v[72:75]
    buffer_load_dwordx4 v6, s[24:27], s34 offen offset:1024 lds
    v_mfma_f32_16x16x32_bf16 v[72:75], a[80:83], a[16:19], v[72:75]
    ds_read_b128 a[116:119], v9 offset:13312
    v_mov_b32 v106, v58
    v_mfma_f32_16x16x32_bf16 v[72:75], a[84:87], a[20:23], v[72:75]
    buffer_load_dword v37, v3, s[24:27], s8 offen offset:64 sc1
    v_mfma_f32_16x16x32_bf16 v[76:79], a[84:87], a[52:55], v[76:79]
    ds_read_b128 a[112:115], v9 offset:12288
    v_mov_b32 v107, v59
    v_mfma_f32_16x16x32_bf16 v[76:79], a[80:83], a[48:51], v[76:79]
    s_waitcnt lgkmcnt(6)
    v_mfma_f32_16x16x32_bf16 v[76:79], a[88:91], a[56:59], v[76:79]
    ds_read_b128 a[124:127], v9 offset:15360
    v_mov_b32 v110, v62
    v_mfma_f32_16x16x32_bf16 v[76:79], a[92:95], a[60:63], v[76:79]
    buffer_load_dwordx4 v6, s[24:27], s34 offen offset:2048 lds
    v_mfma_f32_16x16x32_bf16 v[72:75], a[92:95], a[28:31], v[72:75]
    ds_read_b128 a[120:123], v9 offset:14336
    v_mov_b32 v111, v63
    v_mfma_f32_16x16x32_bf16 v[72:75], a[88:91], a[24:27], v[72:75]
    s_waitcnt lgkmcnt(6)
    v_mfma_f32_16x16x32_bf16 v[80:83], a[96:99], a[0:3], v[16:19]
    ds_read_b128 a[68:71], v9 offset:17408
    v_mov_b32 v112, v64
    v_mfma_f32_16x16x32_bf16 v[80:83], a[100:103], a[4:7], v[80:83]
    buffer_load_dwordx4 a[168:171], v8, s[24:27], s4 offen offset:0 sc1
    v_mfma_f32_16x16x32_bf16 v[84:87], a[96:99], a[32:35], v[20:23]
    s_waitcnt lgkmcnt(5)
    ds_read_b128 a[64:67], v9 offset:16384
    v_mov_b32 v113, v65
    v_mfma_f32_16x16x32_bf16 v[84:87], a[100:103], a[36:39], v[84:87]
    buffer_load_dwordx4 v6, s[24:27], s34 offen offset:3072 lds
    v_mfma_f32_16x16x32_bf16 v[84:87], a[104:107], a[40:43], v[84:87]
    s_add_u32 m0, m0, 4096
    ds_read_b128 a[76:79], v9 offset:19456
    v_mov_b32 v116, v68
    v_mfma_f32_16x16x32_bf16 v[84:87], a[108:111], a[44:47], v[84:87]
    v_exp_f32 v40, v72
    v_mfma_f32_16x16x32_bf16 v[80:83], a[108:111], a[12:15], v[80:83]
    ds_read_b128 a[72:75], v9 offset:18432
    v_mov_b32 v117, v69
    v_mfma_f32_16x16x32_bf16 v[80:83], a[104:107], a[8:11], v[80:83]
    s_waitcnt lgkmcnt(6)
    v_exp_f32 v41, v73
    v_mfma_f32_16x16x32_bf16 v[80:83], a[112:115], a[16:19], v[80:83]
    ds_read_b128 a[84:87], v9 offset:21504
    v_mov_b32 v114, v66
    v_mfma_f32_16x16x32_bf16 v[80:83], a[116:119], a[20:23], v[80:83]
    buffer_load_dwordx4 v7, s[24:27], s34 offen offset:0 lds
    v_mfma_f32_16x16x32_bf16 v[84:87], a[116:119], a[52:55], v[84:87]
    ds_read_b128 a[80:83], v9 offset:20480
    v_mov_b32 v115, v67
    v_mfma_f32_16x16x32_bf16 v[84:87], a[112:115], a[48:51], v[84:87]
    s_waitcnt lgkmcnt(6)
    v_exp_f32 v42, v74
    v_mfma_f32_16x16x32_bf16 v[84:87], a[120:123], a[56:59], v[84:87]
    ds_read_b128 a[92:95], v9 offset:23552
    v_mov_b32 v118, v70
    v_mfma_f32_16x16x32_bf16 v[84:87], a[124:127], a[60:63], v[84:87]
    buffer_load_dwordx4 a[172:175], v8, s[24:27], s4 offen offset:1024 sc1
    v_mfma_f32_16x16x32_bf16 v[80:83], a[124:127], a[28:31], v[80:83]
    s_waitcnt lgkmcnt(5)
    ds_read_b128 a[88:91], v9 offset:22528
    v_mov_b32 v119, v71
    v_mfma_f32_16x16x32_bf16 v[80:83], a[120:123], a[24:27], v[80:83]
    buffer_load_dwordx4 v7, s[24:27], s34 offen offset:1024 lds
    v_mfma_f32_16x16x32_bf16 v[88:91], a[64:67], a[0:3], v[16:19]
    ds_read_b128 a[100:103], v9 offset:25600
    v_add_u32 v10, s29, v8
    v_mfma_f32_16x16x32_bf16 v[88:91], a[68:71], a[4:7], v[88:91]
    buffer_load_dwordx4 a[176:179], v8, s[24:27], s4 offen offset:2048 sc1
    v_mfma_f32_16x16x32_bf16 v[92:95], a[64:67], a[32:35], v[20:23]
    ds_read_b128 a[96:99], v9 offset:24576
    v_cvt_pk_bf16_f32 v56, v40, v41
    v_mfma_f32_16x16x32_bf16 v[92:95], a[68:71], a[36:39], v[92:95]
    s_waitcnt lgkmcnt(6)
    v_exp_f32 v43, v75
    v_mfma_f32_16x16x32_bf16 v[92:95], a[72:75], a[40:43], v[92:95]
    ds_read_b128 a[108:111], v9 offset:27648
    v_cvt_pk_bf16_f32 v57, v42, v43
    v_mfma_f32_16x16x32_bf16 v[92:95], a[76:79], a[44:47], v[92:95]
    buffer_load_dwordx4 v7, s[24:27], s34 offen offset:2048 lds
    v_mfma_f32_16x16x32_bf16 v[88:91], a[76:79], a[12:15], v[88:91]
    ds_read_b128 a[104:107], v9 offset:26624
    v_or_b32 v14, v56, v57
    v_mfma_f32_16x16x32_bf16 v[88:91], a[72:75], a[8:11], v[88:91]
    s_waitcnt lgkmcnt(6)
    v_exp_f32 v44, v76
    v_mfma_f32_16x16x32_bf16 v[88:91], a[80:83], a[16:19], v[88:91]
    ds_read_b128 a[116:119], v9 offset:29696
    v_mfma_f32_16x16x32_bf16 v[88:91], a[84:87], a[20:23], v[88:91]
    buffer_load_dwordx4 a[180:183], v8, s[24:27], s4 offen offset:3072 sc1
    v_mfma_f32_16x16x32_bf16 v[92:95], a[84:87], a[52:55], v[92:95]
    s_waitcnt lgkmcnt(5)
    ds_read_b128 a[112:115], v9 offset:28672
    v_mfma_f32_16x16x32_bf16 v[92:95], a[80:83], a[48:51], v[92:95]
    buffer_load_dwordx4 v7, s[24:27], s34 offen offset:3072 lds
    v_mfma_f32_16x16x32_bf16 v[92:95], a[88:91], a[56:59], v[92:95]
    s_add_u32 m0, s31, s44
    ds_read_b128 a[124:127], v9 offset:31744
    v_mfma_f32_16x16x32_bf16 v[92:95], a[92:95], a[60:63], v[92:95]
    s_waitcnt lgkmcnt(5)
    v_exp_f32 v45, v77
    v_mfma_f32_16x16x32_bf16 v[88:91], a[92:95], a[28:31], v[88:91]
    s_waitcnt vmcnt(22)
    ds_read_b128 a[120:123], v9 offset:30720
    v_cvt_pk_bf16_f32 v60, v44, v45
    v_mfma_f32_16x16x32_bf16 v[88:91], a[88:91], a[24:27], v[88:91]
    s_barrier
    v_exp_f32 v46, v78
    v_mfma_f32_16x16x32_bf16 v[96:99], a[96:99], a[0:3], v[16:19]
    s_add_u32 s35, s35, 1
    ds_read_b128 a[68:71], v10 offset:16384
    v_mfma_f32_16x16x32_bf16 v[96:99], a[100:103], a[4:7], v[96:99]
    s_add_u32 s34, s34, 32768
    v_exp_f32 v47, v79
    v_mfma_f32_16x16x32_bf16 v[100:103], a[96:99], a[32:35], v[20:23]
    s_cmp_eq_u32 s35, s36
    ds_read_b128 a[64:67], v10 offset:0
    v_cvt_pk_bf16_f32 v61, v46, v47
    v_mfma_f32_16x16x32_bf16 v[100:103], a[100:103], a[36:39], v[100:103]
    s_waitcnt lgkmcnt(6)
    v_exp_f32 v48, v80
    v_mfma_f32_16x16x32_bf16 v[100:103], a[104:107], a[40:43], v[100:103]
    s_cselect_b32 s34, s40, s34
    ds_read_b128 a[76:79], v10 offset:17408
    v_or3_b32 v14, v60, v61, v14
    v_mfma_f32_16x16x32_bf16 v[100:103], a[108:111], a[44:47], v[100:103]
    buffer_load_dwordx4 v6, s[24:27], s32 offen offset:0 lds
    v_mfma_f32_16x16x32_bf16 v[96:99], a[108:111], a[12:15], v[96:99]
    s_cmp_eq_u32 s35, s37
    ds_read_b128 a[72:75], v10 offset:1024
    v_mfma_f32_16x16x32_bf16 v[96:99], a[104:107], a[8:11], v[96:99]
    s_waitcnt lgkmcnt(6)
    v_exp_f32 v49, v81
    v_mfma_f32_16x16x32_bf16 v[96:99], a[112:115], a[16:19], v[96:99]
    s_cselect_b32 s34, s65, s34
    ds_read_b128 a[84:87], v10 offset:18432
    v_cvt_pk_bf16_f32 v58, v48, v49
    v_mfma_f32_16x16x32_bf16 v[96:99], a[116:119], a[20:23], v[96:99]
    buffer_load_dwordx4 a[184:187], v8, s[24:27], s5 offen offset:0 sc1
    v_mfma_f32_16x16x32_bf16 v[100:103], a[116:119], a[52:55], v[100:103]
    ds_read_b128 a[80:83], v10 offset:2048
    v_mfma_f32_16x16x32_bf16 v[100:103], a[112:115], a[48:51], v[100:103]
    s_waitcnt lgkmcnt(6)
    v_exp_f32 v50, v82
    v_mfma_f32_16x16x32_bf16 v[100:103], a[120:123], a[56:59], v[100:103]
    ds_read_b128 a[92:95], v10 offset:19456
    v_mfma_f32_16x16x32_bf16 v[100:103], a[124:127], a[60:63], v[100:103]
    buffer_load_dwordx4 v6, s[24:27], s32 offen offset:1024 lds
    v_mfma_f32_16x16x32_bf16 v[96:99], a[124:127], a[28:31], v[96:99]
    ds_read_b128 a[88:91], v10 offset:3072
    v_mfma_f32_16x16x32_bf16 v[96:99], a[120:123], a[24:27], v[96:99]
    s_waitcnt lgkmcnt(6)
    v_exp_f32 v51, v83
    v_mfma_f32_16x16x32_bf16 v[128:131], a[64:67], v[104:107], v[128:131]
    s_mov_b32 s30, s28
    ds_read_b128 a[100:103], v10 offset:20480
    v_cvt_pk_bf16_f32 v59, v50, v51
    v_mfma_f32_16x16x32_bf16 v[128:131], a[68:71], v[112:115], v[128:131]
    s_add_u32 s28, s28, 65536
    v_exp_f32 v52, v84
    v_mfma_f32_16x16x32_bf16 v[192:195], a[68:71], v[116:119], v[192:195]
    s_cmp_ge_u32 s28, 163840
    ds_read_b128 a[96:99], v10 offset:4096
    v_mfma_f32_16x16x32_bf16 v[192:195], a[64:67], v[108:111], v[192:195]
    s_waitcnt lgkmcnt(6)
    v_exp_f32 v53, v85
    v_mfma_f32_16x16x32_bf16 v[196:199], a[72:75], v[108:111], v[196:199]
    s_cselect_b32 s50, 163840, 0
    ds_read_b128 a[108:111], v10 offset:21504
    v_mfma_f32_16x16x32_bf16 v[196:199], a[76:79], v[116:119], v[196:199]
    buffer_load_dwordx4 v6, s[24:27], s32 offen offset:2048 lds
    v_mfma_f32_16x16x32_bf16 v[132:135], a[76:79], v[112:115], v[132:135]
    s_sub_u32 s28, s28, s50
    ds_read_b128 a[104:107], v10 offset:5120
    v_or3_b32 v14, v58, v59, v14
    v_mfma_f32_16x16x32_bf16 v[132:135], a[72:75], v[104:107], v[132:135]
    buffer_load_dwordx4 a[188:191], v8, s[24:27], s5 offen offset:1024 sc1
    v_mfma_f32_16x16x32_bf16 v[24:27], v[32:35], v[104:107], v[24:27]
    buffer_load_dwordx4 a[192:195], v8, s[24:27], s5 offen offset:2048 sc1
    v_mfma_f32_16x16x32_bf16 v[24:27], v[32:35], v[112:115], v[24:27]
    buffer_load_dwordx4 a[196:199], v8, s[24:27], s5 offen offset:3072 sc1
    v_mfma_f32_16x16x32_bf16 v[28:31], v[32:35], v[108:111], v[28:31]
    buffer_load_dwordx4 a[200:203], v8, s[24:27], s6 offen offset:0 sc1
    v_mfma_f32_16x16x32_bf16 v[28:31], v[32:35], v[116:119], v[28:31]
    s_waitcnt lgkmcnt(6)
    v_exp_f32 v54, v86
    v_mfma_f32_16x16x32_bf16 v[136:139], a[80:83], v[104:107], v[136:139]
    ds_read_b128 a[116:119], v10 offset:22528
    v_add_u32 v9, s28, v8
    v_mfma_f32_16x16x32_bf16 v[136:139], a[84:87], v[112:115], v[136:139]
    buffer_load_dwordx4 v6, s[24:27], s32 offen offset:3072 lds
    v_mfma_f32_16x16x32_bf16 v[200:203], a[84:87], v[116:119], v[200:203]
    s_add_u32 m0, m0, 4096
    ds_read_b128 a[112:115], v10 offset:6144
    v_mfma_f32_16x16x32_bf16 v[200:203], a[80:83], v[108:111], v[200:203]
    s_waitcnt lgkmcnt(6)
    v_exp_f32 v55, v87
    v_mfma_f32_16x16x32_bf16 v[204:207], a[88:91], v[108:111], v[204:207]
    ds_read_b128 a[124:127], v10 offset:23552
    v_cvt_pk_bf16_f32 v62, v52, v53
    v_mfma_f32_16x16x32_bf16 v[204:207], a[92:95], v[116:119], v[204:207]
    buffer_load_dwordx4 a[204:207], v8, s[24:27], s6 offen offset:1024 sc1
    v_mfma_f32_16x16x32_bf16 v[140:143], a[92:95], v[112:115], v[140:143]
    ds_read_b128 a[120:123], v10 offset:7168
    v_cvt_pk_bf16_f32 v63, v54, v55
    v_mfma_f32_16x16x32_bf16 v[140:143], a[88:91], v[104:107], v[140:143]
    s_waitcnt lgkmcnt(6)
    v_exp_f32 v40, v88
    v_mfma_f32_16x16x32_bf16 v[144:147], a[96:99], v[104:107], v[144:147]
    ds_read_b128 a[68:71], v10 offset:24576
    v_or3_b32 v14, v62, v63, v14
    v_mfma_f32_16x16x32_bf16 v[144:147], a[100:103], v[112:115], v[144:147]
    buffer_load_dwordx4 v7, s[24:27], s32 offen offset:0 lds
    v_mfma_f32_16x16x32_bf16 v[208:211], a[100:103], v[116:119], v[208:211]
    s_mov_b32 s31, s29
    ds_read_b128 a[64:67], v10 offset:8192
    v_mfma_f32_16x16x32_bf16 v[208:211], a[96:99], v[108:111], v[208:211]
    s_waitcnt lgkmcnt(6)
    v_exp_f32 v41, v89
    v_mfma_f32_16x16x32_bf16 v[212:215], a[104:107], v[108:111], v[212:215]
    s_add_u32 s29, s29, 65536
    ds_read_b128 a[76:79], v10 offset:25600
    v_mfma_f32_16x16x32_bf16 v[212:215], a[108:111], v[116:119], v[212:215]
    s_cmp_ge_u32 s29, 163840
    v_exp_f32 v42, v90
    v_mfma_f32_16x16x32_bf16 v[148:151], a[108:111], v[112:115], v[148:151]
    s_cselect_b32 s50, 163840, 0
    ds_read_b128 a[72:75], v10 offset:9216
    v_mfma_f32_16x16x32_bf16 v[148:151], a[104:107], v[104:107], v[148:151]
    s_waitcnt lgkmcnt(6)
    v_exp_f32 v43, v91
    v_mfma_f32_16x16x32_bf16 v[152:155], a[112:115], v[104:107], v[152:155]
    s_sub_u32 s29, s29, s50
    ds_read_b128 a[84:87], v10 offset:26624
    v_cvt_pk_bf16_f32 v64, v40, v41
    v_mfma_f32_16x16x32_bf16 v[152:155], a[116:119], v[112:115], v[152:155]
    buffer_load_dwordx4 v7, s[24:27], s32 offen offset:1024 lds
    v_mfma_f32_16x16x32_bf16 v[216:219], a[116:119], v[116:119], v[216:219]
    ds_read_b128 a[80:83], v10 offset:10240
    v_cvt_pk_bf16_f32 v65, v42, v43
    v_mfma_f32_16x16x32_bf16 v[216:219], a[112:115], v[108:111], v[216:219]
    s_waitcnt lgkmcnt(6)
    v_exp_f32 v44, v92
    v_mfma_f32_16x16x32_bf16 v[220:223], a[120:123], v[108:111], v[220:223]
    ds_read_b128 a[92:95], v10 offset:27648
    v_or3_b32 v14, v64, v65, v14
    v_mfma_f32_16x16x32_bf16 v[220:223], a[124:127], v[116:119], v[220:223]
    buffer_load_dwordx4 a[208:211], v8, s[24:27], s6 offen offset:2048 sc1
    v_mfma_f32_16x16x32_bf16 v[156:159], a[124:127], v[112:115], v[156:159]
    ds_read_b128 a[88:91], v10 offset:11264
    v_mfma_f32_16x16x32_bf16 v[156:159], a[120:123], v[104:107], v[156:159]
    s_waitcnt lgkmcnt(6)
    v_exp_f32 v45, v93
    v_mfma_f32_16x16x32_bf16 v[160:163], a[64:67], v[104:107], v[160:163]
    ds_read_b128 a[100:103], v10 offset:28672
    v_cvt_pk_bf16_f32 v68, v44, v45
    v_mfma_f32_16x16x32_bf16 v[160:163], a[68:71], v[112:115], v[160:163]
    buffer_load_dwordx4 v7, s[24:27], s32 offen offset:2048 lds
    v_mfma_f32_16x16x32_bf16 v[224:227], a[68:71], v[116:119], v[224:227]
    ds_read_b128 a[96:99], v10 offset:12288
    v_mfma_f32_16x16x32_bf16 v[224:227], a[64:67], v[108:111], v[224:227]
    s_waitcnt lgkmcnt(6)
    v_exp_f32 v46, v94
    v_mfma_f32_16x16x32_bf16 v[228:231], a[72:75], v[108:111], v[228:231]
    ds_read_b128 a[108:111], v10 offset:29696
    v_mfma_f32_16x16x32_bf16 v[228:231], a[76:79], v[116:119], v[228:231]
    buffer_load_dwordx4 a[212:215], v8, s[24:27], s6 offen offset:3072 sc1
    v_mfma_f32_16x16x32_bf16 v[164:167], a[76:79], v[112:115], v[164:167]
    ds_read_b128 a[104:107], v10 offset:13312
    v_mfma_f32_16x16x32_bf16 v[164:167], a[72:75], v[104:107], v[164:167]
    s_waitcnt lgkmcnt(6)
    v_exp_f32 v47, v95
    v_mfma_f32_16x16x32_bf16 v[168:171], a[80:83], v[104:107], v[168:171]
    ds_read_b128 a[116:119], v10 offset:30720
    v_cvt_pk_bf16_f32 v69, v46, v47
    v_mfma_f32_16x16x32_bf16 v[168:171], a[84:87], v[112:115], v[168:171]
    buffer_load_dwordx4 v7, s[24:27], s32 offen offset:3072 lds
    v_mfma_f32_16x16x32_bf16 v[232:235], a[84:87], v[116:119], v[232:235]
    s_add_u32 s33, s33, 1
    ds_read_b128 a[112:115], v10 offset:14336
    v_or3_b32 v14, v68, v69, v14
    v_mfma_f32_16x16x32_bf16 v[232:235], a[80:83], v[108:111], v[232:235]
    s_waitcnt lgkmcnt(6)
    v_exp_f32 v48, v96
    v_mfma_f32_16x16x32_bf16 v[236:239], a[88:91], v[108:111], v[236:239]
    s_add_u32 s32, s32, 32768
    ds_read_b128 a[124:127], v10 offset:31744
    v_mfma_f32_16x16x32_bf16 v[236:239], a[92:95], v[116:119], v[236:239]
    s_waitcnt lgkmcnt(5)
    v_exp_f32 v49, v97
    v_mfma_f32_16x16x32_bf16 v[172:175], a[92:95], v[112:115], v[172:175]
    s_waitcnt vmcnt(30)
    ds_read_b128 a[120:123], v10 offset:15360
    v_cvt_pk_bf16_f32 v66, v48, v49
    v_mfma_f32_16x16x32_bf16 v[172:175], a[88:91], v[104:107], v[172:175]
    s_barrier
    v_exp_f32 v50, v98
    v_mfma_f32_16x16x32_bf16 v[176:179], a[96:99], v[104:107], v[176:179]
    s_cmp_eq_u32 s33, s36
    ds_read_b128 a[68:71], v9 offset:1024
    v_mfma_f32_16x16x32_bf16 v[176:179], a[100:103], v[112:115], v[176:179]
    s_cselect_b32 s32, s39, s32
    v_exp_f32 v51, v99
    v_mfma_f32_16x16x32_bf16 v[240:243], a[100:103], v[116:119], v[240:243]
    s_cmp_eq_u32 s33, s37
    ds_read_b128 a[64:67], v9 offset:0
    v_cvt_pk_bf16_f32 v67, v50, v51
    v_mfma_f32_16x16x32_bf16 v[240:243], a[96:99], v[108:111], v[240:243]
    s_waitcnt lgkmcnt(6)
    v_exp_f32 v52, v100
    v_mfma_f32_16x16x32_bf16 v[244:247], a[104:107], v[108:111], v[244:247]
    s_cselect_b32 s32, s65, s32
    ds_read_b128 a[76:79], v9 offset:3072
    v_or3_b32 v14, v66, v67, v14
    v_mfma_f32_16x16x32_bf16 v[244:247], a[108:111], v[116:119], v[244:247]
    s_add_u32 s38, s38, 1
    v_exp_f32 v53, v101
    v_mfma_f32_16x16x32_bf16 v[180:183], a[108:111], v[112:115], v[180:183]
    s_cmp_ge_i32 s38, s17
    ds_read_b128 a[72:75], v9 offset:2048
    v_cvt_pk_bf16_f32 v70, v52, v53
    v_mfma_f32_16x16x32_bf16 v[180:183], a[104:107], v[104:107], v[180:183]
    s_waitcnt lgkmcnt(6)
    v_exp_f32 v54, v102
    v_mfma_f32_16x16x32_bf16 v[184:187], a[112:115], v[104:107], v[184:187]
    ds_read_b128 a[84:87], v9 offset:5120
    v_mfma_f32_16x16x32_bf16 v[184:187], a[116:119], v[112:115], v[184:187]
    buffer_load_dwordx4 a[216:219], v8, s[24:27], s7 offen offset:0 sc1
    v_mfma_f32_16x16x32_bf16 v[248:251], a[116:119], v[116:119], v[248:251]
    ds_read_b128 a[80:83], v9 offset:4096
    v_mfma_f32_16x16x32_bf16 v[248:251], a[112:115], v[108:111], v[248:251]
    s_waitcnt lgkmcnt(6)
    v_exp_f32 v55, v103
    v_mfma_f32_16x16x32_bf16 v[252:255], a[120:123], v[108:111], v[252:255]
    ds_read_b128 a[92:95], v9 offset:7168
    v_cvt_pk_bf16_f32 v71, v54, v55
    v_mfma_f32_16x16x32_bf16 v[252:255], a[124:127], v[116:119], v[252:255]
    buffer_load_dwordx4 a[220:223], v8, s[24:27], s7 offen offset:1024 sc1
    v_mfma_f32_16x16x32_bf16 v[188:191], a[124:127], v[112:115], v[188:191]
    ds_read_b128 a[88:91], v9 offset:6144
    v_or3_b32 v14, v70, v71, v14
    v_and_b32 v14, 0x40004000, v14
    v_cmp_ne_u32 vcc, 0, v14
    buffer_load_dwordx4 a[224:227], v8, s[24:27], s7 offen offset:2048 sc1
    buffer_load_dwordx4 a[228:231], v8, s[24:27], s7 offen offset:3072 sc1
    v_mfma_f32_16x16x32_bf16 v[188:191], a[120:123], v[104:107], v[188:191]
    s_waitcnt lgkmcnt(6)
    s_branch K2_HB
K2_FINAL:
    s_nop 3
    s_load_dwordx2 s[48:49], s[0:1], 80
    v_add_u32 v10, s29, v8
    s_mov_b32 s54, s100
    v_mov_b32 v5, 0
    s_waitcnt vmcnt(8) lgkmcnt(0)
    buffer_load_dword v4, v5, s[24:27], s54 offen sc1
    v_mov_b32 v104, v56
    v_mov_b32 v105, v57
    v_mov_b32 v106, v58
    v_mov_b32 v107, v59
    v_mov_b32 v108, v60
    v_mov_b32 v109, v61
    v_mov_b32 v110, v62
    v_mov_b32 v111, v63
    v_mov_b32 v112, v64
    v_mov_b32 v113, v65
    v_mov_b32 v114, v66
    v_mov_b32 v115, v67
    v_mov_b32 v116, v68
    v_mov_b32 v117, v69
    v_mov_b32 v118, v70
    v_mov_b32 v119, v71
    s_barrier
    ds_read_b128 a[68:71], v10 offset:16384
    ds_read_b128 a[64:67], v10 offset:0
    ds_read_b128 a[76:79], v10 offset:17408
    ds_read_b128 a[72:75], v10 offset:1024
    ds_read_b128 a[84:87], v10 offset:18432
    ds_read_b128 a[80:83], v10 offset:2048
    ds_read_b128 a[92:95], v10 offset:19456
    ds_read_b128 a[88:91], v10 offset:3072
    s_lshl_b32 s51, s46, 16
    s_lshl_b32 s52, s20, 14
    s_add_u32 s51, s51, s52
    s_add_u32 s51, s51, 71303168
    s_lshl_b32 s52, s46, 9
    s_lshl_b32 s53, s20, 7
    s_add_u32 s52, s52, s53
    s_add_u32 s52, s52, 70516736
    v_and_b32 v3, 15, v2
    v_lshlrev_b32 v3, 2, v3
    s_and_b32 s60, s45, 0x1ffff
    s_lshr_b32 s61, s60, 4
    s_add_u32 s61, s61, 70320128
    s_andn2_b32 s50, s19, s101
    s_cbranch_scc1 K2_FINAL_L
    s_mov_b32 s18, 1
    s_waitcnt lgkmcnt(6)
    v_mfma_f32_16x16x32_bf16 v[128:131], a[64:67], v[104:107], v[128:131]
    ds_read_b128 a[100:103], v10 offset:20480
    v_mfma_f32_16x16x32_bf16 v[128:131], a[68:71], v[112:115], v[128:131]
    buffer_load_dword v14, v3, s[24:27], s61 offen offset:0
    v_mfma_f32_16x16x32_bf16 v[192:195], a[68:71], v[116:119], v[192:195]
    s_waitcnt lgkmcnt(5)
    ds_read_b128 a[96:99], v10 offset:4096
    v_mfma_f32_16x16x32_bf16 v[192:195], a[64:67], v[108:111], v[192:195]
    buffer_load_dword v15, v3, s[24:27], s61 offen offset:64
    v_mfma_f32_16x16x32_bf16 v[196:199], a[72:75], v[108:111], v[196:199]
    s_add_u32 s56, s65, 65536
    s_add_u32 m0, s30, s44
    ds_read_b128 a[108:111], v10 offset:21504
    v_mfma_f32_16x16x32_bf16 v[196:199], a[76:79], v[116:119], v[196:199]
    buffer_load_dwordx4 v6, s[24:27], s56 offen offset:0 lds
    v_mfma_f32_16x16x32_bf16 v[132:135], a[76:79], v[112:115], v[132:135]
    ds_read_b128 a[104:107], v10 offset:5120
    v_mfma_f32_16x16x32_bf16 v[132:135], a[72:75], v[104:107], v[132:135]
    buffer_load_dwordx4 v6, s[24:27], s56 offen offset:1024 lds
    v_mfma_f32_16x16x32_bf16 v[24:27], v[32:35], v[104:107], v[24:27]
    buffer_load_dwordx4 v6, s[24:27], s56 offen offset:2048 lds
    v_mfma_f32_16x16x32_bf16 v[24:27], v[32:35], v[112:115], v[24:27]
    buffer_load_dwordx4 v6, s[24:27], s56 offen offset:3072 lds
    v_mfma_f32_16x16x32_bf16 v[28:31], v[32:35], v[108:111], v[28:31]
    s_waitcnt lgkmcnt(6)
    s_add_u32 m0, m0, 4096
    v_mfma_f32_16x16x32_bf16 v[28:31], v[32:35], v[116:119], v[28:31]
    buffer_load_dwordx4 v7, s[24:27], s56 offen offset:0 lds
    v_mfma_f32_16x16x32_bf16 v[136:139], a[80:83], v[104:107], v[136:139]
    ds_read_b128 a[116:119], v10 offset:22528
    v_mfma_f32_16x16x32_bf16 v[136:139], a[84:87], v[112:115], v[136:139]
    buffer_load_dwordx4 v7, s[24:27], s56 offen offset:1024 lds
    v_mfma_f32_16x16x32_bf16 v[200:203], a[84:87], v[116:119], v[200:203]
    s_waitcnt lgkmcnt(5)
    ds_read_b128 a[112:115], v10 offset:6144
    v_mfma_f32_16x16x32_bf16 v[200:203], a[80:83], v[108:111], v[200:203]
    buffer_load_dwordx4 v7, s[24:27], s56 offen offset:2048 lds
    v_mfma_f32_16x16x32_bf16 v[204:207], a[88:91], v[108:111], v[204:207]
    ds_read_b128 a[124:127], v10 offset:23552
    v_mfma_f32_16x16x32_bf16 v[204:207], a[92:95], v[116:119], v[204:207]
    buffer_load_dwordx4 v7, s[24:27], s56 offen offset:3072 lds
    v_mfma_f32_16x16x32_bf16 v[140:143], a[92:95], v[112:115], v[140:143]
    s_waitcnt lgkmcnt(5)
    ds_read_b128 a[120:123], v10 offset:7168
    v_mfma_f32_16x16x32_bf16 v[140:143], a[88:91], v[104:107], v[140:143]
    v_mfma_f32_16x16x32_bf16 v[144:147], a[96:99], v[104:107], v[144:147]
    ds_read_b128 a[68:71], v10 offset:24576
    v_accvgpr_read_b32 v40, a168
    v_mfma_f32_16x16x32_bf16 v[144:147], a[100:103], v[112:115], v[144:147]
    v_accvgpr_read_b32 v41, a169
    v_accvgpr_read_b32 v42, a170
    v_mfma_f32_16x16x32_bf16 v[208:211], a[100:103], v[116:119], v[208:211]
    s_waitcnt lgkmcnt(5)
    ds_read_b128 a[64:67], v10 offset:8192
    v_accvgpr_read_b32 v43, a171
    v_mfma_f32_16x16x32_bf16 v[208:211], a[96:99], v[108:111], v[208:211]
    v_accvgpr_read_b32 v44, a172
    v_accvgpr_read_b32 v45, a173
    v_mfma_f32_16x16x32_bf16 v[212:215], a[104:107], v[108:111], v[212:215]
    ds_read_b128 a[76:79], v10 offset:25600
    v_accvgpr_read_b32 v46, a174
    v_mfma_f32_16x16x32_bf16 v[212:215], a[108:111], v[116:119], v[212:215]
    v_accvgpr_read_b32 v47, a175
    v_accvgpr_read_b32 v48, a176
    v_mfma_f32_16x16x32_bf16 v[148:151], a[108:111], v[112:115], v[148:151]
    s_waitcnt lgkmcnt(5)
    ds_read_b128 a[72:75], v10 offset:9216
    v_accvgpr_read_b32 v49, a177
    v_mfma_f32_16x16x32_bf16 v[148:151], a[104:107], v[104:107], v[148:151]
    v_accvgpr_read_b32 v50, a178
    v_accvgpr_read_b32 v51, a179
    v_mfma_f32_16x16x32_bf16 v[152:155], a[112:115], v[104:107], v[152:155]
    ds_read_b128 a[84:87], v10 offset:26624
    v_accvgpr_read_b32 v52, a180
    v_mfma_f32_16x16x32_bf16 v[152:155], a[116:119], v[112:115], v[152:155]
    v_accvgpr_read_b32 v53, a181
    v_accvgpr_read_b32 v54, a182
    v_mfma_f32_16x16x32_bf16 v[216:219], a[116:119], v[116:119], v[216:219]
    s_waitcnt lgkmcnt(5)
    ds_read_b128 a[80:83], v10 offset:10240
    v_accvgpr_read_b32 v55, a183
    v_mfma_f32_16x16x32_bf16 v[216:219], a[112:115], v[108:111], v[216:219]
    v_accvgpr_read_b32 v56, a184
    v_accvgpr_read_b32 v57, a185
    v_mfma_f32_16x16x32_bf16 v[220:223], a[120:123], v[108:111], v[220:223]
    ds_read_b128 a[92:95], v10 offset:27648
    v_accvgpr_read_b32 v58, a186
    v_mfma_f32_16x16x32_bf16 v[220:223], a[124:127], v[116:119], v[220:223]
    v_accvgpr_read_b32 v59, a187
    v_accvgpr_read_b32 v60, a188
    v_mfma_f32_16x16x32_bf16 v[156:159], a[124:127], v[112:115], v[156:159]
    s_waitcnt lgkmcnt(5)
    ds_read_b128 a[88:91], v10 offset:11264
    v_accvgpr_read_b32 v61, a189
    v_mfma_f32_16x16x32_bf16 v[156:159], a[120:123], v[104:107], v[156:159]
    v_accvgpr_read_b32 v62, a190
    v_accvgpr_read_b32 v63, a191
    v_mfma_f32_16x16x32_bf16 v[160:163], a[64:67], v[104:107], v[160:163]
    ds_read_b128 a[100:103], v10 offset:28672
    v_accvgpr_read_b32 v64, a192
    v_mfma_f32_16x16x32_bf16 v[160:163], a[68:71], v[112:115], v[160:163]
    v_accvgpr_read_b32 v65, a193
    v_accvgpr_read_b32 v66, a194
    v_mfma_f32_16x16x32_bf16 v[224:227], a[68:71], v[116:119], v[224:227]
    s_waitcnt lgkmcnt(5)
    ds_read_b128 a[96:99], v10 offset:12288
    v_accvgpr_read_b32 v67, a195
    v_mfma_f32_16x16x32_bf16 v[224:227], a[64:67], v[108:111], v[224:227]
    v_accvgpr_read_b32 v68, a196
    v_accvgpr_read_b32 v69, a197
    v_mfma_f32_16x16x32_bf16 v[228:231], a[72:75], v[108:111], v[228:231]
    ds_read_b128 a[108:111], v10 offset:29696
    v_accvgpr_read_b32 v70, a198
    v_mfma_f32_16x16x32_bf16 v[228:231], a[76:79], v[116:119], v[228:231]
    v_accvgpr_read_b32 v71, a199
    v_accvgpr_read_b32 v72, a200
    v_mfma_f32_16x16x32_bf16 v[164:167], a[76:79], v[112:115], v[164:167]
    s_waitcnt lgkmcnt(5)
    ds_read_b128 a[104:107], v10 offset:13312
    v_accvgpr_read_b32 v73, a201
    v_mfma_f32_16x16x32_bf16 v[164:167], a[72:75], v[104:107], v[164:167]
    v_accvgpr_read_b32 v74, a202
    v_accvgpr_read_b32 v75, a203
    v_mfma_f32_16x16x32_bf16 v[168:171], a[80:83], v[104:107], v[168:171]
    ds_read_b128 a[116:119], v10 offset:30720
    v_accvgpr_read_b32 v76, a204
    v_mfma_f32_16x16x32_bf16 v[168:171], a[84:87], v[112:115], v[168:171]
    v_accvgpr_read_b32 v77, a205
    v_accvgpr_read_b32 v78, a206
    v_mfma_f32_16x16x32_bf16 v[232:235], a[84:87], v[116:119], v[232:235]
    s_waitcnt lgkmcnt(5)
    ds_read_b128 a[112:115], v10 offset:14336
    v_accvgpr_read_b32 v79, a207
    v_mfma_f32_16x16x32_bf16 v[232:235], a[80:83], v[108:111], v[232:235]
    s_waitcnt vmcnt(18)
    v_accvgpr_read_b32 v80, a208
    v_accvgpr_read_b32 v81, a209
    v_mfma_f32_16x16x32_bf16 v[236:239], a[88:91], v[108:111], v[236:239]
    ds_read_b128 a[124:127], v10 offset:31744
    v_accvgpr_read_b32 v82, a210
    v_mfma_f32_16x16x32_bf16 v[236:239], a[92:95], v[116:119], v[236:239]
    v_accvgpr_read_b32 v83, a211
    s_waitcnt vmcnt(16)
    v_accvgpr_read_b32 v84, a212
    v_mfma_f32_16x16x32_bf16 v[172:175], a[92:95], v[112:115], v[172:175]
    s_waitcnt lgkmcnt(5)
    ds_read_b128 a[120:123], v10 offset:15360
    v_accvgpr_read_b32 v85, a213
    v_mfma_f32_16x16x32_bf16 v[172:175], a[88:91], v[104:107], v[172:175]
    v_accvgpr_read_b32 v86, a214
    v_accvgpr_read_b32 v87, a215
    v_mfma_f32_16x16x32_bf16 v[176:179], a[96:99], v[104:107], v[176:179]
    s_waitcnt vmcnt(14)
    v_accvgpr_read_b32 v88, a216
    v_accvgpr_read_b32 v89, a217
    v_mfma_f32_16x16x32_bf16 v[176:179], a[100:103], v[112:115], v[176:179]
    v_accvgpr_read_b32 v90, a218
    v_accvgpr_read_b32 v91, a219
    v_mfma_f32_16x16x32_bf16 v[240:243], a[100:103], v[116:119], v[240:243]
    s_waitcnt lgkmcnt(4)
    s_waitcnt vmcnt(13)
    v_accvgpr_read_b32 v92, a220
    v_accvgpr_read_b32 v93, a221
    v_mfma_f32_16x16x32_bf16 v[240:243], a[96:99], v[108:111], v[240:243]
    v_accvgpr_read_b32 v94, a222
    v_accvgpr_read_b32 v95, a223
    v_mfma_f32_16x16x32_bf16 v[244:247], a[104:107], v[108:111], v[244:247]
    s_waitcnt vmcnt(12)
    v_accvgpr_read_b32 v96, a224
    v_accvgpr_read_b32 v97, a225
    v_mfma_f32_16x16x32_bf16 v[244:247], a[108:111], v[116:119], v[244:247]
    v_accvgpr_read_b32 v98, a226
    v_accvgpr_read_b32 v99, a227
    v_mfma_f32_16x16x32_bf16 v[180:183], a[108:111], v[112:115], v[180:183]
    s_waitcnt lgkmcnt(2)
    s_waitcnt vmcnt(11)
    v_accvgpr_read_b32 v100, a228
    v_accvgpr_read_b32 v101, a229
    v_mfma_f32_16x16x32_bf16 v[180:183], a[104:107], v[104:107], v[180:183]
    v_accvgpr_read_b32 v102, a230
    v_accvgpr_read_b32 v103, a231
    v_mfma_f32_16x16x32_bf16 v[184:187], a[112:115], v[104:107], v[184:187]
    v_mfma_f32_16x16x32_bf16 v[184:187], a[116:119], v[112:115], v[184:187]
    v_mfma_f32_16x16x32_bf16 v[248:251], a[116:119], v[116:119], v[248:251]
    s_waitcnt lgkmcnt(0)
    v_mfma_f32_16x16x32_bf16 v[248:251], a[112:115], v[108:111], v[248:251]
    v_mfma_f32_16x16x32_bf16 v[252:255], a[120:123], v[108:111], v[252:255]
    v_mfma_f32_16x16x32_bf16 v[252:255], a[124:127], v[116:119], v[252:255]
    v_mfma_f32_16x16x32_bf16 v[188:191], a[124:127], v[112:115], v[188:191]
    v_mfma_f32_16x16x32_bf16 v[188:191], a[120:123], v[104:107], v[188:191]
K2_FINAL_J:
    s_barrier
    v_rcp_f32 v120, v24
    v_rcp_f32 v121, v28
    s_waitcnt vmcnt(9)
    v_mul_f32 v120, v120, v14
    s_waitcnt vmcnt(8)
    v_mul_f32 v121, v121, v15
    s_nop 4
    s_cmp_eq_u32 s19, 0
    s_cbranch_scc1 K2_PLAIN
K2_MERGE:
    s_cmp_eq_u32 s18, 1
    s_cbranch_scc1 K2_GOT
K2_POLL:
    buffer_load_dword v4, v5, s[24:27], s54 offen sc1
    s_waitcnt vmcnt(0)
    v_cmp_ne_u32 vcc, 0, v4
    s_nop 0
    s_cbranch_vccnz K2_POLLED
    s_sleep 4
    s_branch K2_POLL
K2_POLLED:
    s_lshl_b32 s51, s46, 16
    s_lshl_b32 s52, s20, 14
    s_add_u32 s51, s51, s52
    s_add_u32 s51, s51, 71303168
    s_lshl_b32 s52, s46, 9
    s_lshl_b32 s53, s20, 7
    s_add_u32 s52, s52, s53
    s_add_u32 s52, s52, 70516736
    v_and_b32 v3, 15, v2
    v_lshlrev_b32 v3, 2, v3
    buffer_load_dword v36, v3, s[24:27], s52 offen offset:0 sc1
    buffer_load_dword v37, v3, s[24:27], s52 offen offset:64 sc1
    s_add_u32 s53, s51, 0
    s_add_u32 s55, s51, 8192
    buffer_load_dwordx4 v[40:43], v8, s[24:27], s53 offen offset:0 sc1
    buffer_load_dwordx4 v[72:75], v8, s[24:27], s55 offen offset:0 sc1
    buffer_load_dwordx4 v[44:47], v8, s[24:27], s53 offen offset:1024 sc1
    buffer_load_dwordx4 v[76:79], v8, s[24:27], s55 offen offset:1024 sc1
    buffer_load_dwordx4 v[48:51], v8, s[24:27], s53 offen offset:2048 sc1
    buffer_load_dwordx4 v[80:83], v8, s[24:27], s55 offen offset:2048 sc1
    buffer_load_dwordx4 v[52:55], v8, s[24:27], s53 offen offset:3072 sc1
    buffer_load_dwordx4 v[84:87], v8, s[24:27], s55 offen offset:3072 sc1
    s_add_u32 s53, s51, 4096
    s_add_u32 s55, s51, 12288
    buffer_load_dwordx4 v[56:59], v8, s[24:27], s53 offen offset:0 sc1
    buffer_load_dwordx4 v[88:91], v8, s[24:27], s55 offen offset:0 sc1
    buffer_load_dwordx4 v[60:63], v8, s[24:27], s53 offen offset:1024 sc1
    buffer_load_dwordx4 v[92:95], v8, s[24:27], s55 offen offset:1024 sc1
    buffer_load_dwordx4 v[64:67], v8, s[24:27], s53 offen offset:2048 sc1
    buffer_load_dwordx4 v[96:99], v8, s[24:27], s55 offen offset:2048 sc1
    buffer_load_dwordx4 v[68:71], v8, s[24:27], s53 offen offset:3072 sc1
    buffer_load_dwordx4 v[100:103], v8, s[24:27], s55 offen offset:3072 sc1
K2_GOT:
    s_waitcnt vmcnt(16)
    v_log_f32 v122, v24
    s_nop 0
    v_sub_f32 v122, v122, v16
    v_sub_f32 v122, v36, v122
    v_exp_f32 v36, v122
    v_exp_f32 v38, -v122
    v_add_f32 v36, 1.0, v36
    v_add_f32 v38, 1.0, v38
    v_rcp_f32 v36, v36
    v_rcp_f32 v38, v38
    v_mul_f32 v120, v120, v36
    v_mul_f32 v38, v38, v14
    v_log_f32 v123, v28
    s_nop 0
    v_sub_f32 v123, v123, v20
    v_sub_f32 v123, v37, v123
    v_exp_f32 v37, v123
    v_exp_f32 v39, -v123
    v_add_f32 v37, 1.0, v37
    v_add_f32 v39, 1.0, v39
    v_rcp_f32 v37, v37
    v_rcp_f32 v39, v39
    v_mul_f32 v121, v121, v37
    v_mul_f32 v39, v39, v15
    s_add_u32 s56, s65, 98304
    v_pk_mul_f32 v[128:129], v[128:129], v[120:121] op_sel_hi:[1,0]
    v_pk_mul_f32 v[130:131], v[130:131], v[120:121] op_sel_hi:[1,0]
    v_pk_mul_f32 v[132:133], v[132:133], v[120:121] op_sel_hi:[1,0]
    v_pk_mul_f32 v[134:135], v[134:135], v[120:121] op_sel_hi:[1,0]
    s_waitcnt vmcnt(15)
    v_lshlrev_b32 v124, 16, v40
    v_and_b32 v125, 0xffff0000, v40
    v_pk_fma_f32 v[128:129], v[124:125], v[38:39], v[128:129] op_sel_hi:[1,0,1]
    v_lshlrev_b32 v126, 16, v41
    v_and_b32 v127, 0xffff0000, v41
    v_pk_fma_f32 v[130:131], v[126:127], v[38:39], v[130:131] op_sel_hi:[1,0,1]
    s_add_u32 m0, s31, s44
    v_lshlrev_b32 v124, 16, v42
    v_and_b32 v125, 0xffff0000, v42
    v_pk_fma_f32 v[132:133], v[124:125], v[38:39], v[132:133] op_sel_hi:[1,0,1]
    v_lshlrev_b32 v126, 16, v43
    v_and_b32 v127, 0xffff0000, v43
    v_pk_fma_f32 v[134:135], v[126:127], v[38:39], v[134:135] op_sel_hi:[1,0,1]
    v_cvt_pk_bf16_f32 v128, v128, v129
    v_cvt_pk_bf16_f32 v129, v130, v131
    v_cvt_pk_bf16_f32 v130, v132, v133
    buffer_load_dwordx4 v6, s[24:27], s56 offen offset:0 lds
    v_cvt_pk_bf16_f32 v131, v134, v135
    v_pk_mul_f32 v[192:193], v[192:193], v[120:121] op_sel:[0,1] op_sel_hi:[1,1]
    v_pk_mul_f32 v[194:195], v[194:195], v[120:121] op_sel:[0,1] op_sel_hi:[1,1]
    v_pk_mul_f32 v[196:197], v[196:197], v[120:121] op_sel:[0,1] op_sel_hi:[1,1]
    v_pk_mul_f32 v[198:199], v[198:199], v[120:121] op_sel:[0,1] op_sel_hi:[1,1]
    s_waitcnt vmcnt(15)
    v_lshlrev_b32 v124, 16, v72
    v_and_b32 v125, 0xffff0000, v72
    v_pk_fma_f32 v[192:193], v[124:125], v[38:39], v[192:193] op_sel:[0,1,0] op_sel_hi:[1,1,1]
    v_lshlrev_b32 v126, 16, v73
    buffer_load_dwordx4 v6, s[24:27], s56 offen offset:1024 lds
    v_and_b32 v127, 0xffff0000, v73
    v_pk_fma_f32 v[194:195], v[126:127], v[38:39], v[194:195] op_sel:[0,1,0] op_sel_hi:[1,1,1]
    v_lshlrev_b32 v124, 16, v74
    v_and_b32 v125, 0xffff0000, v74
    v_pk_fma_f32 v[196:197], v[124:125], v[38:39], v[196:197] op_sel:[0,1,0] op_sel_hi:[1,1,1]
    v_lshlrev_b32 v126, 16, v75
    v_and_b32 v127, 0xffff0000, v75
    v_pk_fma_f32 v[198:199], v[126:127], v[38:39], v[198:199] op_sel:[0,1,0] op_sel_hi:[1,1,1]
    v_cvt_pk_bf16_f32 v192, v192, v193
    buffer_load_dwordx4 v6, s[24:27], s56 offen offset:2048 lds
    v_cvt_pk_bf16_f32 v193, v194, v195
    v_cvt_pk_bf16_f32 v194, v196, v197
    v_cvt_pk_bf16_f32 v195, v198, v199
    v_pk_mul_f32 v[136:137], v[136:137], v[120:121] op_sel_hi:[1,0]
    v_pk_mul_f32 v[138:139], v[138:139], v[120:121] op_sel_hi:[1,0]
    v_pk_mul_f32 v[140:141], v[140:141], v[120:121] op_sel_hi:[1,0]
    v_pk_mul_f32 v[142:143], v[142:143], v[120:121] op_sel_hi:[1,0]
    s_waitcnt vmcnt(16)
    v_lshlrev_b32 v124, 16, v44
    v_and_b32 v125, 0xffff0000, v44
    buffer_load_dwordx4 v6, s[24:27], s56 offen offset:3072 lds
    v_pk_fma_f32 v[136:137], v[124:125], v[38:39], v[136:137] op_sel_hi:[1,0,1]
    v_lshlrev_b32 v126, 16, v45
    v_and_b32 v127, 0xffff0000, v45
    v_pk_fma_f32 v[138:139], v[126:127], v[38:39], v[138:139] op_sel_hi:[1,0,1]
    v_lshlrev_b32 v124, 16, v46
    v_and_b32 v125, 0xffff0000, v46
    v_pk_fma_f32 v[140:141], v[124:125], v[38:39], v[140:141] op_sel_hi:[1,0,1]
    v_lshlrev_b32 v126, 16, v47
    v_and_b32 v127, 0xffff0000, v47
    s_add_u32 m0, m0, 4096
    v_pk_fma_f32 v[142:143], v[126:127], v[38:39], v[142:143] op_sel_hi:[1,0,1]
    v_cvt_pk_bf16_f32 v136, v136, v137
    v_cvt_pk_bf16_f32 v137, v138, v139
    v_cvt_pk_bf16_f32 v138, v140, v141
    v_cvt_pk_bf16_f32 v139, v142, v143
    v_pk_mul_f32 v[200:201], v[200:201], v[120:121] op_sel:[0,1] op_sel_hi:[1,1]
    v_pk_mul_f32 v[202:203], v[202:203], v[120:121] op_sel:[0,1] op_sel_hi:[1,1]
    v_pk_mul_f32 v[204:205], v[204:205], v[120:121] op_sel:[0,1] op_sel_hi:[1,1]
    v_pk_mul_f32 v[206:207], v[206:207], v[120:121] op_sel:[0,1] op_sel_hi:[1,1]
    buffer_load_dwordx4 v7, s[24:27], s56 offen offset:0 lds
    s_waitcnt vmcnt(17)
    v_lshlrev_b32 v124, 16, v76
    v_and_b32 v125, 0xffff0000, v76
    v_pk_fma_f32 v[200:201], v[124:125], v[38:39], v[200:201] op_sel:[0,1,0] op_sel_hi:[1,1,1]
    v_lshlrev_b32 v126, 16, v77
    v_and_b32 v127, 0xffff0000, v77
    v_pk_fma_f32 v[202:203], v[126:127], v[38:39], v[202:203] op_sel:[0,1,0] op_sel_hi:[1,1,1]
    v_lshlrev_b32 v124, 16, v78
    v_and_b32 v125, 0xffff0000, v78
    v_pk_fma_f32 v[204:205], v[124:125], v[38:39], v[204:205] op_sel:[0,1,0] op_sel_hi:[1,1,1]
    buffer_load_dwordx4 v7, s[24:27], s56 offen offset:1024 lds
    v_lshlrev_b32 v126, 16, v79
    v_and_b32 v127, 0xffff0000, v79
    v_pk_fma_f32 v[206:207], v[126:127], v[38:39], v[206:207] op_sel:[0,1,0] op_sel_hi:[1,1,1]
    v_cvt_pk_bf16_f32 v200, v200, v201
    v_cvt_pk_bf16_f32 v201, v202, v203
    v_cvt_pk_bf16_f32 v202, v204, v205
    v_cvt_pk_bf16_f32 v203, v206, v207
    s_add_u32 s50, s45, 0
    buffer_store_dwordx4 v[128:131], v8, s[24:27], s50 offen sc1
    buffer_load_dwordx4 v7, s[24:27], s56 offen offset:2048 lds
    v_pk_mul_f32 v[144:145], v[144:145], v[120:121] op_sel_hi:[1,0]
    v_pk_mul_f32 v[146:147], v[146:147], v[120:121] op_sel_hi:[1,0]
    v_pk_mul_f32 v[148:149], v[148:149], v[120:121] op_sel_hi:[1,0]
    v_pk_mul_f32 v[150:151], v[150:151], v[120:121] op_sel_hi:[1,0]
    s_waitcnt vmcnt(19)
    v_lshlrev_b32 v124, 16, v48
    v_and_b32 v125, 0xffff0000, v48
    v_pk_fma_f32 v[144:145], v[124:125], v[38:39], v[144:145] op_sel_hi:[1,0,1]
    v_lshlrev_b32 v126, 16, v49
    v_and_b32 v127, 0xffff0000, v49
    v_pk_fma_f32 v[146:147], v[126:127], v[38:39], v[146:147] op_sel_hi:[1,0,1]
    buffer_load_dwordx4 v7, s[24:27], s56 offen offset:3072 lds
    v_lshlrev_b32 v124, 16, v50
    v_and_b32 v125, 0xffff0000, v50
    v_pk_fma_f32 v[148:149], v[124:125], v[38:39], v[148:149] op_sel_hi:[1,0,1]
    v_lshlrev_b32 v126, 16, v51
    v_and_b32 v127, 0xffff0000, v51
    v_pk_fma_f32 v[150:151], v[126:127], v[38:39], v[150:151] op_sel_hi:[1,0,1]
    v_cvt_pk_bf16_f32 v144, v144, v145
    v_cvt_pk_bf16_f32 v145, v146, v147
    v_cvt_pk_bf16_f32 v146, v148, v149
    s_mov_b32 s36, s48
    v_cvt_pk_bf16_f32 v147, v150, v151
    v_pk_mul_f32 v[208:209], v[208:209], v[120:121] op_sel:[0,1] op_sel_hi:[1,1]
    v_pk_mul_f32 v[210:211], v[210:211], v[120:121] op_sel:[0,1] op_sel_hi:[1,1]
    v_pk_mul_f32 v[212:213], v[212:213], v[120:121] op_sel:[0,1] op_sel_hi:[1,1]
    v_pk_mul_f32 v[214:215], v[214:215], v[120:121] op_sel:[0,1] op_sel_hi:[1,1]
    s_waitcnt vmcnt(19)
    v_lshlrev_b32 v124, 16, v80
    v_and_b32 v125, 0xffff0000, v80
    v_pk_fma_f32 v[208:209], v[124:125], v[38:39], v[208:209] op_sel:[0,1,0] op_sel_hi:[1,1,1]
    v_lshlrev_b32 v126, 16, v81
    s_and_b32 s37, s49, 0xffff
    v_and_b32 v127, 0xffff0000, v81
    v_pk_fma_f32 v[210:211], v[126:127], v[38:39], v[210:211] op_sel:[0,1,0] op_sel_hi:[1,1,1]
    v_lshlrev_b32 v124, 16, v82
    v_and_b32 v125, 0xffff0000, v82
    v_pk_fma_f32 v[212:213], v[124:125], v[38:39], v[212:213] op_sel:[0,1,0] op_sel_hi:[1,1,1]
    v_lshlrev_b32 v126, 16, v83
    v_and_b32 v127, 0xffff0000, v83
    v_pk_fma_f32 v[214:215], v[126:127], v[38:39], v[214:215] op_sel:[0,1,0] op_sel_hi:[1,1,1]
    v_cvt_pk_bf16_f32 v208, v208, v209
    s_mov_b32 s38, 1835008
    v_cvt_pk_bf16_f32 v209, v210, v211
    v_cvt_pk_bf16_f32 v210, v212, v213
    v_cvt_pk_bf16_f32 v211, v214, v215
    v_pk_mul_f32 v[152:153], v[152:153], v[120:121] op_sel_hi:[1,0]
    v_pk_mul_f32 v[154:155], v[154:155], v[120:121] op_sel_hi:[1,0]
    v_pk_mul_f32 v[156:157], v[156:157], v[120:121] op_sel_hi:[1,0]
    v_pk_mul_f32 v[158:159], v[158:159], v[120:121] op_sel_hi:[1,0]
    s_waitcnt vmcnt(18)
    v_lshlrev_b32 v124, 16, v52
    v_and_b32 v125, 0xffff0000, v52
    s_mov_b32 s39, 0x20000
    v_pk_fma_f32 v[152:153], v[124:125], v[38:39], v[152:153] op_sel_hi:[1,0,1]
    v_lshlrev_b32 v126, 16, v53
    v_and_b32 v127, 0xffff0000, v53
    v_pk_fma_f32 v[154:155], v[126:127], v[38:39], v[154:155] op_sel_hi:[1,0,1]
    v_lshlrev_b32 v124, 16, v54
    v_and_b32 v125, 0xffff0000, v54
    v_pk_fma_f32 v[156:157], v[124:125], v[38:39], v[156:157] op_sel_hi:[1,0,1]
    v_lshlrev_b32 v126, 16, v55
    v_and_b32 v127, 0xffff0000, v55
    s_lshr_b32 s6, s60, 13
    v_pk_fma_f32 v[158:159], v[126:127], v[38:39], v[158:159] op_sel_hi:[1,0,1]
    v_cvt_pk_bf16_f32 v152, v152, v153
    v_cvt_pk_bf16_f32 v153, v154, v155
    v_cvt_pk_bf16_f32 v154, v156, v157
    v_cvt_pk_bf16_f32 v155, v158, v159
    v_pk_mul_f32 v[216:217], v[216:217], v[120:121] op_sel:[0,1] op_sel_hi:[1,1]
    v_pk_mul_f32 v[218:219], v[218:219], v[120:121] op_sel:[0,1] op_sel_hi:[1,1]
    v_pk_mul_f32 v[220:221], v[220:221], v[120:121] op_sel:[0,1] op_sel_hi:[1,1]
    v_pk_mul_f32 v[222:223], v[222:223], v[120:121] op_sel:[0,1] op_sel_hi:[1,1]
    s_lshr_b32 s5, s21, 1
    s_waitcnt vmcnt(17)
    v_lshlrev_b32 v124, 16, v84
    v_and_b32 v125, 0xffff0000, v84
    v_pk_fma_f32 v[216:217], v[124:125], v[38:39], v[216:217] op_sel:[0,1,0] op_sel_hi:[1,1,1]
    v_lshlrev_b32 v126, 16, v85
    v_and_b32 v127, 0xffff0000, v85
    v_pk_fma_f32 v[218:219], v[126:127], v[38:39], v[218:219] op_sel:[0,1,0] op_sel_hi:[1,1,1]
    v_lshlrev_b32 v124, 16, v86
    v_and_b32 v125, 0xffff0000, v86
    v_pk_fma_f32 v[220:221], v[124:125], v[38:39], v[220:221] op_sel:[0,1,0] op_sel_hi:[1,1,1]
    s_and_b32 s7, s21, 1
    v_lshlrev_b32 v126, 16, v87
    v_and_b32 v127, 0xffff0000, v87
    v_pk_fma_f32 v[222:223], v[126:127], v[38:39], v[222:223] op_sel:[0,1,0] op_sel_hi:[1,1,1]
    v_cvt_pk_bf16_f32 v216, v216, v217
    v_cvt_pk_bf16_f32 v217, v218, v219
    v_cvt_pk_bf16_f32 v218, v220, v221
    v_cvt_pk_bf16_f32 v219, v222, v223
    s_add_u32 s50, s45, 1024
    buffer_store_dwordx4 v[192:195], v8, s[24:27], s50 offen sc1
    s_xor_b32 s4, s45, 0x100000
    v_pk_mul_f32 v[160:161], v[160:161], v[120:121] op_sel_hi:[1,0]
    v_pk_mul_f32 v[162:163], v[162:163], v[120:121] op_sel_hi:[1,0]
    v_pk_mul_f32 v[164:165], v[164:165], v[120:121] op_sel_hi:[1,0]
    v_pk_mul_f32 v[166:167], v[166:167], v[120:121] op_sel_hi:[1,0]
    s_waitcnt vmcnt(17)
    v_lshlrev_b32 v124, 16, v56
    v_and_b32 v125, 0xffff0000, v56
    v_pk_fma_f32 v[160:161], v[124:125], v[38:39], v[160:161] op_sel_hi:[1,0,1]
    v_lshlrev_b32 v126, 16, v57
    v_and_b32 v127, 0xffff0000, v57
    v_pk_fma_f32 v[162:163], v[126:127], v[38:39], v[162:163] op_sel_hi:[1,0,1]
    s_add_u32 s32, s28, 65536
    v_lshlrev_b32 v124, 16, v58
    v_and_b32 v125, 0xffff0000, v58
    v_pk_fma_f32 v[164:165], v[124:125], v[38:39], v[164:165] op_sel_hi:[1,0,1]
    v_lshlrev_b32 v126, 16, v59
    v_and_b32 v127, 0xffff0000, v59
    v_pk_fma_f32 v[166:167], v[126:127], v[38:39], v[166:167] op_sel_hi:[1,0,1]
    v_cvt_pk_bf16_f32 v160, v160, v161
    v_cvt_pk_bf16_f32 v161, v162, v163
    v_cvt_pk_bf16_f32 v162, v164, v165
    s_sub_u32 s63, s32, 163840
    v_cvt_pk_bf16_f32 v163, v166, v167
    v_pk_mul_f32 v[224:225], v[224:225], v[120:121] op_sel:[0,1] op_sel_hi:[1,1]
    v_pk_mul_f32 v[226:227], v[226:227], v[120:121] op_sel:[0,1] op_sel_hi:[1,1]
    v_pk_mul_f32 v[228:229], v[228:229], v[120:121] op_sel:[0,1] op_sel_hi:[1,1]
    v_pk_mul_f32 v[230:231], v[230:231], v[120:121] op_sel:[0,1] op_sel_hi:[1,1]
    s_waitcnt vmcnt(16)
    v_lshlrev_b32 v124, 16, v88
    v_and_b32 v125, 0xffff0000, v88
    v_pk_fma_f32 v[224:225], v[124:125], v[38:39], v[224:225] op_sel:[0,1,0] op_sel_hi:[1,1,1]
    v_lshlrev_b32 v126, 16, v89
    s_min_u32 s32, s32, s63
    v_and_b32 v127, 0xffff0000, v89
    v_pk_fma_f32 v[226:227], v[126:127], v[38:39], v[226:227] op_sel:[0,1,0] op_sel_hi:[1,1,1]
    v_lshlrev_b32 v124, 16, v90
    v_and_b32 v125, 0xffff0000, v90
    v_pk_fma_f32 v[228:229], v[124:125], v[38:39], v[228:229] op_sel:[0,1,0] op_sel_hi:[1,1,1]
    v_lshlrev_b32 v126, 16, v91
    v_and_b32 v127, 0xffff0000, v91
    v_pk_fma_f32 v[230:231], v[126:127], v[38:39], v[230:231] op_sel:[0,1,0] op_sel_hi:[1,1,1]
    v_cvt_pk_bf16_f32 v224, v224, v225
    s_lshl_b32 s62, s6, 3
    v_cvt_pk_bf16_f32 v225, v226, v227
    v_cvt_pk_bf16_f32 v226, v228, v229
    v_cvt_pk_bf16_f32 v227, v230, v231
    v_pk_mul_f32 v[168:169], v[168:169], v[120:121] op_sel_hi:[1,0]
    v_pk_mul_f32 v[170:171], v[170:171], v[120:121] op_sel_hi:[1,0]
    v_pk_mul_f32 v[172:173], v[172:173], v[120:121] op_sel_hi:[1,0]
    v_pk_mul_f32 v[174:175], v[174:175], v[120:121] op_sel_hi:[1,0]
    s_waitcnt vmcnt(15)
    v_lshlrev_b32 v124, 16, v60
    v_and_b32 v125, 0xffff0000, v60
    s_add_u32 s62, s62, s5
    v_pk_fma_f32 v[168:169], v[124:125], v[38:39], v[168:169] op_sel_hi:[1,0,1]
    v_lshlrev_b32 v126, 16, v61
    v_and_b32 v127, 0xffff0000, v61
    v_pk_fma_f32 v[170:171], v[126:127], v[38:39], v[170:171] op_sel_hi:[1,0,1]
    v_lshlrev_b32 v124, 16, v62
    v_and_b32 v125, 0xffff0000, v62
    v_pk_fma_f32 v[172:173], v[124:125], v[38:39], v[172:173] op_sel_hi:[1,0,1]
    v_lshlrev_b32 v126, 16, v63
    v_and_b32 v127, 0xffff0000, v63
    s_lshl_b32 s62, s62, 2
    v_pk_fma_f32 v[174:175], v[126:127], v[38:39], v[174:175] op_sel_hi:[1,0,1]
    v_cvt_pk_bf16_f32 v168, v168, v169
    v_cvt_pk_bf16_f32 v169, v170, v171
    v_cvt_pk_bf16_f32 v170, v172, v173
    v_cvt_pk_bf16_f32 v171, v174, v175
    v_pk_mul_f32 v[232:233], v[232:233], v[120:121] op_sel:[0,1] op_sel_hi:[1,1]
    v_pk_mul_f32 v[234:235], v[234:235], v[120:121] op_sel:[0,1] op_sel_hi:[1,1]
    v_pk_mul_f32 v[236:237], v[236:237], v[120:121] op_sel:[0,1] op_sel_hi:[1,1]
    v_pk_mul_f32 v[238:239], v[238:239], v[120:121] op_sel:[0,1] op_sel_hi:[1,1]
    s_add_u32 s62, s62, s20
    s_waitcnt vmcnt(14)
    v_lshlrev_b32 v124, 16, v92
    v_and_b32 v125, 0xffff0000, v92
    v_pk_fma_f32 v[232:233], v[124:125], v[38:39], v[232:233] op_sel:[0,1,0] op_sel_hi:[1,1,1]
    v_lshlrev_b32 v126, 16, v93
    v_and_b32 v127, 0xffff0000, v93
    v_pk_fma_f32 v[234:235], v[126:127], v[38:39], v[234:235] op_sel:[0,1,0] op_sel_hi:[1,1,1]
    v_lshlrev_b32 v124, 16, v94
    v_and_b32 v125, 0xffff0000, v94
    v_pk_fma_f32 v[236:237], v[124:125], v[38:39], v[236:237] op_sel:[0,1,0] op_sel_hi:[1,1,1]
    s_lshl_b32 s62, s62, 6
    v_lshlrev_b32 v126, 16, v95
    v_and_b32 v127, 0xffff0000, v95
    v_pk_fma_f32 v[238:239], v[126:127], v[38:39], v[238:239] op_sel:[0,1,0] op_sel_hi:[1,1,1]
    v_cvt_pk_bf16_f32 v232, v232, v233
    v_cvt_pk_bf16_f32 v233, v234, v235
    v_cvt_pk_bf16_f32 v234, v236, v237
    v_cvt_pk_bf16_f32 v235, v238, v239
    s_add_u32 s50, s45, 131072
    buffer_store_dwordx4 v[136:139], v8, s[24:27], s50 offen sc1
    s_add_u32 s62, s62, 70483968
    v_pk_mul_f32 v[176:177], v[176:177], v[120:121] op_sel_hi:[1,0]
    v_pk_mul_f32 v[178:179], v[178:179], v[120:121] op_sel_hi:[1,0]
    v_pk_mul_f32 v[180:181], v[180:181], v[120:121] op_sel_hi:[1,0]
    v_pk_mul_f32 v[182:183], v[182:183], v[120:121] op_sel_hi:[1,0]
    s_waitcnt vmcnt(14)
    v_lshlrev_b32 v124, 16, v64
    v_and_b32 v125, 0xffff0000, v64
    v_pk_fma_f32 v[176:177], v[124:125], v[38:39], v[176:177] op_sel_hi:[1,0,1]
    v_lshlrev_b32 v126, 16, v65
    v_and_b32 v127, 0xffff0000, v65
    v_pk_fma_f32 v[178:179], v[126:127], v[38:39], v[178:179] op_sel_hi:[1,0,1]
    s_lshl_b32 s9, s6, 1
    v_lshlrev_b32 v124, 16, v66
    v_and_b32 v125, 0xffff0000, v66
    v_pk_fma_f32 v[180:181], v[124:125], v[38:39], v[180:181] op_sel_hi:[1,0,1]
    v_lshlrev_b32 v126, 16, v67
    v_and_b32 v127, 0xffff0000, v67
    v_pk_fma_f32 v[182:183], v[126:127], v[38:39], v[182:183] op_sel_hi:[1,0,1]
    v_cvt_pk_bf16_f32 v176, v176, v177
    v_cvt_pk_bf16_f32 v177, v178, v179
    v_cvt_pk_bf16_f32 v178, v180, v181
    s_add_u32 s9, s9, s7
    v_cvt_pk_bf16_f32 v179, v182, v183
    v_pk_mul_f32 v[240:241], v[240:241], v[120:121] op_sel:[0,1] op_sel_hi:[1,1]
    v_pk_mul_f32 v[242:243], v[242:243], v[120:121] op_sel:[0,1] op_sel_hi:[1,1]
    v_pk_mul_f32 v[244:245], v[244:245], v[120:121] op_sel:[0,1] op_sel_hi:[1,1]
    v_pk_mul_f32 v[246:247], v[246:247], v[120:121] op_sel:[0,1] op_sel_hi:[1,1]
    s_waitcnt vmcnt(13)
    v_lshlrev_b32 v124, 16, v96
    v_and_b32 v125, 0xffff0000, v96
    v_pk_fma_f32 v[240:241], v[124:125], v[38:39], v[240:241] op_sel:[0,1,0] op_sel_hi:[1,1,1]
    v_lshlrev_b32 v126, 16, v97
    s_lshl_b32 s9, s9, 19
    v_and_b32 v127, 0xffff0000, v97
    v_pk_fma_f32 v[242:243], v[126:127], v[38:39], v[242:243] op_sel:[0,1,0] op_sel_hi:[1,1,1]
    v_lshlrev_b32 v124, 16, v98
    v_and_b32 v125, 0xffff0000, v98
    v_pk_fma_f32 v[244:245], v[124:125], v[38:39], v[244:245] op_sel:[0,1,0] op_sel_hi:[1,1,1]
    v_lshlrev_b32 v126, 16, v99
    v_and_b32 v127, 0xffff0000, v99
    v_pk_fma_f32 v[246:247], v[126:127], v[38:39], v[246:247] op_sel:[0,1,0] op_sel_hi:[1,1,1]
    v_cvt_pk_bf16_f32 v240, v240, v241
    s_add_u32 s9, s9, 79691776
    v_cvt_pk_bf16_f32 v241, v242, v243
    v_cvt_pk_bf16_f32 v242, v244, v245
    v_cvt_pk_bf16_f32 v243, v246, v247
    v_pk_mul_f32 v[184:185], v[184:185], v[120:121] op_sel_hi:[1,0]
    v_pk_mul_f32 v[186:187], v[186:187], v[120:121] op_sel_hi:[1,0]
    v_pk_mul_f32 v[188:189], v[188:189], v[120:121] op_sel_hi:[1,0]
    v_pk_mul_f32 v[190:191], v[190:191], v[120:121] op_sel_hi:[1,0]
    s_waitcnt vmcnt(12)
    v_lshlrev_b32 v124, 16, v68
    v_and_b32 v125, 0xffff0000, v68
    s_lshl_b32 s8, s5, 2
    v_pk_fma_f32 v[184:185], v[124:125], v[38:39], v[184:185] op_sel_hi:[1,0,1]
    v_lshlrev_b32 v126, 16, v69
    v_and_b32 v127, 0xffff0000, v69
    v_pk_fma_f32 v[186:187], v[126:127], v[38:39], v[186:187] op_sel_hi:[1,0,1]
    v_lshlrev_b32 v124, 16, v70
    v_and_b32 v125, 0xffff0000, v70
    v_pk_fma_f32 v[188:189], v[124:125], v[38:39], v[188:189] op_sel_hi:[1,0,1]
    v_lshlrev_b32 v126, 16, v71
    v_and_b32 v127, 0xffff0000, v71
    s_add_u32 s8, s8, s20
    v_pk_fma_f32 v[190:191], v[126:127], v[38:39], v[190:191] op_sel_hi:[1,0,1]
    v_cvt_pk_bf16_f32 v184, v184, v185
    v_cvt_pk_bf16_f32 v185, v186, v187
    v_cvt_pk_bf16_f32 v186, v188, v189
    v_cvt_pk_bf16_f32 v187, v190, v191
    v_pk_mul_f32 v[248:249], v[248:249], v[120:121] op_sel:[0,1] op_sel_hi:[1,1]
    v_pk_mul_f32 v[250:251], v[250:251], v[120:121] op_sel:[0,1] op_sel_hi:[1,1]
    v_pk_mul_f32 v[252:253], v[252:253], v[120:121] op_sel:[0,1] op_sel_hi:[1,1]
    v_pk_mul_f32 v[254:255], v[254:255], v[120:121] op_sel:[0,1] op_sel_hi:[1,1]
    s_lshl_b32 s8, s8, 14
    s_waitcnt vmcnt(11)
    v_lshlrev_b32 v124, 16, v100
    v_and_b32 v125, 0xffff0000, v100
    v_pk_fma_f32 v[248:249], v[124:125], v[38:39], v[248:249] op_sel:[0,1,0] op_sel_hi:[1,1,1]
    v_lshlrev_b32 v126, 16, v101
    v_and_b32 v127, 0xffff0000, v101
    v_pk_fma_f32 v[250:251], v[126:127], v[38:39], v[250:251] op_sel:[0,1,0] op_sel_hi:[1,1,1]
    v_lshlrev_b32 v124, 16, v102
    v_and_b32 v125, 0xffff0000, v102
    v_pk_fma_f32 v[252:253], v[124:125], v[38:39], v[252:253] op_sel:[0,1,0] op_sel_hi:[1,1,1]
    s_add_u32 s8, s8, s9
    v_lshlrev_b32 v126, 16, v103
    v_and_b32 v127, 0xffff0000, v103
    v_pk_fma_f32 v[254:255], v[126:127], v[38:39], v[254:255] op_sel:[0,1,0] op_sel_hi:[1,1,1]
    v_cvt_pk_bf16_f32 v248, v248, v249
    v_cvt_pk_bf16_f32 v249, v250, v251
    v_cvt_pk_bf16_f32 v250, v252, v253
    v_cvt_pk_bf16_f32 v251, v254, v255
    s_add_u32 s50, s45, 132096
    buffer_store_dwordx4 v[200:203], v8, s[24:27], s50 offen sc1
    s_nop 4
K2_TAIL:
    ds_read_b128 a[68:71], v9 offset:1024
    ds_read_b128 a[64:67], v9 offset:0
    ds_read_b128 a[76:79], v9 offset:3072
    ds_read_b128 a[72:75], v9 offset:2048
    ds_read_b128 a[84:87], v9 offset:5120
    ds_read_b128 a[80:83], v9 offset:4096
    ds_read_b128 a[92:95], v9 offset:7168
    ds_read_b128 a[88:91], v9 offset:6144
    v_cmp_gt_u32 vcc, 48, v2
    s_nop 1
    v_cndmask_b32 v12, 0, 1.0, vcc
    s_lshl_b32 s63, s7, 2
    v_mov_b32 v3, s63
    v_xor_b32 v11, 4, v3
    v_min_u32 v13, 1, v2
    v_lshl_or_b32 v3, v13, 30, v3
    v_mov_b32 v1, 1
    v_mfma_f32_16x16x32_bf16 v[24:27], a[136:139], a[152:155], 0
    s_add_u32 s50, s45, 262144
    v_mfma_f32_16x16x32_bf16 v[16:19], a[128:131], a[152:155], 0
    buffer_store_dwordx4 v[144:147], v8, s[24:27], s50 offen sc1
    v_mfma_f32_16x16x32_bf16 v[20:23], a[132:135], a[152:155], 0
    v_mfma_f32_16x16x32_bf16 v[36:39], a[136:139], a[156:159], 0
    s_add_u32 s50, s45, 263168
    v_mfma_f32_16x16x32_bf16 v[28:31], a[128:131], a[156:159], 0
    v_mfma_f32_16x16x32_bf16 v[32:35], a[132:135], a[156:159], 0
    v_mfma_f32_16x16x32_bf16 v[48:51], a[148:151], a[160:163], 0
    v_add_f32 v112, 0x358637bd, v24
    v_sub_f32 v113, 1.0, v14
    v_mfma_f32_16x16x32_bf16 v[40:43], a[140:143], a[160:163], 0
    v_rcp_f32 v112, v112
    v_mfma_f32_16x16x32_bf16 v[44:47], a[144:147], a[160:163], 0
    v_mul_f32 v112, v112, v113
    v_mul_f32 v113, v112, v12
    v_mfma_f32_16x16x32_bf16 v[60:63], a[148:151], a[164:167], 0
    v_mul_f32 v16, v16, v112
    v_mul_f32 v17, v17, v112
    v_mfma_f32_16x16x32_bf16 v[52:55], a[140:143], a[164:167], 0
    s_waitcnt lgkmcnt(6)
    v_mul_f32 v18, v18, v112
    v_mul_f32 v19, v19, v112
    v_mfma_f32_16x16x32_bf16 v[56:59], a[144:147], a[164:167], 0
    buffer_store_dwordx4 v[208:211], v8, s[24:27], s50 offen sc1
    v_mfma_f32_16x16x32_bf16 v[132:135], a[64:67], v[128:131], 0
    ds_read_b128 a[100:103], v9 offset:9216
    v_mul_f32 v20, v20, v113
    v_mfma_f32_16x16x32_bf16 v[132:135], a[68:71], v[136:139], v[132:135]
    s_add_u32 s50, s45, 393216
    v_mul_f32 v21, v21, v113
    v_mul_f32 v22, v22, v113
    v_mfma_f32_16x16x32_bf16 v[196:199], a[64:67], v[192:195], 0
    s_waitcnt lgkmcnt(5)
    ds_read_b128 a[96:99], v9 offset:8192
    v_mul_f32 v23, v23, v113
    v_mfma_f32_16x16x32_bf16 v[196:199], a[68:71], v[200:203], v[196:199]
    v_cvt_pk_bf16_f32 v16, v16, v17
    v_cvt_pk_bf16_f32 v17, v18, v19
    v_mfma_f32_16x16x32_bf16 v[140:143], a[72:75], v[128:131], 0
    ds_read_b128 a[108:111], v9 offset:11264
    v_add_u32 v10, s32, v8
    v_mfma_f32_16x16x32_bf16 v[140:143], a[76:79], v[136:139], v[140:143]
    v_cvt_pk_bf16_f32 v18, v20, v21
    v_cvt_pk_bf16_f32 v19, v22, v23
    v_mfma_f32_16x16x32_bf16 v[204:207], a[72:75], v[192:195], 0
    s_waitcnt lgkmcnt(5)
    ds_read_b128 a[104:107], v9 offset:10240
    v_add_f32 v114, 0x358637bd, v36
    v_mfma_f32_16x16x32_bf16 v[204:207], a[76:79], v[200:203], v[204:207]
    v_rcp_f32 v114, v114
    v_mfma_f32_16x16x32_bf16 v[148:151], a[80:83], v[128:131], 0
    ds_read_b128 a[116:119], v9 offset:13312
    v_sub_f32 v115, 1.0, v15
    v_mfma_f32_16x16x32_bf16 v[148:151], a[84:87], v[136:139], v[148:151]
    buffer_store_dwordx4 v[152:155], v8, s[24:27], s50 offen sc1
    v_mfma_f32_16x16x32_bf16 v[212:215], a[80:83], v[192:195], 0
    s_waitcnt lgkmcnt(5)
    ds_read_b128 a[112:115], v9 offset:12288
    v_mul_f32 v114, v114, v115
    v_mfma_f32_16x16x32_bf16 v[212:215], a[84:87], v[200:203], v[212:215]
    s_add_u32 s50, s45, 394240
    v_mul_f32 v115, v114, v12
    v_mul_f32 v28, v28, v114
    v_mfma_f32_16x16x32_bf16 v[156:159], a[88:91], v[128:131], 0
    ds_read_b128 a[124:127], v9 offset:15360
    v_mul_f32 v29, v29, v114
    v_mfma_f32_16x16x32_bf16 v[156:159], a[92:95], v[136:139], v[156:159]
    v_mul_f32 v30, v30, v114
    v_mul_f32 v31, v31, v114
    v_mfma_f32_16x16x32_bf16 v[220:223], a[88:91], v[192:195], 0
    s_waitcnt lgkmcnt(5)
    ds_read_b128 a[120:123], v9 offset:14336
    v_mul_f32 v32, v32, v115
    v_mfma_f32_16x16x32_bf16 v[220:223], a[92:95], v[200:203], v[220:223]
    v_mul_f32 v33, v33, v115
    v_mul_f32 v34, v34, v115
    v_mfma_f32_16x16x32_bf16 v[164:167], a[96:99], v[128:131], 0
    ds_read_b128 a[68:71], v9 offset:17408
    v_mul_f32 v35, v35, v115
    v_mfma_f32_16x16x32_bf16 v[164:167], a[100:103], v[136:139], v[164:167]
    v_cvt_pk_bf16_f32 v28, v28, v29
    v_cvt_pk_bf16_f32 v29, v30, v31
    v_mfma_f32_16x16x32_bf16 v[228:231], a[96:99], v[192:195], 0
    s_waitcnt lgkmcnt(5)
    ds_read_b128 a[64:67], v9 offset:16384
    v_cvt_pk_bf16_f32 v30, v32, v33
    v_mfma_f32_16x16x32_bf16 v[228:231], a[100:103], v[200:203], v[228:231]
    buffer_store_dwordx4 v[216:219], v8, s[24:27], s50 offen sc1
    v_mfma_f32_16x16x32_bf16 v[172:175], a[104:107], v[128:131], 0
    ds_read_b128 a[76:79], v9 offset:19456
    v_cvt_pk_bf16_f32 v31, v34, v35
    v_mfma_f32_16x16x32_bf16 v[172:175], a[108:111], v[136:139], v[172:175]
    s_add_u32 s50, s45, 524288
    v_add_f32 v116, 0x358637bd, v48
    v_sub_f32 v117, 1.0, v14
    v_mfma_f32_16x16x32_bf16 v[236:239], a[104:107], v[192:195], 0
    s_waitcnt lgkmcnt(5)
    ds_read_b128 a[72:75], v9 offset:18432
    v_add_f32 v118, 0x358637bd, v60
    v_mfma_f32_16x16x32_bf16 v[236:239], a[108:111], v[200:203], v[236:239]
    v_rcp_f32 v116, v116
    v_mfma_f32_16x16x32_bf16 v[180:183], a[112:115], v[128:131], 0
    ds_read_b128 a[84:87], v9 offset:21504
    v_mul_f32 v116, v116, v117
    v_mfma_f32_16x16x32_bf16 v[180:183], a[116:119], v[136:139], v[180:183]
    v_rcp_f32 v118, v118
    v_mfma_f32_16x16x32_bf16 v[244:247], a[112:115], v[192:195], 0
    s_waitcnt lgkmcnt(5)
    ds_read_b128 a[80:83], v9 offset:20480
    v_mul_f32 v117, v116, v12
    v_mfma_f32_16x16x32_bf16 v[244:247], a[116:119], v[200:203], v[244:247]
    v_mul_f32 v40, v40, v116
    v_mul_f32 v41, v41, v116
    v_mfma_f32_16x16x32_bf16 v[188:191], a[120:123], v[128:131], 0
    ds_read_b128 a[92:95], v9 offset:23552
    v_mul_f32 v42, v42, v116
    v_mfma_f32_16x16x32_bf16 v[188:191], a[124:127], v[136:139], v[188:191]
    buffer_store_dwordx4 v[160:163], v8, s[24:27], s50 offen sc1
    v_mfma_f32_16x16x32_bf16 v[252:255], a[120:123], v[192:195], 0
    s_waitcnt lgkmcnt(5)
    ds_read_b128 a[88:91], v9 offset:22528
    v_mul_f32 v43, v43, v116
    v_mfma_f32_16x16x32_bf16 v[252:255], a[124:127], v[200:203], v[252:255]
    s_add_u32 s50, s45, 525312
    v_mul_f32 v44, v44, v117
    v_mul_f32 v45, v45, v117
    v_mfma_f32_16x16x32_bf16 v[64:67], a[64:67], v[128:131], 0
    ds_read_b128 a[100:103], v9 offset:25600
    v_mul_f32 v46, v46, v117
    v_mfma_f32_16x16x32_bf16 v[64:67], a[68:71], v[136:139], v[64:67]
    v_mul_f32 v47, v47, v117
    v_cvt_pk_bf16_f32 v40, v40, v41
    v_mfma_f32_16x16x32_bf16 v[68:71], a[64:67], v[192:195], 0
    s_waitcnt lgkmcnt(5)
    ds_read_b128 a[96:99], v9 offset:24576
    v_cvt_pk_bf16_f32 v41, v42, v43
    v_mfma_f32_16x16x32_bf16 v[68:71], a[68:71], v[200:203], v[68:71]
    v_cvt_pk_bf16_f32 v42, v44, v45
    v_cvt_pk_bf16_f32 v43, v46, v47
    v_mfma_f32_16x16x32_bf16 v[72:75], a[72:75], v[128:131], 0
    ds_read_b128 a[108:111], v9 offset:27648
    v_sub_f32 v119, 1.0, v15
    v_mfma_f32_16x16x32_bf16 v[72:75], a[76:79], v[136:139], v[72:75]
    v_mul_f32 v118, v118, v119
    v_mul_f32 v119, v118, v12
    v_mfma_f32_16x16x32_bf16 v[76:79], a[72:75], v[192:195], 0
    s_waitcnt lgkmcnt(5)
    ds_read_b128 a[104:107], v9 offset:26624
    v_mul_f32 v52, v52, v118
    v_mfma_f32_16x16x32_bf16 v[76:79], a[76:79], v[200:203], v[76:79]
    buffer_store_dwordx4 v[224:227], v8, s[24:27], s50 offen sc1
    v_mfma_f32_16x16x32_bf16 v[80:83], a[80:83], v[128:131], 0
    ds_read_b128 a[116:119], v9 offset:29696
    v_mul_f32 v53, v53, v118
    v_mfma_f32_16x16x32_bf16 v[80:83], a[84:87], v[136:139], v[80:83]
    s_add_u32 s50, s45, 655360
    v_mul_f32 v54, v54, v118
    v_mul_f32 v55, v55, v118
    v_mfma_f32_16x16x32_bf16 v[84:87], a[80:83], v[192:195], 0
    s_waitcnt lgkmcnt(5)
    ds_read_b128 a[112:115], v9 offset:28672
    v_mul_f32 v56, v56, v119
    v_mfma_f32_16x16x32_bf16 v[84:87], a[84:87], v[200:203], v[84:87]
    v_mul_f32 v57, v57, v119
    v_mul_f32 v58, v58, v119
    v_mfma_f32_16x16x32_bf16 v[88:91], a[88:91], v[128:131], 0
    ds_read_b128 a[124:127], v9 offset:31744
    v_mul_f32 v59, v59, v119
    v_mfma_f32_16x16x32_bf16 v[88:91], a[92:95], v[136:139], v[88:91]
    s_waitcnt lgkmcnt(5)
    v_cvt_pk_bf16_f32 v52, v52, v53
    v_cvt_pk_bf16_f32 v53, v54, v55
    v_mfma_f32_16x16x32_bf16 v[92:95], a[88:91], v[192:195], 0
    ds_read_b128 a[120:123], v9 offset:30720
    v_cvt_pk_bf16_f32 v54, v56, v57
    v_mfma_f32_16x16x32_bf16 v[92:95], a[92:95], v[200:203], v[92:95]
    s_barrier
    v_cvt_pk_bf16_f32 v55, v58, v59
    v_mfma_f32_16x16x32_bf16 v[96:99], a[96:99], v[128:131], 0
    ds_read_b128 a[68:71], v10 offset:1024
    v_mfma_f32_16x16x32_bf16 v[96:99], a[100:103], v[136:139], v[96:99]
    buffer_store_dwordx4 v[168:171], v8, s[24:27], s50 offen sc1
    v_mfma_f32_16x16x32_bf16 v[100:103], a[96:99], v[192:195], 0
    s_waitcnt lgkmcnt(5)
    ds_read_b128 a[64:67], v10 offset:0
    v_mfma_f32_16x16x32_bf16 v[100:103], a[100:103], v[200:203], v[100:103]
    s_add_u32 s50, s45, 656384
    v_mfma_f32_16x16x32_bf16 v[104:107], a[104:107], v[128:131], 0
    s_add_u32 s56, s65, 131072
    ds_read_b128 a[76:79], v10 offset:3072
    v_mfma_f32_16x16x32_bf16 v[104:107], a[108:111], v[136:139], v[104:107]
    s_add_u32 m0, s29, s44
    v_mfma_f32_16x16x32_bf16 v[108:111], a[104:107], v[192:195], 0
    s_waitcnt lgkmcnt(5)
    ds_read_b128 a[72:75], v10 offset:2048
    v_mfma_f32_16x16x32_bf16 v[108:111], a[108:111], v[200:203], v[108:111]
    buffer_load_dwordx4 v6, s[24:27], s56 offen offset:0 lds
    v_mfma_f32_16x16x32_bf16 v[132:135], a[112:115], v[144:147], v[132:135]
    ds_read_b128 a[84:87], v10 offset:5120
    v_mfma_f32_16x16x32_bf16 v[132:135], a[116:119], v[152:155], v[132:135]
    buffer_load_dwordx4 v6, s[24:27], s56 offen offset:1024 lds
    v_mfma_f32_16x16x32_bf16 v[196:199], a[116:119], v[216:219], v[196:199]
    s_waitcnt lgkmcnt(5)
    ds_read_b128 a[80:83], v10 offset:4096
    v_mfma_f32_16x16x32_bf16 v[196:199], a[112:115], v[208:211], v[196:199]
    buffer_store_dwordx4 v[232:235], v8, s[24:27], s50 offen sc1
    v_mfma_f32_16x16x32_bf16 v[204:207], a[120:123], v[208:211], v[204:207]
    ds_read_b128 a[92:95], v10 offset:7168
    v_mfma_f32_16x16x32_bf16 v[204:207], a[124:127], v[216:219], v[204:207]
    s_add_u32 s50, s45, 786432
    v_mfma_f32_16x16x32_bf16 v[140:143], a[124:127], v[152:155], v[140:143]
    s_waitcnt lgkmcnt(5)
    ds_read_b128 a[88:91], v10 offset:6144
    v_mfma_f32_16x16x32_bf16 v[140:143], a[120:123], v[144:147], v[140:143]
    buffer_load_dwordx4 v6, s[24:27], s56 offen offset:2048 lds
    v_mfma_f32_16x16x32_bf16 v[148:151], a[64:67], v[144:147], v[148:151]
    ds_read_b128 a[100:103], v10 offset:9216
    v_mfma_f32_16x16x32_bf16 v[148:151], a[68:71], v[152:155], v[148:151]
    v_mfma_f32_16x16x32_bf16 v[212:215], a[68:71], v[216:219], v[212:215]
    s_waitcnt lgkmcnt(5)
    ds_read_b128 a[96:99], v10 offset:8192
    v_mfma_f32_16x16x32_bf16 v[212:215], a[64:67], v[208:211], v[212:215]
    v_mfma_f32_16x16x32_bf16 v[220:223], a[72:75], v[208:211], v[220:223]
    ds_read_b128 a[108:111], v10 offset:11264
    v_add_u32 v9, s30, v8
    v_mfma_f32_16x16x32_bf16 v[220:223], a[76:79], v[216:219], v[220:223]
    buffer_store_dwordx4 v[176:179], v8, s[24:27], s50 offen sc1
    v_mfma_f32_16x16x32_bf16 v[156:159], a[76:79], v[152:155], v[156:159]
    s_waitcnt lgkmcnt(5)
    ds_read_b128 a[104:107], v10 offset:10240
    v_mfma_f32_16x16x32_bf16 v[156:159], a[72:75], v[144:147], v[156:159]
    buffer_load_dwordx4 v6, s[24:27], s56 offen offset:3072 lds
    v_mfma_f32_16x16x32_bf16 v[164:167], a[80:83], v[144:147], v[164:167]
    s_add_u32 s50, s45, 787456
    ds_read_b128 a[116:119], v10 offset:13312
    v_mfma_f32_16x16x32_bf16 v[164:167], a[84:87], v[152:155], v[164:167]
    s_add_u32 m0, m0, 4096
    v_mfma_f32_16x16x32_bf16 v[228:231], a[84:87], v[216:219], v[228:231]
    s_waitcnt lgkmcnt(5)
    ds_read_b128 a[112:115], v10 offset:12288
    v_mfma_f32_16x16x32_bf16 v[228:231], a[80:83], v[208:211], v[228:231]
    v_mfma_f32_16x16x32_bf16 v[236:239], a[88:91], v[208:211], v[236:239]
    ds_read_b128 a[124:127], v10 offset:15360
    v_mfma_f32_16x16x32_bf16 v[236:239], a[92:95], v[216:219], v[236:239]
    buffer_load_dwordx4 v7, s[24:27], s56 offen offset:0 lds
    v_mfma_f32_16x16x32_bf16 v[172:175], a[92:95], v[152:155], v[172:175]
    s_waitcnt lgkmcnt(5)
    ds_read_b128 a[120:123], v10 offset:14336
    v_mfma_f32_16x16x32_bf16 v[172:175], a[88:91], v[144:147], v[172:175]
    buffer_store_dwordx4 v[240:243], v8, s[24:27], s50 offen sc1
    v_mfma_f32_16x16x32_bf16 v[180:183], a[96:99], v[144:147], v[180:183]
    ds_read_b128 a[68:71], v10 offset:17408
    v_mfma_f32_16x16x32_bf16 v[180:183], a[100:103], v[152:155], v[180:183]
    s_add_u32 s50, s45, 917504
    v_mfma_f32_16x16x32_bf16 v[244:247], a[100:103], v[216:219], v[244:247]
    s_waitcnt lgkmcnt(5)
    ds_read_b128 a[64:67], v10 offset:16384
    v_mfma_f32_16x16x32_bf16 v[244:247], a[96:99], v[208:211], v[244:247]
    v_mfma_f32_16x16x32_bf16 v[252:255], a[104:107], v[208:211], v[252:255]
    ds_read_b128 a[76:79], v10 offset:19456
    v_mfma_f32_16x16x32_bf16 v[252:255], a[108:111], v[216:219], v[252:255]
    buffer_load_dwordx4 v7, s[24:27], s56 offen offset:1024 lds
    v_mfma_f32_16x16x32_bf16 v[188:191], a[108:111], v[152:155], v[188:191]
    s_waitcnt lgkmcnt(5)
    ds_read_b128 a[72:75], v10 offset:18432
    v_mfma_f32_16x16x32_bf16 v[188:191], a[104:107], v[144:147], v[188:191]
    v_mfma_f32_16x16x32_bf16 v[64:67], a[112:115], v[144:147], v[64:67]
    ds_read_b128 a[84:87], v10 offset:21504
    v_mfma_f32_16x16x32_bf16 v[64:67], a[116:119], v[152:155], v[64:67]
    buffer_store_dwordx4 v[184:187], v8, s[24:27], s50 offen sc1
    v_mfma_f32_16x16x32_bf16 v[68:71], a[116:119], v[216:219], v[68:71]
    s_waitcnt lgkmcnt(5)
    ds_read_b128 a[80:83], v10 offset:20480
    v_mfma_f32_16x16x32_bf16 v[68:71], a[112:115], v[208:211], v[68:71]
    buffer_load_dwordx4 v7, s[24:27], s56 offen offset:2048 lds
    v_mfma_f32_16x16x32_bf16 v[76:79], a[120:123], v[208:211], v[76:79]
    s_add_u32 s50, s45, 918528
    ds_read_b128 a[92:95], v10 offset:23552
    v_mfma_f32_16x16x32_bf16 v[76:79], a[124:127], v[216:219], v[76:79]
    v_mfma_f32_16x16x32_bf16 v[72:75], a[124:127], v[152:155], v[72:75]
    s_waitcnt lgkmcnt(5)
    ds_read_b128 a[88:91], v10 offset:22528
    v_mfma_f32_16x16x32_bf16 v[72:75], a[120:123], v[144:147], v[72:75]
    v_mfma_f32_16x16x32_bf16 v[80:83], a[64:67], v[144:147], v[80:83]
    ds_read_b128 a[100:103], v10 offset:25600
    v_mfma_f32_16x16x32_bf16 v[80:83], a[68:71], v[152:155], v[80:83]
    v_mfma_f32_16x16x32_bf16 v[84:87], a[68:71], v[216:219], v[84:87]
    s_waitcnt lgkmcnt(5)
    ds_read_b128 a[96:99], v10 offset:24576
    v_mfma_f32_16x16x32_bf16 v[84:87], a[64:67], v[208:211], v[84:87]
    buffer_store_dwordx4 v[248:251], v8, s[24:27], s50 offen sc1
    v_mfma_f32_16x16x32_bf16 v[92:95], a[72:75], v[208:211], v[92:95]
    ds_read_b128 a[108:111], v10 offset:27648
    v_mfma_f32_16x16x32_bf16 v[92:95], a[76:79], v[216:219], v[92:95]
    buffer_load_dwordx4 v7, s[24:27], s56 offen offset:3072 lds
    v_mfma_f32_16x16x32_bf16 v[88:91], a[76:79], v[152:155], v[88:91]
    s_waitcnt lgkmcnt(5)
    ds_read_b128 a[104:107], v10 offset:26624
    v_mfma_f32_16x16x32_bf16 v[88:91], a[72:75], v[144:147], v[88:91]
    v_mfma_f32_16x16x32_bf16 v[96:99], a[80:83], v[144:147], v[96:99]
    ds_read_b128 a[116:119], v10 offset:29696
    v_mfma_f32_16x16x32_bf16 v[96:99], a[84:87], v[152:155], v[96:99]
    v_mfma_f32_16x16x32_bf16 v[100:103], a[84:87], v[216:219], v[100:103]
    s_waitcnt lgkmcnt(5)
    ds_read_b128 a[112:115], v10 offset:28672
    v_mfma_f32_16x16x32_bf16 v[100:103], a[80:83], v[208:211], v[100:103]
    v_mfma_f32_16x16x32_bf16 v[108:111], a[88:91], v[208:211], v[108:111]
    ds_read_b128 a[124:127], v10 offset:31744
    v_mfma_f32_16x16x32_bf16 v[108:111], a[92:95], v[216:219], v[108:111]
    s_waitcnt lgkmcnt(5)
    v_mfma_f32_16x16x32_bf16 v[104:107], a[92:95], v[152:155], v[104:107]
    ds_read_b128 a[120:123], v10 offset:30720
    v_mfma_f32_16x16x32_bf16 v[104:107], a[88:91], v[144:147], v[104:107]
    s_barrier
    v_mfma_f32_16x16x32_bf16 v[132:135], a[96:99], v[160:163], v[132:135]
    ds_read_b128 a[68:71], v9 offset:1024
    v_mfma_f32_16x16x32_bf16 v[132:135], a[100:103], v[168:171], v[132:135]
    s_add_u32 s56, s65, 163840
    v_mfma_f32_16x16x32_bf16 v[196:199], a[100:103], v[232:235], v[196:199]
    s_waitcnt lgkmcnt(5)
    ds_read_b128 a[64:67], v9 offset:0
    v_mfma_f32_16x16x32_bf16 v[196:199], a[96:99], v[224:227], v[196:199]
    s_add_u32 m0, s28, s44
    v_mfma_f32_16x16x32_bf16 v[204:207], a[104:107], v[224:227], v[204:207]
    ds_read_b128 a[76:79], v9 offset:3072
    v_mfma_f32_16x16x32_bf16 v[204:207], a[108:111], v[232:235], v[204:207]
    buffer_load_dwordx4 v6, s[24:27], s56 offen offset:0 lds
    v_mfma_f32_16x16x32_bf16 v[140:143], a[108:111], v[168:171], v[140:143]
    s_waitcnt lgkmcnt(5)
    ds_read_b128 a[72:75], v9 offset:2048
    v_mfma_f32_16x16x32_bf16 v[140:143], a[104:107], v[160:163], v[140:143]
    v_mfma_f32_16x16x32_bf16 v[148:151], a[112:115], v[160:163], v[148:151]
    ds_read_b128 a[84:87], v9 offset:5120
    v_mfma_f32_16x16x32_bf16 v[148:151], a[116:119], v[168:171], v[148:151]
    buffer_load_dwordx4 v6, s[24:27], s56 offen offset:1024 lds
    v_mfma_f32_16x16x32_bf16 v[212:215], a[116:119], v[232:235], v[212:215]
    s_waitcnt lgkmcnt(5)
    ds_read_b128 a[80:83], v9 offset:4096
    v_mfma_f32_16x16x32_bf16 v[212:215], a[112:115], v[224:227], v[212:215]
    v_mfma_f32_16x16x32_bf16 v[220:223], a[120:123], v[224:227], v[220:223]
    ds_read_b128 a[92:95], v9 offset:7168
    v_mfma_f32_16x16x32_bf16 v[220:223], a[124:127], v[232:235], v[220:223]
    v_mfma_f32_16x16x32_bf16 v[156:159], a[124:127], v[168:171], v[156:159]
    s_waitcnt lgkmcnt(5)
    ds_read_b128 a[88:91], v9 offset:6144
    v_mfma_f32_16x16x32_bf16 v[156:159], a[120:123], v[160:163], v[156:159]
    buffer_load_dwordx4 v6, s[24:27], s56 offen offset:2048 lds
    v_mfma_f32_16x16x32_bf16 v[164:167], a[64:67], v[160:163], v[164:167]
    ds_read_b128 a[100:103], v9 offset:9216
    v_mfma_f32_16x16x32_bf16 v[164:167], a[68:71], v[168:171], v[164:167]
    v_mfma_f32_16x16x32_bf16 v[228:231], a[68:71], v[232:235], v[228:231]
    s_waitcnt lgkmcnt(5)
    ds_read_b128 a[96:99], v9 offset:8192
    v_mfma_f32_16x16x32_bf16 v[228:231], a[64:67], v[224:227], v[228:231]
    v_mfma_f32_16x16x32_bf16 v[236:239], a[72:75], v[224:227], v[236:239]
    ds_read_b128 a[108:111], v9 offset:11264
    v_add_u32 v10, s31, v8
    v_mfma_f32_16x16x32_bf16 v[236:239], a[76:79], v[232:235], v[236:239]
    v_mfma_f32_16x16x32_bf16 v[172:175], a[76:79], v[168:171], v[172:175]
    s_waitcnt lgkmcnt(5)
    ds_read_b128 a[104:107], v9 offset:10240
    v_mfma_f32_16x16x32_bf16 v[172:175], a[72:75], v[160:163], v[172:175]
    buffer_load_dwordx4 v6, s[24:27], s56 offen offset:3072 lds
    v_mfma_f32_16x16x32_bf16 v[180:183], a[80:83], v[160:163], v[180:183]
    s_add_u32 m0, m0, 4096
    ds_read_b128 a[116:119], v9 offset:13312
    v_mfma_f32_16x16x32_bf16 v[180:183], a[84:87], v[168:171], v[180:183]
    v_mfma_f32_16x16x32_bf16 v[244:247], a[84:87], v[232:235], v[244:247]
    s_waitcnt lgkmcnt(5)
    ds_read_b128 a[112:115], v9 offset:12288
    v_mfma_f32_16x16x32_bf16 v[244:247], a[80:83], v[224:227], v[244:247]
    v_mfma_f32_16x16x32_bf16 v[252:255], a[88:91], v[224:227], v[252:255]
    ds_read_b128 a[124:127], v9 offset:15360
    v_mfma_f32_16x16x32_bf16 v[252:255], a[92:95], v[232:235], v[252:255]
    buffer_load_dwordx4 v7, s[24:27], s56 offen offset:0 lds
    v_mfma_f32_16x16x32_bf16 v[188:191], a[92:95], v[168:171], v[188:191]
    s_waitcnt lgkmcnt(5)
    ds_read_b128 a[120:123], v9 offset:14336
    v_mfma_f32_16x16x32_bf16 v[188:191], a[88:91], v[160:163], v[188:191]
    v_mfma_f32_16x16x32_bf16 v[64:67], a[96:99], v[160:163], v[64:67]
    ds_read_b128 a[68:71], v9 offset:17408
    v_mfma_f32_16x16x32_bf16 v[64:67], a[100:103], v[168:171], v[64:67]
    v_mfma_f32_16x16x32_bf16 v[68:71], a[100:103], v[232:235], v[68:71]
    s_waitcnt lgkmcnt(5)
    ds_read_b128 a[64:67], v9 offset:16384
    v_mfma_f32_16x16x32_bf16 v[68:71], a[96:99], v[224:227], v[68:71]
    v_mfma_f32_16x16x32_bf16 v[76:79], a[104:107], v[224:227], v[76:79]
    ds_read_b128 a[76:79], v9 offset:19456
    v_mfma_f32_16x16x32_bf16 v[76:79], a[108:111], v[232:235], v[76:79]
    buffer_load_dwordx4 v7, s[24:27], s56 offen offset:1024 lds
    v_mfma_f32_16x16x32_bf16 v[72:75], a[108:111], v[168:171], v[72:75]
    s_waitcnt lgkmcnt(5)
    ds_read_b128 a[72:75], v9 offset:18432
    v_mfma_f32_16x16x32_bf16 v[72:75], a[104:107], v[160:163], v[72:75]
    s_waitcnt vmcnt(7)
    buffer_store_dword v1, v3, s[24:27], s62 offen sc1
    v_mfma_f32_16x16x32_bf16 v[80:83], a[112:115], v[160:163], v[80:83]
    ds_read_b128 a[84:87], v9 offset:21504
    v_mfma_f32_16x16x32_bf16 v[80:83], a[116:119], v[168:171], v[80:83]
    v_mfma_f32_16x16x32_bf16 v[84:87], a[116:119], v[232:235], v[84:87]
    s_waitcnt lgkmcnt(5)
    ds_read_b128 a[80:83], v9 offset:20480
    v_mfma_f32_16x16x32_bf16 v[84:87], a[112:115], v[224:227], v[84:87]
    buffer_load_dwordx4 v7, s[24:27], s56 offen offset:2048 lds
    v_mfma_f32_16x16x32_bf16 v[92:95], a[120:123], v[224:227], v[92:95]
    ds_read_b128 a[92:95], v9 offset:23552
    v_mfma_f32_16x16x32_bf16 v[92:95], a[124:127], v[232:235], v[92:95]
    v_mfma_f32_16x16x32_bf16 v[88:91], a[124:127], v[168:171], v[88:91]
    s_waitcnt lgkmcnt(5)
    ds_read_b128 a[88:91], v9 offset:22528
    v_mfma_f32_16x16x32_bf16 v[88:91], a[120:123], v[160:163], v[88:91]
    v_mfma_f32_16x16x32_bf16 v[96:99], a[64:67], v[160:163], v[96:99]
    ds_read_b128 a[100:103], v9 offset:25600
    v_mfma_f32_16x16x32_bf16 v[96:99], a[68:71], v[168:171], v[96:99]
    v_mfma_f32_16x16x32_bf16 v[100:103], a[68:71], v[232:235], v[100:103]
    s_waitcnt lgkmcnt(5)
    ds_read_b128 a[96:99], v9 offset:24576
    v_mfma_f32_16x16x32_bf16 v[100:103], a[64:67], v[224:227], v[100:103]
    buffer_load_dwordx4 v7, s[24:27], s56 offen offset:3072 lds
    v_mfma_f32_16x16x32_bf16 v[108:111], a[72:75], v[224:227], v[108:111]
    ds_read_b128 a[108:111], v9 offset:27648
    v_mfma_f32_16x16x32_bf16 v[108:111], a[76:79], v[232:235], v[108:111]
    v_mfma_f32_16x16x32_bf16 v[104:107], a[76:79], v[168:171], v[104:107]
    s_waitcnt lgkmcnt(5)
    ds_read_b128 a[104:107], v9 offset:26624
    v_mfma_f32_16x16x32_bf16 v[104:107], a[72:75], v[160:163], v[104:107]
    v_mfma_f32_16x16x32_bf16 v[132:135], a[80:83], v[176:179], v[132:135]
    ds_read_b128 a[116:119], v9 offset:29696
    v_mfma_f32_16x16x32_bf16 v[132:135], a[84:87], v[184:187], v[132:135]
    v_mfma_f32_16x16x32_bf16 v[196:199], a[84:87], v[248:251], v[196:199]
    s_waitcnt lgkmcnt(5)
    ds_read_b128 a[112:115], v9 offset:28672
    v_mfma_f32_16x16x32_bf16 v[196:199], a[80:83], v[240:243], v[196:199]
    v_mfma_f32_16x16x32_bf16 v[204:207], a[88:91], v[240:243], v[204:207]
    ds_read_b128 a[124:127], v9 offset:31744
    v_mfma_f32_16x16x32_bf16 v[204:207], a[92:95], v[248:251], v[204:207]
    s_waitcnt lgkmcnt(5)
    v_mfma_f32_16x16x32_bf16 v[140:143], a[92:95], v[184:187], v[140:143]
    ds_read_b128 a[120:123], v9 offset:30720
    v_mfma_f32_16x16x32_bf16 v[140:143], a[88:91], v[176:179], v[140:143]
    s_barrier
    v_mfma_f32_16x16x32_bf16 v[148:151], a[96:99], v[176:179], v[148:151]
    ds_read_b128 a[68:71], v10 offset:1024
    v_mfma_f32_16x16x32_bf16 v[148:151], a[100:103], v[184:187], v[148:151]
    s_add_u32 s56, s65, 196608
    v_mfma_f32_16x16x32_bf16 v[212:215], a[100:103], v[248:251], v[212:215]
    s_waitcnt lgkmcnt(5)
    ds_read_b128 a[64:67], v10 offset:0
    v_mfma_f32_16x16x32_bf16 v[212:215], a[96:99], v[240:243], v[212:215]
    s_add_u32 m0, s32, s44
    v_mfma_f32_16x16x32_bf16 v[220:223], a[104:107], v[240:243], v[220:223]
    ds_read_b128 a[76:79], v10 offset:3072
    v_mfma_f32_16x16x32_bf16 v[220:223], a[108:111], v[248:251], v[220:223]
    buffer_load_dwordx4 v6, s[24:27], s56 offen offset:0 lds
    v_mfma_f32_16x16x32_bf16 v[156:159], a[108:111], v[184:187], v[156:159]
    s_waitcnt lgkmcnt(5)
    ds_read_b128 a[72:75], v10 offset:2048
    v_mfma_f32_16x16x32_bf16 v[156:159], a[104:107], v[176:179], v[156:159]
    buffer_load_dword v120, v11, s[24:27], s62 offen sc1
    v_mfma_f32_16x16x32_bf16 v[164:167], a[112:115], v[176:179], v[164:167]
    ds_read_b128 a[84:87], v10 offset:5120
    v_mfma_f32_16x16x32_bf16 v[164:167], a[116:119], v[184:187], v[164:167]
    buffer_load_dwordx4 v6, s[24:27], s56 offen offset:1024 lds
    v_mfma_f32_16x16x32_bf16 v[228:231], a[116:119], v[248:251], v[228:231]
    s_waitcnt lgkmcnt(5)
    ds_read_b128 a[80:83], v10 offset:4096
    v_mfma_f32_16x16x32_bf16 v[228:231], a[112:115], v[240:243], v[228:231]
    v_mfma_f32_16x16x32_bf16 v[236:239], a[120:123], v[240:243], v[236:239]
    ds_read_b128 a[92:95], v10 offset:7168
    v_mfma_f32_16x16x32_bf16 v[236:239], a[124:127], v[248:251], v[236:239]
    v_mfma_f32_16x16x32_bf16 v[172:175], a[124:127], v[184:187], v[172:175]
    s_waitcnt lgkmcnt(5)
    ds_read_b128 a[88:91], v10 offset:6144
    v_mfma_f32_16x16x32_bf16 v[172:175], a[120:123], v[176:179], v[172:175]
    buffer_load_dwordx4 v6, s[24:27], s56 offen offset:2048 lds
    v_mfma_f32_16x16x32_bf16 v[180:183], a[64:67], v[176:179], v[180:183]
    ds_read_b128 a[100:103], v10 offset:9216
    v_mfma_f32_16x16x32_bf16 v[180:183], a[68:71], v[184:187], v[180:183]
    v_mfma_f32_16x16x32_bf16 v[244:247], a[68:71], v[248:251], v[244:247]
    s_waitcnt lgkmcnt(5)
    ds_read_b128 a[96:99], v10 offset:8192
    v_mfma_f32_16x16x32_bf16 v[244:247], a[64:67], v[240:243], v[244:247]
    v_mfma_f32_16x16x32_bf16 v[252:255], a[72:75], v[240:243], v[252:255]
    ds_read_b128 a[108:111], v10 offset:11264
    v_add_u32 v9, s29, v8
    v_mfma_f32_16x16x32_bf16 v[252:255], a[76:79], v[248:251], v[252:255]
    v_mfma_f32_16x16x32_bf16 v[188:191], a[76:79], v[184:187], v[188:191]
    s_waitcnt lgkmcnt(5)
    ds_read_b128 a[104:107], v10 offset:10240
    v_mfma_f32_16x16x32_bf16 v[188:191], a[72:75], v[176:179], v[188:191]
    buffer_load_dwordx4 v6, s[24:27], s56 offen offset:3072 lds
    v_mfma_f32_16x16x32_bf16 v[64:67], a[80:83], v[176:179], v[64:67]
    s_add_u32 m0, m0, 4096
    ds_read_b128 a[116:119], v10 offset:13312
    v_mfma_f32_16x16x32_bf16 v[64:67], a[84:87], v[184:187], v[64:67]
    v_mfma_f32_16x16x32_bf16 v[68:71], a[84:87], v[248:251], v[68:71]
    s_waitcnt lgkmcnt(5)
    ds_read_b128 a[112:115], v10 offset:12288
    v_mfma_f32_16x16x32_bf16 v[68:71], a[80:83], v[240:243], v[68:71]
    v_mfma_f32_16x16x32_bf16 v[76:79], a[88:91], v[240:243], v[76:79]
    ds_read_b128 a[124:127], v10 offset:15360
    v_mfma_f32_16x16x32_bf16 v[76:79], a[92:95], v[248:251], v[76:79]
    buffer_load_dwordx4 v7, s[24:27], s56 offen offset:0 lds
    v_mfma_f32_16x16x32_bf16 v[72:75], a[92:95], v[184:187], v[72:75]
    s_waitcnt lgkmcnt(5)
    ds_read_b128 a[120:123], v10 offset:14336
    v_mfma_f32_16x16x32_bf16 v[72:75], a[88:91], v[176:179], v[72:75]
    v_mfma_f32_16x16x32_bf16 v[80:83], a[96:99], v[176:179], v[80:83]
    ds_read_b128 a[68:71], v10 offset:17408
    v_mfma_f32_16x16x32_bf16 v[80:83], a[100:103], v[184:187], v[80:83]
    v_mfma_f32_16x16x32_bf16 v[84:87], a[100:103], v[248:251], v[84:87]
    s_waitcnt lgkmcnt(5)
    ds_read_b128 a[64:67], v10 offset:16384
    v_mfma_f32_16x16x32_bf16 v[84:87], a[96:99], v[240:243], v[84:87]
    v_mfma_f32_16x16x32_bf16 v[92:95], a[104:107], v[240:243], v[92:95]
    ds_read_b128 a[76:79], v10 offset:19456
    v_mfma_f32_16x16x32_bf16 v[92:95], a[108:111], v[248:251], v[92:95]
    buffer_load_dwordx4 v7, s[24:27], s56 offen offset:1024 lds
    v_mfma_f32_16x16x32_bf16 v[88:91], a[108:111], v[184:187], v[88:91]
    s_waitcnt lgkmcnt(5)
    ds_read_b128 a[72:75], v10 offset:18432
    v_mfma_f32_16x16x32_bf16 v[88:91], a[104:107], v[176:179], v[88:91]
    v_mfma_f32_16x16x32_bf16 v[96:99], a[112:115], v[176:179], v[96:99]
    s_add_u32 s58, s4, 0
    ds_read_b128 a[84:87], v10 offset:21504
    v_mfma_f32_16x16x32_bf16 v[96:99], a[116:119], v[184:187], v[96:99]
    v_mfma_f32_16x16x32_bf16 v[100:103], a[116:119], v[248:251], v[100:103]
    s_waitcnt lgkmcnt(5)
    ds_read_b128 a[80:83], v10 offset:20480
    v_mfma_f32_16x16x32_bf16 v[100:103], a[112:115], v[240:243], v[100:103]
    buffer_load_dwordx4 v7, s[24:27], s56 offen offset:2048 lds
    v_mfma_f32_16x16x32_bf16 v[108:111], a[120:123], v[240:243], v[108:111]
    ds_read_b128 a[92:95], v10 offset:23552
    v_mfma_f32_16x16x32_bf16 v[108:111], a[124:127], v[248:251], v[108:111]
    v_mfma_f32_16x16x32_bf16 v[104:107], a[124:127], v[184:187], v[104:107]
    s_waitcnt lgkmcnt(5)
    ds_read_b128 a[88:91], v10 offset:22528
    v_mfma_f32_16x16x32_bf16 v[104:107], a[120:123], v[176:179], v[104:107]
    s_waitcnt vmcnt(6)
    v_cmp_eq_u32 vcc, 0, v120
    s_nop 0
    s_cbranch_vccnz K2_CSLOW
K2_CSLOWR:
    v_mfma_f32_16x16x32_bf16 v[132:135], a[64:67], v[16:19], v[132:135]
    ds_read_b128 a[100:103], v10 offset:25600
    v_mfma_f32_16x16x32_bf16 v[132:135], a[68:71], v[40:43], v[132:135]
    buffer_load_dwordx4 a[0:3], v8, s[24:27], s58 offen offset:0 sc1
    v_mfma_f32_16x16x32_bf16 v[196:199], a[68:71], v[52:55], v[196:199]
    s_waitcnt lgkmcnt(5)
    ds_read_b128 a[96:99], v10 offset:24576
    v_mfma_f32_16x16x32_bf16 v[196:199], a[64:67], v[28:31], v[196:199]
    buffer_load_dwordx4 v7, s[24:27], s56 offen offset:3072 lds
    v_mfma_f32_16x16x32_bf16 v[204:207], a[72:75], v[28:31], v[204:207]
    ds_read_b128 a[108:111], v10 offset:27648
    v_mfma_f32_16x16x32_bf16 v[204:207], a[76:79], v[52:55], v[204:207]
    v_mfma_f32_16x16x32_bf16 v[140:143], a[76:79], v[40:43], v[140:143]
    s_waitcnt lgkmcnt(5)
    ds_read_b128 a[104:107], v10 offset:26624
    v_mfma_f32_16x16x32_bf16 v[140:143], a[72:75], v[16:19], v[140:143]
    buffer_load_dwordx4 a[4:7], v8, s[24:27], s58 offen offset:1024 sc1
    v_mfma_f32_16x16x32_bf16 v[148:151], a[80:83], v[16:19], v[148:151]
    s_add_u32 s59, s4, 131072
    ds_read_b128 a[116:119], v10 offset:29696
    v_mfma_f32_16x16x32_bf16 v[148:151], a[84:87], v[40:43], v[148:151]
    v_mfma_f32_16x16x32_bf16 v[212:215], a[84:87], v[52:55], v[212:215]
    s_waitcnt lgkmcnt(5)
    ds_read_b128 a[112:115], v10 offset:28672
    v_mfma_f32_16x16x32_bf16 v[212:215], a[80:83], v[28:31], v[212:215]
    v_mfma_f32_16x16x32_bf16 v[220:223], a[88:91], v[28:31], v[220:223]
    ds_read_b128 a[124:127], v10 offset:31744
    v_mfma_f32_16x16x32_bf16 v[220:223], a[92:95], v[52:55], v[220:223]
    s_waitcnt lgkmcnt(5)
    v_mfma_f32_16x16x32_bf16 v[156:159], a[92:95], v[40:43], v[156:159]
    ds_read_b128 a[120:123], v10 offset:30720
    v_mfma_f32_16x16x32_bf16 v[156:159], a[88:91], v[16:19], v[156:159]
    s_barrier
    v_mfma_f32_16x16x32_bf16 v[164:167], a[96:99], v[16:19], v[164:167]
    ds_read_b128 a[68:71], v9 offset:1024
    v_mfma_f32_16x16x32_bf16 v[164:167], a[100:103], v[40:43], v[164:167]
    buffer_load_dwordx4 a[8:11], v8, s[24:27], s59 offen offset:0 sc1
    v_mfma_f32_16x16x32_bf16 v[228:231], a[100:103], v[52:55], v[228:231]
    s_waitcnt lgkmcnt(5)
    ds_read_b128 a[64:67], v9 offset:0
    v_mfma_f32_16x16x32_bf16 v[228:231], a[96:99], v[28:31], v[228:231]
    s_add_u32 s56, s65, 229376
    v_mfma_f32_16x16x32_bf16 v[236:239], a[104:107], v[28:31], v[236:239]
    s_add_u32 m0, s30, s44
    ds_read_b128 a[76:79], v9 offset:3072
    v_mfma_f32_16x16x32_bf16 v[236:239], a[108:111], v[52:55], v[236:239]
    buffer_load_dwordx4 v6, s[24:27], s56 offen offset:0 lds
    v_mfma_f32_16x16x32_bf16 v[172:175], a[108:111], v[40:43], v[172:175]
    s_waitcnt lgkmcnt(5)
    ds_read_b128 a[72:75], v9 offset:2048
    v_mfma_f32_16x16x32_bf16 v[172:175], a[104:107], v[16:19], v[172:175]
    buffer_load_dwordx4 a[12:15], v8, s[24:27], s59 offen offset:1024 sc1
    v_mfma_f32_16x16x32_bf16 v[180:183], a[112:115], v[16:19], v[180:183]
    s_add_u32 s58, s4, 262144
    ds_read_b128 a[84:87], v9 offset:5120
    v_mfma_f32_16x16x32_bf16 v[180:183], a[116:119], v[40:43], v[180:183]
    buffer_load_dwordx4 v6, s[24:27], s56 offen offset:1024 lds
    v_mfma_f32_16x16x32_bf16 v[244:247], a[116:119], v[52:55], v[244:247]
    s_waitcnt lgkmcnt(5)
    ds_read_b128 a[80:83], v9 offset:4096
    v_mfma_f32_16x16x32_bf16 v[244:247], a[112:115], v[28:31], v[244:247]
    v_mfma_f32_16x16x32_bf16 v[252:255], a[120:123], v[28:31], v[252:255]
    ds_read_b128 a[92:95], v9 offset:7168
    v_mfma_f32_16x16x32_bf16 v[252:255], a[124:127], v[52:55], v[252:255]
    buffer_load_dwordx4 a[16:19], v8, s[24:27], s58 offen offset:0 sc1
    v_mfma_f32_16x16x32_bf16 v[188:191], a[124:127], v[40:43], v[188:191]
    s_waitcnt lgkmcnt(5)
    ds_read_b128 a[88:91], v9 offset:6144
    v_mfma_f32_16x16x32_bf16 v[188:191], a[120:123], v[16:19], v[188:191]
    buffer_load_dwordx4 v6, s[24:27], s56 offen offset:2048 lds
    v_mfma_f32_16x16x32_bf16 v[64:67], a[64:67], v[16:19], v[64:67]
    ds_read_b128 a[100:103], v9 offset:9216
    v_mfma_f32_16x16x32_bf16 v[64:67], a[68:71], v[40:43], v[64:67]
    v_mfma_f32_16x16x32_bf16 v[68:71], a[68:71], v[52:55], v[68:71]
    s_waitcnt lgkmcnt(5)
    ds_read_b128 a[96:99], v9 offset:8192
    v_mfma_f32_16x16x32_bf16 v[68:71], a[64:67], v[28:31], v[68:71]
    v_mfma_f32_16x16x32_bf16 v[76:79], a[72:75], v[28:31], v[76:79]
    s_add_u32 s59, s4, 393216
    ds_read_b128 a[108:111], v9 offset:11264
    v_add_u32 v10, s28, v8
    v_mfma_f32_16x16x32_bf16 v[76:79], a[76:79], v[52:55], v[76:79]
    buffer_load_dwordx4 a[20:23], v8, s[24:27], s58 offen offset:1024 sc1
    v_mfma_f32_16x16x32_bf16 v[72:75], a[76:79], v[40:43], v[72:75]
    s_waitcnt lgkmcnt(5)
    ds_read_b128 a[104:107], v9 offset:10240
    v_mfma_f32_16x16x32_bf16 v[72:75], a[72:75], v[16:19], v[72:75]
    buffer_load_dwordx4 v6, s[24:27], s56 offen offset:3072 lds
    v_mfma_f32_16x16x32_bf16 v[80:83], a[80:83], v[16:19], v[80:83]
    s_add_u32 m0, m0, 4096
    ds_read_b128 a[116:119], v9 offset:13312
    v_mfma_f32_16x16x32_bf16 v[80:83], a[84:87], v[40:43], v[80:83]
    v_mfma_f32_16x16x32_bf16 v[84:87], a[84:87], v[52:55], v[84:87]
    s_waitcnt lgkmcnt(5)
    ds_read_b128 a[112:115], v9 offset:12288
    v_mfma_f32_16x16x32_bf16 v[84:87], a[80:83], v[28:31], v[84:87]
    v_mfma_f32_16x16x32_bf16 v[92:95], a[88:91], v[28:31], v[92:95]
    ds_read_b128 a[124:127], v9 offset:15360
    v_mfma_f32_16x16x32_bf16 v[92:95], a[92:95], v[52:55], v[92:95]
    buffer_load_dwordx4 v7, s[24:27], s56 offen offset:0 lds
    v_mfma_f32_16x16x32_bf16 v[88:91], a[92:95], v[40:43], v[88:91]
    s_waitcnt lgkmcnt(5)
    ds_read_b128 a[120:123], v9 offset:14336
    v_mfma_f32_16x16x32_bf16 v[88:91], a[88:91], v[16:19], v[88:91]
    buffer_load_dwordx4 a[24:27], v8, s[24:27], s59 offen offset:0 sc1
    v_mfma_f32_16x16x32_bf16 v[96:99], a[96:99], v[16:19], v[96:99]
    ds_read_b128 a[68:71], v9 offset:17408
    v_mfma_f32_16x16x32_bf16 v[96:99], a[100:103], v[40:43], v[96:99]
    v_mfma_f32_16x16x32_bf16 v[100:103], a[100:103], v[52:55], v[100:103]
    s_waitcnt lgkmcnt(5)
    ds_read_b128 a[64:67], v9 offset:16384
    v_mfma_f32_16x16x32_bf16 v[100:103], a[96:99], v[28:31], v[100:103]
    s_add_u32 s58, s4, 524288
    v_mfma_f32_16x16x32_bf16 v[108:111], a[104:107], v[28:31], v[108:111]
    ds_read_b128 a[76:79], v9 offset:19456
    v_mfma_f32_16x16x32_bf16 v[108:111], a[108:111], v[52:55], v[108:111]
    buffer_load_dwordx4 v7, s[24:27], s56 offen offset:1024 lds
    v_mfma_f32_16x16x32_bf16 v[104:107], a[108:111], v[40:43], v[104:107]
    s_waitcnt lgkmcnt(5)
    ds_read_b128 a[72:75], v9 offset:18432
    v_mfma_f32_16x16x32_bf16 v[104:107], a[104:107], v[16:19], v[104:107]
    buffer_load_dwordx4 a[28:31], v8, s[24:27], s59 offen offset:1024 sc1
    s_waitcnt vmcnt(14)
    v_mfma_f32_16x16x32_bf16 v[132:135], a[112:115], a[0:3], v[132:135]
    ds_read_b128 a[84:87], v9 offset:21504
    s_waitcnt vmcnt(11)
    v_mfma_f32_16x16x32_bf16 v[132:135], a[116:119], a[8:11], v[132:135]
    s_waitcnt vmcnt(9)
    v_mfma_f32_16x16x32_bf16 v[196:199], a[116:119], a[12:15], v[196:199]
    s_waitcnt lgkmcnt(5)
    ds_read_b128 a[80:83], v9 offset:20480
    v_mfma_f32_16x16x32_bf16 v[196:199], a[112:115], a[4:7], v[196:199]
    buffer_load_dwordx4 v7, s[24:27], s56 offen offset:2048 lds
    v_mfma_f32_16x16x32_bf16 v[204:207], a[120:123], a[4:7], v[204:207]
    ds_read_b128 a[92:95], v9 offset:23552
    v_mfma_f32_16x16x32_bf16 v[204:207], a[124:127], a[12:15], v[204:207]
    buffer_load_dwordx4 a[32:35], v8, s[24:27], s58 offen offset:0 sc1
    v_mfma_f32_16x16x32_bf16 v[140:143], a[124:127], a[8:11], v[140:143]
    s_waitcnt lgkmcnt(5)
    ds_read_b128 a[88:91], v9 offset:22528
    v_mfma_f32_16x16x32_bf16 v[140:143], a[120:123], a[0:3], v[140:143]
    v_mfma_f32_16x16x32_bf16 v[148:151], a[64:67], a[0:3], v[148:151]
    ds_read_b128 a[100:103], v9 offset:25600
    v_mfma_f32_16x16x32_bf16 v[148:151], a[68:71], a[8:11], v[148:151]
    v_mfma_f32_16x16x32_bf16 v[212:215], a[68:71], a[12:15], v[212:215]
    s_waitcnt lgkmcnt(5)
    ds_read_b128 a[96:99], v9 offset:24576
    v_mfma_f32_16x16x32_bf16 v[212:215], a[64:67], a[4:7], v[212:215]
    buffer_load_dwordx4 v7, s[24:27], s56 offen offset:3072 lds
    v_mfma_f32_16x16x32_bf16 v[220:223], a[72:75], a[4:7], v[220:223]
    s_add_u32 s59, s4, 655360
    ds_read_b128 a[108:111], v9 offset:27648
    v_mfma_f32_16x16x32_bf16 v[220:223], a[76:79], a[12:15], v[220:223]
    buffer_load_dwordx4 a[36:39], v8, s[24:27], s58 offen offset:1024 sc1
    v_mfma_f32_16x16x32_bf16 v[156:159], a[76:79], a[8:11], v[156:159]
    s_waitcnt lgkmcnt(5)
    ds_read_b128 a[104:107], v9 offset:26624
    v_mfma_f32_16x16x32_bf16 v[156:159], a[72:75], a[0:3], v[156:159]
    v_mfma_f32_16x16x32_bf16 v[164:167], a[80:83], a[0:3], v[164:167]
    ds_read_b128 a[116:119], v9 offset:29696
    v_mfma_f32_16x16x32_bf16 v[164:167], a[84:87], a[8:11], v[164:167]
    v_mfma_f32_16x16x32_bf16 v[228:231], a[84:87], a[12:15], v[228:231]
    s_waitcnt lgkmcnt(5)
    ds_read_b128 a[112:115], v9 offset:28672
    v_mfma_f32_16x16x32_bf16 v[228:231], a[80:83], a[4:7], v[228:231]
    buffer_load_dwordx4 a[40:43], v8, s[24:27], s59 offen offset:0 sc1
    v_mfma_f32_16x16x32_bf16 v[236:239], a[88:91], a[4:7], v[236:239]
    ds_read_b128 a[124:127], v9 offset:31744
    v_mfma_f32_16x16x32_bf16 v[236:239], a[92:95], a[12:15], v[236:239]
    s_waitcnt lgkmcnt(5)
    v_mfma_f32_16x16x32_bf16 v[172:175], a[92:95], a[8:11], v[172:175]
    ds_read_b128 a[120:123], v9 offset:30720
    v_mfma_f32_16x16x32_bf16 v[172:175], a[88:91], a[0:3], v[172:175]
    s_barrier
    v_mfma_f32_16x16x32_bf16 v[180:183], a[96:99], a[0:3], v[180:183]
    ds_read_b128 a[68:71], v10 offset:1024
    v_mfma_f32_16x16x32_bf16 v[180:183], a[100:103], a[8:11], v[180:183]
    buffer_load_dwordx4 a[44:47], v8, s[24:27], s59 offen offset:1024 sc1
    v_mfma_f32_16x16x32_bf16 v[244:247], a[100:103], a[12:15], v[244:247]
    s_waitcnt lgkmcnt(5)
    ds_read_b128 a[64:67], v10 offset:0
    v_mfma_f32_16x16x32_bf16 v[244:247], a[96:99], a[4:7], v[244:247]
    s_add_u32 s58, s4, 786432
    v_mfma_f32_16x16x32_bf16 v[252:255], a[104:107], a[4:7], v[252:255]
    ds_read_b128 a[76:79], v10 offset:3072
    v_mfma_f32_16x16x32_bf16 v[252:255], a[108:111], a[12:15], v[252:255]
    v_mfma_f32_16x16x32_bf16 v[188:191], a[108:111], a[8:11], v[188:191]
    s_waitcnt lgkmcnt(5)
    ds_read_b128 a[72:75], v10 offset:2048
    v_mfma_f32_16x16x32_bf16 v[188:191], a[104:107], a[0:3], v[188:191]
    v_mfma_f32_16x16x32_bf16 v[64:67], a[112:115], a[0:3], v[64:67]
    ds_read_b128 a[84:87], v10 offset:5120
    v_mfma_f32_16x16x32_bf16 v[64:67], a[116:119], a[8:11], v[64:67]
    buffer_load_dwordx4 a[48:51], v8, s[24:27], s58 offen offset:0 sc1
    v_mfma_f32_16x16x32_bf16 v[68:71], a[116:119], a[12:15], v[68:71]
    s_waitcnt lgkmcnt(5)
    ds_read_b128 a[80:83], v10 offset:4096
    v_mfma_f32_16x16x32_bf16 v[68:71], a[112:115], a[4:7], v[68:71]
    v_mfma_f32_16x16x32_bf16 v[76:79], a[120:123], a[4:7], v[76:79]
    ds_read_b128 a[92:95], v10 offset:7168
    v_mfma_f32_16x16x32_bf16 v[76:79], a[124:127], a[12:15], v[76:79]
    v_mfma_f32_16x16x32_bf16 v[72:75], a[124:127], a[8:11], v[72:75]
    s_waitcnt lgkmcnt(5)
    ds_read_b128 a[88:91], v10 offset:6144
    v_mfma_f32_16x16x32_bf16 v[72:75], a[120:123], a[0:3], v[72:75]
    v_mfma_f32_16x16x32_bf16 v[80:83], a[64:67], a[0:3], v[80:83]
    s_add_u32 s59, s4, 917504
    ds_read_b128 a[100:103], v10 offset:9216
    v_mfma_f32_16x16x32_bf16 v[80:83], a[68:71], a[8:11], v[80:83]
    buffer_load_dwordx4 a[52:55], v8, s[24:27], s58 offen offset:1024 sc1
    v_mfma_f32_16x16x32_bf16 v[84:87], a[68:71], a[12:15], v[84:87]
    s_waitcnt lgkmcnt(5)
    ds_read_b128 a[96:99], v10 offset:8192
    v_mfma_f32_16x16x32_bf16 v[84:87], a[64:67], a[4:7], v[84:87]
    v_mfma_f32_16x16x32_bf16 v[92:95], a[72:75], a[4:7], v[92:95]
    ds_read_b128 a[108:111], v10 offset:11264
    v_add_u32 v9, s32, v8
    v_mfma_f32_16x16x32_bf16 v[92:95], a[76:79], a[12:15], v[92:95]
    v_mfma_f32_16x16x32_bf16 v[88:91], a[76:79], a[8:11], v[88:91]
    s_waitcnt lgkmcnt(5)
    ds_read_b128 a[104:107], v10 offset:10240
    v_mfma_f32_16x16x32_bf16 v[88:91], a[72:75], a[0:3], v[88:91]
    v_mfma_f32_16x16x32_bf16 v[96:99], a[80:83], a[0:3], v[96:99]
    ds_read_b128 a[116:119], v10 offset:13312
    v_mfma_f32_16x16x32_bf16 v[96:99], a[84:87], a[8:11], v[96:99]
    buffer_load_dwordx4 a[56:59], v8, s[24:27], s59 offen offset:0 sc1
    v_mfma_f32_16x16x32_bf16 v[100:103], a[84:87], a[12:15], v[100:103]
    s_waitcnt lgkmcnt(5)
    ds_read_b128 a[112:115], v10 offset:12288
    v_mfma_f32_16x16x32_bf16 v[100:103], a[80:83], a[4:7], v[100:103]
    v_mfma_f32_16x16x32_bf16 v[108:111], a[88:91], a[4:7], v[108:111]
    ds_read_b128 a[124:127], v10 offset:15360
    v_mfma_f32_16x16x32_bf16 v[108:111], a[92:95], a[12:15], v[108:111]
    v_mfma_f32_16x16x32_bf16 v[104:107], a[92:95], a[8:11], v[104:107]
    s_waitcnt lgkmcnt(5)
    ds_read_b128 a[120:123], v10 offset:14336
    v_mfma_f32_16x16x32_bf16 v[104:107], a[88:91], a[0:3], v[104:107]
    buffer_load_dwordx4 a[60:63], v8, s[24:27], s59 offen offset:1024 sc1
    s_waitcnt vmcnt(17)
    v_mfma_f32_16x16x32_bf16 v[132:135], a[96:99], a[16:19], v[132:135]
    ds_read_b128 a[68:71], v10 offset:17408
    s_waitcnt vmcnt(12)
    v_mfma_f32_16x16x32_bf16 v[132:135], a[100:103], a[24:27], v[132:135]
    s_waitcnt vmcnt(10)
    v_mfma_f32_16x16x32_bf16 v[196:199], a[100:103], a[28:31], v[196:199]
    s_waitcnt lgkmcnt(5)
    ds_read_b128 a[64:67], v10 offset:16384
    v_mfma_f32_16x16x32_bf16 v[196:199], a[96:99], a[20:23], v[196:199]
    v_mfma_f32_16x16x32_bf16 v[204:207], a[104:107], a[20:23], v[204:207]
    ds_read_b128 a[76:79], v10 offset:19456
    v_mfma_f32_16x16x32_bf16 v[204:207], a[108:111], a[28:31], v[204:207]
    v_mfma_f32_16x16x32_bf16 v[140:143], a[108:111], a[24:27], v[140:143]
    s_waitcnt lgkmcnt(5)
    ds_read_b128 a[72:75], v10 offset:18432
    v_mfma_f32_16x16x32_bf16 v[140:143], a[104:107], a[16:19], v[140:143]
    v_mfma_f32_16x16x32_bf16 v[148:151], a[112:115], a[16:19], v[148:151]
    ds_read_b128 a[84:87], v10 offset:21504
    v_mfma_f32_16x16x32_bf16 v[148:151], a[116:119], a[24:27], v[148:151]
    v_mfma_f32_16x16x32_bf16 v[212:215], a[116:119], a[28:31], v[212:215]
    s_waitcnt lgkmcnt(5)
    ds_read_b128 a[80:83], v10 offset:20480
    v_mfma_f32_16x16x32_bf16 v[212:215], a[112:115], a[20:23], v[212:215]
    v_mfma_f32_16x16x32_bf16 v[220:223], a[120:123], a[20:23], v[220:223]
    ds_read_b128 a[92:95], v10 offset:23552
    v_mfma_f32_16x16x32_bf16 v[220:223], a[124:127], a[28:31], v[220:223]
    v_mfma_f32_16x16x32_bf16 v[156:159], a[124:127], a[24:27], v[156:159]
    s_waitcnt lgkmcnt(5)
    ds_read_b128 a[88:91], v10 offset:22528
    v_mfma_f32_16x16x32_bf16 v[156:159], a[120:123], a[16:19], v[156:159]
    v_mfma_f32_16x16x32_bf16 v[164:167], a[64:67], a[16:19], v[164:167]
    ds_read_b128 a[100:103], v10 offset:25600
    v_mfma_f32_16x16x32_bf16 v[164:167], a[68:71], a[24:27], v[164:167]
    v_mfma_f32_16x16x32_bf16 v[228:231], a[68:71], a[28:31], v[228:231]
    s_waitcnt lgkmcnt(5)
    ds_read_b128 a[96:99], v10 offset:24576
    v_mfma_f32_16x16x32_bf16 v[228:231], a[64:67], a[20:23], v[228:231]
    v_mfma_f32_16x16x32_bf16 v[236:239], a[72:75], a[20:23], v[236:239]
    ds_read_b128 a[108:111], v10 offset:27648
    v_mfma_f32_16x16x32_bf16 v[236:239], a[76:79], a[28:31], v[236:239]
    v_mfma_f32_16x16x32_bf16 v[172:175], a[76:79], a[24:27], v[172:175]
    s_waitcnt lgkmcnt(5)
    ds_read_b128 a[104:107], v10 offset:26624
    v_mfma_f32_16x16x32_bf16 v[172:175], a[72:75], a[16:19], v[172:175]
    v_mfma_f32_16x16x32_bf16 v[180:183], a[80:83], a[16:19], v[180:183]
    ds_read_b128 a[116:119], v10 offset:29696
    v_mfma_f32_16x16x32_bf16 v[180:183], a[84:87], a[24:27], v[180:183]
    v_mfma_f32_16x16x32_bf16 v[244:247], a[84:87], a[28:31], v[244:247]
    s_waitcnt lgkmcnt(5)
    ds_read_b128 a[112:115], v10 offset:28672
    v_mfma_f32_16x16x32_bf16 v[244:247], a[80:83], a[20:23], v[244:247]
    v_mfma_f32_16x16x32_bf16 v[252:255], a[88:91], a[20:23], v[252:255]
    ds_read_b128 a[124:127], v10 offset:31744
    v_mfma_f32_16x16x32_bf16 v[252:255], a[92:95], a[28:31], v[252:255]
    s_waitcnt lgkmcnt(5)
    v_mfma_f32_16x16x32_bf16 v[188:191], a[92:95], a[24:27], v[188:191]
    ds_read_b128 a[120:123], v10 offset:30720
    v_mfma_f32_16x16x32_bf16 v[188:191], a[88:91], a[16:19], v[188:191]
    s_barrier
    v_mfma_f32_16x16x32_bf16 v[64:67], a[96:99], a[16:19], v[64:67]
    ds_read_b128 a[68:71], v9 offset:1024
    v_mfma_f32_16x16x32_bf16 v[64:67], a[100:103], a[24:27], v[64:67]
    v_mfma_f32_16x16x32_bf16 v[68:71], a[100:103], a[28:31], v[68:71]
    s_waitcnt lgkmcnt(5)
    ds_read_b128 a[64:67], v9 offset:0
    v_mfma_f32_16x16x32_bf16 v[68:71], a[96:99], a[20:23], v[68:71]
    v_mfma_f32_16x16x32_bf16 v[76:79], a[104:107], a[20:23], v[76:79]
    ds_read_b128 a[76:79], v9 offset:3072
    v_mfma_f32_16x16x32_bf16 v[76:79], a[108:111], a[28:31], v[76:79]
    v_mfma_f32_16x16x32_bf16 v[72:75], a[108:111], a[24:27], v[72:75]
    s_waitcnt lgkmcnt(5)
    ds_read_b128 a[72:75], v9 offset:2048
    v_mfma_f32_16x16x32_bf16 v[72:75], a[104:107], a[16:19], v[72:75]
    v_mfma_f32_16x16x32_bf16 v[80:83], a[112:115], a[16:19], v[80:83]
    ds_read_b128 a[84:87], v9 offset:5120
    v_mfma_f32_16x16x32_bf16 v[80:83], a[116:119], a[24:27], v[80:83]
    v_mfma_f32_16x16x32_bf16 v[84:87], a[116:119], a[28:31], v[84:87]
    s_waitcnt lgkmcnt(5)
    ds_read_b128 a[80:83], v9 offset:4096
    v_mfma_f32_16x16x32_bf16 v[84:87], a[112:115], a[20:23], v[84:87]
    v_mfma_f32_16x16x32_bf16 v[92:95], a[120:123], a[20:23], v[92:95]
    ds_read_b128 a[92:95], v9 offset:7168
    v_mfma_f32_16x16x32_bf16 v[92:95], a[124:127], a[28:31], v[92:95]
    v_mfma_f32_16x16x32_bf16 v[88:91], a[124:127], a[24:27], v[88:91]
    s_waitcnt lgkmcnt(5)
    ds_read_b128 a[88:91], v9 offset:6144
    v_mfma_f32_16x16x32_bf16 v[88:91], a[120:123], a[16:19], v[88:91]
    v_mfma_f32_16x16x32_bf16 v[96:99], a[64:67], a[16:19], v[96:99]
    ds_read_b128 a[100:103], v9 offset:9216
    v_mfma_f32_16x16x32_bf16 v[96:99], a[68:71], a[24:27], v[96:99]
    v_mfma_f32_16x16x32_bf16 v[100:103], a[68:71], a[28:31], v[100:103]
    s_waitcnt lgkmcnt(5)
    ds_read_b128 a[96:99], v9 offset:8192
    v_mfma_f32_16x16x32_bf16 v[100:103], a[64:67], a[20:23], v[100:103]
    v_mfma_f32_16x16x32_bf16 v[108:111], a[72:75], a[20:23], v[108:111]
    ds_read_b128 a[108:111], v9 offset:11264
    v_add_u32 v10, s30, v8
    v_mfma_f32_16x16x32_bf16 v[108:111], a[76:79], a[28:31], v[108:111]
    v_mfma_f32_16x16x32_bf16 v[104:107], a[76:79], a[24:27], v[104:107]
    s_waitcnt lgkmcnt(5)
    ds_read_b128 a[104:107], v9 offset:10240
    v_mfma_f32_16x16x32_bf16 v[104:107], a[72:75], a[16:19], v[104:107]
    s_waitcnt vmcnt(8)
    v_mfma_f32_16x16x32_bf16 v[132:135], a[80:83], a[32:35], v[132:135]
    ds_read_b128 a[116:119], v9 offset:13312
    s_waitcnt vmcnt(5)
    v_mfma_f32_16x16x32_bf16 v[132:135], a[84:87], a[40:43], v[132:135]
    s_waitcnt vmcnt(4)
    v_mfma_f32_16x16x32_bf16 v[196:199], a[84:87], a[44:47], v[196:199]
    s_waitcnt lgkmcnt(5)
    ds_read_b128 a[112:115], v9 offset:12288
    v_mfma_f32_16x16x32_bf16 v[196:199], a[80:83], a[36:39], v[196:199]
    s_waitcnt vmcnt(2)
    v_mfma_f32_16x16x32_bf16 v[196:199], a[88:91], a[52:55], v[196:199]
    ds_read_b128 a[124:127], v9 offset:15360
    s_waitcnt vmcnt(0)
    v_mfma_f32_16x16x32_bf16 v[196:199], a[92:95], a[60:63], v[196:199]
    v_mfma_f32_16x16x32_bf16 v[132:135], a[92:95], a[56:59], v[132:135]
    s_waitcnt lgkmcnt(5)
    ds_read_b128 a[120:123], v9 offset:14336
    v_mfma_f32_16x16x32_bf16 v[132:135], a[88:91], a[48:51], v[132:135]
    v_mfma_f32_16x16x32_bf16 v[140:143], a[96:99], a[32:35], v[140:143]
    ds_read_b128 a[68:71], v9 offset:17408
    v_mfma_f32_16x16x32_bf16 v[140:143], a[100:103], a[40:43], v[140:143]
    v_mfma_f32_16x16x32_bf16 v[204:207], a[100:103], a[44:47], v[204:207]
    s_waitcnt lgkmcnt(5)
    ds_read_b128 a[64:67], v9 offset:16384
    v_mfma_f32_16x16x32_bf16 v[204:207], a[96:99], a[36:39], v[204:207]
    v_mfma_f32_16x16x32_bf16 v[204:207], a[104:107], a[52:55], v[204:207]
    ds_read_b128 a[76:79], v9 offset:19456
    v_mfma_f32_16x16x32_bf16 v[204:207], a[108:111], a[60:63], v[204:207]
    v_mfma_f32_16x16x32_bf16 v[140:143], a[108:111], a[56:59], v[140:143]
    s_waitcnt lgkmcnt(5)
    ds_read_b128 a[72:75], v9 offset:18432
    v_mfma_f32_16x16x32_bf16 v[140:143], a[104:107], a[48:51], v[140:143]
    v_mfma_f32_16x16x32_bf16 v[148:151], a[112:115], a[32:35], v[148:151]
    ds_read_b128 a[84:87], v9 offset:21504
    v_mfma_f32_16x16x32_bf16 v[148:151], a[116:119], a[40:43], v[148:151]
    v_mfma_f32_16x16x32_bf16 v[212:215], a[116:119], a[44:47], v[212:215]
    s_waitcnt lgkmcnt(5)
    ds_read_b128 a[80:83], v9 offset:20480
    v_mfma_f32_16x16x32_bf16 v[212:215], a[112:115], a[36:39], v[212:215]
    s_add_u32 s58, s8, 0
    v_cvt_pk_bf16_f32 v132, v132, v133
    v_cvt_pk_bf16_f32 v133, v134, v135
    v_mfma_f32_16x16x32_bf16 v[212:215], a[120:123], a[52:55], v[212:215]
    ds_read_b128 a[92:95], v9 offset:23552
    v_cvt_pk_bf16_f32 v134, v140, v141
    v_mfma_f32_16x16x32_bf16 v[212:215], a[124:127], a[60:63], v[212:215]
    v_cvt_pk_bf16_f32 v135, v142, v143
    v_mfma_f32_16x16x32_bf16 v[148:151], a[124:127], a[56:59], v[148:151]
    s_waitcnt lgkmcnt(5)
    ds_read_b128 a[88:91], v9 offset:22528
    v_mfma_f32_16x16x32_bf16 v[148:151], a[120:123], a[48:51], v[148:151]
    buffer_store_dwordx4 v[132:135], v8, s[24:27], s58 offen sc1
    v_mfma_f32_16x16x32_bf16 v[156:159], a[64:67], a[32:35], v[156:159]
    ds_read_b128 a[100:103], v9 offset:25600
    v_mfma_f32_16x16x32_bf16 v[156:159], a[68:71], a[40:43], v[156:159]
    v_mfma_f32_16x16x32_bf16 v[220:223], a[68:71], a[44:47], v[220:223]
    s_waitcnt lgkmcnt(5)
    ds_read_b128 a[96:99], v9 offset:24576
    v_mfma_f32_16x16x32_bf16 v[220:223], a[64:67], a[36:39], v[220:223]
    s_add_u32 s59, s8, 7168
    v_cvt_pk_bf16_f32 v196, v196, v197
    v_mfma_f32_16x16x32_bf16 v[220:223], a[72:75], a[52:55], v[220:223]
    ds_read_b128 a[108:111], v9 offset:27648
    v_cvt_pk_bf16_f32 v197, v198, v199
    v_mfma_f32_16x16x32_bf16 v[220:223], a[76:79], a[60:63], v[220:223]
    v_cvt_pk_bf16_f32 v198, v204, v205
    v_cvt_pk_bf16_f32 v199, v206, v207
    v_mfma_f32_16x16x32_bf16 v[156:159], a[76:79], a[56:59], v[156:159]
    s_waitcnt lgkmcnt(5)
    ds_read_b128 a[104:107], v9 offset:26624
    v_mfma_f32_16x16x32_bf16 v[156:159], a[72:75], a[48:51], v[156:159]
    buffer_store_dwordx4 v[196:199], v8, s[24:27], s59 offen sc1
    v_mfma_f32_16x16x32_bf16 v[164:167], a[80:83], a[32:35], v[164:167]
    ds_read_b128 a[116:119], v9 offset:29696
    v_mfma_f32_16x16x32_bf16 v[164:167], a[84:87], a[40:43], v[164:167]
    v_mfma_f32_16x16x32_bf16 v[228:231], a[84:87], a[44:47], v[228:231]
    s_waitcnt lgkmcnt(5)
    ds_read_b128 a[112:115], v9 offset:28672
    v_mfma_f32_16x16x32_bf16 v[228:231], a[80:83], a[36:39], v[228:231]
    s_add_u32 s58, s8, 1024
    v_cvt_pk_bf16_f32 v148, v148, v149
    v_mfma_f32_16x16x32_bf16 v[228:231], a[88:91], a[52:55], v[228:231]
    ds_read_b128 a[124:127], v9 offset:31744
    v_cvt_pk_bf16_f32 v149, v150, v151
    v_mfma_f32_16x16x32_bf16 v[228:231], a[92:95], a[60:63], v[228:231]
    s_waitcnt lgkmcnt(5)
    v_cvt_pk_bf16_f32 v150, v156, v157
    v_cvt_pk_bf16_f32 v151, v158, v159
    v_mfma_f32_16x16x32_bf16 v[164:167], a[92:95], a[56:59], v[164:167]
    ds_read_b128 a[120:123], v9 offset:30720
    v_mfma_f32_16x16x32_bf16 v[164:167], a[88:91], a[48:51], v[164:167]
    s_barrier
    v_mfma_f32_16x16x32_bf16 v[172:175], a[96:99], a[32:35], v[172:175]
    ds_read_b128 a[68:71], v10 offset:1024
    v_mfma_f32_16x16x32_bf16 v[172:175], a[100:103], a[40:43], v[172:175]
    buffer_store_dwordx4 v[148:151], v8, s[24:27], s58 offen sc1
    v_mfma_f32_16x16x32_bf16 v[236:239], a[100:103], a[44:47], v[236:239]
    s_waitcnt lgkmcnt(5)
    ds_read_b128 a[64:67], v10 offset:0
    v_mfma_f32_16x16x32_bf16 v[236:239], a[96:99], a[36:39], v[236:239]
    s_add_u32 s59, s8, 8192
    v_cvt_pk_bf16_f32 v212, v212, v213
    v_mfma_f32_16x16x32_bf16 v[236:239], a[104:107], a[52:55], v[236:239]
    ds_read_b128 a[76:79], v10 offset:3072
    v_cvt_pk_bf16_f32 v213, v214, v215
    v_mfma_f32_16x16x32_bf16 v[236:239], a[108:111], a[60:63], v[236:239]
    v_cvt_pk_bf16_f32 v214, v220, v221
    v_cvt_pk_bf16_f32 v215, v222, v223
    v_mfma_f32_16x16x32_bf16 v[172:175], a[108:111], a[56:59], v[172:175]
    s_waitcnt lgkmcnt(5)
    ds_read_b128 a[72:75], v10 offset:2048
    v_mfma_f32_16x16x32_bf16 v[172:175], a[104:107], a[48:51], v[172:175]
    buffer_store_dwordx4 v[212:215], v8, s[24:27], s59 offen sc1
    v_mfma_f32_16x16x32_bf16 v[180:183], a[112:115], a[32:35], v[180:183]
    ds_read_b128 a[84:87], v10 offset:5120
    v_mfma_f32_16x16x32_bf16 v[180:183], a[116:119], a[40:43], v[180:183]
    v_mfma_f32_16x16x32_bf16 v[244:247], a[116:119], a[44:47], v[244:247]
    s_waitcnt lgkmcnt(5)
    ds_read_b128 a[80:83], v10 offset:4096
    v_mfma_f32_16x16x32_bf16 v[244:247], a[112:115], a[36:39], v[244:247]
    s_add_u32 s58, s8, 2048
    v_cvt_pk_bf16_f32 v164, v164, v165
    v_mfma_f32_16x16x32_bf16 v[244:247], a[120:123], a[52:55], v[244:247]
    ds_read_b128 a[92:95], v10 offset:7168
    v_cvt_pk_bf16_f32 v165, v166, v167
    v_mfma_f32_16x16x32_bf16 v[244:247], a[124:127], a[60:63], v[244:247]
    v_cvt_pk_bf16_f32 v166, v172, v173
    v_cvt_pk_bf16_f32 v167, v174, v175
    v_mfma_f32_16x16x32_bf16 v[180:183], a[124:127], a[56:59], v[180:183]
    s_waitcnt lgkmcnt(5)
    ds_read_b128 a[88:91], v10 offset:6144
    v_mfma_f32_16x16x32_bf16 v[180:183], a[120:123], a[48:51], v[180:183]
    buffer_store_dwordx4 v[164:167], v8, s[24:27], s58 offen sc1
    v_mfma_f32_16x16x32_bf16 v[188:191], a[64:67], a[32:35], v[188:191]
    ds_read_b128 a[100:103], v10 offset:9216
    v_mfma_f32_16x16x32_bf16 v[188:191], a[68:71], a[40:43], v[188:191]
    v_mfma_f32_16x16x32_bf16 v[252:255], a[68:71], a[44:47], v[252:255]
    s_waitcnt lgkmcnt(5)
    ds_read_b128 a[96:99], v10 offset:8192
    v_mfma_f32_16x16x32_bf16 v[252:255], a[64:67], a[36:39], v[252:255]
    s_add_u32 s59, s8, 9216
    v_cvt_pk_bf16_f32 v228, v228, v229
    v_mfma_f32_16x16x32_bf16 v[252:255], a[72:75], a[52:55], v[252:255]
    ds_read_b128 a[108:111], v10 offset:11264
    v_cvt_pk_bf16_f32 v229, v230, v231
    v_mfma_f32_16x16x32_bf16 v[252:255], a[76:79], a[60:63], v[252:255]
    v_cvt_pk_bf16_f32 v230, v236, v237
    v_cvt_pk_bf16_f32 v231, v238, v239
    v_mfma_f32_16x16x32_bf16 v[188:191], a[76:79], a[56:59], v[188:191]
    s_waitcnt lgkmcnt(5)
    ds_read_b128 a[104:107], v10 offset:10240
    v_mfma_f32_16x16x32_bf16 v[188:191], a[72:75], a[48:51], v[188:191]
    buffer_store_dwordx4 v[228:231], v8, s[24:27], s59 offen sc1
    v_mfma_f32_16x16x32_bf16 v[64:67], a[80:83], a[32:35], v[64:67]
    ds_read_b128 a[116:119], v10 offset:13312
    v_mfma_f32_16x16x32_bf16 v[64:67], a[84:87], a[40:43], v[64:67]
    v_mfma_f32_16x16x32_bf16 v[68:71], a[84:87], a[44:47], v[68:71]
    s_waitcnt lgkmcnt(5)
    ds_read_b128 a[112:115], v10 offset:12288
    v_mfma_f32_16x16x32_bf16 v[68:71], a[80:83], a[36:39], v[68:71]
    s_add_u32 s58, s8, 3072
    v_cvt_pk_bf16_f32 v180, v180, v181
    v_mfma_f32_16x16x32_bf16 v[68:71], a[88:91], a[52:55], v[68:71]
    ds_read_b128 a[124:127], v10 offset:15360
    v_cvt_pk_bf16_f32 v181, v182, v183
    v_mfma_f32_16x16x32_bf16 v[68:71], a[92:95], a[60:63], v[68:71]
    v_cvt_pk_bf16_f32 v182, v188, v189
    v_cvt_pk_bf16_f32 v183, v190, v191
    v_mfma_f32_16x16x32_bf16 v[64:67], a[92:95], a[56:59], v[64:67]
    s_waitcnt lgkmcnt(5)
    ds_read_b128 a[120:123], v10 offset:14336
    v_mfma_f32_16x16x32_bf16 v[64:67], a[88:91], a[48:51], v[64:67]
    buffer_store_dwordx4 v[180:183], v8, s[24:27], s58 offen sc1
    v_mfma_f32_16x16x32_bf16 v[72:75], a[96:99], a[32:35], v[72:75]
    ds_read_b128 a[68:71], v10 offset:17408
    v_mfma_f32_16x16x32_bf16 v[72:75], a[100:103], a[40:43], v[72:75]
    v_mfma_f32_16x16x32_bf16 v[76:79], a[100:103], a[44:47], v[76:79]
    s_waitcnt lgkmcnt(5)
    ds_read_b128 a[64:67], v10 offset:16384
    v_mfma_f32_16x16x32_bf16 v[76:79], a[96:99], a[36:39], v[76:79]
    s_add_u32 s59, s8, 10240
    v_cvt_pk_bf16_f32 v244, v244, v245
    v_mfma_f32_16x16x32_bf16 v[76:79], a[104:107], a[52:55], v[76:79]
    ds_read_b128 a[76:79], v10 offset:19456
    v_cvt_pk_bf16_f32 v245, v246, v247
    v_mfma_f32_16x16x32_bf16 v[76:79], a[108:111], a[60:63], v[76:79]
    v_cvt_pk_bf16_f32 v246, v252, v253
    v_cvt_pk_bf16_f32 v247, v254, v255
    v_mfma_f32_16x16x32_bf16 v[72:75], a[108:111], a[56:59], v[72:75]
    s_waitcnt lgkmcnt(5)
    ds_read_b128 a[72:75], v10 offset:18432
    v_mfma_f32_16x16x32_bf16 v[72:75], a[104:107], a[48:51], v[72:75]
    buffer_store_dwordx4 v[244:247], v8, s[24:27], s59 offen sc1
    v_mfma_f32_16x16x32_bf16 v[80:83], a[112:115], a[32:35], v[80:83]
    ds_read_b128 a[84:87], v10 offset:21504
    v_mfma_f32_16x16x32_bf16 v[80:83], a[116:119], a[40:43], v[80:83]
    v_mfma_f32_16x16x32_bf16 v[84:87], a[116:119], a[44:47], v[84:87]
    s_waitcnt lgkmcnt(5)
    ds_read_b128 a[80:83], v10 offset:20480
    v_mfma_f32_16x16x32_bf16 v[84:87], a[112:115], a[36:39], v[84:87]
    s_add_u32 s58, s8, 4096
    v_cvt_pk_bf16_f32 v64, v64, v65
    v_mfma_f32_16x16x32_bf16 v[84:87], a[120:123], a[52:55], v[84:87]
    ds_read_b128 a[92:95], v10 offset:23552
    v_cvt_pk_bf16_f32 v65, v66, v67
    v_mfma_f32_16x16x32_bf16 v[84:87], a[124:127], a[60:63], v[84:87]
    v_cvt_pk_bf16_f32 v66, v72, v73
    v_cvt_pk_bf16_f32 v67, v74, v75
    v_mfma_f32_16x16x32_bf16 v[80:83], a[124:127], a[56:59], v[80:83]
    s_waitcnt lgkmcnt(5)
    ds_read_b128 a[88:91], v10 offset:22528
    v_mfma_f32_16x16x32_bf16 v[80:83], a[120:123], a[48:51], v[80:83]
    buffer_store_dwordx4 v[64:67], v8, s[24:27], s58 offen sc1
    v_mfma_f32_16x16x32_bf16 v[88:91], a[64:67], a[32:35], v[88:91]
    ds_read_b128 a[100:103], v10 offset:25600
    v_mfma_f32_16x16x32_bf16 v[88:91], a[68:71], a[40:43], v[88:91]
    v_mfma_f32_16x16x32_bf16 v[92:95], a[68:71], a[44:47], v[92:95]
    s_waitcnt lgkmcnt(5)
    ds_read_b128 a[96:99], v10 offset:24576
    v_mfma_f32_16x16x32_bf16 v[92:95], a[64:67], a[36:39], v[92:95]
    s_add_u32 s59, s8, 11264
    v_cvt_pk_bf16_f32 v68, v68, v69
    v_mfma_f32_16x16x32_bf16 v[92:95], a[72:75], a[52:55], v[92:95]
    ds_read_b128 a[108:111], v10 offset:27648
    v_cvt_pk_bf16_f32 v69, v70, v71
    v_mfma_f32_16x16x32_bf16 v[92:95], a[76:79], a[60:63], v[92:95]
    v_cvt_pk_bf16_f32 v70, v76, v77
    v_cvt_pk_bf16_f32 v71, v78, v79
    v_mfma_f32_16x16x32_bf16 v[88:91], a[76:79], a[56:59], v[88:91]
    s_waitcnt lgkmcnt(5)
    ds_read_b128 a[104:107], v10 offset:26624
    v_mfma_f32_16x16x32_bf16 v[88:91], a[72:75], a[48:51], v[88:91]
    buffer_store_dwordx4 v[68:71], v8, s[24:27], s59 offen sc1
    v_mfma_f32_16x16x32_bf16 v[96:99], a[80:83], a[32:35], v[96:99]
    v_mfma_f32_16x16x32_bf16 v[96:99], a[84:87], a[40:43], v[96:99]
    v_mfma_f32_16x16x32_bf16 v[100:103], a[84:87], a[44:47], v[100:103]
    s_waitcnt lgkmcnt(4)
    v_mfma_f32_16x16x32_bf16 v[100:103], a[80:83], a[36:39], v[100:103]
    s_add_u32 s58, s8, 5120
    v_cvt_pk_bf16_f32 v80, v80, v81
    v_mfma_f32_16x16x32_bf16 v[100:103], a[88:91], a[52:55], v[100:103]
    v_cvt_pk_bf16_f32 v81, v82, v83
    v_cvt_pk_bf16_f32 v82, v88, v89
    v_mfma_f32_16x16x32_bf16 v[100:103], a[92:95], a[60:63], v[100:103]
    v_cvt_pk_bf16_f32 v83, v90, v91
    v_mfma_f32_16x16x32_bf16 v[96:99], a[92:95], a[56:59], v[96:99]
    s_waitcnt lgkmcnt(2)
    v_mfma_f32_16x16x32_bf16 v[96:99], a[88:91], a[48:51], v[96:99]
    buffer_store_dwordx4 v[80:83], v8, s[24:27], s58 offen sc1
    v_mfma_f32_16x16x32_bf16 v[104:107], a[96:99], a[32:35], v[104:107]
    v_mfma_f32_16x16x32_bf16 v[104:107], a[100:103], a[40:43], v[104:107]
    v_mfma_f32_16x16x32_bf16 v[108:111], a[100:103], a[44:47], v[108:111]
    s_waitcnt lgkmcnt(0)
    v_mfma_f32_16x16x32_bf16 v[108:111], a[96:99], a[36:39], v[108:111]
    s_add_u32 s59, s8, 12288
    v_cvt_pk_bf16_f32 v84, v84, v85
    v_mfma_f32_16x16x32_bf16 v[108:111], a[104:107], a[52:55], v[108:111]
    v_cvt_pk_bf16_f32 v85, v86, v87
    v_cvt_pk_bf16_f32 v86, v92, v93
    v_mfma_f32_16x16x32_bf16 v[108:111], a[108:111], a[60:63], v[108:111]
    v_cvt_pk_bf16_f32 v87, v94, v95
    v_mfma_f32_16x16x32_bf16 v[104:107], a[108:111], a[56:59], v[104:107]
    buffer_store_dwordx4 v[84:87], v8, s[24:27], s59 offen sc1
    v_mfma_f32_16x16x32_bf16 v[104:107], a[104:107], a[48:51], v[104:107]
    v_cvt_pk_bf16_f32 v96, v96, v97
    v_cvt_pk_bf16_f32 v97, v98, v99
    s_nop 5
    v_cvt_pk_bf16_f32 v98, v104, v105
    v_cvt_pk_bf16_f32 v99, v106, v107
    s_add_u32 s58, s8, 6144
    buffer_store_dwordx4 v[96:99], v8, s[24:27], s58 offen sc1
    v_cvt_pk_bf16_f32 v100, v100, v101
    v_cvt_pk_bf16_f32 v101, v102, v103
    v_cvt_pk_bf16_f32 v102, v108, v109
    v_cvt_pk_bf16_f32 v103, v110, v111
    s_add_u32 s59, s8, 13312
    buffer_store_dwordx4 v[100:103], v8, s[24:27], s59 offen sc1
    s_lshl_b32 s56, s6, 1
    s_add_u32 s56, s56, s7
    s_lshl_b32 s59, s56, 12
    s_add_u32 s59, s59, 70647808
    s_lshl_b32 s60, s5, 7
    s_lshl_b32 s61, s20, 10
    s_add_u32 s60, s60, s61
    v_mov_b32 v3, s60
    v_lshl_or_b32 v3, v13, 30, v3
    s_lshr_b32 s61, s5, 1
    s_lshl_b32 s60, s61, 10
    v_and_b32 v9, 7, v2
    v_lshl_add_u32 v9, v9, 7, s60
    s_lshl_b32 s61, s61, 14
    s_add_u32 s56, s9, s61
    s_and_b32 s61, s5, 1
    s_mul_i32 s61, s61, 7
    s_add_u32 s61, s61, s20
    s_lshl_b32 s61, s61, 10
    s_add_u32 s56, s56, s61
    s_cmp_eq_u32 s20, 3
    s_cselect_b32 s58, 0x40000000, 0
    s_add_u32 s63, s58, 4096
    s_waitcnt vmcnt(0)
    buffer_store_dword v1, v3, s[24:27], s59 offen sc1
    s_mov_b32 s60, 0
K2_XPOLL:
    buffer_load_dword v4, v9, s[24:27], s59 offen sc1
    s_waitcnt vmcnt(0)
    v_cmp_ne_u32 vcc, 0, v4
    s_nop 1
    s_andn2_b32 s61, vcc_lo, s60
    s_or_b32 s60, s60, s61
    s_bitcmp1_b32 s61, 0
    s_cbranch_scc0 K2_XS0
    s_add_u32 s57, s56, 0
    buffer_load_dwordx4 v[32:35], v8, s[24:27], s57 offen sc1
    s_add_u32 s57, s57, s63
    buffer_load_dwordx4 v[64:67], v8, s[24:27], s57 offen sc1
K2_XS0:
    s_bitcmp1_b32 s61, 1
    s_cbranch_scc0 K2_XS1
    s_add_u32 s57, s56, 65536
    buffer_load_dwordx4 v[36:39], v8, s[24:27], s57 offen sc1
    s_add_u32 s57, s57, s63
    buffer_load_dwordx4 v[68:71], v8, s[24:27], s57 offen sc1
K2_XS1:
    s_bitcmp1_b32 s61, 2
    s_cbranch_scc0 K2_XS2
    s_add_u32 s57, s56, 131072
    buffer_load_dwordx4 v[40:43], v8, s[24:27], s57 offen sc1
    s_add_u32 s57, s57, s63
    buffer_load_dwordx4 v[72:75], v8, s[24:27], s57 offen sc1
K2_XS2:
    s_bitcmp1_b32 s61, 3
    s_cbranch_scc0 K2_XS3
    s_add_u32 s57, s56, 196608
    buffer_load_dwordx4 v[44:47], v8, s[24:27], s57 offen sc1
    s_add_u32 s57, s57, s63
    buffer_load_dwordx4 v[76:79], v8, s[24:27], s57 offen sc1
K2_XS3:
    s_bitcmp1_b32 s61, 4
    s_cbranch_scc0 K2_XS4
    s_add_u32 s57, s56, 262144
    buffer_load_dwordx4 v[48:51], v8, s[24:27], s57 offen sc1
    s_add_u32 s57, s57, s63
    buffer_load_dwordx4 v[80:83], v8, s[24:27], s57 offen sc1
K2_XS4:
    s_bitcmp1_b32 s61, 5
    s_cbranch_scc0 K2_XS5
    s_add_u32 s57, s56, 327680
    buffer_load_dwordx4 v[52:55], v8, s[24:27], s57 offen sc1
    s_add_u32 s57, s57, s63
    buffer_load_dwordx4 v[84:87], v8, s[24:27], s57 offen sc1
K2_XS5:
    s_bitcmp1_b32 s61, 6
    s_cbranch_scc0 K2_XS6
    s_add_u32 s57, s56, 393216
    buffer_load_dwordx4 v[56:59], v8, s[24:27], s57 offen sc1
    s_add_u32 s57, s57, s63
    buffer_load_dwordx4 v[88:91], v8, s[24:27], s57 offen sc1
K2_XS6:
    s_bitcmp1_b32 s61, 7
    s_cbranch_scc0 K2_XS7
    s_add_u32 s57, s56, 458752
    buffer_load_dwordx4 v[60:63], v8, s[24:27], s57 offen sc1
    s_add_u32 s57, s57, s63
    buffer_load_dwordx4 v[92:95], v8, s[24:27], s57 offen sc1
K2_XS7:
    s_cmp_eq_u32 s60, -1
    s_cbranch_scc1 K2_XGO
    s_sleep 1
    s_branch K2_XPOLL
K2_XGO:
    v_and_b32 v5, 15, v2
    v_mul_u32_u24 v5, 896, v5
    v_lshrrev_b32 v6, 4, v2
    v_lshl_add_u32 v5, v6, 3, v5
    s_lshl_b32 s56, s6, 3
    s_add_u32 s56, s56, s5
    s_mul_i32 s56, s56, 14336
    s_mul_i32 s57, s7, 448
    s_add_u32 s56, s56, s57
    s_lshl_b32 s57, s20, 6
    s_add_u32 s56, s56, s57
    s_waitcnt vmcnt(0)
    v_lshlrev_b32 v16, 16, v32
    v_and_b32 v17, 0xffff0000, v32
    v_lshlrev_b32 v18, 16, v33
    v_and_b32 v19, 0xffff0000, v33
    v_lshlrev_b32 v20, 16, v34
    v_and_b32 v21, 0xffff0000, v34
    v_lshlrev_b32 v22, 16, v35
    v_and_b32 v23, 0xffff0000, v35
    v_lshlrev_b32 v120, 16, v36
    v_and_b32 v121, 0xffff0000, v36
    v_pk_add_f32 v[16:17], v[16:17], v[120:121]
    v_lshlrev_b32 v122, 16, v37
    v_and_b32 v123, 0xffff0000, v37
    v_pk_add_f32 v[18:19], v[18:19], v[122:123]
    v_lshlrev_b32 v120, 16, v38
    v_and_b32 v121, 0xffff0000, v38
    v_pk_add_f32 v[20:21], v[20:21], v[120:121]
    v_lshlrev_b32 v122, 16, v39
    v_and_b32 v123, 0xffff0000, v39
    v_pk_add_f32 v[22:23], v[22:23], v[122:123]
    v_lshlrev_b32 v120, 16, v40
    v_and_b32 v121, 0xffff0000, v40
    v_pk_add_f32 v[16:17], v[16:17], v[120:121]
    v_lshlrev_b32 v122, 16, v41
    v_and_b32 v123, 0xffff0000, v41
    v_pk_add_f32 v[18:19], v[18:19], v[122:123]
    v_lshlrev_b32 v120, 16, v42
    v_and_b32 v121, 0xffff0000, v42
    v_pk_add_f32 v[20:21], v[20:21], v[120:121]
    v_lshlrev_b32 v122, 16, v43
    v_and_b32 v123, 0xffff0000, v43
    v_pk_add_f32 v[22:23], v[22:23], v[122:123]
    v_lshlrev_b32 v120, 16, v44
    v_and_b32 v121, 0xffff0000, v44
    v_pk_add_f32 v[16:17], v[16:17], v[120:121]
    v_lshlrev_b32 v122, 16, v45
    v_and_b32 v123, 0xffff0000, v45
    v_pk_add_f32 v[18:19], v[18:19], v[122:123]
    v_lshlrev_b32 v120, 16, v46
    v_and_b32 v121, 0xffff0000, v46
    v_pk_add_f32 v[20:21], v[20:21], v[120:121]
    v_lshlrev_b32 v122, 16, v47
    v_and_b32 v123, 0xffff0000, v47
    v_pk_add_f32 v[22:23], v[22:23], v[122:123]
    v_lshlrev_b32 v120, 16, v48
    v_and_b32 v121, 0xffff0000, v48
    v_pk_add_f32 v[16:17], v[16:17], v[120:121]
    v_lshlrev_b32 v122, 16, v49
    v_and_b32 v123, 0xffff0000, v49
    v_pk_add_f32 v[18:19], v[18:19], v[122:123]
    v_lshlrev_b32 v120, 16, v50
    v_and_b32 v121, 0xffff0000, v50
    v_pk_add_f32 v[20:21], v[20:21], v[120:121]
    v_lshlrev_b32 v122, 16, v51
    v_and_b32 v123, 0xffff0000, v51
    v_pk_add_f32 v[22:23], v[22:23], v[122:123]
    v_lshlrev_b32 v120, 16, v52
    v_and_b32 v121, 0xffff0000, v52
    v_pk_add_f32 v[16:17], v[16:17], v[120:121]
    v_lshlrev_b32 v122, 16, v53
    v_and_b32 v123, 0xffff0000, v53
    v_pk_add_f32 v[18:19], v[18:19], v[122:123]
    v_lshlrev_b32 v120, 16, v54
    v_and_b32 v121, 0xffff0000, v54
    v_pk_add_f32 v[20:21], v[20:21], v[120:121]
    v_lshlrev_b32 v122, 16, v55
    v_and_b32 v123, 0xffff0000, v55
    v_pk_add_f32 v[22:23], v[22:23], v[122:123]
    v_lshlrev_b32 v120, 16, v56
    v_and_b32 v121, 0xffff0000, v56
    v_pk_add_f32 v[16:17], v[16:17], v[120:121]
    v_lshlrev_b32 v122, 16, v57
    v_and_b32 v123, 0xffff0000, v57
    v_pk_add_f32 v[18:19], v[18:19], v[122:123]
    v_lshlrev_b32 v120, 16, v58
    v_and_b32 v121, 0xffff0000, v58
    v_pk_add_f32 v[20:21], v[20:21], v[120:121]
    v_lshlrev_b32 v122, 16, v59
    v_and_b32 v123, 0xffff0000, v59
    v_pk_add_f32 v[22:23], v[22:23], v[122:123]
    v_lshlrev_b32 v120, 16, v60
    v_and_b32 v121, 0xffff0000, v60
    v_pk_add_f32 v[16:17], v[16:17], v[120:121]
    v_lshlrev_b32 v122, 16, v61
    v_and_b32 v123, 0xffff0000, v61
    v_pk_add_f32 v[18:19], v[18:19], v[122:123]
    v_lshlrev_b32 v120, 16, v62
    v_and_b32 v121, 0xffff0000, v62
    v_pk_add_f32 v[20:21], v[20:21], v[120:121]
    v_lshlrev_b32 v122, 16, v63
    v_and_b32 v123, 0xffff0000, v63
    v_pk_add_f32 v[22:23], v[22:23], v[122:123]
    v_cvt_pk_bf16_f32 v16, v16, v17
    v_cvt_pk_bf16_f32 v17, v18, v19
    v_cvt_pk_bf16_f32 v18, v20, v21
    v_cvt_pk_bf16_f32 v19, v22, v23
    buffer_store_dwordx2 v[16:17], v5, s[36:39], s56 offen offset:0
    buffer_store_dwordx2 v[18:19], v5, s[36:39], s56 offen offset:32
    s_add_u32 s56, s56, s58
    v_lshlrev_b32 v24, 16, v64
    v_and_b32 v25, 0xffff0000, v64
    v_lshlrev_b32 v26, 16, v65
    v_and_b32 v27, 0xffff0000, v65
    v_lshlrev_b32 v28, 16, v66
    v_and_b32 v29, 0xffff0000, v66
    v_lshlrev_b32 v30, 16, v67
    v_and_b32 v31, 0xffff0000, v67
    v_lshlrev_b32 v120, 16, v68
    v_and_b32 v121, 0xffff0000, v68
    v_pk_add_f32 v[24:25], v[24:25], v[120:121]
    v_lshlrev_b32 v122, 16, v69
    v_and_b32 v123, 0xffff0000, v69
    v_pk_add_f32 v[26:27], v[26:27], v[122:123]
    v_lshlrev_b32 v120, 16, v70
    v_and_b32 v121, 0xffff0000, v70
    v_pk_add_f32 v[28:29], v[28:29], v[120:121]
    v_lshlrev_b32 v122, 16, v71
    v_and_b32 v123, 0xffff0000, v71
    v_pk_add_f32 v[30:31], v[30:31], v[122:123]
    v_lshlrev_b32 v120, 16, v72
    v_and_b32 v121, 0xffff0000, v72
    v_pk_add_f32 v[24:25], v[24:25], v[120:121]
    v_lshlrev_b32 v122, 16, v73
    v_and_b32 v123, 0xffff0000, v73
    v_pk_add_f32 v[26:27], v[26:27], v[122:123]
    v_lshlrev_b32 v120, 16, v74
    v_and_b32 v121, 0xffff0000, v74
    v_pk_add_f32 v[28:29], v[28:29], v[120:121]
    v_lshlrev_b32 v122, 16, v75
    v_and_b32 v123, 0xffff0000, v75
    v_pk_add_f32 v[30:31], v[30:31], v[122:123]
    v_lshlrev_b32 v120, 16, v76
    v_and_b32 v121, 0xffff0000, v76
    v_pk_add_f32 v[24:25], v[24:25], v[120:121]
    v_lshlrev_b32 v122, 16, v77
    v_and_b32 v123, 0xffff0000, v77
    v_pk_add_f32 v[26:27], v[26:27], v[122:123]
    v_lshlrev_b32 v120, 16, v78
    v_and_b32 v121, 0xffff0000, v78
    v_pk_add_f32 v[28:29], v[28:29], v[120:121]
    v_lshlrev_b32 v122, 16, v79
    v_and_b32 v123, 0xffff0000, v79
    v_pk_add_f32 v[30:31], v[30:31], v[122:123]
    v_lshlrev_b32 v120, 16, v80
    v_and_b32 v121, 0xffff0000, v80
    v_pk_add_f32 v[24:25], v[24:25], v[120:121]
    v_lshlrev_b32 v122, 16, v81
    v_and_b32 v123, 0xffff0000, v81
    v_pk_add_f32 v[26:27], v[26:27], v[122:123]
    v_lshlrev_b32 v120, 16, v82
    v_and_b32 v121, 0xffff0000, v82
    v_pk_add_f32 v[28:29], v[28:29], v[120:121]
    v_lshlrev_b32 v122, 16, v83
    v_and_b32 v123, 0xffff0000, v83
    v_pk_add_f32 v[30:31], v[30:31], v[122:123]
    v_lshlrev_b32 v120, 16, v84
    v_and_b32 v121, 0xffff0000, v84
    v_pk_add_f32 v[24:25], v[24:25], v[120:121]
    v_lshlrev_b32 v122, 16, v85
    v_and_b32 v123, 0xffff0000, v85
    v_pk_add_f32 v[26:27], v[26:27], v[122:123]
    v_lshlrev_b32 v120, 16, v86
    v_and_b32 v121, 0xffff0000, v86
    v_pk_add_f32 v[28:29], v[28:29], v[120:121]
    v_lshlrev_b32 v122, 16, v87
    v_and_b32 v123, 0xffff0000, v87
    v_pk_add_f32 v[30:31], v[30:31], v[122:123]
    v_lshlrev_b32 v120, 16, v88
    v_and_b32 v121, 0xffff0000, v88
    v_pk_add_f32 v[24:25], v[24:25], v[120:121]
    v_lshlrev_b32 v122, 16, v89
    v_and_b32 v123, 0xffff0000, v89
    v_pk_add_f32 v[26:27], v[26:27], v[122:123]
    v_lshlrev_b32 v120, 16, v90
    v_and_b32 v121, 0xffff0000, v90
    v_pk_add_f32 v[28:29], v[28:29], v[120:121]
    v_lshlrev_b32 v122, 16, v91
    v_and_b32 v123, 0xffff0000, v91
    v_pk_add_f32 v[30:31], v[30:31], v[122:123]
    v_lshlrev_b32 v120, 16, v92
    v_and_b32 v121, 0xffff0000, v92
    v_pk_add_f32 v[24:25], v[24:25], v[120:121]
    v_lshlrev_b32 v122, 16, v93
    v_and_b32 v123, 0xffff0000, v93
    v_pk_add_f32 v[26:27], v[26:27], v[122:123]
    v_lshlrev_b32 v120, 16, v94
    v_and_b32 v121, 0xffff0000, v94
    v_pk_add_f32 v[28:29], v[28:29], v[120:121]
    v_lshlrev_b32 v122, 16, v95
    v_and_b32 v123, 0xffff0000, v95
    v_pk_add_f32 v[30:31], v[30:31], v[122:123]
    v_cvt_pk_bf16_f32 v24, v24, v25
    v_cvt_pk_bf16_f32 v25, v26, v27
    v_cvt_pk_bf16_f32 v26, v28, v29
    v_cvt_pk_bf16_f32 v27, v30, v31
    buffer_store_dwordx2 v[24:25], v5, s[36:39], s56 offen offset:256
    buffer_store_dwordx2 v[26:27], v5, s[36:39], s56 offen offset:288
    s_endpgm
K2_PLAIN:
    s_waitcnt vmcnt(0)
    s_add_u32 s56, s65, 98304
    v_pk_mul_f32 v[128:129], v[128:129], v[120:121] op_sel_hi:[1,0]
    v_pk_mul_f32 v[130:131], v[130:131], v[120:121] op_sel_hi:[1,0]
    v_pk_mul_f32 v[132:133], v[132:133], v[120:121] op_sel_hi:[1,0]
    v_pk_mul_f32 v[134:135], v[134:135], v[120:121] op_sel_hi:[1,0]
    s_add_u32 m0, s31, s44
    v_cvt_pk_bf16_f32 v128, v128, v129
    v_cvt_pk_bf16_f32 v129, v130, v131
    v_cvt_pk_bf16_f32 v130, v132, v133
    v_cvt_pk_bf16_f32 v131, v134, v135
    buffer_load_dwordx4 v6, s[24:27], s56 offen offset:0 lds
    v_pk_mul_f32 v[192:193], v[192:193], v[120:121] op_sel:[0,1] op_sel_hi:[1,1]
    v_pk_mul_f32 v[194:195], v[194:195], v[120:121] op_sel:[0,1] op_sel_hi:[1,1]
    v_pk_mul_f32 v[196:197], v[196:197], v[120:121] op_sel:[0,1] op_sel_hi:[1,1]
    v_pk_mul_f32 v[198:199], v[198:199], v[120:121] op_sel:[0,1] op_sel_hi:[1,1]
    buffer_load_dwordx4 v6, s[24:27], s56 offen offset:1024 lds
    v_cvt_pk_bf16_f32 v192, v192, v193
    v_cvt_pk_bf16_f32 v193, v194, v195
    v_cvt_pk_bf16_f32 v194, v196, v197
    v_cvt_pk_bf16_f32 v195, v198, v199
    buffer_load_dwordx4 v6, s[24:27], s56 offen offset:2048 lds
    v_pk_mul_f32 v[136:137], v[136:137], v[120:121] op_sel_hi:[1,0]
    v_pk_mul_f32 v[138:139], v[138:139], v[120:121] op_sel_hi:[1,0]
    v_pk_mul_f32 v[140:141], v[140:141], v[120:121] op_sel_hi:[1,0]
    buffer_load_dwordx4 v6, s[24:27], s56 offen offset:3072 lds
    v_pk_mul_f32 v[142:143], v[142:143], v[120:121] op_sel_hi:[1,0]
    v_cvt_pk_bf16_f32 v136, v136, v137
    v_cvt_pk_bf16_f32 v137, v138, v139
    v_cvt_pk_bf16_f32 v138, v140, v141
    s_add_u32 m0, m0, 4096
    v_cvt_pk_bf16_f32 v139, v142, v143
    v_pk_mul_f32 v[200:201], v[200:201], v[120:121] op_sel:[0,1] op_sel_hi:[1,1]
    v_pk_mul_f32 v[202:203], v[202:203], v[120:121] op_sel:[0,1] op_sel_hi:[1,1]
    v_pk_mul_f32 v[204:205], v[204:205], v[120:121] op_sel:[0,1] op_sel_hi:[1,1]
    buffer_load_dwordx4 v7, s[24:27], s56 offen offset:0 lds
    v_pk_mul_f32 v[206:207], v[206:207], v[120:121] op_sel:[0,1] op_sel_hi:[1,1]
    v_cvt_pk_bf16_f32 v200, v200, v201
    v_cvt_pk_bf16_f32 v201, v202, v203
    v_cvt_pk_bf16_f32 v202, v204, v205
    buffer_load_dwordx4 v7, s[24:27], s56 offen offset:1024 lds
    v_cvt_pk_bf16_f32 v203, v206, v207
    s_add_u32 s50, s45, 0
    buffer_store_dwordx4 v[128:131], v8, s[24:27], s50 offen sc1
    buffer_load_dwordx4 v7, s[24:27], s56 offen offset:2048 lds
    v_pk_mul_f32 v[144:145], v[144:145], v[120:121] op_sel_hi:[1,0]
    v_pk_mul_f32 v[146:147], v[146:147], v[120:121] op_sel_hi:[1,0]
    v_pk_mul_f32 v[148:149], v[148:149], v[120:121] op_sel_hi:[1,0]
    v_pk_mul_f32 v[150:151], v[150:151], v[120:121] op_sel_hi:[1,0]
    buffer_load_dwordx4 v7, s[24:27], s56 offen offset:3072 lds
    v_cvt_pk_bf16_f32 v144, v144, v145
    v_cvt_pk_bf16_f32 v145, v146, v147
    v_cvt_pk_bf16_f32 v146, v148, v149
    v_cvt_pk_bf16_f32 v147, v150, v151
    s_mov_b32 s36, s48
    v_pk_mul_f32 v[208:209], v[208:209], v[120:121] op_sel:[0,1] op_sel_hi:[1,1]
    v_pk_mul_f32 v[210:211], v[210:211], v[120:121] op_sel:[0,1] op_sel_hi:[1,1]
    v_pk_mul_f32 v[212:213], v[212:213], v[120:121] op_sel:[0,1] op_sel_hi:[1,1]
    v_pk_mul_f32 v[214:215], v[214:215], v[120:121] op_sel:[0,1] op_sel_hi:[1,1]
    s_and_b32 s37, s49, 0xffff
    v_cvt_pk_bf16_f32 v208, v208, v209
    v_cvt_pk_bf16_f32 v209, v210, v211
    v_cvt_pk_bf16_f32 v210, v212, v213
    v_cvt_pk_bf16_f32 v211, v214, v215
    s_mov_b32 s38, 1835008
    v_pk_mul_f32 v[152:153], v[152:153], v[120:121] op_sel_hi:[1,0]
    v_pk_mul_f32 v[154:155], v[154:155], v[120:121] op_sel_hi:[1,0]
    v_pk_mul_f32 v[156:157], v[156:157], v[120:121] op_sel_hi:[1,0]
    s_mov_b32 s39, 0x20000
    v_pk_mul_f32 v[158:159], v[158:159], v[120:121] op_sel_hi:[1,0]
    v_cvt_pk_bf16_f32 v152, v152, v153
    v_cvt_pk_bf16_f32 v153, v154, v155
    v_cvt_pk_bf16_f32 v154, v156, v157
    s_lshr_b32 s6, s60, 13
    v_cvt_pk_bf16_f32 v155, v158, v159
    v_pk_mul_f32 v[216:217], v[216:217], v[120:121] op_sel:[0,1] op_sel_hi:[1,1]
    v_pk_mul_f32 v[218:219], v[218:219], v[120:121] op_sel:[0,1] op_sel_hi:[1,1]
    v_pk_mul_f32 v[220:221], v[220:221], v[120:121] op_sel:[0,1] op_sel_hi:[1,1]
    s_lshr_b32 s5, s21, 1
    v_pk_mul_f32 v[222:223], v[222:223], v[120:121] op_sel:[0,1] op_sel_hi:[1,1]
    v_cvt_pk_bf16_f32 v216, v216, v217
    v_cvt_pk_bf16_f32 v217, v218, v219
    v_cvt_pk_bf16_f32 v218, v220, v221
    s_and_b32 s7, s21, 1
    v_cvt_pk_bf16_f32 v219, v222, v223
    s_add_u32 s50, s45, 1024
    buffer_store_dwordx4 v[192:195], v8, s[24:27], s50 offen sc1
    s_xor_b32 s4, s45, 0x100000
    v_pk_mul_f32 v[160:161], v[160:161], v[120:121] op_sel_hi:[1,0]
    v_pk_mul_f32 v[162:163], v[162:163], v[120:121] op_sel_hi:[1,0]
    v_pk_mul_f32 v[164:165], v[164:165], v[120:121] op_sel_hi:[1,0]
    v_pk_mul_f32 v[166:167], v[166:167], v[120:121] op_sel_hi:[1,0]
    s_add_u32 s32, s28, 65536
    v_cvt_pk_bf16_f32 v160, v160, v161
    v_cvt_pk_bf16_f32 v161, v162, v163
    v_cvt_pk_bf16_f32 v162, v164, v165
    v_cvt_pk_bf16_f32 v163, v166, v167
    s_sub_u32 s63, s32, 163840
    v_pk_mul_f32 v[224:225], v[224:225], v[120:121] op_sel:[0,1] op_sel_hi:[1,1]
    v_pk_mul_f32 v[226:227], v[226:227], v[120:121] op_sel:[0,1] op_sel_hi:[1,1]
    v_pk_mul_f32 v[228:229], v[228:229], v[120:121] op_sel:[0,1] op_sel_hi:[1,1]
    v_pk_mul_f32 v[230:231], v[230:231], v[120:121] op_sel:[0,1] op_sel_hi:[1,1]
    s_min_u32 s32, s32, s63
    v_cvt_pk_bf16_f32 v224, v224, v225
    v_cvt_pk_bf16_f32 v225, v226, v227
    v_cvt_pk_bf16_f32 v226, v228, v229
    v_cvt_pk_bf16_f32 v227, v230, v231
    s_lshl_b32 s62, s6, 3
    v_pk_mul_f32 v[168:169], v[168:169], v[120:121] op_sel_hi:[1,0]
    v_pk_mul_f32 v[170:171], v[170:171], v[120:121] op_sel_hi:[1,0]
    v_pk_mul_f32 v[172:173], v[172:173], v[120:121] op_sel_hi:[1,0]
    s_add_u32 s62, s62, s5
    v_pk_mul_f32 v[174:175], v[174:175], v[120:121] op_sel_hi:[1,0]
    v_cvt_pk_bf16_f32 v168, v168, v169
    v_cvt_pk_bf16_f32 v169, v170, v171
    v_cvt_pk_bf16_f32 v170, v172, v173
    s_lshl_b32 s62, s62, 2
    v_cvt_pk_bf16_f32 v171, v174, v175
    v_pk_mul_f32 v[232:233], v[232:233], v[120:121] op_sel:[0,1] op_sel_hi:[1,1]
    v_pk_mul_f32 v[234:235], v[234:235], v[120:121] op_sel:[0,1] op_sel_hi:[1,1]
    v_pk_mul_f32 v[236:237], v[236:237], v[120:121] op_sel:[0,1] op_sel_hi:[1,1]
    s_add_u32 s62, s62, s20
    v_pk_mul_f32 v[238:239], v[238:239], v[120:121] op_sel:[0,1] op_sel_hi:[1,1]
    v_cvt_pk_bf16_f32 v232, v232, v233
    v_cvt_pk_bf16_f32 v233, v234, v235
    v_cvt_pk_bf16_f32 v234, v236, v237
    s_lshl_b32 s62, s62, 6
    v_cvt_pk_bf16_f32 v235, v238, v239
    s_add_u32 s50, s45, 131072
    buffer_store_dwordx4 v[136:139], v8, s[24:27], s50 offen sc1
    s_add_u32 s62, s62, 70483968
    v_pk_mul_f32 v[176:177], v[176:177], v[120:121] op_sel_hi:[1,0]
    v_pk_mul_f32 v[178:179], v[178:179], v[120:121] op_sel_hi:[1,0]
    v_pk_mul_f32 v[180:181], v[180:181], v[120:121] op_sel_hi:[1,0]
    v_pk_mul_f32 v[182:183], v[182:183], v[120:121] op_sel_hi:[1,0]
    s_lshl_b32 s9, s6, 1
    v_cvt_pk_bf16_f32 v176, v176, v177
    v_cvt_pk_bf16_f32 v177, v178, v179
    v_cvt_pk_bf16_f32 v178, v180, v181
    v_cvt_pk_bf16_f32 v179, v182, v183
    s_add_u32 s9, s9, s7
    v_pk_mul_f32 v[240:241], v[240:241], v[120:121] op_sel:[0,1] op_sel_hi:[1,1]
    v_pk_mul_f32 v[242:243], v[242:243], v[120:121] op_sel:[0,1] op_sel_hi:[1,1]
    v_pk_mul_f32 v[244:245], v[244:245], v[120:121] op_sel:[0,1] op_sel_hi:[1,1]
    v_pk_mul_f32 v[246:247], v[246:247], v[120:121] op_sel:[0,1] op_sel_hi:[1,1]
    s_lshl_b32 s9, s9, 19
    v_cvt_pk_bf16_f32 v240, v240, v241
    v_cvt_pk_bf16_f32 v241, v242, v243
    v_cvt_pk_bf16_f32 v242, v244, v245
    v_cvt_pk_bf16_f32 v243, v246, v247
    s_add_u32 s9, s9, 79691776
    v_pk_mul_f32 v[184:185], v[184:185], v[120:121] op_sel_hi:[1,0]
    v_pk_mul_f32 v[186:187], v[186:187], v[120:121] op_sel_hi:[1,0]
    v_pk_mul_f32 v[188:189], v[188:189], v[120:121] op_sel_hi:[1,0]
    s_lshl_b32 s8, s5, 2
    v_pk_mul_f32 v[190:191], v[190:191], v[120:121] op_sel_hi:[1,0]
    v_cvt_pk_bf16_f32 v184, v184, v185
    v_cvt_pk_bf16_f32 v185, v186, v187
    v_cvt_pk_bf16_f32 v186, v188, v189
    s_add_u32 s8, s8, s20
    v_cvt_pk_bf16_f32 v187, v190, v191
    v_pk_mul_f32 v[248:249], v[248:249], v[120:121] op_sel:[0,1] op_sel_hi:[1,1]
    v_pk_mul_f32 v[250:251], v[250:251], v[120:121] op_sel:[0,1] op_sel_hi:[1,1]
    v_pk_mul_f32 v[252:253], v[252:253], v[120:121] op_sel:[0,1] op_sel_hi:[1,1]
    s_lshl_b32 s8, s8, 14
    v_pk_mul_f32 v[254:255], v[254:255], v[120:121] op_sel:[0,1] op_sel_hi:[1,1]
    v_cvt_pk_bf16_f32 v248, v248, v249
    v_cvt_pk_bf16_f32 v249, v250, v251
    v_cvt_pk_bf16_f32 v250, v252, v253
    s_add_u32 s8, s8, s9
    v_cvt_pk_bf16_f32 v251, v254, v255
    s_add_u32 s50, s45, 132096
    buffer_store_dwordx4 v[200:203], v8, s[24:27], s50 offen sc1
    s_nop 4
    s_branch K2_TAIL
K2_CSLOW:
    s_sleep 1
    buffer_load_dword v120, v11, s[24:27], s62 offen sc1
    s_waitcnt vmcnt(0)
    v_cmp_eq_u32 vcc, 0, v120
    s_nop 0
    s_cbranch_vccnz K2_CSLOW
    s_branch K2_CSLOWR
K2P_MASK:
    s_nop 7
    s_add_u32 s50, s38, s47
    s_add_u32 s50, s50, 1
    s_lshl_b32 s50, s50, 6
    v_subrev_u32 v120, s50, v11
    v_mov_b32 v121, 0xff800000
    v_cmp_gt_i32 s[52:53], -16, v120
    s_nop 1
    v_cndmask_b32 v76, v76, v121, s[52:53]
    v_cmp_gt_i32 s[54:55], -15, v120
    s_nop 1
    v_cndmask_b32 v77, v77, v121, s[54:55]
    v_cmp_gt_i32 s[56:57], -14, v120
    s_nop 1
    v_cndmask_b32 v78, v78, v121, s[56:57]
    v_cmp_gt_i32 s[58:59], -13, v120
    s_nop 1
    v_cndmask_b32 v79, v79, v121, s[58:59]
    v_cmp_gt_i32 s[52:53], 0, v120
    s_nop 1
    v_cndmask_b32 v72, v72, v121, s[52:53]
    v_cndmask_b32 v84, v84, v121, s[52:53]
    v_cmp_gt_i32 s[54:55], 1, v120
    s_nop 1
    v_cndmask_b32 v73, v73, v121, s[54:55]
    v_cndmask_b32 v85, v85, v121, s[54:55]
    v_cmp_gt_i32 s[56:57], 2, v120
    s_nop 1
    v_cndmask_b32 v74, v74, v121, s[56:57]
    v_cndmask_b32 v86, v86, v121, s[56:57]
    v_cmp_gt_i32 s[58:59], 3, v120
    s_nop 1
    v_cndmask_b32 v75, v75, v121, s[58:59]
    v_cndmask_b32 v87, v87, v121, s[58:59]
    v_cmp_gt_i32 s[52:53], 16, v120
    s_nop 1
    v_cndmask_b32 v80, v80, v121, s[52:53]
    v_cndmask_b32 v92, v92, v121, s[52:53]
    v_cmp_gt_i32 s[54:55], 17, v120
    s_nop 1
    v_cndmask_b32 v81, v81, v121, s[54:55]
    v_cndmask_b32 v93, v93, v121, s[54:55]
    v_cmp_gt_i32 s[56:57], 18, v120
    s_nop 1
    v_cndmask_b32 v82, v82, v121, s[56:57]
    v_cndmask_b32 v94, v94, v121, s[56:57]
    v_cmp_gt_i32 s[58:59], 19, v120
    s_nop 1
    v_cndmask_b32 v83, v83, v121, s[58:59]
    v_cndmask_b32 v95, v95, v121, s[58:59]
    v_cmp_gt_i32 s[52:53], 32, v120
    s_nop 1
    v_cndmask_b32 v88, v88, v121, s[52:53]
    v_cndmask_b32 v100, v100, v121, s[52:53]
    v_cmp_gt_i32 s[54:55], 33, v120
    s_nop 1
    v_cndmask_b32 v89, v89, v121, s[54:55]
    v_cndmask_b32 v101, v101, v121, s[54:55]
    v_cmp_gt_i32 s[56:57], 34, v120
    s_nop 1
    v_cndmask_b32 v90, v90, v121, s[56:57]
    v_cndmask_b32 v102, v102, v121, s[56:57]
    v_cmp_gt_i32 s[58:59], 35, v120
    s_nop 1
    v_cndmask_b32 v91, v91, v121, s[58:59]
    v_cndmask_b32 v103, v103, v121, s[58:59]
    v_cmp_gt_i32 s[52:53], 48, v120
    s_nop 1
    v_cndmask_b32 v96, v96, v121, s[52:53]
    v_cmp_gt_i32 s[54:55], 49, v120
    s_nop 1
    v_cndmask_b32 v97, v97, v121, s[54:55]
    v_cmp_gt_i32 s[56:57], 50, v120
    s_nop 1
    v_cndmask_b32 v98, v98, v121, s[56:57]
    v_cmp_gt_i32 s[58:59], 51, v120
    s_nop 1
    v_cndmask_b32 v99, v99, v121, s[58:59]
    s_nop 4
    s_cmp_lg_u32 s36, 1
    s_cbranch_scc1 K2P_MASKR
    s_add_u32 s50, s42, 0
    s_add_u32 s51, s42, 8192
    buffer_load_dwordx4 a[0:3], v8, s[24:27], s50 offen offset:0
    buffer_load_dwordx4 a[32:35], v8, s[24:27], s51 offen offset:0
    buffer_load_dwordx4 a[4:7], v8, s[24:27], s50 offen offset:1024
    buffer_load_dwordx4 a[36:39], v8, s[24:27], s51 offen offset:1024
    buffer_load_dwordx4 a[8:11], v8, s[24:27], s50 offen offset:2048
    buffer_load_dwordx4 a[40:43], v8, s[24:27], s51 offen offset:2048
    buffer_load_dwordx4 a[12:15], v8, s[24:27], s50 offen offset:3072
    buffer_load_dwordx4 a[44:47], v8, s[24:27], s51 offen offset:3072
    s_add_u32 s50, s42, 4096
    s_add_u32 s51, s42, 12288
    buffer_load_dwordx4 a[16:19], v8, s[24:27], s50 offen offset:0
    buffer_load_dwordx4 a[48:51], v8, s[24:27], s51 offen offset:0
    buffer_load_dwordx4 a[20:23], v8, s[24:27], s50 offen offset:1024
    buffer_load_dwordx4 a[52:55], v8, s[24:27], s51 offen offset:1024
    buffer_load_dwordx4 a[24:27], v8, s[24:27], s50 offen offset:2048
    buffer_load_dwordx4 a[56:59], v8, s[24:27], s51 offen offset:2048
    buffer_load_dwordx4 a[28:31], v8, s[24:27], s50 offen offset:3072
    buffer_load_dwordx4 a[60:63], v8, s[24:27], s51 offen offset:3072
    s_branch K2P_MASKR
K2P_SEG2:
    s_nop 7
    s_waitcnt vmcnt(0)
    v_mov_b32 v36, v16
    v_mov_b32 v16, 0
    v_mov_b32 v17, 0
    v_mov_b32 v18, 0
    v_mov_b32 v19, 0
    v_mov_b32 v37, v20
    v_mov_b32 v20, 0
    v_mov_b32 v21, 0
    v_mov_b32 v22, 0
    v_mov_b32 v23, 0
    s_sub_u32 s47, 0, s36
    s_mov_b32 s41, s49
    v_lshrrev_b32 v120, 4, v2
    v_lshlrev_b32 v120, 2, v120
    v_and_b32 v11, 15, v2
    v_sub_u32 v11, v11, v120
    v_add_u32 v11, s48, v11
    s_nop 4
    s_branch K2_NEXT
K2_FINAL_L:
    s_waitcnt lgkmcnt(6)
    v_mfma_f32_16x16x32_bf16 v[128:131], a[64:67], v[104:107], v[128:131]
    ds_read_b128 a[100:103], v10 offset:20480
    v_mfma_f32_16x16x32_bf16 v[128:131], a[68:71], v[112:115], v[128:131]
    buffer_load_dword v14, v3, s[24:27], s61 offen offset:0
    v_mfma_f32_16x16x32_bf16 v[192:195], a[68:71], v[116:119], v[192:195]
    s_waitcnt lgkmcnt(5)
    ds_read_b128 a[96:99], v10 offset:4096
    v_mfma_f32_16x16x32_bf16 v[192:195], a[64:67], v[108:111], v[192:195]
    buffer_load_dword v15, v3, s[24:27], s61 offen offset:64
    v_mfma_f32_16x16x32_bf16 v[196:199], a[72:75], v[108:111], v[196:199]
    s_add_u32 s56, s65, 65536
    s_add_u32 m0, s30, s44
    ds_read_b128 a[108:111], v10 offset:21504
    v_mfma_f32_16x16x32_bf16 v[196:199], a[76:79], v[116:119], v[196:199]
    buffer_load_dwordx4 v6, s[24:27], s56 offen offset:0 lds
    v_mfma_f32_16x16x32_bf16 v[132:135], a[76:79], v[112:115], v[132:135]
    ds_read_b128 a[104:107], v10 offset:5120
    v_mfma_f32_16x16x32_bf16 v[132:135], a[72:75], v[104:107], v[132:135]
    buffer_load_dwordx4 v6, s[24:27], s56 offen offset:1024 lds
    v_mfma_f32_16x16x32_bf16 v[24:27], v[32:35], v[104:107], v[24:27]
    buffer_load_dwordx4 v6, s[24:27], s56 offen offset:2048 lds
    v_mfma_f32_16x16x32_bf16 v[24:27], v[32:35], v[112:115], v[24:27]
    buffer_load_dwordx4 v6, s[24:27], s56 offen offset:3072 lds
    v_mfma_f32_16x16x32_bf16 v[28:31], v[32:35], v[108:111], v[28:31]
    s_waitcnt lgkmcnt(6)
    s_add_u32 m0, m0, 4096
    v_mfma_f32_16x16x32_bf16 v[28:31], v[32:35], v[116:119], v[28:31]
    buffer_load_dwordx4 v7, s[24:27], s56 offen offset:0 lds
    v_mfma_f32_16x16x32_bf16 v[136:139], a[80:83], v[104:107], v[136:139]
    ds_read_b128 a[116:119], v10 offset:22528
    v_mfma_f32_16x16x32_bf16 v[136:139], a[84:87], v[112:115], v[136:139]
    buffer_load_dwordx4 v7, s[24:27], s56 offen offset:1024 lds
    v_mfma_f32_16x16x32_bf16 v[200:203], a[84:87], v[116:119], v[200:203]
    s_waitcnt lgkmcnt(5)
    ds_read_b128 a[112:115], v10 offset:6144
    v_mfma_f32_16x16x32_bf16 v[200:203], a[80:83], v[108:111], v[200:203]
    buffer_load_dwordx4 v7, s[24:27], s56 offen offset:2048 lds
    v_mfma_f32_16x16x32_bf16 v[204:207], a[88:91], v[108:111], v[204:207]
    ds_read_b128 a[124:127], v10 offset:23552
    v_mfma_f32_16x16x32_bf16 v[204:207], a[92:95], v[116:119], v[204:207]
    buffer_load_dwordx4 v7, s[24:27], s56 offen offset:3072 lds
    v_mfma_f32_16x16x32_bf16 v[140:143], a[92:95], v[112:115], v[140:143]
    s_waitcnt lgkmcnt(5)
    ds_read_b128 a[120:123], v10 offset:7168
    v_mfma_f32_16x16x32_bf16 v[140:143], a[88:91], v[104:107], v[140:143]
    v_mfma_f32_16x16x32_bf16 v[144:147], a[96:99], v[104:107], v[144:147]
    ds_read_b128 a[68:71], v10 offset:24576
    v_mfma_f32_16x16x32_bf16 v[144:147], a[100:103], v[112:115], v[144:147]
    v_mfma_f32_16x16x32_bf16 v[208:211], a[100:103], v[116:119], v[208:211]
    s_waitcnt lgkmcnt(5)
    s_waitcnt vmcnt(10)
    ds_read_b128 a[64:67], v10 offset:8192
    v_mfma_f32_16x16x32_bf16 v[208:211], a[96:99], v[108:111], v[208:211]
    v_readfirstlane_b32 s18, v4
    v_mfma_f32_16x16x32_bf16 v[212:215], a[104:107], v[108:111], v[212:215]
    s_nop 0
    s_and_b32 s18, s18, s19
    ds_read_b128 a[76:79], v10 offset:25600
    v_mfma_f32_16x16x32_bf16 v[212:215], a[108:111], v[116:119], v[212:215]
    s_cselect_b32 s51, s51, 0x7f000000
    s_cselect_b32 s52, s52, 0x7f000000
    v_mfma_f32_16x16x32_bf16 v[148:151], a[108:111], v[112:115], v[148:151]
    s_waitcnt lgkmcnt(5)
    ds_read_b128 a[72:75], v10 offset:9216
    v_mfma_f32_16x16x32_bf16 v[148:151], a[104:107], v[104:107], v[148:151]
    buffer_load_dword v36, v3, s[24:27], s52 offen offset:0 sc1
    v_mfma_f32_16x16x32_bf16 v[152:155], a[112:115], v[104:107], v[152:155]
    ds_read_b128 a[84:87], v10 offset:26624
    v_mfma_f32_16x16x32_bf16 v[152:155], a[116:119], v[112:115], v[152:155]
    buffer_load_dword v37, v3, s[24:27], s52 offen offset:64 sc1
    v_mfma_f32_16x16x32_bf16 v[216:219], a[116:119], v[116:119], v[216:219]
    s_waitcnt lgkmcnt(5)
    s_add_u32 s53, s51, 0
    ds_read_b128 a[80:83], v10 offset:10240
    v_mfma_f32_16x16x32_bf16 v[216:219], a[112:115], v[108:111], v[216:219]
    s_add_u32 s55, s51, 8192
    v_mfma_f32_16x16x32_bf16 v[220:223], a[120:123], v[108:111], v[220:223]
    ds_read_b128 a[92:95], v10 offset:27648
    v_mfma_f32_16x16x32_bf16 v[220:223], a[124:127], v[116:119], v[220:223]
    buffer_load_dwordx4 v[40:43], v8, s[24:27], s53 offen offset:0 sc1
    v_mfma_f32_16x16x32_bf16 v[156:159], a[124:127], v[112:115], v[156:159]
    s_waitcnt lgkmcnt(5)
    ds_read_b128 a[88:91], v10 offset:11264
    v_mfma_f32_16x16x32_bf16 v[156:159], a[120:123], v[104:107], v[156:159]
    buffer_load_dwordx4 v[72:75], v8, s[24:27], s55 offen offset:0 sc1
    v_mfma_f32_16x16x32_bf16 v[160:163], a[64:67], v[104:107], v[160:163]
    ds_read_b128 a[100:103], v10 offset:28672
    v_mfma_f32_16x16x32_bf16 v[160:163], a[68:71], v[112:115], v[160:163]
    buffer_load_dwordx4 v[44:47], v8, s[24:27], s53 offen offset:1024 sc1
    v_mfma_f32_16x16x32_bf16 v[224:227], a[68:71], v[116:119], v[224:227]
    s_waitcnt lgkmcnt(5)
    ds_read_b128 a[96:99], v10 offset:12288
    v_mfma_f32_16x16x32_bf16 v[224:227], a[64:67], v[108:111], v[224:227]
    buffer_load_dwordx4 v[76:79], v8, s[24:27], s55 offen offset:1024 sc1
    v_mfma_f32_16x16x32_bf16 v[228:231], a[72:75], v[108:111], v[228:231]
    ds_read_b128 a[108:111], v10 offset:29696
    v_mfma_f32_16x16x32_bf16 v[228:231], a[76:79], v[116:119], v[228:231]
    buffer_load_dwordx4 v[48:51], v8, s[24:27], s53 offen offset:2048 sc1
    v_mfma_f32_16x16x32_bf16 v[164:167], a[76:79], v[112:115], v[164:167]
    s_waitcnt lgkmcnt(5)
    ds_read_b128 a[104:107], v10 offset:13312
    v_mfma_f32_16x16x32_bf16 v[164:167], a[72:75], v[104:107], v[164:167]
    buffer_load_dwordx4 v[80:83], v8, s[24:27], s55 offen offset:2048 sc1
    v_mfma_f32_16x16x32_bf16 v[168:171], a[80:83], v[104:107], v[168:171]
    ds_read_b128 a[116:119], v10 offset:30720
    v_mfma_f32_16x16x32_bf16 v[168:171], a[84:87], v[112:115], v[168:171]
    buffer_load_dwordx4 v[52:55], v8, s[24:27], s53 offen offset:3072 sc1
    v_mfma_f32_16x16x32_bf16 v[232:235], a[84:87], v[116:119], v[232:235]
    s_waitcnt lgkmcnt(5)
    ds_read_b128 a[112:115], v10 offset:14336
    v_mfma_f32_16x16x32_bf16 v[232:235], a[80:83], v[108:111], v[232:235]
    buffer_load_dwordx4 v[84:87], v8, s[24:27], s55 offen offset:3072 sc1
    v_mfma_f32_16x16x32_bf16 v[236:239], a[88:91], v[108:111], v[236:239]
    s_add_u32 s53, s51, 4096
    ds_read_b128 a[124:127], v10 offset:31744
    v_mfma_f32_16x16x32_bf16 v[236:239], a[92:95], v[116:119], v[236:239]
    s_add_u32 s55, s51, 12288
    v_mfma_f32_16x16x32_bf16 v[172:175], a[92:95], v[112:115], v[172:175]
    s_waitcnt lgkmcnt(5)
    ds_read_b128 a[120:123], v10 offset:15360
    v_mfma_f32_16x16x32_bf16 v[172:175], a[88:91], v[104:107], v[172:175]
    buffer_load_dwordx4 v[56:59], v8, s[24:27], s53 offen offset:0 sc1
    v_mfma_f32_16x16x32_bf16 v[176:179], a[96:99], v[104:107], v[176:179]
    buffer_load_dwordx4 v[88:91], v8, s[24:27], s55 offen offset:0 sc1
    v_mfma_f32_16x16x32_bf16 v[176:179], a[100:103], v[112:115], v[176:179]
    buffer_load_dwordx4 v[60:63], v8, s[24:27], s53 offen offset:1024 sc1
    v_mfma_f32_16x16x32_bf16 v[240:243], a[100:103], v[116:119], v[240:243]
    s_waitcnt lgkmcnt(4)
    v_mfma_f32_16x16x32_bf16 v[240:243], a[96:99], v[108:111], v[240:243]
    buffer_load_dwordx4 v[92:95], v8, s[24:27], s55 offen offset:1024 sc1
    v_mfma_f32_16x16x32_bf16 v[244:247], a[104:107], v[108:111], v[244:247]
    buffer_load_dwordx4 v[64:67], v8, s[24:27], s53 offen offset:2048 sc1
    v_mfma_f32_16x16x32_bf16 v[244:247], a[108:111], v[116:119], v[244:247]
    buffer_load_dwordx4 v[96:99], v8, s[24:27], s55 offen offset:2048 sc1
    v_mfma_f32_16x16x32_bf16 v[180:183], a[108:111], v[112:115], v[180:183]
    s_waitcnt lgkmcnt(2)
    v_mfma_f32_16x16x32_bf16 v[180:183], a[104:107], v[104:107], v[180:183]
    buffer_load_dwordx4 v[68:71], v8, s[24:27], s53 offen offset:3072 sc1
    v_mfma_f32_16x16x32_bf16 v[184:187], a[112:115], v[104:107], v[184:187]
    buffer_load_dwordx4 v[100:103], v8, s[24:27], s55 offen offset:3072 sc1
    v_mfma_f32_16x16x32_bf16 v[184:187], a[116:119], v[112:115], v[184:187]
    v_mfma_f32_16x16x32_bf16 v[248:251], a[116:119], v[116:119], v[248:251]
    s_waitcnt lgkmcnt(0)
    v_mfma_f32_16x16x32_bf16 v[248:251], a[112:115], v[108:111], v[248:251]
    v_mfma_f32_16x16x32_bf16 v[252:255], a[120:123], v[108:111], v[252:255]
    v_mfma_f32_16x16x32_bf16 v[252:255], a[124:127], v[116:119], v[252:255]
    v_mfma_f32_16x16x32_bf16 v[188:191], a[124:127], v[112:115], v[188:191]
    v_mfma_f32_16x16x32_bf16 v[188:191], a[120:123], v[104:107], v[188:191]
    s_branch K2_FINAL_J
K2_END:
    s_endpgm
CODE_END:
    s_endpgm
.section .rodata,"a"
.p2align 6
.amdhsa_kernel proj_kernel
  .amdhsa_next_free_vgpr 512
  .amdhsa_next_free_sgpr 102
  .amdhsa_accum_offset 256
  .amdhsa_group_segment_fixed_size 0
  .amdhsa_kernarg_size 104
  .amdhsa_user_sgpr_count 2
  .amdhsa_user_sgpr_kernarg_segment_ptr 1
  .amdhsa_system_sgpr_workgroup_id_x 1
.end_amdhsa_kernel
.p2align 6
.amdhsa_kernel attn_kernel
  .amdhsa_next_free_vgpr 512
  .amdhsa_next_free_sgpr 102
  .amdhsa_accum_offset 256
  .amdhsa_group_segment_fixed_size 0
  .amdhsa_kernarg_size 104
  .amdhsa_user_sgpr_count 2
  .amdhsa_user_sgpr_kernarg_segment_ptr 1
  .amdhsa_system_sgpr_workgroup_id_x 1
.end_amdhsa_kernel
```
